```python
import torch

def _softmax(x, axis=-1):
    return torch.softmax(x, dim=axis)

def _gelu(x):
    return torch.nn.functional.gelu(x, approximate='tanh')

def _silu(x):
    return torch.nn.functional.silu(x)

def _sigmoid(x):
    return torch.sigmoid(x)

def _layernorm(x, axis=-1, eps=1e-05):
    m = x.mean(dim=axis, keepdim=True)
    v = x.var(dim=axis, keepdim=True, unbiased=False)
    return (x - m) / torch.sqrt(v + eps)

def _scatter_add(tgt, idx, src, axis=0):
    return tgt.clone().index_add_(axis, idx, src)

def _segment_sum(src, seg, n):
    out = torch.zeros((n,) + src.shape[1:], dtype=src.dtype)
    return out.index_add_(0, seg, src)

def _pad(x, pw):
    flat = tuple((v for pair in reversed(pw) for v in pair))
    return torch.nn.functional.pad(x, flat)
kernel_name = 'sequential_preLN__memory_aug_recurrent_mem_tr__glu_gated_reglu__prompt'

def setup_inputs():

    _w = lambda a: (lambda t: t.to(torch.bfloat16) if t.is_floating_point() else t)(torch.as_tensor(a))

    def _A_setup():
        B, S, Dm = (1, 2048, 640)
        H, Dh = (32, 128)
        M, seg = (8, 32)
        seg = min(seg, S)
        S = S // seg * seg
        return {'x': _w((lambda *s: torch.randn(*s, dtype=torch.bfloat16) * 0.05)(B, S, Dm)), 'mem0': _w((lambda *s: torch.randn(*s, dtype=torch.bfloat16) * 0.2)(B, M, Dm)), 'Wq': _w((lambda *s: torch.randn(*s, dtype=torch.bfloat16) * 1.6)(Dm, H, Dh) * Dm ** (-0.5)), 'Wk': _w((lambda *s: torch.randn(*s, dtype=torch.bfloat16) * 1.6)(Dm, H, Dh) * Dm ** (-0.5)), 'Wv': _w((lambda *s: torch.randn(*s, dtype=torch.bfloat16) * 0.2)(Dm, H, Dh) * Dm ** (-0.5)), 'Wo': _w((lambda *s: torch.randn(*s, dtype=torch.bfloat16) * 0.2)(H, Dh, Dm) * (H * Dh) ** (-0.5)), 'seg_len': seg}
    _A_in = _A_setup()

    def _B_setup():
        B, S, D, F = (1, 2048, 640, 1728)
        return {'x': _w((lambda *s: torch.randn(*s, dtype=torch.bfloat16) * 0.05)(B, S, D)), 'W_gate': _w((lambda *s: torch.randn(*s, dtype=torch.bfloat16) * 0.2)(D, F) * (2.0 / D) ** 0.5), 'W_up': _w((lambda *s: torch.randn(*s, dtype=torch.bfloat16) * 0.2)(D, F) * (2.0 / D) ** 0.5), 'W_down': _w((lambda *s: torch.randn(*s, dtype=torch.bfloat16) * 0.2)(F, D) * (1.0 / F) ** 0.5)}
    _B_in = _B_setup()
    return {'A_x': _A_in['x'], 'A_mem0': _A_in['mem0'], 'A_Wq': _A_in['Wq'], 'A_Wk': _A_in['Wk'], 'A_Wv': _A_in['Wv'], 'A_Wo': _A_in['Wo'], 'A_seg_len': _A_in['seg_len'], 'B_x': _B_in['x'], 'B_W_gate': _B_in['W_gate'], 'B_W_up': _B_in['W_up'], 'B_W_down': _B_in['W_down']}

def reference(A_x, A_mem0, A_Wq, A_Wk, A_Wv, A_Wo, A_seg_len, B_x, B_W_gate, B_W_up, B_W_down):

    def _A_ref(x, mem0, Wq, Wk, Wv, Wo, seg_len):
        B, S, Dm = x.shape
        H, Dh = (Wq.shape[1], Wq.shape[2])
        M = mem0.shape[1]
        scale = Dh ** (-0.5)
        n_seg = S // seg_len
        L = M + seg_len
        idx = torch.arange(L)
        mask = (idx[:, None] < M) | (idx[:, None] >= idx[None, :])
        mem = mem0
        outs = []
        for s in range(n_seg):
            xs = x[:, s * seg_len:(s + 1) * seg_len, :].clone()
            h = torch.concatenate([mem, xs], axis=1)
            q = torch.einsum('btd,dhe->bhte', h, Wq)
            k = torch.einsum('btd,dhe->bhte', h, Wk)
            v = torch.einsum('btd,dhe->bhte', h, Wv)
            scores = torch.einsum('bhqe,bhke->bhqk', q, k) * scale
            scores = torch.where(mask[None, None], scores, -1000000000.0)
            p = _softmax(scores, axis=-1)
            o = torch.einsum('bhqk,bhke->bhqe', p, v)
            o = torch.einsum('bhte,hed->btd', o, Wo)
            mem = o[:, :M, :].clone()
            outs.append(o[:, M:, :])
        return torch.concatenate(outs, axis=1)

    def _B_ref(x, W_gate, W_up, W_down):
        gate = torch.einsum('bsd,df->bsf', x, W_gate)
        up = torch.einsum('bsd,df->bsf', x, W_up)
        gate = gate * (lambda x, dt: x.to(dt))(gate > 0, gate.dtype)
        h = gate * up
        return torch.einsum('bsf,fd->bsd', h, W_down)
    x = A_x
    h = x + _A_ref(_layernorm(x, axis=-1), A_mem0, A_Wq, A_Wk, A_Wv, A_Wo, A_seg_len)
    h2 = h + _B_ref(_layernorm(h, axis=-1), B_W_gate, B_W_up, B_W_down)
    return h2
```

```asm
; @launch kernel=prep_kernel grid=(203,1,1) block=(256,1,1) lds=18432
; @launch kernel=chain_kernel grid=(256,1,1) block=(256,1,1) lds=163840
; @launch kernel=osmall_kernel grid=(640,1,1) block=(512,1,1) lds=8192
; @launch kernel=ln2_kernel grid=(16,1,1) block=(256,1,1) lds=0
; @launch kernel=gusmall_kernel grid=(432,1,1) block=(256,1,1) lds=32768
; @launch kernel=dsmall_kernel grid=(960,1,1) block=(384,1,1) lds=6144
.amdgcn_target "amdgcn-amd-amdhsa--gfx950"
.text
.globl prep_kernel
.p2align 8
.type prep_kernel,@function
prep_kernel:
    s_load_dwordx16 s[16:31], s[0:1], 0
    s_load_dwordx8 s[32:39], s[0:1], 64
    s_load_dwordx4 s[40:43], s[0:1], 96
    v_lshrrev_b32 v1, 6, v0
    s_nop 0
    v_readfirstlane_b32 s3, v1
    v_and_b32 v0, 63, v0
    s_lshl_b32 s14, s2, 2
    s_add_u32 s14, s14, s3
    s_waitcnt lgkmcnt(0)
    s_mov_b32 s4, s42
    s_and_b32 s5, s43, 0xffff
    s_mov_b32 s6, 0x10000000
    s_mov_b32 s7, 0x00020000
    s_cmp_ge_u32 s14, 809
    s_cbranch_scc1 prep_end
    s_cmp_ge_u32 s14, 513
    s_cbranch_scc1 prep_fill
    s_cmp_ge_u32 s14, 512
    s_cbranch_scc1 prep_m0
prep_ln:
    s_sub_u32 s44, s14, 0
    s_mov_b32 s8, s16
    s_and_b32 s9, s17, 0xffff
    s_mov_b32 s10, 0x280000
    s_mov_b32 s11, 0x00020000
    s_mul_i32 s12, s44, 5120
    s_lshr_b32 s45, s44, 4
    s_mul_i32 s13, s45, 81920
    s_bfe_u32 s46, s44, 0x20002
    s_lshl_b32 s46, s46, 10
    s_add_u32 s13, s13, s46
    s_and_b32 s46, s44, 3
    s_lshl_b32 s46, s46, 6
    s_add_u32 s13, s13, s46
    s_add_u32 s13, s13, 0
    v_lshrrev_b32 v1, 4, v0
    v_and_b32 v2, 3, v0
    v_bfe_u32 v3, v0, 2, 2
    v_mul_u32_u24 v4, 1280, v1
    v_lshl_add_u32 v4, v2, 3, v4
    v_mul_u32_u24 v5, 320, v3
    v_add_u32 v4, v4, v5
    buffer_load_dwordx2 v[16:17], v4, s[8:11], s12 offen offset:0
    buffer_load_dwordx2 v[18:19], v4, s[8:11], s12 offen offset:32
    buffer_load_dwordx2 v[20:21], v4, s[8:11], s12 offen offset:64
    buffer_load_dwordx2 v[22:23], v4, s[8:11], s12 offen offset:96
    buffer_load_dwordx2 v[24:25], v4, s[8:11], s12 offen offset:128
    buffer_load_dwordx2 v[26:27], v4, s[8:11], s12 offen offset:160
    buffer_load_dwordx2 v[28:29], v4, s[8:11], s12 offen offset:192
    buffer_load_dwordx2 v[30:31], v4, s[8:11], s12 offen offset:224
    buffer_load_dwordx2 v[32:33], v4, s[8:11], s12 offen offset:256
    buffer_load_dwordx2 v[34:35], v4, s[8:11], s12 offen offset:288
    v_mul_u32_u24 v10, 20480, v3
    v_lshl_add_u32 v10, v2, 8, v10
    v_lshl_add_u32 v10, v1, 4, v10
    v_mov_b32 v4, 0
    v_mov_b32 v5, 0
    s_waitcnt vmcnt(0)
    v_lshlrev_b32 v40, 16, v16
    v_and_b32 v41, 0xffff0000, v16
    v_add_f32 v4, v4, v40
    v_add_f32 v5, v5, v41
    v_lshlrev_b32 v42, 16, v17
    v_and_b32 v43, 0xffff0000, v17
    v_add_f32 v4, v4, v42
    v_add_f32 v5, v5, v43
    v_lshlrev_b32 v44, 16, v18
    v_and_b32 v45, 0xffff0000, v18
    v_add_f32 v4, v4, v44
    v_add_f32 v5, v5, v45
    v_lshlrev_b32 v46, 16, v19
    v_and_b32 v47, 0xffff0000, v19
    v_add_f32 v4, v4, v46
    v_add_f32 v5, v5, v47
    v_lshlrev_b32 v48, 16, v20
    v_and_b32 v49, 0xffff0000, v20
    v_add_f32 v4, v4, v48
    v_add_f32 v5, v5, v49
    v_lshlrev_b32 v50, 16, v21
    v_and_b32 v51, 0xffff0000, v21
    v_add_f32 v4, v4, v50
    v_add_f32 v5, v5, v51
    v_lshlrev_b32 v52, 16, v22
    v_and_b32 v53, 0xffff0000, v22
    v_add_f32 v4, v4, v52
    v_add_f32 v5, v5, v53
    v_lshlrev_b32 v54, 16, v23
    v_and_b32 v55, 0xffff0000, v23
    v_add_f32 v4, v4, v54
    v_add_f32 v5, v5, v55
    v_lshlrev_b32 v56, 16, v24
    v_and_b32 v57, 0xffff0000, v24
    v_add_f32 v4, v4, v56
    v_add_f32 v5, v5, v57
    v_lshlrev_b32 v58, 16, v25
    v_and_b32 v59, 0xffff0000, v25
    v_add_f32 v4, v4, v58
    v_add_f32 v5, v5, v59
    v_lshlrev_b32 v60, 16, v26
    v_and_b32 v61, 0xffff0000, v26
    v_add_f32 v4, v4, v60
    v_add_f32 v5, v5, v61
    v_lshlrev_b32 v62, 16, v27
    v_and_b32 v63, 0xffff0000, v27
    v_add_f32 v4, v4, v62
    v_add_f32 v5, v5, v63
    v_lshlrev_b32 v64, 16, v28
    v_and_b32 v65, 0xffff0000, v28
    v_add_f32 v4, v4, v64
    v_add_f32 v5, v5, v65
    v_lshlrev_b32 v66, 16, v29
    v_and_b32 v67, 0xffff0000, v29
    v_add_f32 v4, v4, v66
    v_add_f32 v5, v5, v67
    v_lshlrev_b32 v68, 16, v30
    v_and_b32 v69, 0xffff0000, v30
    v_add_f32 v4, v4, v68
    v_add_f32 v5, v5, v69
    v_lshlrev_b32 v70, 16, v31
    v_and_b32 v71, 0xffff0000, v31
    v_add_f32 v4, v4, v70
    v_add_f32 v5, v5, v71
    v_lshlrev_b32 v72, 16, v32
    v_and_b32 v73, 0xffff0000, v32
    v_add_f32 v4, v4, v72
    v_add_f32 v5, v5, v73
    v_lshlrev_b32 v74, 16, v33
    v_and_b32 v75, 0xffff0000, v33
    v_add_f32 v4, v4, v74
    v_add_f32 v5, v5, v75
    v_lshlrev_b32 v76, 16, v34
    v_and_b32 v77, 0xffff0000, v34
    v_add_f32 v4, v4, v76
    v_add_f32 v5, v5, v77
    v_lshlrev_b32 v78, 16, v35
    v_and_b32 v79, 0xffff0000, v35
    v_add_f32 v4, v4, v78
    v_add_f32 v5, v5, v79
    v_add_f32 v4, v4, v5
    s_nop 1
    v_add_f32_dpp v4, v4, v4 row_ror:8 row_mask:0xf bank_mask:0xf
    s_nop 1
    v_add_f32_dpp v4, v4, v4 row_ror:4 row_mask:0xf bank_mask:0xf
    s_nop 1
    v_add_f32_dpp v4, v4, v4 row_ror:2 row_mask:0xf bank_mask:0xf
    s_nop 1
    v_add_f32_dpp v4, v4, v4 row_ror:1 row_mask:0xf bank_mask:0xf
    v_mul_f32 v4, 0x3acccccd, v4
    v_mov_b32 v8, 0
    v_mov_b32 v9, 0
    v_sub_f32 v6, v40, v4
    v_sub_f32 v7, v41, v4
    v_fmac_f32 v8, v6, v6
    v_fmac_f32 v9, v7, v7
    v_sub_f32 v6, v42, v4
    v_sub_f32 v7, v43, v4
    v_fmac_f32 v8, v6, v6
    v_fmac_f32 v9, v7, v7
    v_sub_f32 v6, v44, v4
    v_sub_f32 v7, v45, v4
    v_fmac_f32 v8, v6, v6
    v_fmac_f32 v9, v7, v7
    v_sub_f32 v6, v46, v4
    v_sub_f32 v7, v47, v4
    v_fmac_f32 v8, v6, v6
    v_fmac_f32 v9, v7, v7
    v_sub_f32 v6, v48, v4
    v_sub_f32 v7, v49, v4
    v_fmac_f32 v8, v6, v6
    v_fmac_f32 v9, v7, v7
    v_sub_f32 v6, v50, v4
    v_sub_f32 v7, v51, v4
    v_fmac_f32 v8, v6, v6
    v_fmac_f32 v9, v7, v7
    v_sub_f32 v6, v52, v4
    v_sub_f32 v7, v53, v4
    v_fmac_f32 v8, v6, v6
    v_fmac_f32 v9, v7, v7
    v_sub_f32 v6, v54, v4
    v_sub_f32 v7, v55, v4
    v_fmac_f32 v8, v6, v6
    v_fmac_f32 v9, v7, v7
    v_sub_f32 v6, v56, v4
    v_sub_f32 v7, v57, v4
    v_fmac_f32 v8, v6, v6
    v_fmac_f32 v9, v7, v7
    v_sub_f32 v6, v58, v4
    v_sub_f32 v7, v59, v4
    v_fmac_f32 v8, v6, v6
    v_fmac_f32 v9, v7, v7
    v_sub_f32 v6, v60, v4
    v_sub_f32 v7, v61, v4
    v_fmac_f32 v8, v6, v6
    v_fmac_f32 v9, v7, v7
    v_sub_f32 v6, v62, v4
    v_sub_f32 v7, v63, v4
    v_fmac_f32 v8, v6, v6
    v_fmac_f32 v9, v7, v7
    v_sub_f32 v6, v64, v4
    v_sub_f32 v7, v65, v4
    v_fmac_f32 v8, v6, v6
    v_fmac_f32 v9, v7, v7
    v_sub_f32 v6, v66, v4
    v_sub_f32 v7, v67, v4
    v_fmac_f32 v8, v6, v6
    v_fmac_f32 v9, v7, v7
    v_sub_f32 v6, v68, v4
    v_sub_f32 v7, v69, v4
    v_fmac_f32 v8, v6, v6
    v_fmac_f32 v9, v7, v7
    v_sub_f32 v6, v70, v4
    v_sub_f32 v7, v71, v4
    v_fmac_f32 v8, v6, v6
    v_fmac_f32 v9, v7, v7
    v_sub_f32 v6, v72, v4
    v_sub_f32 v7, v73, v4
    v_fmac_f32 v8, v6, v6
    v_fmac_f32 v9, v7, v7
    v_sub_f32 v6, v74, v4
    v_sub_f32 v7, v75, v4
    v_fmac_f32 v8, v6, v6
    v_fmac_f32 v9, v7, v7
    v_sub_f32 v6, v76, v4
    v_sub_f32 v7, v77, v4
    v_fmac_f32 v8, v6, v6
    v_fmac_f32 v9, v7, v7
    v_sub_f32 v6, v78, v4
    v_sub_f32 v7, v79, v4
    v_fmac_f32 v8, v6, v6
    v_fmac_f32 v9, v7, v7
    v_add_f32 v8, v8, v9
    s_nop 1
    v_add_f32_dpp v8, v8, v8 row_ror:8 row_mask:0xf bank_mask:0xf
    s_nop 1
    v_add_f32_dpp v8, v8, v8 row_ror:4 row_mask:0xf bank_mask:0xf
    s_nop 1
    v_add_f32_dpp v8, v8, v8 row_ror:2 row_mask:0xf bank_mask:0xf
    s_nop 1
    v_add_f32_dpp v8, v8, v8 row_ror:1 row_mask:0xf bank_mask:0xf
    v_mul_f32 v8, 0x3acccccd, v8
    v_cvt_pk_bf16_f32 v4, v4, v8
    v_and_b32 v8, 0xffff0000, v4
    v_lshlrev_b32 v4, 16, v4
    v_add_f32 v8, 0x3727c5ac, v8
    v_cvt_pk_bf16_f32 v8, v8, v8
    v_lshlrev_b32 v8, 16, v8
    v_sqrt_f32 v8, v8
    s_nop 0
    v_cvt_pk_bf16_f32 v8, v8, v8
    v_lshlrev_b32 v8, 16, v8
    v_rcp_f32 v8, v8
    s_nop 0
    v_sub_f32 v6, v40, v4
    v_sub_f32 v7, v41, v4
    v_cvt_pk_bf16_f32 v6, v6, v7
    v_and_b32 v7, 0xffff0000, v6
    v_lshlrev_b32 v6, 16, v6
    v_mul_f32 v6, v6, v8
    v_mul_f32 v7, v7, v8
    v_cvt_pk_bf16_f32 v16, v6, v7
    v_sub_f32 v6, v42, v4
    v_sub_f32 v7, v43, v4
    v_cvt_pk_bf16_f32 v6, v6, v7
    v_and_b32 v7, 0xffff0000, v6
    v_lshlrev_b32 v6, 16, v6
    v_mul_f32 v6, v6, v8
    v_mul_f32 v7, v7, v8
    v_cvt_pk_bf16_f32 v17, v6, v7
    v_sub_f32 v6, v44, v4
    v_sub_f32 v7, v45, v4
    v_cvt_pk_bf16_f32 v6, v6, v7
    v_and_b32 v7, 0xffff0000, v6
    v_lshlrev_b32 v6, 16, v6
    v_mul_f32 v6, v6, v8
    v_mul_f32 v7, v7, v8
    v_cvt_pk_bf16_f32 v18, v6, v7
    v_sub_f32 v6, v46, v4
    v_sub_f32 v7, v47, v4
    v_cvt_pk_bf16_f32 v6, v6, v7
    v_and_b32 v7, 0xffff0000, v6
    v_lshlrev_b32 v6, 16, v6
    v_mul_f32 v6, v6, v8
    v_mul_f32 v7, v7, v8
    v_cvt_pk_bf16_f32 v19, v6, v7
    v_sub_f32 v6, v48, v4
    v_sub_f32 v7, v49, v4
    v_cvt_pk_bf16_f32 v6, v6, v7
    v_and_b32 v7, 0xffff0000, v6
    v_lshlrev_b32 v6, 16, v6
    v_mul_f32 v6, v6, v8
    v_mul_f32 v7, v7, v8
    v_cvt_pk_bf16_f32 v20, v6, v7
    v_sub_f32 v6, v50, v4
    v_sub_f32 v7, v51, v4
    v_cvt_pk_bf16_f32 v6, v6, v7
    v_and_b32 v7, 0xffff0000, v6
    v_lshlrev_b32 v6, 16, v6
    v_mul_f32 v6, v6, v8
    v_mul_f32 v7, v7, v8
    v_cvt_pk_bf16_f32 v21, v6, v7
    v_sub_f32 v6, v52, v4
    v_sub_f32 v7, v53, v4
    v_cvt_pk_bf16_f32 v6, v6, v7
    v_and_b32 v7, 0xffff0000, v6
    v_lshlrev_b32 v6, 16, v6
    v_mul_f32 v6, v6, v8
    v_mul_f32 v7, v7, v8
    v_cvt_pk_bf16_f32 v22, v6, v7
    v_sub_f32 v6, v54, v4
    v_sub_f32 v7, v55, v4
    v_cvt_pk_bf16_f32 v6, v6, v7
    v_and_b32 v7, 0xffff0000, v6
    v_lshlrev_b32 v6, 16, v6
    v_mul_f32 v6, v6, v8
    v_mul_f32 v7, v7, v8
    v_cvt_pk_bf16_f32 v23, v6, v7
    v_sub_f32 v6, v56, v4
    v_sub_f32 v7, v57, v4
    v_cvt_pk_bf16_f32 v6, v6, v7
    v_and_b32 v7, 0xffff0000, v6
    v_lshlrev_b32 v6, 16, v6
    v_mul_f32 v6, v6, v8
    v_mul_f32 v7, v7, v8
    v_cvt_pk_bf16_f32 v24, v6, v7
    v_sub_f32 v6, v58, v4
    v_sub_f32 v7, v59, v4
    v_cvt_pk_bf16_f32 v6, v6, v7
    v_and_b32 v7, 0xffff0000, v6
    v_lshlrev_b32 v6, 16, v6
    v_mul_f32 v6, v6, v8
    v_mul_f32 v7, v7, v8
    v_cvt_pk_bf16_f32 v25, v6, v7
    v_sub_f32 v6, v60, v4
    v_sub_f32 v7, v61, v4
    v_cvt_pk_bf16_f32 v6, v6, v7
    v_and_b32 v7, 0xffff0000, v6
    v_lshlrev_b32 v6, 16, v6
    v_mul_f32 v6, v6, v8
    v_mul_f32 v7, v7, v8
    v_cvt_pk_bf16_f32 v26, v6, v7
    v_sub_f32 v6, v62, v4
    v_sub_f32 v7, v63, v4
    v_cvt_pk_bf16_f32 v6, v6, v7
    v_and_b32 v7, 0xffff0000, v6
    v_lshlrev_b32 v6, 16, v6
    v_mul_f32 v6, v6, v8
    v_mul_f32 v7, v7, v8
    v_cvt_pk_bf16_f32 v27, v6, v7
    v_sub_f32 v6, v64, v4
    v_sub_f32 v7, v65, v4
    v_cvt_pk_bf16_f32 v6, v6, v7
    v_and_b32 v7, 0xffff0000, v6
    v_lshlrev_b32 v6, 16, v6
    v_mul_f32 v6, v6, v8
    v_mul_f32 v7, v7, v8
    v_cvt_pk_bf16_f32 v28, v6, v7
    v_sub_f32 v6, v66, v4
    v_sub_f32 v7, v67, v4
    v_cvt_pk_bf16_f32 v6, v6, v7
    v_and_b32 v7, 0xffff0000, v6
    v_lshlrev_b32 v6, 16, v6
    v_mul_f32 v6, v6, v8
    v_mul_f32 v7, v7, v8
    v_cvt_pk_bf16_f32 v29, v6, v7
    v_sub_f32 v6, v68, v4
    v_sub_f32 v7, v69, v4
    v_cvt_pk_bf16_f32 v6, v6, v7
    v_and_b32 v7, 0xffff0000, v6
    v_lshlrev_b32 v6, 16, v6
    v_mul_f32 v6, v6, v8
    v_mul_f32 v7, v7, v8
    v_cvt_pk_bf16_f32 v30, v6, v7
    v_sub_f32 v6, v70, v4
    v_sub_f32 v7, v71, v4
    v_cvt_pk_bf16_f32 v6, v6, v7
    v_and_b32 v7, 0xffff0000, v6
    v_lshlrev_b32 v6, 16, v6
    v_mul_f32 v6, v6, v8
    v_mul_f32 v7, v7, v8
    v_cvt_pk_bf16_f32 v31, v6, v7
    v_sub_f32 v6, v72, v4
    v_sub_f32 v7, v73, v4
    v_cvt_pk_bf16_f32 v6, v6, v7
    v_and_b32 v7, 0xffff0000, v6
    v_lshlrev_b32 v6, 16, v6
    v_mul_f32 v6, v6, v8
    v_mul_f32 v7, v7, v8
    v_cvt_pk_bf16_f32 v32, v6, v7
    v_sub_f32 v6, v74, v4
    v_sub_f32 v7, v75, v4
    v_cvt_pk_bf16_f32 v6, v6, v7
    v_and_b32 v7, 0xffff0000, v6
    v_lshlrev_b32 v6, 16, v6
    v_mul_f32 v6, v6, v8
    v_mul_f32 v7, v7, v8
    v_cvt_pk_bf16_f32 v33, v6, v7
    v_sub_f32 v6, v76, v4
    v_sub_f32 v7, v77, v4
    v_cvt_pk_bf16_f32 v6, v6, v7
    v_and_b32 v7, 0xffff0000, v6
    v_lshlrev_b32 v6, 16, v6
    v_mul_f32 v6, v6, v8
    v_mul_f32 v7, v7, v8
    v_cvt_pk_bf16_f32 v34, v6, v7
    v_sub_f32 v6, v78, v4
    v_sub_f32 v7, v79, v4
    v_cvt_pk_bf16_f32 v6, v6, v7
    v_and_b32 v7, 0xffff0000, v6
    v_lshlrev_b32 v6, 16, v6
    v_mul_f32 v6, v6, v8
    v_mul_f32 v7, v7, v8
    v_cvt_pk_bf16_f32 v35, v6, v7
    buffer_store_dwordx4 v[16:19], v10, s[4:7], s13 offen
    s_add_u32 s13, s13, 4096
    buffer_store_dwordx4 v[20:23], v10, s[4:7], s13 offen
    s_add_u32 s13, s13, 4096
    buffer_store_dwordx4 v[24:27], v10, s[4:7], s13 offen
    s_add_u32 s13, s13, 4096
    buffer_store_dwordx4 v[28:31], v10, s[4:7], s13 offen
    s_add_u32 s13, s13, 4096
    buffer_store_dwordx4 v[32:35], v10, s[4:7], s13 offen
    s_branch prep_end
prep_m0:
    v_lshlrev_b32 v4, 4, v0
    v_mov_b32 v16, 0
    v_mov_b32 v17, 0
    v_mov_b32 v18, 0
    v_mov_b32 v19, 0
    s_mov_b32 s13, 122908672
    buffer_store_dwordx4 v[16:19], v4, s[4:7], s13 offen offset:0
    buffer_store_dwordx4 v[16:19], v4, s[4:7], s13 offen offset:1024
    buffer_store_dwordx4 v[16:19], v4, s[4:7], s13 offen offset:2048
    buffer_store_dwordx4 v[16:19], v4, s[4:7], s13 offen offset:3072
    s_add_u32 s13, s13, 4096
    buffer_store_dwordx4 v[16:19], v4, s[4:7], s13 offen offset:0
    buffer_store_dwordx4 v[16:19], v4, s[4:7], s13 offen offset:1024
    buffer_store_dwordx4 v[16:19], v4, s[4:7], s13 offen offset:2048
    buffer_store_dwordx4 v[16:19], v4, s[4:7], s13 offen offset:3072
    s_add_u32 s13, s13, 4096
    buffer_store_dwordx4 v[16:19], v4, s[4:7], s13 offen offset:0
    buffer_store_dwordx4 v[16:19], v4, s[4:7], s13 offen offset:1024
    buffer_store_dwordx4 v[16:19], v4, s[4:7], s13 offen offset:2048
    buffer_store_dwordx4 v[16:19], v4, s[4:7], s13 offen offset:3072
    s_add_u32 s13, s13, 4096
    buffer_store_dwordx4 v[16:19], v4, s[4:7], s13 offen offset:0
    buffer_store_dwordx4 v[16:19], v4, s[4:7], s13 offen offset:1024
    buffer_store_dwordx4 v[16:19], v4, s[4:7], s13 offen offset:2048
    buffer_store_dwordx4 v[16:19], v4, s[4:7], s13 offen offset:3072
    s_add_u32 s13, s13, 4096
    buffer_store_dwordx4 v[16:19], v4, s[4:7], s13 offen offset:0
    buffer_store_dwordx4 v[16:19], v4, s[4:7], s13 offen offset:1024
    buffer_store_dwordx4 v[16:19], v4, s[4:7], s13 offen offset:2048
    buffer_store_dwordx4 v[16:19], v4, s[4:7], s13 offen offset:3072
    s_add_u32 s13, s13, 4096
    buffer_store_dwordx4 v[16:19], v4, s[4:7], s13 offen offset:0
    buffer_store_dwordx4 v[16:19], v4, s[4:7], s13 offen offset:1024
    buffer_store_dwordx4 v[16:19], v4, s[4:7], s13 offen offset:2048
    buffer_store_dwordx4 v[16:19], v4, s[4:7], s13 offen offset:3072
    s_add_u32 s13, s13, 4096
    buffer_store_dwordx4 v[16:19], v4, s[4:7], s13 offen offset:0
    buffer_store_dwordx4 v[16:19], v4, s[4:7], s13 offen offset:1024
    buffer_store_dwordx4 v[16:19], v4, s[4:7], s13 offen offset:2048
    buffer_store_dwordx4 v[16:19], v4, s[4:7], s13 offen offset:3072
    s_add_u32 s13, s13, 4096
    buffer_store_dwordx4 v[16:19], v4, s[4:7], s13 offen offset:0
    buffer_store_dwordx4 v[16:19], v4, s[4:7], s13 offen offset:1024
    buffer_store_dwordx4 v[16:19], v4, s[4:7], s13 offen offset:2048
    buffer_store_dwordx4 v[16:19], v4, s[4:7], s13 offen offset:3072
    s_add_u32 s13, s13, 4096
    s_mov_b32 s8, s18
    s_and_b32 s9, s19, 0xffff
    s_mov_b32 s10, 0x2800
    s_mov_b32 s11, 0x00020000
    v_and_b32 v1, 7, v0
    v_bfe_u32 v2, v0, 3, 2
    v_mul_u32_u24 v3, 1280, v1
    v_lshl_add_u32 v3, v2, 3, v3
    v_lshrrev_b32 v4, 1, v1
    v_lshlrev_b32 v4, 7, v4
    v_lshl_add_u32 v4, v2, 5, v4
    v_and_b32 v5, 1, v0
    v_lshl_add_u32 v4, v5, 4, v4
    v_cmp_gt_u32 vcc, 32, v0
    s_and_saveexec_b64 s[44:45], vcc
    buffer_load_dwordx2 v[16:17], v3, s[8:11], 0 offen offset:0
    buffer_load_dwordx2 v[18:19], v3, s[8:11], 0 offen offset:32
    buffer_load_dwordx2 v[20:21], v3, s[8:11], 0 offen offset:64
    buffer_load_dwordx2 v[22:23], v3, s[8:11], 0 offen offset:96
    buffer_load_dwordx2 v[24:25], v3, s[8:11], 0 offen offset:128
    buffer_load_dwordx2 v[26:27], v3, s[8:11], 0 offen offset:160
    buffer_load_dwordx2 v[28:29], v3, s[8:11], 0 offen offset:192
    buffer_load_dwordx2 v[30:31], v3, s[8:11], 0 offen offset:224
    buffer_load_dwordx2 v[32:33], v3, s[8:11], 0 offen offset:256
    buffer_load_dwordx2 v[34:35], v3, s[8:11], 0 offen offset:288
    buffer_load_dwordx2 v[36:37], v3, s[8:11], 0 offen offset:320
    buffer_load_dwordx2 v[38:39], v3, s[8:11], 0 offen offset:352
    buffer_load_dwordx2 v[40:41], v3, s[8:11], 0 offen offset:384
    buffer_load_dwordx2 v[42:43], v3, s[8:11], 0 offen offset:416
    buffer_load_dwordx2 v[44:45], v3, s[8:11], 0 offen offset:448
    buffer_load_dwordx2 v[46:47], v3, s[8:11], 0 offen offset:480
    buffer_load_dwordx2 v[48:49], v3, s[8:11], 0 offen offset:512
    buffer_load_dwordx2 v[50:51], v3, s[8:11], 0 offen offset:544
    buffer_load_dwordx2 v[52:53], v3, s[8:11], 0 offen offset:576
    buffer_load_dwordx2 v[54:55], v3, s[8:11], 0 offen offset:608
    buffer_load_dwordx2 v[56:57], v3, s[8:11], 0 offen offset:640
    buffer_load_dwordx2 v[58:59], v3, s[8:11], 0 offen offset:672
    buffer_load_dwordx2 v[60:61], v3, s[8:11], 0 offen offset:704
    buffer_load_dwordx2 v[62:63], v3, s[8:11], 0 offen offset:736
    buffer_load_dwordx2 v[64:65], v3, s[8:11], 0 offen offset:768
    buffer_load_dwordx2 v[66:67], v3, s[8:11], 0 offen offset:800
    buffer_load_dwordx2 v[68:69], v3, s[8:11], 0 offen offset:832
    buffer_load_dwordx2 v[70:71], v3, s[8:11], 0 offen offset:864
    buffer_load_dwordx2 v[72:73], v3, s[8:11], 0 offen offset:896
    buffer_load_dwordx2 v[74:75], v3, s[8:11], 0 offen offset:928
    buffer_load_dwordx2 v[76:77], v3, s[8:11], 0 offen offset:960
    buffer_load_dwordx2 v[78:79], v3, s[8:11], 0 offen offset:992
    buffer_load_dwordx2 v[80:81], v3, s[8:11], 0 offen offset:1024
    buffer_load_dwordx2 v[82:83], v3, s[8:11], 0 offen offset:1056
    buffer_load_dwordx2 v[84:85], v3, s[8:11], 0 offen offset:1088
    buffer_load_dwordx2 v[86:87], v3, s[8:11], 0 offen offset:1120
    buffer_load_dwordx2 v[88:89], v3, s[8:11], 0 offen offset:1152
    buffer_load_dwordx2 v[90:91], v3, s[8:11], 0 offen offset:1184
    buffer_load_dwordx2 v[92:93], v3, s[8:11], 0 offen offset:1216
    buffer_load_dwordx2 v[94:95], v3, s[8:11], 0 offen offset:1248
    s_mov_b32 s13, 80560128
    s_waitcnt vmcnt(0)
    buffer_store_dwordx4 v[16:19], v4, s[4:7], s13 offen offset:0
    buffer_store_dwordx4 v[20:23], v4, s[4:7], s13 offen offset:512
    buffer_store_dwordx4 v[24:27], v4, s[4:7], s13 offen offset:1024
    buffer_store_dwordx4 v[28:31], v4, s[4:7], s13 offen offset:1536
    buffer_store_dwordx4 v[32:35], v4, s[4:7], s13 offen offset:2048
    buffer_store_dwordx4 v[36:39], v4, s[4:7], s13 offen offset:2560
    buffer_store_dwordx4 v[40:43], v4, s[4:7], s13 offen offset:3072
    buffer_store_dwordx4 v[44:47], v4, s[4:7], s13 offen offset:3584
    s_add_u32 s13, s13, 4096
    buffer_store_dwordx4 v[48:51], v4, s[4:7], s13 offen offset:0
    buffer_store_dwordx4 v[52:55], v4, s[4:7], s13 offen offset:512
    buffer_store_dwordx4 v[56:59], v4, s[4:7], s13 offen offset:1024
    buffer_store_dwordx4 v[60:63], v4, s[4:7], s13 offen offset:1536
    buffer_store_dwordx4 v[64:67], v4, s[4:7], s13 offen offset:2048
    buffer_store_dwordx4 v[68:71], v4, s[4:7], s13 offen offset:2560
    buffer_store_dwordx4 v[72:75], v4, s[4:7], s13 offen offset:3072
    buffer_store_dwordx4 v[76:79], v4, s[4:7], s13 offen offset:3584
    s_add_u32 s13, s13, 4096
    buffer_store_dwordx4 v[80:83], v4, s[4:7], s13 offen offset:0
    buffer_store_dwordx4 v[84:87], v4, s[4:7], s13 offen offset:512
    buffer_store_dwordx4 v[88:91], v4, s[4:7], s13 offen offset:1024
    buffer_store_dwordx4 v[92:95], v4, s[4:7], s13 offen offset:1536
    s_branch prep_end
prep_fill:
    s_sub_u32 s44, s14, 513
    s_lshl_b32 s13, s44, 14
    s_add_u32 s13, s13, 80570368
    v_lshlrev_b32 v4, 4, v0
    v_mov_b32 v16, -1
    v_mov_b32 v17, -1
    v_mov_b32 v18, -1
    v_mov_b32 v19, -1
    buffer_store_dwordx4 v[16:19], v4, s[4:7], s13 offen offset:0
    buffer_store_dwordx4 v[16:19], v4, s[4:7], s13 offen offset:1024
    buffer_store_dwordx4 v[16:19], v4, s[4:7], s13 offen offset:2048
    buffer_store_dwordx4 v[16:19], v4, s[4:7], s13 offen offset:3072
    s_add_u32 s13, s13, 4096
    buffer_store_dwordx4 v[16:19], v4, s[4:7], s13 offen offset:0
    buffer_store_dwordx4 v[16:19], v4, s[4:7], s13 offen offset:1024
    buffer_store_dwordx4 v[16:19], v4, s[4:7], s13 offen offset:2048
    buffer_store_dwordx4 v[16:19], v4, s[4:7], s13 offen offset:3072
    s_add_u32 s13, s13, 4096
    buffer_store_dwordx4 v[16:19], v4, s[4:7], s13 offen offset:0
    buffer_store_dwordx4 v[16:19], v4, s[4:7], s13 offen offset:1024
    buffer_store_dwordx4 v[16:19], v4, s[4:7], s13 offen offset:2048
    buffer_store_dwordx4 v[16:19], v4, s[4:7], s13 offen offset:3072
    s_add_u32 s13, s13, 4096
    buffer_store_dwordx4 v[16:19], v4, s[4:7], s13 offen offset:0
    buffer_store_dwordx4 v[16:19], v4, s[4:7], s13 offen offset:1024
    buffer_store_dwordx4 v[16:19], v4, s[4:7], s13 offen offset:2048
    buffer_store_dwordx4 v[16:19], v4, s[4:7], s13 offen offset:3072
    s_add_u32 s13, s13, 4096
prep_end:
    s_endpgm
.globl chain_kernel
.p2align 8
.type chain_kernel,@function
chain_kernel:
    s_cmp_ge_u32 s2, 256
    s_cbranch_scc1 chain_end
    s_load_dwordx16 s[16:31], s[0:1], 0
    s_load_dwordx8 s[32:39], s[0:1], 64
    s_load_dwordx4 s[40:43], s[0:1], 96
    v_lshrrev_b32 v1, 6, v0
    s_nop 0
    v_readfirstlane_b32 s3, v1
    v_and_b32 v0, 63, v0
    s_waitcnt lgkmcnt(0)
    s_mov_b32 s4, s42
    s_and_b32 s5, s43, 0xffff
    s_mov_b32 s6, 0x10000000
    s_mov_b32 s7, 0x00020000
    v_lshlrev_b32 v1, 4, v0
    v_lshrrev_b32 v3, 4, v0
    v_and_b32 v4, 7, v0
    v_lshlrev_b32 v2, 7, v3
    v_lshl_add_u32 v2, v4, 4, v2
    v_and_b32 v4, 15, v0
    v_cmp_gt_u32 s[60:61], 8, v4
    v_cmp_gt_u32 s[62:63], 32, v0
    s_cmp_ge_u32 s2, 112
    s_cbranch_scc1 chain_spare
    v_lshrrev_b32 v11, 5, v0
    v_lshlrev_b32 v11, 8, v11
    v_lshl_add_u32 v11, v4, 4, v11
    v_and_b32 v4, 1, v3
    v_lshl_add_u32 v11, v4, 3, v11
    s_cmp_ge_u32 s2, 32
    s_cbranch_scc1 chain_wo
    s_lshl_b32 s44, s2, 1
    s_lshr_b32 s45, s3, 1
    s_add_u32 s44, s44, s45
    s_mul_i32 s44, s44, 81920
    s_and_b32 s45, s3, 1
    s_lshl_b32 s45, s45, 11
    s_add_u32 s44, s44, s45
    s_add_u32 s44, s44, 2621440
    s_mul_i32 s46, s3, 36864
    v_add_u32 v5, s46, v1
    s_lshl_b32 s47, s2, 8
    s_lshl_b32 s45, s3, 6
    s_add_u32 s47, s47, s45
    s_mul_i32 s48, s3, 2560
    s_add_u32 s48, s48, 147456
    v_lshrrev_b32 v4, 2, v0
    s_mov_b32 s45, 8192
    v_mul_lo_u32 v6, v4, s45
    v_and_b32 v7, 3, v0
    v_lshl_add_u32 v6, v7, 4, v6
    v_mul_u32_u24 v4, 80, v4
    v_lshl_add_u32 v7, v7, 4, v4
    v_add_u32 v7, s48, v7
    v_bfe_u32 v4, v0, 4, 1
    v_lshlrev_b32 v8, 4, v4
    v_lshrrev_b32 v4, 5, v0
    v_lshl_add_u32 v8, v4, 2, v8
    v_bfe_u32 v4, v0, 2, 2
    v_add_u32 v8, v8, v4
    v_mul_u32_u24 v8, 80, v8
    v_and_b32 v4, 3, v0
    v_lshl_add_u32 v8, v4, 3, v8
    v_add_u32 v8, s48, v8
    s_mov_b32 s8, s20
    s_and_b32 s9, s21, 0xffff
    s_mov_b32 s10, 0x500000
    s_mov_b32 s11, 0x00020000
    s_mov_b32 s12, s22
    s_and_b32 s13, s23, 0xffff
    s_mov_b32 s14, 0x500000
    s_mov_b32 s15, 0x00020000
    s_mov_b32 s80, s24
    s_and_b32 s81, s25, 0xffff
    s_mov_b32 s82, 0x500000
    s_mov_b32 s83, 0x00020000
    s_add_u32 s45, s47, 0
    buffer_load_dwordx4 v[12:15], v6, s[8:11], s45 offen
    s_add_u32 s45, s47, 131072
    buffer_load_dwordx4 v[16:19], v6, s[8:11], s45 offen
    s_add_u32 s45, s47, 262144
    buffer_load_dwordx4 v[20:23], v6, s[8:11], s45 offen
    s_add_u32 s45, s47, 393216
    buffer_load_dwordx4 v[24:27], v6, s[8:11], s45 offen
    s_add_u32 s45, s47, 524288
    buffer_load_dwordx4 v[28:31], v6, s[8:11], s45 offen
    s_add_u32 s45, s47, 655360
    buffer_load_dwordx4 v[32:35], v6, s[8:11], s45 offen
    s_add_u32 s45, s47, 786432
    buffer_load_dwordx4 v[36:39], v6, s[8:11], s45 offen
    s_add_u32 s45, s47, 917504
    buffer_load_dwordx4 v[40:43], v6, s[8:11], s45 offen
    s_add_u32 s45, s47, 1048576
    buffer_load_dwordx4 v[44:47], v6, s[8:11], s45 offen
    s_add_u32 s45, s47, 1179648
    buffer_load_dwordx4 v[48:51], v6, s[8:11], s45 offen
    s_add_u32 s45, s47, 1310720
    buffer_load_dwordx4 v[52:55], v6, s[8:11], s45 offen
    s_add_u32 s45, s47, 1441792
    buffer_load_dwordx4 v[56:59], v6, s[8:11], s45 offen
    s_add_u32 s45, s47, 1572864
    buffer_load_dwordx4 v[60:63], v6, s[8:11], s45 offen
    s_add_u32 s45, s47, 1703936
    buffer_load_dwordx4 v[64:67], v6, s[8:11], s45 offen
    s_add_u32 s45, s47, 1835008
    buffer_load_dwordx4 v[68:71], v6, s[8:11], s45 offen
    s_add_u32 s45, s47, 1966080
    buffer_load_dwordx4 v[72:75], v6, s[8:11], s45 offen
    s_add_u32 s45, s47, 2097152
    buffer_load_dwordx4 v[76:79], v6, s[8:11], s45 offen
    s_add_u32 s45, s47, 2228224
    buffer_load_dwordx4 v[80:83], v6, s[8:11], s45 offen
    s_add_u32 s45, s47, 2359296
    buffer_load_dwordx4 v[84:87], v6, s[8:11], s45 offen
    s_add_u32 s45, s47, 2490368
    buffer_load_dwordx4 v[88:91], v6, s[8:11], s45 offen
    s_add_u32 s45, s47, 2621440
    buffer_load_dwordx4 v[92:95], v6, s[8:11], s45 offen
    s_add_u32 s45, s47, 2752512
    buffer_load_dwordx4 v[96:99], v6, s[8:11], s45 offen
    s_add_u32 s45, s47, 2883584
    buffer_load_dwordx4 v[100:103], v6, s[8:11], s45 offen
    s_add_u32 s45, s47, 3014656
    buffer_load_dwordx4 v[104:107], v6, s[8:11], s45 offen
    s_add_u32 s45, s47, 3145728
    buffer_load_dwordx4 v[108:111], v6, s[8:11], s45 offen
    s_add_u32 s45, s47, 3276800
    buffer_load_dwordx4 v[112:115], v6, s[8:11], s45 offen
    s_add_u32 s45, s47, 3407872
    buffer_load_dwordx4 v[116:119], v6, s[8:11], s45 offen
    s_add_u32 s45, s47, 3538944
    buffer_load_dwordx4 v[120:123], v6, s[8:11], s45 offen
    s_waitcnt vmcnt(26)
    ds_write_b128 v7, v[12:15] offset:0
    ds_write_b128 v7, v[16:19] offset:1280
    ds_read_b64_tr_b16 v[124:125], v8 offset:0
    ds_read_b64_tr_b16 v[128:129], v8 offset:640
    ds_read_b64_tr_b16 v[132:133], v8 offset:32
    ds_read_b64_tr_b16 v[136:137], v8 offset:672
    s_add_u32 s45, s47, 3670016
    buffer_load_dwordx4 v[12:15], v6, s[8:11], s45 offen
    s_add_u32 s45, s47, 3801088
    buffer_load_dwordx4 v[16:19], v6, s[8:11], s45 offen
    s_waitcnt vmcnt(26)
    ds_write_b128 v7, v[20:23] offset:0
    ds_write_b128 v7, v[24:27] offset:1280
    ds_read_b64_tr_b16 v[126:127], v8 offset:0
    ds_read_b64_tr_b16 v[130:131], v8 offset:640
    ds_read_b64_tr_b16 v[134:135], v8 offset:32
    ds_read_b64_tr_b16 v[138:139], v8 offset:672
    s_waitcnt lgkmcnt(0)
    v_accvgpr_write_b32 a0, v124
    v_accvgpr_write_b32 a1, v126
    v_accvgpr_write_b32 a2, v125
    v_accvgpr_write_b32 a3, v127
    v_accvgpr_write_b32 a4, v128
    v_accvgpr_write_b32 a5, v130
    v_accvgpr_write_b32 a6, v129
    v_accvgpr_write_b32 a7, v131
    v_accvgpr_write_b32 a80, v132
    v_accvgpr_write_b32 a81, v134
    v_accvgpr_write_b32 a82, v133
    v_accvgpr_write_b32 a83, v135
    v_accvgpr_write_b32 a84, v136
    v_accvgpr_write_b32 a85, v138
    v_accvgpr_write_b32 a86, v137
    v_accvgpr_write_b32 a87, v139
    s_add_u32 s45, s47, 3932160
    buffer_load_dwordx4 v[20:23], v6, s[8:11], s45 offen
    s_add_u32 s45, s47, 4063232
    buffer_load_dwordx4 v[24:27], v6, s[8:11], s45 offen
    s_waitcnt vmcnt(26)
    ds_write_b128 v7, v[28:31] offset:0
    ds_write_b128 v7, v[32:35] offset:1280
    ds_read_b64_tr_b16 v[124:125], v8 offset:0
    ds_read_b64_tr_b16 v[128:129], v8 offset:640
    ds_read_b64_tr_b16 v[132:133], v8 offset:32
    ds_read_b64_tr_b16 v[136:137], v8 offset:672
    s_add_u32 s45, s47, 4194304
    buffer_load_dwordx4 v[28:31], v6, s[8:11], s45 offen
    s_add_u32 s45, s47, 4325376
    buffer_load_dwordx4 v[32:35], v6, s[8:11], s45 offen
    s_waitcnt vmcnt(26)
    ds_write_b128 v7, v[36:39] offset:0
    ds_write_b128 v7, v[40:43] offset:1280
    ds_read_b64_tr_b16 v[126:127], v8 offset:0
    ds_read_b64_tr_b16 v[130:131], v8 offset:640
    ds_read_b64_tr_b16 v[134:135], v8 offset:32
    ds_read_b64_tr_b16 v[138:139], v8 offset:672
    s_waitcnt lgkmcnt(0)
    v_accvgpr_write_b32 a8, v124
    v_accvgpr_write_b32 a9, v126
    v_accvgpr_write_b32 a10, v125
    v_accvgpr_write_b32 a11, v127
    v_accvgpr_write_b32 a12, v128
    v_accvgpr_write_b32 a13, v130
    v_accvgpr_write_b32 a14, v129
    v_accvgpr_write_b32 a15, v131
    v_accvgpr_write_b32 a88, v132
    v_accvgpr_write_b32 a89, v134
    v_accvgpr_write_b32 a90, v133
    v_accvgpr_write_b32 a91, v135
    v_accvgpr_write_b32 a92, v136
    v_accvgpr_write_b32 a93, v138
    v_accvgpr_write_b32 a94, v137
    v_accvgpr_write_b32 a95, v139
    s_add_u32 s45, s47, 4456448
    buffer_load_dwordx4 v[36:39], v6, s[8:11], s45 offen
    s_add_u32 s45, s47, 4587520
    buffer_load_dwordx4 v[40:43], v6, s[8:11], s45 offen
    s_waitcnt vmcnt(26)
    ds_write_b128 v7, v[44:47] offset:0
    ds_write_b128 v7, v[48:51] offset:1280
    ds_read_b64_tr_b16 v[124:125], v8 offset:0
    ds_read_b64_tr_b16 v[128:129], v8 offset:640
    ds_read_b64_tr_b16 v[132:133], v8 offset:32
    ds_read_b64_tr_b16 v[136:137], v8 offset:672
    s_add_u32 s45, s47, 4718592
    buffer_load_dwordx4 v[44:47], v6, s[8:11], s45 offen
    s_add_u32 s45, s47, 4849664
    buffer_load_dwordx4 v[48:51], v6, s[8:11], s45 offen
    s_waitcnt vmcnt(26)
    ds_write_b128 v7, v[52:55] offset:0
    ds_write_b128 v7, v[56:59] offset:1280
    ds_read_b64_tr_b16 v[126:127], v8 offset:0
    ds_read_b64_tr_b16 v[130:131], v8 offset:640
    ds_read_b64_tr_b16 v[134:135], v8 offset:32
    ds_read_b64_tr_b16 v[138:139], v8 offset:672
    s_waitcnt lgkmcnt(0)
    v_accvgpr_write_b32 a16, v124
    v_accvgpr_write_b32 a17, v126
    v_accvgpr_write_b32 a18, v125
    v_accvgpr_write_b32 a19, v127
    v_accvgpr_write_b32 a20, v128
    v_accvgpr_write_b32 a21, v130
    v_accvgpr_write_b32 a22, v129
    v_accvgpr_write_b32 a23, v131
    v_accvgpr_write_b32 a96, v132
    v_accvgpr_write_b32 a97, v134
    v_accvgpr_write_b32 a98, v133
    v_accvgpr_write_b32 a99, v135
    v_accvgpr_write_b32 a100, v136
    v_accvgpr_write_b32 a101, v138
    v_accvgpr_write_b32 a102, v137
    v_accvgpr_write_b32 a103, v139
    s_add_u32 s45, s47, 4980736
    buffer_load_dwordx4 v[52:55], v6, s[8:11], s45 offen
    s_add_u32 s45, s47, 5111808
    buffer_load_dwordx4 v[56:59], v6, s[8:11], s45 offen
    s_waitcnt vmcnt(26)
    ds_write_b128 v7, v[60:63] offset:0
    ds_write_b128 v7, v[64:67] offset:1280
    ds_read_b64_tr_b16 v[124:125], v8 offset:0
    ds_read_b64_tr_b16 v[128:129], v8 offset:640
    ds_read_b64_tr_b16 v[132:133], v8 offset:32
    ds_read_b64_tr_b16 v[136:137], v8 offset:672
    s_add_u32 s45, s47, 0
    buffer_load_dwordx4 v[60:63], v6, s[12:15], s45 offen
    s_add_u32 s45, s47, 131072
    buffer_load_dwordx4 v[64:67], v6, s[12:15], s45 offen
    s_waitcnt vmcnt(26)
    ds_write_b128 v7, v[68:71] offset:0
    ds_write_b128 v7, v[72:75] offset:1280
    ds_read_b64_tr_b16 v[126:127], v8 offset:0
    ds_read_b64_tr_b16 v[130:131], v8 offset:640
    ds_read_b64_tr_b16 v[134:135], v8 offset:32
    ds_read_b64_tr_b16 v[138:139], v8 offset:672
    s_waitcnt lgkmcnt(0)
    v_accvgpr_write_b32 a24, v124
    v_accvgpr_write_b32 a25, v126
    v_accvgpr_write_b32 a26, v125
    v_accvgpr_write_b32 a27, v127
    v_accvgpr_write_b32 a28, v128
    v_accvgpr_write_b32 a29, v130
    v_accvgpr_write_b32 a30, v129
    v_accvgpr_write_b32 a31, v131
    v_accvgpr_write_b32 a104, v132
    v_accvgpr_write_b32 a105, v134
    v_accvgpr_write_b32 a106, v133
    v_accvgpr_write_b32 a107, v135
    v_accvgpr_write_b32 a108, v136
    v_accvgpr_write_b32 a109, v138
    v_accvgpr_write_b32 a110, v137
    v_accvgpr_write_b32 a111, v139
    s_add_u32 s45, s47, 262144
    buffer_load_dwordx4 v[68:71], v6, s[12:15], s45 offen
    s_add_u32 s45, s47, 393216
    buffer_load_dwordx4 v[72:75], v6, s[12:15], s45 offen
    s_waitcnt vmcnt(26)
    ds_write_b128 v7, v[76:79] offset:0
    ds_write_b128 v7, v[80:83] offset:1280
    ds_read_b64_tr_b16 v[124:125], v8 offset:0
    ds_read_b64_tr_b16 v[128:129], v8 offset:640
    ds_read_b64_tr_b16 v[132:133], v8 offset:32
    ds_read_b64_tr_b16 v[136:137], v8 offset:672
    s_add_u32 s45, s47, 524288
    buffer_load_dwordx4 v[76:79], v6, s[12:15], s45 offen
    s_add_u32 s45, s47, 655360
    buffer_load_dwordx4 v[80:83], v6, s[12:15], s45 offen
    s_waitcnt vmcnt(26)
    ds_write_b128 v7, v[84:87] offset:0
    ds_write_b128 v7, v[88:91] offset:1280
    ds_read_b64_tr_b16 v[126:127], v8 offset:0
    ds_read_b64_tr_b16 v[130:131], v8 offset:640
    ds_read_b64_tr_b16 v[134:135], v8 offset:32
    ds_read_b64_tr_b16 v[138:139], v8 offset:672
    s_waitcnt lgkmcnt(0)
    v_accvgpr_write_b32 a32, v124
    v_accvgpr_write_b32 a33, v126
    v_accvgpr_write_b32 a34, v125
    v_accvgpr_write_b32 a35, v127
    v_accvgpr_write_b32 a36, v128
    v_accvgpr_write_b32 a37, v130
    v_accvgpr_write_b32 a38, v129
    v_accvgpr_write_b32 a39, v131
    v_accvgpr_write_b32 a112, v132
    v_accvgpr_write_b32 a113, v134
    v_accvgpr_write_b32 a114, v133
    v_accvgpr_write_b32 a115, v135
    v_accvgpr_write_b32 a116, v136
    v_accvgpr_write_b32 a117, v138
    v_accvgpr_write_b32 a118, v137
    v_accvgpr_write_b32 a119, v139
    s_add_u32 s45, s47, 786432
    buffer_load_dwordx4 v[84:87], v6, s[12:15], s45 offen
    s_add_u32 s45, s47, 917504
    buffer_load_dwordx4 v[88:91], v6, s[12:15], s45 offen
    s_waitcnt vmcnt(26)
    ds_write_b128 v7, v[92:95] offset:0
    ds_write_b128 v7, v[96:99] offset:1280
    ds_read_b64_tr_b16 v[124:125], v8 offset:0
    ds_read_b64_tr_b16 v[128:129], v8 offset:640
    ds_read_b64_tr_b16 v[132:133], v8 offset:32
    ds_read_b64_tr_b16 v[136:137], v8 offset:672
    s_add_u32 s45, s47, 1048576
    buffer_load_dwordx4 v[92:95], v6, s[12:15], s45 offen
    s_add_u32 s45, s47, 1179648
    buffer_load_dwordx4 v[96:99], v6, s[12:15], s45 offen
    s_waitcnt vmcnt(26)
    ds_write_b128 v7, v[100:103] offset:0
    ds_write_b128 v7, v[104:107] offset:1280
    ds_read_b64_tr_b16 v[126:127], v8 offset:0
    ds_read_b64_tr_b16 v[130:131], v8 offset:640
    ds_read_b64_tr_b16 v[134:135], v8 offset:32
    ds_read_b64_tr_b16 v[138:139], v8 offset:672
    s_waitcnt lgkmcnt(0)
    v_accvgpr_write_b32 a40, v124
    v_accvgpr_write_b32 a41, v126
    v_accvgpr_write_b32 a42, v125
    v_accvgpr_write_b32 a43, v127
    v_accvgpr_write_b32 a44, v128
    v_accvgpr_write_b32 a45, v130
    v_accvgpr_write_b32 a46, v129
    v_accvgpr_write_b32 a47, v131
    v_accvgpr_write_b32 a120, v132
    v_accvgpr_write_b32 a121, v134
    v_accvgpr_write_b32 a122, v133
    v_accvgpr_write_b32 a123, v135
    v_accvgpr_write_b32 a124, v136
    v_accvgpr_write_b32 a125, v138
    v_accvgpr_write_b32 a126, v137
    v_accvgpr_write_b32 a127, v139
    s_add_u32 s45, s47, 1310720
    buffer_load_dwordx4 v[100:103], v6, s[12:15], s45 offen
    s_add_u32 s45, s47, 1441792
    buffer_load_dwordx4 v[104:107], v6, s[12:15], s45 offen
    s_waitcnt vmcnt(26)
    ds_write_b128 v7, v[108:111] offset:0
    ds_write_b128 v7, v[112:115] offset:1280
    ds_read_b64_tr_b16 v[124:125], v8 offset:0
    ds_read_b64_tr_b16 v[128:129], v8 offset:640
    ds_read_b64_tr_b16 v[132:133], v8 offset:32
    ds_read_b64_tr_b16 v[136:137], v8 offset:672
    s_add_u32 s45, s47, 1572864
    buffer_load_dwordx4 v[108:111], v6, s[12:15], s45 offen
    s_add_u32 s45, s47, 1703936
    buffer_load_dwordx4 v[112:115], v6, s[12:15], s45 offen
    s_waitcnt vmcnt(26)
    ds_write_b128 v7, v[116:119] offset:0
    ds_write_b128 v7, v[120:123] offset:1280
    ds_read_b64_tr_b16 v[126:127], v8 offset:0
    ds_read_b64_tr_b16 v[130:131], v8 offset:640
    ds_read_b64_tr_b16 v[134:135], v8 offset:32
    ds_read_b64_tr_b16 v[138:139], v8 offset:672
    s_waitcnt lgkmcnt(0)
    v_accvgpr_write_b32 a48, v124
    v_accvgpr_write_b32 a49, v126
    v_accvgpr_write_b32 a50, v125
    v_accvgpr_write_b32 a51, v127
    v_accvgpr_write_b32 a52, v128
    v_accvgpr_write_b32 a53, v130
    v_accvgpr_write_b32 a54, v129
    v_accvgpr_write_b32 a55, v131
    v_accvgpr_write_b32 a128, v132
    v_accvgpr_write_b32 a129, v134
    v_accvgpr_write_b32 a130, v133
    v_accvgpr_write_b32 a131, v135
    v_accvgpr_write_b32 a132, v136
    v_accvgpr_write_b32 a133, v138
    v_accvgpr_write_b32 a134, v137
    v_accvgpr_write_b32 a135, v139
    s_add_u32 s45, s47, 1835008
    buffer_load_dwordx4 v[116:119], v6, s[12:15], s45 offen
    s_add_u32 s45, s47, 1966080
    buffer_load_dwordx4 v[120:123], v6, s[12:15], s45 offen
    s_waitcnt vmcnt(26)
    ds_write_b128 v7, v[12:15] offset:0
    ds_write_b128 v7, v[16:19] offset:1280
    ds_read_b64_tr_b16 v[124:125], v8 offset:0
    ds_read_b64_tr_b16 v[128:129], v8 offset:640
    ds_read_b64_tr_b16 v[132:133], v8 offset:32
    ds_read_b64_tr_b16 v[136:137], v8 offset:672
    s_add_u32 s45, s47, 2097152
    buffer_load_dwordx4 v[12:15], v6, s[12:15], s45 offen
    s_add_u32 s45, s47, 2228224
    buffer_load_dwordx4 v[16:19], v6, s[12:15], s45 offen
    s_waitcnt vmcnt(26)
    ds_write_b128 v7, v[20:23] offset:0
    ds_write_b128 v7, v[24:27] offset:1280
    ds_read_b64_tr_b16 v[126:127], v8 offset:0
    ds_read_b64_tr_b16 v[130:131], v8 offset:640
    ds_read_b64_tr_b16 v[134:135], v8 offset:32
    ds_read_b64_tr_b16 v[138:139], v8 offset:672
    s_waitcnt lgkmcnt(0)
    v_accvgpr_write_b32 a56, v124
    v_accvgpr_write_b32 a57, v126
    v_accvgpr_write_b32 a58, v125
    v_accvgpr_write_b32 a59, v127
    v_accvgpr_write_b32 a60, v128
    v_accvgpr_write_b32 a61, v130
    v_accvgpr_write_b32 a62, v129
    v_accvgpr_write_b32 a63, v131
    v_accvgpr_write_b32 a136, v132
    v_accvgpr_write_b32 a137, v134
    v_accvgpr_write_b32 a138, v133
    v_accvgpr_write_b32 a139, v135
    v_accvgpr_write_b32 a140, v136
    v_accvgpr_write_b32 a141, v138
    v_accvgpr_write_b32 a142, v137
    v_accvgpr_write_b32 a143, v139
    s_add_u32 s45, s47, 2359296
    buffer_load_dwordx4 v[20:23], v6, s[12:15], s45 offen
    s_add_u32 s45, s47, 2490368
    buffer_load_dwordx4 v[24:27], v6, s[12:15], s45 offen
    s_waitcnt vmcnt(26)
    ds_write_b128 v7, v[28:31] offset:0
    ds_write_b128 v7, v[32:35] offset:1280
    ds_read_b64_tr_b16 v[124:125], v8 offset:0
    ds_read_b64_tr_b16 v[128:129], v8 offset:640
    ds_read_b64_tr_b16 v[132:133], v8 offset:32
    ds_read_b64_tr_b16 v[136:137], v8 offset:672
    s_add_u32 s45, s47, 2621440
    buffer_load_dwordx4 v[28:31], v6, s[12:15], s45 offen
    s_add_u32 s45, s47, 2752512
    buffer_load_dwordx4 v[32:35], v6, s[12:15], s45 offen
    s_waitcnt vmcnt(26)
    ds_write_b128 v7, v[36:39] offset:0
    ds_write_b128 v7, v[40:43] offset:1280
    ds_read_b64_tr_b16 v[126:127], v8 offset:0
    ds_read_b64_tr_b16 v[130:131], v8 offset:640
    ds_read_b64_tr_b16 v[134:135], v8 offset:32
    ds_read_b64_tr_b16 v[138:139], v8 offset:672
    s_waitcnt lgkmcnt(0)
    v_accvgpr_write_b32 a64, v124
    v_accvgpr_write_b32 a65, v126
    v_accvgpr_write_b32 a66, v125
    v_accvgpr_write_b32 a67, v127
    v_accvgpr_write_b32 a68, v128
    v_accvgpr_write_b32 a69, v130
    v_accvgpr_write_b32 a70, v129
    v_accvgpr_write_b32 a71, v131
    v_accvgpr_write_b32 a144, v132
    v_accvgpr_write_b32 a145, v134
    v_accvgpr_write_b32 a146, v133
    v_accvgpr_write_b32 a147, v135
    v_accvgpr_write_b32 a148, v136
    v_accvgpr_write_b32 a149, v138
    v_accvgpr_write_b32 a150, v137
    v_accvgpr_write_b32 a151, v139
    s_add_u32 s45, s47, 2883584
    buffer_load_dwordx4 v[36:39], v6, s[12:15], s45 offen
    s_add_u32 s45, s47, 3014656
    buffer_load_dwordx4 v[40:43], v6, s[12:15], s45 offen
    s_waitcnt vmcnt(26)
    ds_write_b128 v7, v[44:47] offset:0
    ds_write_b128 v7, v[48:51] offset:1280
    ds_read_b64_tr_b16 v[124:125], v8 offset:0
    ds_read_b64_tr_b16 v[128:129], v8 offset:640
    ds_read_b64_tr_b16 v[132:133], v8 offset:32
    ds_read_b64_tr_b16 v[136:137], v8 offset:672
    s_add_u32 s45, s47, 3145728
    buffer_load_dwordx4 v[44:47], v6, s[12:15], s45 offen
    s_add_u32 s45, s47, 3276800
    buffer_load_dwordx4 v[48:51], v6, s[12:15], s45 offen
    s_waitcnt vmcnt(26)
    ds_write_b128 v7, v[52:55] offset:0
    ds_write_b128 v7, v[56:59] offset:1280
    ds_read_b64_tr_b16 v[126:127], v8 offset:0
    ds_read_b64_tr_b16 v[130:131], v8 offset:640
    ds_read_b64_tr_b16 v[134:135], v8 offset:32
    ds_read_b64_tr_b16 v[138:139], v8 offset:672
    s_waitcnt lgkmcnt(0)
    v_accvgpr_write_b32 a72, v124
    v_accvgpr_write_b32 a73, v126
    v_accvgpr_write_b32 a74, v125
    v_accvgpr_write_b32 a75, v127
    v_accvgpr_write_b32 a76, v128
    v_accvgpr_write_b32 a77, v130
    v_accvgpr_write_b32 a78, v129
    v_accvgpr_write_b32 a79, v131
    v_accvgpr_write_b32 a152, v132
    v_accvgpr_write_b32 a153, v134
    v_accvgpr_write_b32 a154, v133
    v_accvgpr_write_b32 a155, v135
    v_accvgpr_write_b32 a156, v136
    v_accvgpr_write_b32 a157, v138
    v_accvgpr_write_b32 a158, v137
    v_accvgpr_write_b32 a159, v139
    s_add_u32 s45, s47, 3407872
    buffer_load_dwordx4 v[52:55], v6, s[12:15], s45 offen
    s_add_u32 s45, s47, 3538944
    buffer_load_dwordx4 v[56:59], v6, s[12:15], s45 offen
    s_waitcnt vmcnt(26)
    ds_write_b128 v7, v[60:63] offset:0
    ds_write_b128 v7, v[64:67] offset:1280
    ds_read_b64_tr_b16 v[124:125], v8 offset:0
    ds_read_b64_tr_b16 v[128:129], v8 offset:640
    ds_read_b64_tr_b16 v[132:133], v8 offset:32
    ds_read_b64_tr_b16 v[136:137], v8 offset:672
    s_add_u32 s45, s47, 3670016
    buffer_load_dwordx4 v[60:63], v6, s[12:15], s45 offen
    s_add_u32 s45, s47, 3801088
    buffer_load_dwordx4 v[64:67], v6, s[12:15], s45 offen
    s_waitcnt vmcnt(26)
    ds_write_b128 v7, v[68:71] offset:0
    ds_write_b128 v7, v[72:75] offset:1280
    ds_read_b64_tr_b16 v[126:127], v8 offset:0
    ds_read_b64_tr_b16 v[130:131], v8 offset:640
    ds_read_b64_tr_b16 v[134:135], v8 offset:32
    ds_read_b64_tr_b16 v[138:139], v8 offset:672
    s_waitcnt lgkmcnt(0)
    v_accvgpr_write_b32 a160, v124
    v_accvgpr_write_b32 a161, v126
    v_accvgpr_write_b32 a162, v125
    v_accvgpr_write_b32 a163, v127
    v_accvgpr_write_b32 a164, v128
    v_accvgpr_write_b32 a165, v130
    v_accvgpr_write_b32 a166, v129
    v_accvgpr_write_b32 a167, v131
    v_mov_b32 v164, v132
    v_mov_b32 v165, v134
    v_mov_b32 v166, v133
    v_mov_b32 v167, v135
    v_mov_b32 v168, v136
    v_mov_b32 v169, v138
    v_mov_b32 v170, v137
    v_mov_b32 v171, v139
    ds_write_b128 v5, v[164:167] offset:0
    ds_write_b128 v5, v[168:171] offset:1024
    s_waitcnt lgkmcnt(0)
    s_add_u32 s45, s47, 3932160
    buffer_load_dwordx4 v[68:71], v6, s[12:15], s45 offen
    s_add_u32 s45, s47, 4063232
    buffer_load_dwordx4 v[72:75], v6, s[12:15], s45 offen
    s_waitcnt vmcnt(26)
    ds_write_b128 v7, v[76:79] offset:0
    ds_write_b128 v7, v[80:83] offset:1280
    ds_read_b64_tr_b16 v[124:125], v8 offset:0
    ds_read_b64_tr_b16 v[128:129], v8 offset:640
    ds_read_b64_tr_b16 v[132:133], v8 offset:32
    ds_read_b64_tr_b16 v[136:137], v8 offset:672
    s_add_u32 s45, s47, 4194304
    buffer_load_dwordx4 v[76:79], v6, s[12:15], s45 offen
    s_add_u32 s45, s47, 4325376
    buffer_load_dwordx4 v[80:83], v6, s[12:15], s45 offen
    s_waitcnt vmcnt(26)
    ds_write_b128 v7, v[84:87] offset:0
    ds_write_b128 v7, v[88:91] offset:1280
    ds_read_b64_tr_b16 v[126:127], v8 offset:0
    ds_read_b64_tr_b16 v[130:131], v8 offset:640
    ds_read_b64_tr_b16 v[134:135], v8 offset:32
    ds_read_b64_tr_b16 v[138:139], v8 offset:672
    s_waitcnt lgkmcnt(0)
    v_accvgpr_write_b32 a168, v124
    v_accvgpr_write_b32 a169, v126
    v_accvgpr_write_b32 a170, v125
    v_accvgpr_write_b32 a171, v127
    v_accvgpr_write_b32 a172, v128
    v_accvgpr_write_b32 a173, v130
    v_accvgpr_write_b32 a174, v129
    v_accvgpr_write_b32 a175, v131
    v_mov_b32 v164, v132
    v_mov_b32 v165, v134
    v_mov_b32 v166, v133
    v_mov_b32 v167, v135
    v_mov_b32 v168, v136
    v_mov_b32 v169, v138
    v_mov_b32 v170, v137
    v_mov_b32 v171, v139
    ds_write_b128 v5, v[164:167] offset:2048
    ds_write_b128 v5, v[168:171] offset:3072
    s_waitcnt lgkmcnt(0)
    s_add_u32 s45, s47, 4456448
    buffer_load_dwordx4 v[84:87], v6, s[12:15], s45 offen
    s_add_u32 s45, s47, 4587520
    buffer_load_dwordx4 v[88:91], v6, s[12:15], s45 offen
    s_waitcnt vmcnt(26)
    ds_write_b128 v7, v[92:95] offset:0
    ds_write_b128 v7, v[96:99] offset:1280
    ds_read_b64_tr_b16 v[124:125], v8 offset:0
    ds_read_b64_tr_b16 v[128:129], v8 offset:640
    ds_read_b64_tr_b16 v[132:133], v8 offset:32
    ds_read_b64_tr_b16 v[136:137], v8 offset:672
    s_add_u32 s45, s47, 4718592
    buffer_load_dwordx4 v[92:95], v6, s[12:15], s45 offen
    s_add_u32 s45, s47, 4849664
    buffer_load_dwordx4 v[96:99], v6, s[12:15], s45 offen
    s_waitcnt vmcnt(26)
    ds_write_b128 v7, v[100:103] offset:0
    ds_write_b128 v7, v[104:107] offset:1280
    ds_read_b64_tr_b16 v[126:127], v8 offset:0
    ds_read_b64_tr_b16 v[130:131], v8 offset:640
    ds_read_b64_tr_b16 v[134:135], v8 offset:32
    ds_read_b64_tr_b16 v[138:139], v8 offset:672
    s_waitcnt lgkmcnt(0)
    v_mov_b32 v164, v124
    v_mov_b32 v165, v126
    v_mov_b32 v166, v125
    v_mov_b32 v167, v127
    v_mov_b32 v168, v128
    v_mov_b32 v169, v130
    v_mov_b32 v170, v129
    v_mov_b32 v171, v131
    ds_write_b128 v5, v[164:167] offset:20480
    ds_write_b128 v5, v[168:171] offset:21504
    s_waitcnt lgkmcnt(0)
    v_mov_b32 v164, v132
    v_mov_b32 v165, v134
    v_mov_b32 v166, v133
    v_mov_b32 v167, v135
    v_mov_b32 v168, v136
    v_mov_b32 v169, v138
    v_mov_b32 v170, v137
    v_mov_b32 v171, v139
    ds_write_b128 v5, v[164:167] offset:4096
    ds_write_b128 v5, v[168:171] offset:5120
    s_waitcnt lgkmcnt(0)
    s_add_u32 s45, s47, 4980736
    buffer_load_dwordx4 v[100:103], v6, s[12:15], s45 offen
    s_add_u32 s45, s47, 5111808
    buffer_load_dwordx4 v[104:107], v6, s[12:15], s45 offen
    s_waitcnt vmcnt(26)
    ds_write_b128 v7, v[108:111] offset:0
    ds_write_b128 v7, v[112:115] offset:1280
    ds_read_b64_tr_b16 v[124:125], v8 offset:0
    ds_read_b64_tr_b16 v[128:129], v8 offset:640
    ds_read_b64_tr_b16 v[132:133], v8 offset:32
    ds_read_b64_tr_b16 v[136:137], v8 offset:672
    s_add_u32 s45, s47, 0
    buffer_load_dwordx4 v[108:111], v6, s[80:83], s45 offen
    s_add_u32 s45, s47, 131072
    buffer_load_dwordx4 v[112:115], v6, s[80:83], s45 offen
    s_waitcnt vmcnt(26)
    ds_write_b128 v7, v[116:119] offset:0
    ds_write_b128 v7, v[120:123] offset:1280
    ds_read_b64_tr_b16 v[126:127], v8 offset:0
    ds_read_b64_tr_b16 v[130:131], v8 offset:640
    ds_read_b64_tr_b16 v[134:135], v8 offset:32
    ds_read_b64_tr_b16 v[138:139], v8 offset:672
    s_waitcnt lgkmcnt(0)
    v_mov_b32 v164, v124
    v_mov_b32 v165, v126
    v_mov_b32 v166, v125
    v_mov_b32 v167, v127
    v_mov_b32 v168, v128
    v_mov_b32 v169, v130
    v_mov_b32 v170, v129
    v_mov_b32 v171, v131
    ds_write_b128 v5, v[164:167] offset:22528
    ds_write_b128 v5, v[168:171] offset:23552
    s_waitcnt lgkmcnt(0)
    v_mov_b32 v164, v132
    v_mov_b32 v165, v134
    v_mov_b32 v166, v133
    v_mov_b32 v167, v135
    v_mov_b32 v168, v136
    v_mov_b32 v169, v138
    v_mov_b32 v170, v137
    v_mov_b32 v171, v139
    ds_write_b128 v5, v[164:167] offset:6144
    ds_write_b128 v5, v[168:171] offset:7168
    s_waitcnt lgkmcnt(0)
    s_add_u32 s45, s47, 262144
    buffer_load_dwordx4 v[116:119], v6, s[80:83], s45 offen
    s_add_u32 s45, s47, 393216
    buffer_load_dwordx4 v[120:123], v6, s[80:83], s45 offen
    s_waitcnt vmcnt(26)
    ds_write_b128 v7, v[12:15] offset:0
    ds_write_b128 v7, v[16:19] offset:1280
    ds_read_b64_tr_b16 v[124:125], v8 offset:0
    ds_read_b64_tr_b16 v[128:129], v8 offset:640
    ds_read_b64_tr_b16 v[132:133], v8 offset:32
    ds_read_b64_tr_b16 v[136:137], v8 offset:672
    s_add_u32 s45, s47, 524288
    buffer_load_dwordx4 v[12:15], v6, s[80:83], s45 offen
    s_add_u32 s45, s47, 655360
    buffer_load_dwordx4 v[16:19], v6, s[80:83], s45 offen
    s_waitcnt vmcnt(26)
    ds_write_b128 v7, v[20:23] offset:0
    ds_write_b128 v7, v[24:27] offset:1280
    ds_read_b64_tr_b16 v[126:127], v8 offset:0
    ds_read_b64_tr_b16 v[130:131], v8 offset:640
    ds_read_b64_tr_b16 v[134:135], v8 offset:32
    ds_read_b64_tr_b16 v[138:139], v8 offset:672
    s_waitcnt lgkmcnt(0)
    v_mov_b32 v164, v124
    v_mov_b32 v165, v126
    v_mov_b32 v166, v125
    v_mov_b32 v167, v127
    v_mov_b32 v168, v128
    v_mov_b32 v169, v130
    v_mov_b32 v170, v129
    v_mov_b32 v171, v131
    ds_write_b128 v5, v[164:167] offset:24576
    ds_write_b128 v5, v[168:171] offset:25600
    s_waitcnt lgkmcnt(0)
    v_mov_b32 v164, v132
    v_mov_b32 v165, v134
    v_mov_b32 v166, v133
    v_mov_b32 v167, v135
    v_mov_b32 v168, v136
    v_mov_b32 v169, v138
    v_mov_b32 v170, v137
    v_mov_b32 v171, v139
    ds_write_b128 v5, v[164:167] offset:8192
    ds_write_b128 v5, v[168:171] offset:9216
    s_waitcnt lgkmcnt(0)
    s_add_u32 s45, s47, 786432
    buffer_load_dwordx4 v[20:23], v6, s[80:83], s45 offen
    s_add_u32 s45, s47, 917504
    buffer_load_dwordx4 v[24:27], v6, s[80:83], s45 offen
    s_waitcnt vmcnt(26)
    ds_write_b128 v7, v[28:31] offset:0
    ds_write_b128 v7, v[32:35] offset:1280
    ds_read_b64_tr_b16 v[124:125], v8 offset:0
    ds_read_b64_tr_b16 v[128:129], v8 offset:640
    ds_read_b64_tr_b16 v[132:133], v8 offset:32
    ds_read_b64_tr_b16 v[136:137], v8 offset:672
    s_add_u32 s45, s47, 1048576
    buffer_load_dwordx4 v[28:31], v6, s[80:83], s45 offen
    s_add_u32 s45, s47, 1179648
    buffer_load_dwordx4 v[32:35], v6, s[80:83], s45 offen
    s_waitcnt vmcnt(26)
    ds_write_b128 v7, v[36:39] offset:0
    ds_write_b128 v7, v[40:43] offset:1280
    ds_read_b64_tr_b16 v[126:127], v8 offset:0
    ds_read_b64_tr_b16 v[130:131], v8 offset:640
    ds_read_b64_tr_b16 v[134:135], v8 offset:32
    ds_read_b64_tr_b16 v[138:139], v8 offset:672
    s_waitcnt lgkmcnt(0)
    v_mov_b32 v164, v124
    v_mov_b32 v165, v126
    v_mov_b32 v166, v125
    v_mov_b32 v167, v127
    v_mov_b32 v168, v128
    v_mov_b32 v169, v130
    v_mov_b32 v170, v129
    v_mov_b32 v171, v131
    ds_write_b128 v5, v[164:167] offset:26624
    ds_write_b128 v5, v[168:171] offset:27648
    s_waitcnt lgkmcnt(0)
    v_mov_b32 v164, v132
    v_mov_b32 v165, v134
    v_mov_b32 v166, v133
    v_mov_b32 v167, v135
    v_mov_b32 v168, v136
    v_mov_b32 v169, v138
    v_mov_b32 v170, v137
    v_mov_b32 v171, v139
    ds_write_b128 v5, v[164:167] offset:10240
    ds_write_b128 v5, v[168:171] offset:11264
    s_waitcnt lgkmcnt(0)
    s_add_u32 s45, s47, 1310720
    buffer_load_dwordx4 v[36:39], v6, s[80:83], s45 offen
    s_add_u32 s45, s47, 1441792
    buffer_load_dwordx4 v[40:43], v6, s[80:83], s45 offen
    s_waitcnt vmcnt(26)
    ds_write_b128 v7, v[44:47] offset:0
    ds_write_b128 v7, v[48:51] offset:1280
    ds_read_b64_tr_b16 v[124:125], v8 offset:0
    ds_read_b64_tr_b16 v[128:129], v8 offset:640
    ds_read_b64_tr_b16 v[132:133], v8 offset:32
    ds_read_b64_tr_b16 v[136:137], v8 offset:672
    s_add_u32 s45, s47, 1572864
    buffer_load_dwordx4 v[44:47], v6, s[80:83], s45 offen
    s_add_u32 s45, s47, 1703936
    buffer_load_dwordx4 v[48:51], v6, s[80:83], s45 offen
    s_waitcnt vmcnt(26)
    ds_write_b128 v7, v[52:55] offset:0
    ds_write_b128 v7, v[56:59] offset:1280
    ds_read_b64_tr_b16 v[126:127], v8 offset:0
    ds_read_b64_tr_b16 v[130:131], v8 offset:640
    ds_read_b64_tr_b16 v[134:135], v8 offset:32
    ds_read_b64_tr_b16 v[138:139], v8 offset:672
    s_waitcnt lgkmcnt(0)
    v_mov_b32 v164, v124
    v_mov_b32 v165, v126
    v_mov_b32 v166, v125
    v_mov_b32 v167, v127
    v_mov_b32 v168, v128
    v_mov_b32 v169, v130
    v_mov_b32 v170, v129
    v_mov_b32 v171, v131
    ds_write_b128 v5, v[164:167] offset:28672
    ds_write_b128 v5, v[168:171] offset:29696
    s_waitcnt lgkmcnt(0)
    v_mov_b32 v164, v132
    v_mov_b32 v165, v134
    v_mov_b32 v166, v133
    v_mov_b32 v167, v135
    v_mov_b32 v168, v136
    v_mov_b32 v169, v138
    v_mov_b32 v170, v137
    v_mov_b32 v171, v139
    ds_write_b128 v5, v[164:167] offset:12288
    ds_write_b128 v5, v[168:171] offset:13312
    s_waitcnt lgkmcnt(0)
    s_add_u32 s45, s47, 1835008
    buffer_load_dwordx4 v[52:55], v6, s[80:83], s45 offen
    s_add_u32 s45, s47, 1966080
    buffer_load_dwordx4 v[56:59], v6, s[80:83], s45 offen
    s_waitcnt vmcnt(26)
    ds_write_b128 v7, v[60:63] offset:0
    ds_write_b128 v7, v[64:67] offset:1280
    ds_read_b64_tr_b16 v[124:125], v8 offset:0
    ds_read_b64_tr_b16 v[128:129], v8 offset:640
    ds_read_b64_tr_b16 v[132:133], v8 offset:32
    ds_read_b64_tr_b16 v[136:137], v8 offset:672
    s_add_u32 s45, s47, 2097152
    buffer_load_dwordx4 v[60:63], v6, s[80:83], s45 offen
    s_add_u32 s45, s47, 2228224
    buffer_load_dwordx4 v[64:67], v6, s[80:83], s45 offen
    s_waitcnt vmcnt(26)
    ds_write_b128 v7, v[68:71] offset:0
    ds_write_b128 v7, v[72:75] offset:1280
    ds_read_b64_tr_b16 v[126:127], v8 offset:0
    ds_read_b64_tr_b16 v[130:131], v8 offset:640
    ds_read_b64_tr_b16 v[134:135], v8 offset:32
    ds_read_b64_tr_b16 v[138:139], v8 offset:672
    s_waitcnt lgkmcnt(0)
    v_mov_b32 v164, v124
    v_mov_b32 v165, v126
    v_mov_b32 v166, v125
    v_mov_b32 v167, v127
    v_mov_b32 v168, v128
    v_mov_b32 v169, v130
    v_mov_b32 v170, v129
    v_mov_b32 v171, v131
    ds_write_b128 v5, v[164:167] offset:30720
    ds_write_b128 v5, v[168:171] offset:31744
    s_waitcnt lgkmcnt(0)
    v_mov_b32 v164, v132
    v_mov_b32 v165, v134
    v_mov_b32 v166, v133
    v_mov_b32 v167, v135
    v_mov_b32 v168, v136
    v_mov_b32 v169, v138
    v_mov_b32 v170, v137
    v_mov_b32 v171, v139
    ds_write_b128 v5, v[164:167] offset:14336
    ds_write_b128 v5, v[168:171] offset:15360
    s_waitcnt lgkmcnt(0)
    s_add_u32 s45, s47, 2359296
    buffer_load_dwordx4 v[68:71], v6, s[80:83], s45 offen
    s_add_u32 s45, s47, 2490368
    buffer_load_dwordx4 v[72:75], v6, s[80:83], s45 offen
    s_waitcnt vmcnt(26)
    ds_write_b128 v7, v[76:79] offset:0
    ds_write_b128 v7, v[80:83] offset:1280
    ds_read_b64_tr_b16 v[124:125], v8 offset:0
    ds_read_b64_tr_b16 v[128:129], v8 offset:640
    ds_read_b64_tr_b16 v[132:133], v8 offset:32
    ds_read_b64_tr_b16 v[136:137], v8 offset:672
    s_add_u32 s45, s47, 2621440
    buffer_load_dwordx4 v[76:79], v6, s[80:83], s45 offen
    s_add_u32 s45, s47, 2752512
    buffer_load_dwordx4 v[80:83], v6, s[80:83], s45 offen
    s_waitcnt vmcnt(26)
    ds_write_b128 v7, v[84:87] offset:0
    ds_write_b128 v7, v[88:91] offset:1280
    ds_read_b64_tr_b16 v[126:127], v8 offset:0
    ds_read_b64_tr_b16 v[130:131], v8 offset:640
    ds_read_b64_tr_b16 v[134:135], v8 offset:32
    ds_read_b64_tr_b16 v[138:139], v8 offset:672
    s_waitcnt lgkmcnt(0)
    v_mov_b32 v164, v124
    v_mov_b32 v165, v126
    v_mov_b32 v166, v125
    v_mov_b32 v167, v127
    v_mov_b32 v168, v128
    v_mov_b32 v169, v130
    v_mov_b32 v170, v129
    v_mov_b32 v171, v131
    ds_write_b128 v5, v[164:167] offset:32768
    ds_write_b128 v5, v[168:171] offset:33792
    s_waitcnt lgkmcnt(0)
    v_mov_b32 v164, v132
    v_mov_b32 v165, v134
    v_mov_b32 v166, v133
    v_mov_b32 v167, v135
    v_mov_b32 v168, v136
    v_mov_b32 v169, v138
    v_mov_b32 v170, v137
    v_mov_b32 v171, v139
    ds_write_b128 v5, v[164:167] offset:16384
    ds_write_b128 v5, v[168:171] offset:17408
    s_waitcnt lgkmcnt(0)
    s_add_u32 s45, s47, 2883584
    buffer_load_dwordx4 v[84:87], v6, s[80:83], s45 offen
    s_add_u32 s45, s47, 3014656
    buffer_load_dwordx4 v[88:91], v6, s[80:83], s45 offen
    s_waitcnt vmcnt(26)
    ds_write_b128 v7, v[92:95] offset:0
    ds_write_b128 v7, v[96:99] offset:1280
    ds_read_b64_tr_b16 v[124:125], v8 offset:0
    ds_read_b64_tr_b16 v[128:129], v8 offset:640
    ds_read_b64_tr_b16 v[132:133], v8 offset:32
    ds_read_b64_tr_b16 v[136:137], v8 offset:672
    s_add_u32 s45, s47, 3145728
    buffer_load_dwordx4 v[92:95], v6, s[80:83], s45 offen
    s_add_u32 s45, s47, 3276800
    buffer_load_dwordx4 v[96:99], v6, s[80:83], s45 offen
    s_waitcnt vmcnt(26)
    ds_write_b128 v7, v[100:103] offset:0
    ds_write_b128 v7, v[104:107] offset:1280
    ds_read_b64_tr_b16 v[126:127], v8 offset:0
    ds_read_b64_tr_b16 v[130:131], v8 offset:640
    ds_read_b64_tr_b16 v[134:135], v8 offset:32
    ds_read_b64_tr_b16 v[138:139], v8 offset:672
    s_waitcnt lgkmcnt(0)
    v_mov_b32 v164, v124
    v_mov_b32 v165, v126
    v_mov_b32 v166, v125
    v_mov_b32 v167, v127
    v_mov_b32 v168, v128
    v_mov_b32 v169, v130
    v_mov_b32 v170, v129
    v_mov_b32 v171, v131
    ds_write_b128 v5, v[164:167] offset:34816
    ds_write_b128 v5, v[168:171] offset:35840
    s_waitcnt lgkmcnt(0)
    v_mov_b32 v164, v132
    v_mov_b32 v165, v134
    v_mov_b32 v166, v133
    v_mov_b32 v167, v135
    v_mov_b32 v168, v136
    v_mov_b32 v169, v138
    v_mov_b32 v170, v137
    v_mov_b32 v171, v139
    ds_write_b128 v5, v[164:167] offset:18432
    ds_write_b128 v5, v[168:171] offset:19456
    s_waitcnt lgkmcnt(0)
    s_add_u32 s45, s47, 3407872
    buffer_load_dwordx4 v[100:103], v6, s[80:83], s45 offen
    s_add_u32 s45, s47, 3538944
    buffer_load_dwordx4 v[104:107], v6, s[80:83], s45 offen
    s_waitcnt vmcnt(26)
    ds_write_b128 v7, v[108:111] offset:0
    ds_write_b128 v7, v[112:115] offset:1280
    ds_read_b64_tr_b16 v[124:125], v8 offset:0
    ds_read_b64_tr_b16 v[128:129], v8 offset:640
    ds_read_b64_tr_b16 v[132:133], v8 offset:32
    ds_read_b64_tr_b16 v[136:137], v8 offset:672
    s_add_u32 s45, s47, 3670016
    buffer_load_dwordx4 v[108:111], v6, s[80:83], s45 offen
    s_add_u32 s45, s47, 3801088
    buffer_load_dwordx4 v[112:115], v6, s[80:83], s45 offen
    s_waitcnt vmcnt(26)
    ds_write_b128 v7, v[116:119] offset:0
    ds_write_b128 v7, v[120:123] offset:1280
    ds_read_b64_tr_b16 v[126:127], v8 offset:0
    ds_read_b64_tr_b16 v[130:131], v8 offset:640
    ds_read_b64_tr_b16 v[134:135], v8 offset:32
    ds_read_b64_tr_b16 v[138:139], v8 offset:672
    s_waitcnt lgkmcnt(0)
    v_accvgpr_write_b32 a176, v124
    v_accvgpr_write_b32 a177, v126
    v_accvgpr_write_b32 a178, v125
    v_accvgpr_write_b32 a179, v127
    v_accvgpr_write_b32 a180, v128
    v_accvgpr_write_b32 a181, v130
    v_accvgpr_write_b32 a182, v129
    v_accvgpr_write_b32 a183, v131
    v_mov_b32 v176, v132
    v_mov_b32 v177, v134
    v_mov_b32 v178, v133
    v_mov_b32 v179, v135
    v_mov_b32 v180, v136
    v_mov_b32 v181, v138
    v_mov_b32 v182, v137
    v_mov_b32 v183, v139
    s_add_u32 s45, s47, 3932160
    buffer_load_dwordx4 v[116:119], v6, s[80:83], s45 offen
    s_add_u32 s45, s47, 4063232
    buffer_load_dwordx4 v[120:123], v6, s[80:83], s45 offen
    s_waitcnt vmcnt(26)
    ds_write_b128 v7, v[12:15] offset:0
    ds_write_b128 v7, v[16:19] offset:1280
    ds_read_b64_tr_b16 v[124:125], v8 offset:0
    ds_read_b64_tr_b16 v[128:129], v8 offset:640
    ds_read_b64_tr_b16 v[132:133], v8 offset:32
    ds_read_b64_tr_b16 v[136:137], v8 offset:672
    s_add_u32 s45, s47, 4194304
    buffer_load_dwordx4 v[12:15], v6, s[80:83], s45 offen
    s_add_u32 s45, s47, 4325376
    buffer_load_dwordx4 v[16:19], v6, s[80:83], s45 offen
    s_waitcnt vmcnt(26)
    ds_write_b128 v7, v[20:23] offset:0
    ds_write_b128 v7, v[24:27] offset:1280
    ds_read_b64_tr_b16 v[126:127], v8 offset:0
    ds_read_b64_tr_b16 v[130:131], v8 offset:640
    ds_read_b64_tr_b16 v[134:135], v8 offset:32
    ds_read_b64_tr_b16 v[138:139], v8 offset:672
    s_waitcnt lgkmcnt(0)
    v_accvgpr_write_b32 a184, v124
    v_accvgpr_write_b32 a185, v126
    v_accvgpr_write_b32 a186, v125
    v_accvgpr_write_b32 a187, v127
    v_accvgpr_write_b32 a188, v128
    v_accvgpr_write_b32 a189, v130
    v_accvgpr_write_b32 a190, v129
    v_accvgpr_write_b32 a191, v131
    v_mov_b32 v184, v132
    v_mov_b32 v185, v134
    v_mov_b32 v186, v133
    v_mov_b32 v187, v135
    v_mov_b32 v188, v136
    v_mov_b32 v189, v138
    v_mov_b32 v190, v137
    v_mov_b32 v191, v139
    s_add_u32 s45, s47, 4456448
    buffer_load_dwordx4 v[20:23], v6, s[80:83], s45 offen
    s_add_u32 s45, s47, 4587520
    buffer_load_dwordx4 v[24:27], v6, s[80:83], s45 offen
    s_waitcnt vmcnt(26)
    ds_write_b128 v7, v[28:31] offset:0
    ds_write_b128 v7, v[32:35] offset:1280
    ds_read_b64_tr_b16 v[124:125], v8 offset:0
    ds_read_b64_tr_b16 v[128:129], v8 offset:640
    ds_read_b64_tr_b16 v[132:133], v8 offset:32
    ds_read_b64_tr_b16 v[136:137], v8 offset:672
    s_add_u32 s45, s47, 4718592
    buffer_load_dwordx4 v[28:31], v6, s[80:83], s45 offen
    s_add_u32 s45, s47, 4849664
    buffer_load_dwordx4 v[32:35], v6, s[80:83], s45 offen
    s_waitcnt vmcnt(26)
    ds_write_b128 v7, v[36:39] offset:0
    ds_write_b128 v7, v[40:43] offset:1280
    ds_read_b64_tr_b16 v[126:127], v8 offset:0
    ds_read_b64_tr_b16 v[130:131], v8 offset:640
    ds_read_b64_tr_b16 v[134:135], v8 offset:32
    ds_read_b64_tr_b16 v[138:139], v8 offset:672
    s_waitcnt lgkmcnt(0)
    v_accvgpr_write_b32 a192, v124
    v_accvgpr_write_b32 a193, v126
    v_accvgpr_write_b32 a194, v125
    v_accvgpr_write_b32 a195, v127
    v_accvgpr_write_b32 a196, v128
    v_accvgpr_write_b32 a197, v130
    v_accvgpr_write_b32 a198, v129
    v_accvgpr_write_b32 a199, v131
    v_mov_b32 v192, v132
    v_mov_b32 v193, v134
    v_mov_b32 v194, v133
    v_mov_b32 v195, v135
    v_mov_b32 v196, v136
    v_mov_b32 v197, v138
    v_mov_b32 v198, v137
    v_mov_b32 v199, v139
    s_add_u32 s45, s47, 4980736
    buffer_load_dwordx4 v[36:39], v6, s[80:83], s45 offen
    s_add_u32 s45, s47, 5111808
    buffer_load_dwordx4 v[40:43], v6, s[80:83], s45 offen
    s_waitcnt vmcnt(26)
    ds_write_b128 v7, v[44:47] offset:0
    ds_write_b128 v7, v[48:51] offset:1280
    ds_read_b64_tr_b16 v[124:125], v8 offset:0
    ds_read_b64_tr_b16 v[128:129], v8 offset:640
    ds_read_b64_tr_b16 v[132:133], v8 offset:32
    ds_read_b64_tr_b16 v[136:137], v8 offset:672
    s_waitcnt vmcnt(24)
    ds_write_b128 v7, v[52:55] offset:0
    ds_write_b128 v7, v[56:59] offset:1280
    ds_read_b64_tr_b16 v[126:127], v8 offset:0
    ds_read_b64_tr_b16 v[130:131], v8 offset:640
    ds_read_b64_tr_b16 v[134:135], v8 offset:32
    ds_read_b64_tr_b16 v[138:139], v8 offset:672
    s_waitcnt lgkmcnt(0)
    v_accvgpr_write_b32 a200, v124
    v_accvgpr_write_b32 a201, v126
    v_accvgpr_write_b32 a202, v125
    v_accvgpr_write_b32 a203, v127
    v_accvgpr_write_b32 a204, v128
    v_accvgpr_write_b32 a205, v130
    v_accvgpr_write_b32 a206, v129
    v_accvgpr_write_b32 a207, v131
    v_mov_b32 v200, v132
    v_mov_b32 v201, v134
    v_mov_b32 v202, v133
    v_mov_b32 v203, v135
    v_mov_b32 v204, v136
    v_mov_b32 v205, v138
    v_mov_b32 v206, v137
    v_mov_b32 v207, v139
    s_waitcnt vmcnt(22)
    ds_write_b128 v7, v[60:63] offset:0
    ds_write_b128 v7, v[64:67] offset:1280
    ds_read_b64_tr_b16 v[124:125], v8 offset:0
    ds_read_b64_tr_b16 v[128:129], v8 offset:640
    ds_read_b64_tr_b16 v[132:133], v8 offset:32
    ds_read_b64_tr_b16 v[136:137], v8 offset:672
    s_waitcnt vmcnt(20)
    ds_write_b128 v7, v[68:71] offset:0
    ds_write_b128 v7, v[72:75] offset:1280
    ds_read_b64_tr_b16 v[126:127], v8 offset:0
    ds_read_b64_tr_b16 v[130:131], v8 offset:640
    ds_read_b64_tr_b16 v[134:135], v8 offset:32
    ds_read_b64_tr_b16 v[138:139], v8 offset:672
    s_waitcnt lgkmcnt(0)
    v_accvgpr_write_b32 a208, v124
    v_accvgpr_write_b32 a209, v126
    v_accvgpr_write_b32 a210, v125
    v_accvgpr_write_b32 a211, v127
    v_accvgpr_write_b32 a212, v128
    v_accvgpr_write_b32 a213, v130
    v_accvgpr_write_b32 a214, v129
    v_accvgpr_write_b32 a215, v131
    v_mov_b32 v208, v132
    v_mov_b32 v209, v134
    v_mov_b32 v210, v133
    v_mov_b32 v211, v135
    v_mov_b32 v212, v136
    v_mov_b32 v213, v138
    v_mov_b32 v214, v137
    v_mov_b32 v215, v139
    s_waitcnt vmcnt(18)
    ds_write_b128 v7, v[76:79] offset:0
    ds_write_b128 v7, v[80:83] offset:1280
    ds_read_b64_tr_b16 v[124:125], v8 offset:0
    ds_read_b64_tr_b16 v[128:129], v8 offset:640
    ds_read_b64_tr_b16 v[132:133], v8 offset:32
    ds_read_b64_tr_b16 v[136:137], v8 offset:672
    s_waitcnt vmcnt(16)
    ds_write_b128 v7, v[84:87] offset:0
    ds_write_b128 v7, v[88:91] offset:1280
    ds_read_b64_tr_b16 v[126:127], v8 offset:0
    ds_read_b64_tr_b16 v[130:131], v8 offset:640
    ds_read_b64_tr_b16 v[134:135], v8 offset:32
    ds_read_b64_tr_b16 v[138:139], v8 offset:672
    s_waitcnt lgkmcnt(0)
    v_accvgpr_write_b32 a216, v124
    v_accvgpr_write_b32 a217, v126
    v_accvgpr_write_b32 a218, v125
    v_accvgpr_write_b32 a219, v127
    v_accvgpr_write_b32 a220, v128
    v_accvgpr_write_b32 a221, v130
    v_accvgpr_write_b32 a222, v129
    v_accvgpr_write_b32 a223, v131
    v_mov_b32 v216, v132
    v_mov_b32 v217, v134
    v_mov_b32 v218, v133
    v_mov_b32 v219, v135
    v_mov_b32 v220, v136
    v_mov_b32 v221, v138
    v_mov_b32 v222, v137
    v_mov_b32 v223, v139
    s_waitcnt vmcnt(14)
    ds_write_b128 v7, v[92:95] offset:0
    ds_write_b128 v7, v[96:99] offset:1280
    ds_read_b64_tr_b16 v[124:125], v8 offset:0
    ds_read_b64_tr_b16 v[128:129], v8 offset:640
    ds_read_b64_tr_b16 v[132:133], v8 offset:32
    ds_read_b64_tr_b16 v[136:137], v8 offset:672
    s_waitcnt vmcnt(12)
    ds_write_b128 v7, v[100:103] offset:0
    ds_write_b128 v7, v[104:107] offset:1280
    ds_read_b64_tr_b16 v[126:127], v8 offset:0
    ds_read_b64_tr_b16 v[130:131], v8 offset:640
    ds_read_b64_tr_b16 v[134:135], v8 offset:32
    ds_read_b64_tr_b16 v[138:139], v8 offset:672
    s_waitcnt lgkmcnt(0)
    v_accvgpr_write_b32 a224, v124
    v_accvgpr_write_b32 a225, v126
    v_accvgpr_write_b32 a226, v125
    v_accvgpr_write_b32 a227, v127
    v_accvgpr_write_b32 a228, v128
    v_accvgpr_write_b32 a229, v130
    v_accvgpr_write_b32 a230, v129
    v_accvgpr_write_b32 a231, v131
    v_mov_b32 v224, v132
    v_mov_b32 v225, v134
    v_mov_b32 v226, v133
    v_mov_b32 v227, v135
    v_mov_b32 v228, v136
    v_mov_b32 v229, v138
    v_mov_b32 v230, v137
    v_mov_b32 v231, v139
    s_waitcnt vmcnt(10)
    ds_write_b128 v7, v[108:111] offset:0
    ds_write_b128 v7, v[112:115] offset:1280
    ds_read_b64_tr_b16 v[124:125], v8 offset:0
    ds_read_b64_tr_b16 v[128:129], v8 offset:640
    ds_read_b64_tr_b16 v[132:133], v8 offset:32
    ds_read_b64_tr_b16 v[136:137], v8 offset:672
    s_waitcnt vmcnt(8)
    ds_write_b128 v7, v[116:119] offset:0
    ds_write_b128 v7, v[120:123] offset:1280
    ds_read_b64_tr_b16 v[126:127], v8 offset:0
    ds_read_b64_tr_b16 v[130:131], v8 offset:640
    ds_read_b64_tr_b16 v[134:135], v8 offset:32
    ds_read_b64_tr_b16 v[138:139], v8 offset:672
    s_waitcnt lgkmcnt(0)
    v_accvgpr_write_b32 a232, v124
    v_accvgpr_write_b32 a233, v126
    v_accvgpr_write_b32 a234, v125
    v_accvgpr_write_b32 a235, v127
    v_accvgpr_write_b32 a236, v128
    v_accvgpr_write_b32 a237, v130
    v_accvgpr_write_b32 a238, v129
    v_accvgpr_write_b32 a239, v131
    v_mov_b32 v232, v132
    v_mov_b32 v233, v134
    v_mov_b32 v234, v133
    v_mov_b32 v235, v135
    v_mov_b32 v236, v136
    v_mov_b32 v237, v138
    v_mov_b32 v238, v137
    v_mov_b32 v239, v139
    s_waitcnt vmcnt(6)
    ds_write_b128 v7, v[12:15] offset:0
    ds_write_b128 v7, v[16:19] offset:1280
    ds_read_b64_tr_b16 v[124:125], v8 offset:0
    ds_read_b64_tr_b16 v[128:129], v8 offset:640
    ds_read_b64_tr_b16 v[132:133], v8 offset:32
    ds_read_b64_tr_b16 v[136:137], v8 offset:672
    s_waitcnt vmcnt(4)
    ds_write_b128 v7, v[20:23] offset:0
    ds_write_b128 v7, v[24:27] offset:1280
    ds_read_b64_tr_b16 v[126:127], v8 offset:0
    ds_read_b64_tr_b16 v[130:131], v8 offset:640
    ds_read_b64_tr_b16 v[134:135], v8 offset:32
    ds_read_b64_tr_b16 v[138:139], v8 offset:672
    s_waitcnt lgkmcnt(0)
    v_accvgpr_write_b32 a240, v124
    v_accvgpr_write_b32 a241, v126
    v_accvgpr_write_b32 a242, v125
    v_accvgpr_write_b32 a243, v127
    v_accvgpr_write_b32 a244, v128
    v_accvgpr_write_b32 a245, v130
    v_accvgpr_write_b32 a246, v129
    v_accvgpr_write_b32 a247, v131
    v_mov_b32 v240, v132
    v_mov_b32 v241, v134
    v_mov_b32 v242, v133
    v_mov_b32 v243, v135
    v_mov_b32 v244, v136
    v_mov_b32 v245, v138
    v_mov_b32 v246, v137
    v_mov_b32 v247, v139
    s_waitcnt vmcnt(2)
    ds_write_b128 v7, v[28:31] offset:0
    ds_write_b128 v7, v[32:35] offset:1280
    ds_read_b64_tr_b16 v[124:125], v8 offset:0
    ds_read_b64_tr_b16 v[128:129], v8 offset:640
    ds_read_b64_tr_b16 v[132:133], v8 offset:32
    ds_read_b64_tr_b16 v[136:137], v8 offset:672
    s_waitcnt vmcnt(0)
    ds_write_b128 v7, v[36:39] offset:0
    ds_write_b128 v7, v[40:43] offset:1280
    ds_read_b64_tr_b16 v[126:127], v8 offset:0
    ds_read_b64_tr_b16 v[130:131], v8 offset:640
    ds_read_b64_tr_b16 v[134:135], v8 offset:32
    ds_read_b64_tr_b16 v[138:139], v8 offset:672
    s_waitcnt lgkmcnt(0)
    v_accvgpr_write_b32 a248, v124
    v_accvgpr_write_b32 a249, v126
    v_accvgpr_write_b32 a250, v125
    v_accvgpr_write_b32 a251, v127
    v_accvgpr_write_b32 a252, v128
    v_accvgpr_write_b32 a253, v130
    v_accvgpr_write_b32 a254, v129
    v_accvgpr_write_b32 a255, v131
    v_mov_b32 v248, v132
    v_mov_b32 v249, v134
    v_mov_b32 v250, v133
    v_mov_b32 v251, v135
    v_mov_b32 v252, v136
    v_mov_b32 v253, v138
    v_mov_b32 v254, v137
    v_mov_b32 v255, v139
    v_bfe_u32 v4, v0, 3, 1
    v_lshl_add_u32 v3, v4, 9, v2
    v_add_u32 v3, 151552, v3
    v_mov_b32 v9, 0x4444
    v_mov_b32 v8, 0xeeee
    v_cmp_eq_u32 vcc, 1, v4
    s_nop 1
    v_cndmask_b32 v9, v9, v8, vcc
    v_lshrrev_b32 v6, 5, v0
    v_lshlrev_b32 v6, 11, v6
    v_bfe_u32 v4, v0, 2, 2
    v_lshl_add_u32 v6, v4, 7, v6
    v_bfe_u32 v4, v0, 4, 1
    v_lshl_add_u32 v6, v4, 6, v6
    v_and_b32 v4, 3, v0
    v_lshl_add_u32 v6, v4, 1, v6
    s_lshl_b32 s47, s3, 9
    s_add_u32 s47, s47, 147456
    v_add_u32 v6, s47, v6
    v_add_u32 v7, 147456, v2
    v_lshrrev_b32 v4, 4, v0
    v_lshlrev_b32 v8, 5, v4
    v_and_b32 v4, 1, v0
    v_lshl_add_u32 v8, v4, 4, v8
    v_bfe_u32 v4, v0, 1, 2
    v_lshl_add_u32 v10, v4, 14, v8
    v_lshl_add_u32 v8, v4, 7, v8
    s_mul_i32 s67, s3, 2560
    s_add_u32 s67, s67, 151552
    v_add_u32 v11, s67, v2
    s_waitcnt lgkmcnt(0)
    s_barrier
    s_mov_b32 s50, 0
    s_mul_i32 s51, s3, 2560
    s_add_u32 s51, s51, 80560128
    s_lshl_b32 s52, s2, 13
    s_lshl_b32 s56, s2, 2
    s_add_u32 s56, s56, s3
    s_lshl_b32 s53, s56, 9
    s_add_u32 s54, s53, 85422080
    s_add_u32 s55, s53, 89616384
    s_lshl_b32 s53, s56, 7
    s_add_u32 s53, s53, 81225728
    s_lshl_b32 s58, s3, 11
    s_lshl_b32 s57, s3, 9
    v_add_u32 v175, s57, v7
chain_hstep:
    s_and_b32 s45, s50, 3
    s_cmp_lg_u32 s45, 0
    s_cbranch_scc1 chain_hkvok
    s_lshl_b32 s45, s50, 5
    s_add_u32 s45, s45, 122908672
    v_mov_b32 v13, 0
    s_mov_b32 s66, 0
wt_1:
    s_add_u32 s66, s66, 1
    s_cmp_gt_u32 s66, 0x40000
    s_cbranch_scc1 chain_end
    buffer_load_dword v12, v13, s[4:7], s45 offen sc1
    s_waitcnt vmcnt(0)
    v_cmp_gt_u32 vcc, 64, v12
    s_cbranch_vccnz wt_1
chain_hkvok:
    s_add_u32 s45, s52, 47005696
    s_add_u32 s46, s45, 4096
    buffer_load_dwordx4 v[92:95], v1, s[4:7], s45 offen offset:0
    buffer_load_dwordx4 v[96:99], v1, s[4:7], s45 offen offset:1024
    buffer_load_dwordx4 v[100:103], v1, s[4:7], s45 offen offset:2048
    buffer_load_dwordx4 v[104:107], v1, s[4:7], s45 offen offset:3072
    buffer_load_dwordx4 v[108:111], v1, s[4:7], s46 offen offset:0
    buffer_load_dwordx4 v[112:115], v1, s[4:7], s46 offen offset:1024
    buffer_load_dwordx4 v[116:119], v1, s[4:7], s46 offen offset:2048
    buffer_load_dwordx4 v[120:123], v1, s[4:7], s46 offen offset:3072
    s_add_u32 s45, s52, s58
    s_add_u32 s45, s45, 63782912
    buffer_load_dwordx4 v[124:127], v1, s[4:7], s45 offen
    buffer_load_dwordx4 v[128:131], v1, s[4:7], s45 offen offset:1024
    v_mov_b32 v68, 0
    v_mov_b32 v69, 0
    v_mov_b32 v70, 0
    v_mov_b32 v71, 0
    v_mov_b32 v72, 0
    v_mov_b32 v73, 0
    v_mov_b32 v74, 0
    v_mov_b32 v75, 0
    v_mov_b32 v76, 0
    v_mov_b32 v77, 0
    v_mov_b32 v78, 0
    v_mov_b32 v79, 0
    v_mov_b32 v80, 0
    v_mov_b32 v81, 0
    v_mov_b32 v82, 0
    v_mov_b32 v83, 0
    v_mov_b32 v84, 0
    v_mov_b32 v85, 0
    v_mov_b32 v86, 0
    v_mov_b32 v87, 0
    v_mov_b32 v88, 0
    v_mov_b32 v89, 0
    v_mov_b32 v90, 0
    v_mov_b32 v91, 0
    s_cmp_eq_u32 s50, 0
    s_cbranch_scc1 chain_hnosleep
    s_sleep 45
chain_hnosleep:
    s_mov_b32 s66, 0
chain_hpoll:
    s_add_u32 s66, s66, 1
    s_cmp_gt_u32 s66, 0x20000
    s_cbranch_scc1 chain_end
    buffer_load_dwordx4 v[12:15], v8, s[4:7], s51 offen offset:0 sc1
    buffer_load_dwordx4 v[16:19], v8, s[4:7], s51 offen offset:512 sc1
    buffer_load_dwordx4 v[20:23], v8, s[4:7], s51 offen offset:1024 sc1
    buffer_load_dwordx4 v[24:27], v8, s[4:7], s51 offen offset:1536 sc1
    buffer_load_dwordx4 v[28:31], v8, s[4:7], s51 offen offset:2048 sc1
    s_waitcnt vmcnt(0)
    v_max3_u32 v4, v12, v13, v14
    v_max3_u32 v4, v4, v15, v16
    v_max3_u32 v4, v4, v17, v18
    v_max3_u32 v4, v4, v19, v20
    v_max3_u32 v4, v4, v21, v22
    v_max3_u32 v4, v4, v23, v24
    v_max3_u32 v4, v4, v25, v26
    v_max3_u32 v4, v4, v27, v28
    v_max3_u32 v4, v4, v29, v30
    v_max_u32 v4, v4, v31
    v_cmp_eq_u32 vcc, -1, v4
    s_cbranch_vccnz chain_hpoll
    ds_write_b128 v11, v[12:15] offset:0
    ds_write_b128 v11, v[16:19] offset:512
    ds_write_b128 v11, v[20:23] offset:1024
    ds_write_b128 v11, v[24:27] offset:1536
    ds_write_b128 v11, v[28:31] offset:2048
    s_waitcnt lgkmcnt(0)
    s_barrier
    ds_read_b128 v[56:59], v3 offset:0
    ds_read_b128 v[60:63], v3 offset:1024
    ds_read_b128 v[32:35], v5 offset:0
    ds_read_b128 v[36:39], v5 offset:1024
    ds_read_b128 v[40:43], v5 offset:2048
    ds_read_b128 v[44:47], v5 offset:3072
    s_waitcnt lgkmcnt(5)
    ds_read_b128 v[64:67], v3 offset:2048
    v_smfmac_f32_16x16x64_bf16 v[68:71], v[56:59], a[0:7], v9
    v_smfmac_f32_16x16x64_bf16 v[72:75], v[56:59], a[80:87], v9
    v_smfmac_f32_16x16x64_bf16 v[76:79], v[56:59], a[160:167], v9
    s_waitcnt lgkmcnt(3)
    v_smfmac_f32_16x16x64_bf16 v[80:83], v[56:59], v[32:39], v9
    ds_read_b128 v[48:51], v5 offset:20480
    ds_read_b128 v[52:55], v5 offset:21504
    s_waitcnt lgkmcnt(7)
    ds_read_b128 v[56:59], v3 offset:3072
    v_smfmac_f32_16x16x64_bf16 v[68:71], v[60:63], a[8:15], v9
    v_smfmac_f32_16x16x64_bf16 v[72:75], v[60:63], a[88:95], v9
    v_smfmac_f32_16x16x64_bf16 v[76:79], v[60:63], a[168:175], v9
    s_waitcnt lgkmcnt(4)
    v_smfmac_f32_16x16x64_bf16 v[80:83], v[60:63], v[40:47], v9
    ds_read_b128 v[32:35], v5 offset:4096
    ds_read_b128 v[36:39], v5 offset:5120
    s_waitcnt lgkmcnt(5)
    ds_read_b128 v[60:63], v3 offset:4096
    v_smfmac_f32_16x16x64_bf16 v[68:71], v[64:67], a[16:23], v9
    v_smfmac_f32_16x16x64_bf16 v[72:75], v[64:67], a[96:103], v9
    s_waitcnt lgkmcnt(4)
    v_smfmac_f32_16x16x64_bf16 v[76:79], v[64:67], v[48:55], v9
    ds_read_b128 v[40:43], v5 offset:22528
    ds_read_b128 v[44:47], v5 offset:23552
    s_waitcnt lgkmcnt(3)
    v_smfmac_f32_16x16x64_bf16 v[80:83], v[64:67], v[32:39], v9
    ds_read_b128 v[48:51], v5 offset:6144
    ds_read_b128 v[52:55], v5 offset:7168
    s_waitcnt lgkmcnt(7)
    ds_read_b128 v[64:67], v3 offset:5120
    v_smfmac_f32_16x16x64_bf16 v[68:71], v[56:59], a[24:31], v9
    v_smfmac_f32_16x16x64_bf16 v[72:75], v[56:59], a[104:111], v9
    s_waitcnt lgkmcnt(3)
    v_smfmac_f32_16x16x64_bf16 v[76:79], v[56:59], v[40:47], v9
    ds_read_b128 v[32:35], v5 offset:24576
    ds_read_b128 v[36:39], v5 offset:25600
    s_waitcnt lgkmcnt(3)
    v_smfmac_f32_16x16x64_bf16 v[80:83], v[56:59], v[48:55], v9
    ds_read_b128 v[40:43], v5 offset:8192
    ds_read_b128 v[44:47], v5 offset:9216
    s_waitcnt lgkmcnt(9)
    ds_read_b128 v[56:59], v3 offset:6144
    v_smfmac_f32_16x16x64_bf16 v[68:71], v[60:63], a[32:39], v9
    v_smfmac_f32_16x16x64_bf16 v[72:75], v[60:63], a[112:119], v9
    s_waitcnt lgkmcnt(3)
    v_smfmac_f32_16x16x64_bf16 v[76:79], v[60:63], v[32:39], v9
    ds_read_b128 v[48:51], v5 offset:26624
    ds_read_b128 v[52:55], v5 offset:27648
    s_waitcnt lgkmcnt(3)
    v_smfmac_f32_16x16x64_bf16 v[80:83], v[60:63], v[40:47], v9
    ds_read_b128 v[32:35], v5 offset:10240
    ds_read_b128 v[36:39], v5 offset:11264
    s_waitcnt lgkmcnt(9)
    ds_read_b128 v[60:63], v3 offset:7168
    v_smfmac_f32_16x16x64_bf16 v[68:71], v[64:67], a[40:47], v9
    v_smfmac_f32_16x16x64_bf16 v[72:75], v[64:67], a[120:127], v9
    s_waitcnt lgkmcnt(3)
    v_smfmac_f32_16x16x64_bf16 v[76:79], v[64:67], v[48:55], v9
    ds_read_b128 v[40:43], v5 offset:28672
    ds_read_b128 v[44:47], v5 offset:29696
    s_waitcnt lgkmcnt(3)
    v_smfmac_f32_16x16x64_bf16 v[80:83], v[64:67], v[32:39], v9
    ds_read_b128 v[48:51], v5 offset:12288
    ds_read_b128 v[52:55], v5 offset:13312
    s_waitcnt lgkmcnt(9)
    ds_read_b128 v[64:67], v3 offset:8192
    v_smfmac_f32_16x16x64_bf16 v[68:71], v[56:59], a[48:55], v9
    v_smfmac_f32_16x16x64_bf16 v[72:75], v[56:59], a[128:135], v9
    s_waitcnt lgkmcnt(3)
    v_smfmac_f32_16x16x64_bf16 v[76:79], v[56:59], v[40:47], v9
    ds_read_b128 v[32:35], v5 offset:30720
    ds_read_b128 v[36:39], v5 offset:31744
    s_waitcnt lgkmcnt(3)
    v_smfmac_f32_16x16x64_bf16 v[80:83], v[56:59], v[48:55], v9
    ds_read_b128 v[40:43], v5 offset:14336
    ds_read_b128 v[44:47], v5 offset:15360
    s_waitcnt lgkmcnt(9)
    ds_read_b128 v[56:59], v3 offset:9216
    v_smfmac_f32_16x16x64_bf16 v[68:71], v[60:63], a[56:63], v9
    v_smfmac_f32_16x16x64_bf16 v[72:75], v[60:63], a[136:143], v9
    s_waitcnt lgkmcnt(3)
    v_smfmac_f32_16x16x64_bf16 v[76:79], v[60:63], v[32:39], v9
    ds_read_b128 v[48:51], v5 offset:32768
    ds_read_b128 v[52:55], v5 offset:33792
    s_waitcnt lgkmcnt(3)
    v_smfmac_f32_16x16x64_bf16 v[80:83], v[60:63], v[40:47], v9
    ds_read_b128 v[32:35], v5 offset:16384
    ds_read_b128 v[36:39], v5 offset:17408
    s_waitcnt lgkmcnt(9)
    v_smfmac_f32_16x16x64_bf16 v[68:71], v[64:67], a[64:71], v9
    v_smfmac_f32_16x16x64_bf16 v[72:75], v[64:67], a[144:151], v9
    s_waitcnt lgkmcnt(2)
    v_smfmac_f32_16x16x64_bf16 v[76:79], v[64:67], v[48:55], v9
    ds_read_b128 v[40:43], v5 offset:34816
    ds_read_b128 v[44:47], v5 offset:35840
    s_waitcnt lgkmcnt(2)
    v_smfmac_f32_16x16x64_bf16 v[80:83], v[64:67], v[32:39], v9
    ds_read_b128 v[48:51], v5 offset:18432
    ds_read_b128 v[52:55], v5 offset:19456
    s_waitcnt lgkmcnt(8)
    v_smfmac_f32_16x16x64_bf16 v[68:71], v[56:59], a[72:79], v9
    v_smfmac_f32_16x16x64_bf16 v[72:75], v[56:59], a[152:159], v9
    s_waitcnt lgkmcnt(2)
    v_smfmac_f32_16x16x64_bf16 v[76:79], v[56:59], v[40:47], v9
    s_waitcnt lgkmcnt(0)
    v_smfmac_f32_16x16x64_bf16 v[80:83], v[56:59], v[48:55], v9
    ds_read_b128 v[56:59], v3 offset:0
    ds_read_b128 v[60:63], v3 offset:1024
    s_waitcnt lgkmcnt(1)
    ds_read_b128 v[64:67], v3 offset:2048
    v_smfmac_f32_16x16x64_bf16 v[84:87], v[56:59], a[176:183], v9
    s_nop 7
    v_permlane32_swap_b32 v68, v76
    v_permlane32_swap_b32 v69, v77
    v_permlane32_swap_b32 v70, v78
    v_permlane32_swap_b32 v71, v79
    v_permlane32_swap_b32 v72, v80
    v_permlane32_swap_b32 v73, v81
    v_permlane32_swap_b32 v74, v82
    v_smfmac_f32_16x16x64_bf16 v[88:91], v[56:59], v[176:183], v9
    v_permlane32_swap_b32 v75, v83
    s_nop 0
    v_add_f32 v68, v68, v76
    v_add_f32 v69, v69, v77
    v_add_f32 v70, v70, v78
    v_add_f32 v71, v71, v79
    v_add_f32 v72, v72, v80
    v_add_f32 v73, v73, v81
    s_waitcnt lgkmcnt(1)
    ds_read_b128 v[56:59], v3 offset:3072
    v_smfmac_f32_16x16x64_bf16 v[84:87], v[60:63], a[184:191], v9
    v_add_f32 v74, v74, v82
    v_add_f32 v75, v75, v83
    v_cvt_pk_bf16_f32 v76, v68, v69
    v_cvt_pk_bf16_f32 v77, v70, v71
    v_cvt_pk_bf16_f32 v78, v72, v73
    v_cvt_pk_bf16_f32 v79, v74, v75
    ds_write_b16 v6, v76 offset:0
    ds_write_b16_d16_hi v6, v76 offset:16
    v_smfmac_f32_16x16x64_bf16 v[88:91], v[60:63], v[184:191], v9
    ds_write_b16 v6, v77 offset:32
    ds_write_b16_d16_hi v6, v77 offset:48
    ds_write_b16 v6, v78 offset:8
    ds_write_b16_d16_hi v6, v78 offset:24
    ds_write_b16 v6, v79 offset:40
    ds_write_b16_d16_hi v6, v79 offset:56
    s_waitcnt lgkmcnt(0)
    s_barrier
    s_waitcnt lgkmcnt(9)
    ds_read_b128 v[60:63], v3 offset:4096
    v_smfmac_f32_16x16x64_bf16 v[84:87], v[64:67], a[192:199], v9
    ds_read_b128 v[132:135], v7 offset:0
    ds_read_b128 v[148:151], v7 offset:2048
    ds_read_b128 v[136:139], v7 offset:512
    ds_read_b128 v[152:155], v7 offset:2560
    ds_read_b128 v[140:143], v7 offset:1024
    ds_read_b128 v[156:159], v7 offset:3072
    ds_read_b128 v[144:147], v7 offset:1536
    ds_read_b128 v[160:163], v7 offset:3584
    v_smfmac_f32_16x16x64_bf16 v[88:91], v[64:67], v[192:199], v9
    ds_read_b128 v[164:167], v175 offset:2048
    s_waitcnt lgkmcnt(0)
    v_mfma_f32_16x16x32_bf16 v[12:15], v[148:151], v[132:135], 0
    v_mfma_f32_16x16x32_bf16 v[16:19], v[92:95], v[132:135], 0
    v_mfma_f32_16x16x32_bf16 v[20:23], v[108:111], v[132:135], 0
    v_mfma_f32_16x16x32_bf16 v[12:15], v[152:155], v[136:139], v[12:15]
    v_mfma_f32_16x16x32_bf16 v[16:19], v[96:99], v[136:139], v[16:19]
    v_mfma_f32_16x16x32_bf16 v[20:23], v[112:115], v[136:139], v[20:23]
    s_waitcnt lgkmcnt(15)
    ds_read_b128 v[64:67], v3 offset:5120
    v_smfmac_f32_16x16x64_bf16 v[84:87], v[56:59], a[200:207], v9
    v_mfma_f32_16x16x32_bf16 v[12:15], v[156:159], v[140:143], v[12:15]
    v_mfma_f32_16x16x32_bf16 v[16:19], v[100:103], v[140:143], v[16:19]
    v_mfma_f32_16x16x32_bf16 v[20:23], v[116:119], v[140:143], v[20:23]
    v_mfma_f32_16x16x32_bf16 v[12:15], v[160:163], v[144:147], v[12:15]
    v_mfma_f32_16x16x32_bf16 v[16:19], v[104:107], v[144:147], v[16:19]
    v_mfma_f32_16x16x32_bf16 v[20:23], v[120:123], v[144:147], v[20:23]
    s_nop 7
    v_cvt_pk_bf16_f32 v12, v12, v13
    v_smfmac_f32_16x16x64_bf16 v[88:91], v[56:59], v[200:207], v9
    v_and_b32 v13, 0xffff0000, v12
    v_lshlrev_b32 v12, 16, v12
    v_mul_f32 v12, 0x3db504f3, v12
    v_mul_f32 v13, 0x3db504f3, v13
    v_cvt_pk_bf16_f32 v12, v12, v13
    v_and_b32 v13, 0xffff0000, v12
    v_lshlrev_b32 v12, 16, v12
    v_cvt_pk_bf16_f32 v14, v14, v15
    s_waitcnt lgkmcnt(10)
    ds_read_b128 v[56:59], v3 offset:6144
    v_smfmac_f32_16x16x64_bf16 v[84:87], v[60:63], a[208:215], v9
    v_and_b32 v15, 0xffff0000, v14
    v_lshlrev_b32 v14, 16, v14
    v_mul_f32 v14, 0x3db504f3, v14
    v_mul_f32 v15, 0x3db504f3, v15
    v_cvt_pk_bf16_f32 v14, v14, v15
    v_and_b32 v15, 0xffff0000, v14
    v_lshlrev_b32 v14, 16, v14
    v_cvt_pk_bf16_f32 v16, v16, v17
    v_smfmac_f32_16x16x64_bf16 v[88:91], v[60:63], v[208:215], v9
    v_and_b32 v17, 0xffff0000, v16
    v_lshlrev_b32 v16, 16, v16
    v_mul_f32 v16, 0x3db504f3, v16
    v_mul_f32 v17, 0x3db504f3, v17
    v_cvt_pk_bf16_f32 v16, v16, v17
    v_and_b32 v17, 0xffff0000, v16
    v_lshlrev_b32 v16, 16, v16
    v_cvt_pk_bf16_f32 v18, v18, v19
    s_waitcnt lgkmcnt(1)
    ds_read_b128 v[60:63], v3 offset:7168
    v_smfmac_f32_16x16x64_bf16 v[84:87], v[64:67], a[216:223], v9
    v_and_b32 v19, 0xffff0000, v18
    v_lshlrev_b32 v18, 16, v18
    v_mul_f32 v18, 0x3db504f3, v18
    v_mul_f32 v19, 0x3db504f3, v19
    v_cvt_pk_bf16_f32 v18, v18, v19
    v_and_b32 v19, 0xffff0000, v18
    v_lshlrev_b32 v18, 16, v18
    v_cvt_pk_bf16_f32 v20, v20, v21
    v_smfmac_f32_16x16x64_bf16 v[88:91], v[64:67], v[216:223], v9
    v_and_b32 v21, 0xffff0000, v20
    v_lshlrev_b32 v20, 16, v20
    v_mul_f32 v20, 0x3db504f3, v20
    v_mul_f32 v21, 0x3db504f3, v21
    v_cvt_pk_bf16_f32 v20, v20, v21
    v_and_b32 v21, 0xffff0000, v20
    v_lshlrev_b32 v20, 16, v20
    v_cvt_pk_bf16_f32 v22, v22, v23
    s_waitcnt lgkmcnt(1)
    ds_read_b128 v[64:67], v3 offset:8192
    v_smfmac_f32_16x16x64_bf16 v[84:87], v[56:59], a[224:231], v9
    v_and_b32 v23, 0xffff0000, v22
    v_lshlrev_b32 v22, 16, v22
    v_mul_f32 v22, 0x3db504f3, v22
    v_mul_f32 v23, 0x3db504f3, v23
    v_cvt_pk_bf16_f32 v22, v22, v23
    v_and_b32 v23, 0xffff0000, v22
    v_lshlrev_b32 v22, 16, v22
    v_mov_b32 v30, 0xff800000
    v_smfmac_f32_16x16x64_bf16 v[88:91], v[56:59], v[224:231], v9
    v_cndmask_b32 v12, v30, v12, s[62:63]
    v_cndmask_b32 v13, v30, v13, s[62:63]
    v_cndmask_b32 v14, v30, v14, s[62:63]
    v_cndmask_b32 v15, v30, v15, s[62:63]
    v_max3_f32 v30, v12, v13, v14
    v_max3_f32 v30, v30, v15, v16
    v_max3_f32 v30, v30, v17, v18
    v_max3_f32 v30, v30, v19, v20
    s_waitcnt lgkmcnt(1)
    ds_read_b128 v[56:59], v3 offset:9216
    v_smfmac_f32_16x16x64_bf16 v[84:87], v[60:63], a[232:239], v9
    v_max3_f32 v30, v30, v21, v22
    v_max_f32 v30, v30, v23
    v_mov_b32 v31, v30
    s_nop 1
    v_permlane16_swap_b32 v30, v31
    s_nop 0
    v_max_f32 v30, v30, v31
    v_mov_b32 v31, v30
    v_smfmac_f32_16x16x64_bf16 v[88:91], v[60:63], v[232:239], v9
    s_nop 1
    v_permlane32_swap_b32 v30, v31
    s_nop 0
    v_max_f32 v30, v30, v31
    v_sub_f32 v12, v12, v30
    v_sub_f32 v13, v13, v30
    v_sub_f32 v14, v14, v30
    v_sub_f32 v15, v15, v30
    s_waitcnt lgkmcnt(1)
    v_smfmac_f32_16x16x64_bf16 v[84:87], v[64:67], a[240:247], v9
    v_sub_f32 v16, v16, v30
    v_sub_f32 v17, v17, v30
    v_sub_f32 v18, v18, v30
    v_sub_f32 v19, v19, v30
    v_sub_f32 v20, v20, v30
    v_sub_f32 v21, v21, v30
    v_sub_f32 v22, v22, v30
    v_sub_f32 v23, v23, v30
    v_smfmac_f32_16x16x64_bf16 v[88:91], v[64:67], v[240:247], v9
    v_mul_f32 v12, 0x3fb8aa3b, v12
    v_mul_f32 v13, 0x3fb8aa3b, v13
    v_mul_f32 v14, 0x3fb8aa3b, v14
    v_mul_f32 v15, 0x3fb8aa3b, v15
    v_mul_f32 v16, 0x3fb8aa3b, v16
    v_mul_f32 v17, 0x3fb8aa3b, v17
    v_mul_f32 v18, 0x3fb8aa3b, v18
    v_mul_f32 v19, 0x3fb8aa3b, v19
    s_waitcnt lgkmcnt(0)
    v_smfmac_f32_16x16x64_bf16 v[84:87], v[56:59], a[248:255], v9
    v_mul_f32 v20, 0x3fb8aa3b, v20
    v_mul_f32 v21, 0x3fb8aa3b, v21
    v_mul_f32 v22, 0x3fb8aa3b, v22
    v_mul_f32 v23, 0x3fb8aa3b, v23
    v_exp_f32 v12, v12
    v_exp_f32 v13, v13
    v_exp_f32 v14, v14
    v_exp_f32 v15, v15
    v_smfmac_f32_16x16x64_bf16 v[88:91], v[56:59], v[248:255], v9
    v_exp_f32 v16, v16
    v_exp_f32 v17, v17
    v_exp_f32 v18, v18
    v_exp_f32 v19, v19
    v_exp_f32 v20, v20
    v_exp_f32 v21, v21
    v_exp_f32 v22, v22
    v_exp_f32 v23, v23
    s_nop 0
    v_add_f32 v30, v12, v13
    v_add_f32 v30, v30, v14
    v_add_f32 v30, v30, v15
    v_add_f32 v30, v30, v16
    v_add_f32 v30, v30, v17
    v_add_f32 v30, v30, v18
    v_add_f32 v30, v30, v19
    v_add_f32 v30, v30, v20
    v_add_f32 v30, v30, v21
    v_add_f32 v30, v30, v22
    v_add_f32 v30, v30, v23
    v_mov_b32 v31, v30
    s_nop 1
    v_permlane16_swap_b32 v30, v31
    s_nop 0
    v_add_f32 v30, v30, v31
    v_mov_b32 v31, v30
    s_nop 1
    v_permlane32_swap_b32 v30, v31
    s_nop 0
    v_add_f32 v30, v30, v31
    v_rcp_f32 v30, v30
    s_nop 0
    v_mul_f32 v12, v12, v30
    v_mul_f32 v13, v13, v30
    v_mul_f32 v14, v14, v30
    v_mul_f32 v15, v15, v30
    v_mul_f32 v16, v16, v30
    v_mul_f32 v17, v17, v30
    v_mul_f32 v18, v18, v30
    v_mul_f32 v19, v19, v30
    v_mul_f32 v20, v20, v30
    v_mul_f32 v21, v21, v30
    v_mul_f32 v22, v22, v30
    v_mul_f32 v23, v23, v30
    v_cvt_pk_bf16_f32 v24, v12, v13
    v_cvt_pk_bf16_f32 v25, v14, v15
    v_cvt_pk_bf16_f32 v26, v16, v17
    v_cvt_pk_bf16_f32 v27, v18, v19
    v_cvt_pk_bf16_f32 v28, v20, v21
    v_cvt_pk_bf16_f32 v29, v22, v23
    s_nop 7
    v_mov_b32 v68, v84
    v_mov_b32 v69, v85
    v_mov_b32 v70, v86
    v_mov_b32 v71, v87
    v_mov_b32 v72, v88
    v_mov_b32 v73, v89
    v_mov_b32 v74, v90
    v_mov_b32 v75, v91
    s_nop 1
    v_permlane32_swap_b32 v84, v68
    v_permlane32_swap_b32 v85, v69
    v_permlane32_swap_b32 v86, v70
    v_permlane32_swap_b32 v87, v71
    v_permlane32_swap_b32 v88, v72
    v_permlane32_swap_b32 v89, v73
    v_permlane32_swap_b32 v90, v74
    v_permlane32_swap_b32 v91, v75
    s_nop 0
    v_add_f32 v84, v84, v68
    v_add_f32 v85, v85, v69
    v_add_f32 v86, v86, v70
    v_add_f32 v87, v87, v71
    v_add_f32 v88, v88, v72
    v_add_f32 v89, v89, v73
    v_add_f32 v90, v90, v74
    v_add_f32 v91, v91, v75
    v_cvt_pk_bf16_f32 v68, v84, v85
    v_cvt_pk_bf16_f32 v69, v86, v87
    v_cvt_pk_bf16_f32 v70, v88, v89
    v_cvt_pk_bf16_f32 v71, v90, v91
    v_mfma_f32_16x16x32_bf16 v[76:79], v[124:127], v[26:29], 0
    v_mfma_f32_16x16x32_bf16 v[80:83], v[128:131], v[26:29], 0
    v_mfma_f32_16x16x16_bf16 v[76:79], v[68:69], v[24:25], v[76:79]
    v_mfma_f32_16x16x16_bf16 v[80:83], v[70:71], v[24:25], v[80:83]
    s_nop 7
    v_cvt_pk_bf16_f32 v132, v76, v77
    v_cvt_pk_bf16_f32 v133, v78, v79
    v_cvt_pk_bf16_f32 v134, v80, v81
    v_cvt_pk_bf16_f32 v135, v82, v83
    v_min_u32 v132, -2, v132
    v_min_u32 v133, -2, v133
    v_min_u32 v134, -2, v134
    v_min_u32 v135, -2, v135
    s_mov_b64 exec, s[60:61]
    buffer_store_dwordx4 v[132:135], v10, s[4:7], s53 offen sc1
    buffer_store_dwordx4 v[164:167], v2, s[4:7], s54 offen sc1
    s_mov_b64 exec, -1
    s_mov_b64 exec, s[62:63]
    v_lshlrev_b32 v4, 3, v0
    buffer_store_dwordx2 v[68:69], v4, s[4:7], s55 offen sc1
    buffer_store_dwordx2 v[70:71], v4, s[4:7], s55 offen offset:256 sc1
    s_mov_b64 exec, -1
    s_cmp_lg_u32 s50, 63
    s_cbranch_scc1 chain_hnosig
    s_lshr_b32 s45, s50, 2
    s_lshl_b32 s45, s45, 9
    s_lshl_b32 s46, s56, 2
    s_add_u32 s45, s45, s46
    s_add_u32 s45, s45, 122916864
    s_waitcnt vmcnt(0)
    s_mov_b64 exec, 1
    v_mov_b32 v4, 1
    buffer_store_dword v4, v1, s[4:7], s45 offen sc1
    s_mov_b64 exec, -1
chain_hnosig:
    s_add_u32 s50, s50, 1
    s_add_u32 s51, s51, 10240
    s_add_u32 s52, s52, 262144
    s_add_u32 s53, s53, 65536
    s_add_u32 s54, s54, 65536
    s_add_u32 s55, s55, 65536
    s_cmp_lt_u32 s50, 64
    s_cbranch_scc1 chain_hstep
    s_branch chain_end
chain_wo:
    s_sub_u32 s44, s2, 32
    s_and_b32 s59, s44, 3
    s_lshr_b32 s44, s44, 2
    s_lshr_b32 s47, s44, 1
    s_lshl_b32 s47, s47, 7
    s_lshl_b32 s46, s3, 5
    s_add_u32 s47, s47, s46
    s_lshl_b32 s47, s47, 12
    s_and_b32 s46, s44, 1
    s_lshl_b32 s46, s46, 11
    s_add_u32 s47, s47, s46
    s_add_u32 s47, s47, 18350080
    s_mul_i32 s47, s3, 1310720
    s_lshl_b32 s45, s44, 6
    s_add_u32 s47, s47, s45
    s_mul_i32 s48, s3, 2560
    v_lshrrev_b32 v4, 2, v0
    s_mov_b32 s45, 1280
    v_mul_lo_u32 v6, v4, s45
    v_and_b32 v7, 3, v0
    v_lshl_add_u32 v6, v7, 4, v6
    v_mul_u32_u24 v4, 80, v4
    v_lshl_add_u32 v7, v7, 4, v4
    v_add_u32 v7, s48, v7
    v_bfe_u32 v4, v0, 4, 1
    v_lshlrev_b32 v8, 4, v4
    v_lshrrev_b32 v4, 5, v0
    v_lshl_add_u32 v8, v4, 2, v8
    v_bfe_u32 v4, v0, 2, 2
    v_add_u32 v8, v8, v4
    v_mul_u32_u24 v8, 80, v8
    v_and_b32 v4, 3, v0
    v_lshl_add_u32 v8, v4, 3, v8
    v_add_u32 v8, s48, v8
    s_mov_b32 s8, s26
    s_and_b32 s9, s27, 0xffff
    s_mov_b32 s10, 0x500000
    s_mov_b32 s11, 0x00020000
    s_add_u32 s45, s47, 0
    buffer_load_dwordx4 v[12:15], v6, s[8:11], s45 offen
    s_add_u32 s45, s47, 20480
    buffer_load_dwordx4 v[16:19], v6, s[8:11], s45 offen
    s_add_u32 s45, s47, 40960
    buffer_load_dwordx4 v[20:23], v6, s[8:11], s45 offen
    s_add_u32 s45, s47, 61440
    buffer_load_dwordx4 v[24:27], v6, s[8:11], s45 offen
    s_add_u32 s45, s47, 81920
    buffer_load_dwordx4 v[28:31], v6, s[8:11], s45 offen
    s_add_u32 s45, s47, 102400
    buffer_load_dwordx4 v[32:35], v6, s[8:11], s45 offen
    s_add_u32 s45, s47, 122880
    buffer_load_dwordx4 v[36:39], v6, s[8:11], s45 offen
    s_add_u32 s45, s47, 143360
    buffer_load_dwordx4 v[40:43], v6, s[8:11], s45 offen
    s_add_u32 s45, s47, 163840
    buffer_load_dwordx4 v[44:47], v6, s[8:11], s45 offen
    s_add_u32 s45, s47, 184320
    buffer_load_dwordx4 v[48:51], v6, s[8:11], s45 offen
    s_add_u32 s45, s47, 204800
    buffer_load_dwordx4 v[52:55], v6, s[8:11], s45 offen
    s_add_u32 s45, s47, 225280
    buffer_load_dwordx4 v[56:59], v6, s[8:11], s45 offen
    s_add_u32 s45, s47, 245760
    buffer_load_dwordx4 v[60:63], v6, s[8:11], s45 offen
    s_add_u32 s45, s47, 266240
    buffer_load_dwordx4 v[64:67], v6, s[8:11], s45 offen
    s_add_u32 s45, s47, 286720
    buffer_load_dwordx4 v[68:71], v6, s[8:11], s45 offen
    s_add_u32 s45, s47, 307200
    buffer_load_dwordx4 v[72:75], v6, s[8:11], s45 offen
    s_add_u32 s45, s47, 327680
    buffer_load_dwordx4 v[76:79], v6, s[8:11], s45 offen
    s_add_u32 s45, s47, 348160
    buffer_load_dwordx4 v[80:83], v6, s[8:11], s45 offen
    s_add_u32 s45, s47, 368640
    buffer_load_dwordx4 v[84:87], v6, s[8:11], s45 offen
    s_add_u32 s45, s47, 389120
    buffer_load_dwordx4 v[88:91], v6, s[8:11], s45 offen
    s_add_u32 s45, s47, 409600
    buffer_load_dwordx4 v[92:95], v6, s[8:11], s45 offen
    s_add_u32 s45, s47, 430080
    buffer_load_dwordx4 v[96:99], v6, s[8:11], s45 offen
    s_add_u32 s45, s47, 450560
    buffer_load_dwordx4 v[100:103], v6, s[8:11], s45 offen
    s_add_u32 s45, s47, 471040
    buffer_load_dwordx4 v[104:107], v6, s[8:11], s45 offen
    s_add_u32 s45, s47, 491520
    buffer_load_dwordx4 v[108:111], v6, s[8:11], s45 offen
    s_add_u32 s45, s47, 512000
    buffer_load_dwordx4 v[112:115], v6, s[8:11], s45 offen
    s_add_u32 s45, s47, 532480
    buffer_load_dwordx4 v[116:119], v6, s[8:11], s45 offen
    s_add_u32 s45, s47, 552960
    buffer_load_dwordx4 v[120:123], v6, s[8:11], s45 offen
    s_waitcnt vmcnt(26)
    ds_write_b128 v7, v[12:15] offset:0
    ds_write_b128 v7, v[16:19] offset:1280
    ds_read_b64_tr_b16 v[124:125], v8 offset:0
    ds_read_b64_tr_b16 v[128:129], v8 offset:640
    ds_read_b64_tr_b16 v[132:133], v8 offset:32
    ds_read_b64_tr_b16 v[136:137], v8 offset:672
    s_add_u32 s45, s47, 573440
    buffer_load_dwordx4 v[12:15], v6, s[8:11], s45 offen
    s_add_u32 s45, s47, 593920
    buffer_load_dwordx4 v[16:19], v6, s[8:11], s45 offen
    s_waitcnt vmcnt(26)
    ds_write_b128 v7, v[20:23] offset:0
    ds_write_b128 v7, v[24:27] offset:1280
    ds_read_b64_tr_b16 v[126:127], v8 offset:0
    ds_read_b64_tr_b16 v[130:131], v8 offset:640
    ds_read_b64_tr_b16 v[134:135], v8 offset:32
    ds_read_b64_tr_b16 v[138:139], v8 offset:672
    s_waitcnt lgkmcnt(0)
    v_accvgpr_write_b32 a0, v124
    v_accvgpr_write_b32 a1, v126
    v_accvgpr_write_b32 a2, v125
    v_accvgpr_write_b32 a3, v127
    v_accvgpr_write_b32 a4, v128
    v_accvgpr_write_b32 a5, v130
    v_accvgpr_write_b32 a6, v129
    v_accvgpr_write_b32 a7, v131
    v_accvgpr_write_b32 a8, v132
    v_accvgpr_write_b32 a9, v134
    v_accvgpr_write_b32 a10, v133
    v_accvgpr_write_b32 a11, v135
    v_accvgpr_write_b32 a12, v136
    v_accvgpr_write_b32 a13, v138
    v_accvgpr_write_b32 a14, v137
    v_accvgpr_write_b32 a15, v139
    s_add_u32 s45, s47, 614400
    buffer_load_dwordx4 v[20:23], v6, s[8:11], s45 offen
    s_add_u32 s45, s47, 634880
    buffer_load_dwordx4 v[24:27], v6, s[8:11], s45 offen
    s_waitcnt vmcnt(26)
    ds_write_b128 v7, v[28:31] offset:0
    ds_write_b128 v7, v[32:35] offset:1280
    ds_read_b64_tr_b16 v[124:125], v8 offset:0
    ds_read_b64_tr_b16 v[128:129], v8 offset:640
    ds_read_b64_tr_b16 v[132:133], v8 offset:32
    ds_read_b64_tr_b16 v[136:137], v8 offset:672
    s_add_u32 s45, s47, 655360
    buffer_load_dwordx4 v[28:31], v6, s[8:11], s45 offen
    s_add_u32 s45, s47, 675840
    buffer_load_dwordx4 v[32:35], v6, s[8:11], s45 offen
    s_waitcnt vmcnt(26)
    ds_write_b128 v7, v[36:39] offset:0
    ds_write_b128 v7, v[40:43] offset:1280
    ds_read_b64_tr_b16 v[126:127], v8 offset:0
    ds_read_b64_tr_b16 v[130:131], v8 offset:640
    ds_read_b64_tr_b16 v[134:135], v8 offset:32
    ds_read_b64_tr_b16 v[138:139], v8 offset:672
    s_waitcnt lgkmcnt(0)
    v_accvgpr_write_b32 a16, v124
    v_accvgpr_write_b32 a17, v126
    v_accvgpr_write_b32 a18, v125
    v_accvgpr_write_b32 a19, v127
    v_accvgpr_write_b32 a20, v128
    v_accvgpr_write_b32 a21, v130
    v_accvgpr_write_b32 a22, v129
    v_accvgpr_write_b32 a23, v131
    v_accvgpr_write_b32 a24, v132
    v_accvgpr_write_b32 a25, v134
    v_accvgpr_write_b32 a26, v133
    v_accvgpr_write_b32 a27, v135
    v_accvgpr_write_b32 a28, v136
    v_accvgpr_write_b32 a29, v138
    v_accvgpr_write_b32 a30, v137
    v_accvgpr_write_b32 a31, v139
    s_add_u32 s45, s47, 696320
    buffer_load_dwordx4 v[36:39], v6, s[8:11], s45 offen
    s_add_u32 s45, s47, 716800
    buffer_load_dwordx4 v[40:43], v6, s[8:11], s45 offen
    s_waitcnt vmcnt(26)
    ds_write_b128 v7, v[44:47] offset:0
    ds_write_b128 v7, v[48:51] offset:1280
    ds_read_b64_tr_b16 v[124:125], v8 offset:0
    ds_read_b64_tr_b16 v[128:129], v8 offset:640
    ds_read_b64_tr_b16 v[132:133], v8 offset:32
    ds_read_b64_tr_b16 v[136:137], v8 offset:672
    s_add_u32 s45, s47, 737280
    buffer_load_dwordx4 v[44:47], v6, s[8:11], s45 offen
    s_add_u32 s45, s47, 757760
    buffer_load_dwordx4 v[48:51], v6, s[8:11], s45 offen
    s_waitcnt vmcnt(26)
    ds_write_b128 v7, v[52:55] offset:0
    ds_write_b128 v7, v[56:59] offset:1280
    ds_read_b64_tr_b16 v[126:127], v8 offset:0
    ds_read_b64_tr_b16 v[130:131], v8 offset:640
    ds_read_b64_tr_b16 v[134:135], v8 offset:32
    ds_read_b64_tr_b16 v[138:139], v8 offset:672
    s_waitcnt lgkmcnt(0)
    v_accvgpr_write_b32 a32, v124
    v_accvgpr_write_b32 a33, v126
    v_accvgpr_write_b32 a34, v125
    v_accvgpr_write_b32 a35, v127
    v_accvgpr_write_b32 a36, v128
    v_accvgpr_write_b32 a37, v130
    v_accvgpr_write_b32 a38, v129
    v_accvgpr_write_b32 a39, v131
    v_accvgpr_write_b32 a40, v132
    v_accvgpr_write_b32 a41, v134
    v_accvgpr_write_b32 a42, v133
    v_accvgpr_write_b32 a43, v135
    v_accvgpr_write_b32 a44, v136
    v_accvgpr_write_b32 a45, v138
    v_accvgpr_write_b32 a46, v137
    v_accvgpr_write_b32 a47, v139
    s_add_u32 s45, s47, 778240
    buffer_load_dwordx4 v[52:55], v6, s[8:11], s45 offen
    s_add_u32 s45, s47, 798720
    buffer_load_dwordx4 v[56:59], v6, s[8:11], s45 offen
    s_waitcnt vmcnt(26)
    ds_write_b128 v7, v[60:63] offset:0
    ds_write_b128 v7, v[64:67] offset:1280
    ds_read_b64_tr_b16 v[124:125], v8 offset:0
    ds_read_b64_tr_b16 v[128:129], v8 offset:640
    ds_read_b64_tr_b16 v[132:133], v8 offset:32
    ds_read_b64_tr_b16 v[136:137], v8 offset:672
    s_add_u32 s45, s47, 819200
    buffer_load_dwordx4 v[60:63], v6, s[8:11], s45 offen
    s_add_u32 s45, s47, 839680
    buffer_load_dwordx4 v[64:67], v6, s[8:11], s45 offen
    s_waitcnt vmcnt(26)
    ds_write_b128 v7, v[68:71] offset:0
    ds_write_b128 v7, v[72:75] offset:1280
    ds_read_b64_tr_b16 v[126:127], v8 offset:0
    ds_read_b64_tr_b16 v[130:131], v8 offset:640
    ds_read_b64_tr_b16 v[134:135], v8 offset:32
    ds_read_b64_tr_b16 v[138:139], v8 offset:672
    s_waitcnt lgkmcnt(0)
    v_accvgpr_write_b32 a48, v124
    v_accvgpr_write_b32 a49, v126
    v_accvgpr_write_b32 a50, v125
    v_accvgpr_write_b32 a51, v127
    v_accvgpr_write_b32 a52, v128
    v_accvgpr_write_b32 a53, v130
    v_accvgpr_write_b32 a54, v129
    v_accvgpr_write_b32 a55, v131
    v_accvgpr_write_b32 a56, v132
    v_accvgpr_write_b32 a57, v134
    v_accvgpr_write_b32 a58, v133
    v_accvgpr_write_b32 a59, v135
    v_accvgpr_write_b32 a60, v136
    v_accvgpr_write_b32 a61, v138
    v_accvgpr_write_b32 a62, v137
    v_accvgpr_write_b32 a63, v139
    s_add_u32 s45, s47, 860160
    buffer_load_dwordx4 v[68:71], v6, s[8:11], s45 offen
    s_add_u32 s45, s47, 880640
    buffer_load_dwordx4 v[72:75], v6, s[8:11], s45 offen
    s_waitcnt vmcnt(26)
    ds_write_b128 v7, v[76:79] offset:0
    ds_write_b128 v7, v[80:83] offset:1280
    ds_read_b64_tr_b16 v[124:125], v8 offset:0
    ds_read_b64_tr_b16 v[128:129], v8 offset:640
    ds_read_b64_tr_b16 v[132:133], v8 offset:32
    ds_read_b64_tr_b16 v[136:137], v8 offset:672
    s_add_u32 s45, s47, 901120
    buffer_load_dwordx4 v[76:79], v6, s[8:11], s45 offen
    s_add_u32 s45, s47, 921600
    buffer_load_dwordx4 v[80:83], v6, s[8:11], s45 offen
    s_waitcnt vmcnt(26)
    ds_write_b128 v7, v[84:87] offset:0
    ds_write_b128 v7, v[88:91] offset:1280
    ds_read_b64_tr_b16 v[126:127], v8 offset:0
    ds_read_b64_tr_b16 v[130:131], v8 offset:640
    ds_read_b64_tr_b16 v[134:135], v8 offset:32
    ds_read_b64_tr_b16 v[138:139], v8 offset:672
    s_waitcnt lgkmcnt(0)
    v_accvgpr_write_b32 a64, v124
    v_accvgpr_write_b32 a65, v126
    v_accvgpr_write_b32 a66, v125
    v_accvgpr_write_b32 a67, v127
    v_accvgpr_write_b32 a68, v128
    v_accvgpr_write_b32 a69, v130
    v_accvgpr_write_b32 a70, v129
    v_accvgpr_write_b32 a71, v131
    v_accvgpr_write_b32 a72, v132
    v_accvgpr_write_b32 a73, v134
    v_accvgpr_write_b32 a74, v133
    v_accvgpr_write_b32 a75, v135
    v_accvgpr_write_b32 a76, v136
    v_accvgpr_write_b32 a77, v138
    v_accvgpr_write_b32 a78, v137
    v_accvgpr_write_b32 a79, v139
    s_add_u32 s45, s47, 942080
    buffer_load_dwordx4 v[84:87], v6, s[8:11], s45 offen
    s_add_u32 s45, s47, 962560
    buffer_load_dwordx4 v[88:91], v6, s[8:11], s45 offen
    s_waitcnt vmcnt(26)
    ds_write_b128 v7, v[92:95] offset:0
    ds_write_b128 v7, v[96:99] offset:1280
    ds_read_b64_tr_b16 v[124:125], v8 offset:0
    ds_read_b64_tr_b16 v[128:129], v8 offset:640
    ds_read_b64_tr_b16 v[132:133], v8 offset:32
    ds_read_b64_tr_b16 v[136:137], v8 offset:672
    s_add_u32 s45, s47, 983040
    buffer_load_dwordx4 v[92:95], v6, s[8:11], s45 offen
    s_add_u32 s45, s47, 1003520
    buffer_load_dwordx4 v[96:99], v6, s[8:11], s45 offen
    s_waitcnt vmcnt(26)
    ds_write_b128 v7, v[100:103] offset:0
    ds_write_b128 v7, v[104:107] offset:1280
    ds_read_b64_tr_b16 v[126:127], v8 offset:0
    ds_read_b64_tr_b16 v[130:131], v8 offset:640
    ds_read_b64_tr_b16 v[134:135], v8 offset:32
    ds_read_b64_tr_b16 v[138:139], v8 offset:672
    s_waitcnt lgkmcnt(0)
    v_accvgpr_write_b32 a80, v124
    v_accvgpr_write_b32 a81, v126
    v_accvgpr_write_b32 a82, v125
    v_accvgpr_write_b32 a83, v127
    v_accvgpr_write_b32 a84, v128
    v_accvgpr_write_b32 a85, v130
    v_accvgpr_write_b32 a86, v129
    v_accvgpr_write_b32 a87, v131
    v_accvgpr_write_b32 a88, v132
    v_accvgpr_write_b32 a89, v134
    v_accvgpr_write_b32 a90, v133
    v_accvgpr_write_b32 a91, v135
    v_accvgpr_write_b32 a92, v136
    v_accvgpr_write_b32 a93, v138
    v_accvgpr_write_b32 a94, v137
    v_accvgpr_write_b32 a95, v139
    s_add_u32 s45, s47, 1024000
    buffer_load_dwordx4 v[100:103], v6, s[8:11], s45 offen
    s_add_u32 s45, s47, 1044480
    buffer_load_dwordx4 v[104:107], v6, s[8:11], s45 offen
    s_waitcnt vmcnt(26)
    ds_write_b128 v7, v[108:111] offset:0
    ds_write_b128 v7, v[112:115] offset:1280
    ds_read_b64_tr_b16 v[124:125], v8 offset:0
    ds_read_b64_tr_b16 v[128:129], v8 offset:640
    ds_read_b64_tr_b16 v[132:133], v8 offset:32
    ds_read_b64_tr_b16 v[136:137], v8 offset:672
    s_add_u32 s45, s47, 1064960
    buffer_load_dwordx4 v[108:111], v6, s[8:11], s45 offen
    s_add_u32 s45, s47, 1085440
    buffer_load_dwordx4 v[112:115], v6, s[8:11], s45 offen
    s_waitcnt vmcnt(26)
    ds_write_b128 v7, v[116:119] offset:0
    ds_write_b128 v7, v[120:123] offset:1280
    ds_read_b64_tr_b16 v[126:127], v8 offset:0
    ds_read_b64_tr_b16 v[130:131], v8 offset:640
    ds_read_b64_tr_b16 v[134:135], v8 offset:32
    ds_read_b64_tr_b16 v[138:139], v8 offset:672
    s_waitcnt lgkmcnt(0)
    v_accvgpr_write_b32 a96, v124
    v_accvgpr_write_b32 a97, v126
    v_accvgpr_write_b32 a98, v125
    v_accvgpr_write_b32 a99, v127
    v_accvgpr_write_b32 a100, v128
    v_accvgpr_write_b32 a101, v130
    v_accvgpr_write_b32 a102, v129
    v_accvgpr_write_b32 a103, v131
    v_accvgpr_write_b32 a104, v132
    v_accvgpr_write_b32 a105, v134
    v_accvgpr_write_b32 a106, v133
    v_accvgpr_write_b32 a107, v135
    v_accvgpr_write_b32 a108, v136
    v_accvgpr_write_b32 a109, v138
    v_accvgpr_write_b32 a110, v137
    v_accvgpr_write_b32 a111, v139
    s_add_u32 s45, s47, 1105920
    buffer_load_dwordx4 v[116:119], v6, s[8:11], s45 offen
    s_add_u32 s45, s47, 1126400
    buffer_load_dwordx4 v[120:123], v6, s[8:11], s45 offen
    s_waitcnt vmcnt(26)
    ds_write_b128 v7, v[12:15] offset:0
    ds_write_b128 v7, v[16:19] offset:1280
    ds_read_b64_tr_b16 v[124:125], v8 offset:0
    ds_read_b64_tr_b16 v[128:129], v8 offset:640
    ds_read_b64_tr_b16 v[132:133], v8 offset:32
    ds_read_b64_tr_b16 v[136:137], v8 offset:672
    s_add_u32 s45, s47, 1146880
    buffer_load_dwordx4 v[12:15], v6, s[8:11], s45 offen
    s_add_u32 s45, s47, 1167360
    buffer_load_dwordx4 v[16:19], v6, s[8:11], s45 offen
    s_waitcnt vmcnt(26)
    ds_write_b128 v7, v[20:23] offset:0
    ds_write_b128 v7, v[24:27] offset:1280
    ds_read_b64_tr_b16 v[126:127], v8 offset:0
    ds_read_b64_tr_b16 v[130:131], v8 offset:640
    ds_read_b64_tr_b16 v[134:135], v8 offset:32
    ds_read_b64_tr_b16 v[138:139], v8 offset:672
    s_waitcnt lgkmcnt(0)
    v_accvgpr_write_b32 a112, v124
    v_accvgpr_write_b32 a113, v126
    v_accvgpr_write_b32 a114, v125
    v_accvgpr_write_b32 a115, v127
    v_accvgpr_write_b32 a116, v128
    v_accvgpr_write_b32 a117, v130
    v_accvgpr_write_b32 a118, v129
    v_accvgpr_write_b32 a119, v131
    v_accvgpr_write_b32 a120, v132
    v_accvgpr_write_b32 a121, v134
    v_accvgpr_write_b32 a122, v133
    v_accvgpr_write_b32 a123, v135
    v_accvgpr_write_b32 a124, v136
    v_accvgpr_write_b32 a125, v138
    v_accvgpr_write_b32 a126, v137
    v_accvgpr_write_b32 a127, v139
    s_add_u32 s45, s47, 1187840
    buffer_load_dwordx4 v[20:23], v6, s[8:11], s45 offen
    s_add_u32 s45, s47, 1208320
    buffer_load_dwordx4 v[24:27], v6, s[8:11], s45 offen
    s_waitcnt vmcnt(26)
    ds_write_b128 v7, v[28:31] offset:0
    ds_write_b128 v7, v[32:35] offset:1280
    ds_read_b64_tr_b16 v[124:125], v8 offset:0
    ds_read_b64_tr_b16 v[128:129], v8 offset:640
    ds_read_b64_tr_b16 v[132:133], v8 offset:32
    ds_read_b64_tr_b16 v[136:137], v8 offset:672
    s_add_u32 s45, s47, 1228800
    buffer_load_dwordx4 v[28:31], v6, s[8:11], s45 offen
    s_add_u32 s45, s47, 1249280
    buffer_load_dwordx4 v[32:35], v6, s[8:11], s45 offen
    s_waitcnt vmcnt(26)
    ds_write_b128 v7, v[36:39] offset:0
    ds_write_b128 v7, v[40:43] offset:1280
    ds_read_b64_tr_b16 v[126:127], v8 offset:0
    ds_read_b64_tr_b16 v[130:131], v8 offset:640
    ds_read_b64_tr_b16 v[134:135], v8 offset:32
    ds_read_b64_tr_b16 v[138:139], v8 offset:672
    s_waitcnt lgkmcnt(0)
    v_accvgpr_write_b32 a128, v124
    v_accvgpr_write_b32 a129, v126
    v_accvgpr_write_b32 a130, v125
    v_accvgpr_write_b32 a131, v127
    v_accvgpr_write_b32 a132, v128
    v_accvgpr_write_b32 a133, v130
    v_accvgpr_write_b32 a134, v129
    v_accvgpr_write_b32 a135, v131
    v_accvgpr_write_b32 a136, v132
    v_accvgpr_write_b32 a137, v134
    v_accvgpr_write_b32 a138, v133
    v_accvgpr_write_b32 a139, v135
    v_accvgpr_write_b32 a140, v136
    v_accvgpr_write_b32 a141, v138
    v_accvgpr_write_b32 a142, v137
    v_accvgpr_write_b32 a143, v139
    s_add_u32 s45, s47, 1269760
    buffer_load_dwordx4 v[36:39], v6, s[8:11], s45 offen
    s_add_u32 s45, s47, 1290240
    buffer_load_dwordx4 v[40:43], v6, s[8:11], s45 offen
    s_waitcnt vmcnt(26)
    ds_write_b128 v7, v[44:47] offset:0
    ds_write_b128 v7, v[48:51] offset:1280
    ds_read_b64_tr_b16 v[124:125], v8 offset:0
    ds_read_b64_tr_b16 v[128:129], v8 offset:640
    ds_read_b64_tr_b16 v[132:133], v8 offset:32
    ds_read_b64_tr_b16 v[136:137], v8 offset:672
    s_waitcnt vmcnt(24)
    ds_write_b128 v7, v[52:55] offset:0
    ds_write_b128 v7, v[56:59] offset:1280
    ds_read_b64_tr_b16 v[126:127], v8 offset:0
    ds_read_b64_tr_b16 v[130:131], v8 offset:640
    ds_read_b64_tr_b16 v[134:135], v8 offset:32
    ds_read_b64_tr_b16 v[138:139], v8 offset:672
    s_waitcnt lgkmcnt(0)
    v_accvgpr_write_b32 a144, v124
    v_accvgpr_write_b32 a145, v126
    v_accvgpr_write_b32 a146, v125
    v_accvgpr_write_b32 a147, v127
    v_accvgpr_write_b32 a148, v128
    v_accvgpr_write_b32 a149, v130
    v_accvgpr_write_b32 a150, v129
    v_accvgpr_write_b32 a151, v131
    v_accvgpr_write_b32 a152, v132
    v_accvgpr_write_b32 a153, v134
    v_accvgpr_write_b32 a154, v133
    v_accvgpr_write_b32 a155, v135
    v_accvgpr_write_b32 a156, v136
    v_accvgpr_write_b32 a157, v138
    v_accvgpr_write_b32 a158, v137
    v_accvgpr_write_b32 a159, v139
    s_waitcnt vmcnt(22)
    ds_write_b128 v7, v[60:63] offset:0
    ds_write_b128 v7, v[64:67] offset:1280
    ds_read_b64_tr_b16 v[124:125], v8 offset:0
    ds_read_b64_tr_b16 v[128:129], v8 offset:640
    ds_read_b64_tr_b16 v[132:133], v8 offset:32
    ds_read_b64_tr_b16 v[136:137], v8 offset:672
    s_waitcnt vmcnt(20)
    ds_write_b128 v7, v[68:71] offset:0
    ds_write_b128 v7, v[72:75] offset:1280
    ds_read_b64_tr_b16 v[126:127], v8 offset:0
    ds_read_b64_tr_b16 v[130:131], v8 offset:640
    ds_read_b64_tr_b16 v[134:135], v8 offset:32
    ds_read_b64_tr_b16 v[138:139], v8 offset:672
    s_waitcnt lgkmcnt(0)
    v_accvgpr_write_b32 a160, v124
    v_accvgpr_write_b32 a161, v126
    v_accvgpr_write_b32 a162, v125
    v_accvgpr_write_b32 a163, v127
    v_accvgpr_write_b32 a164, v128
    v_accvgpr_write_b32 a165, v130
    v_accvgpr_write_b32 a166, v129
    v_accvgpr_write_b32 a167, v131
    v_accvgpr_write_b32 a168, v132
    v_accvgpr_write_b32 a169, v134
    v_accvgpr_write_b32 a170, v133
    v_accvgpr_write_b32 a171, v135
    v_accvgpr_write_b32 a172, v136
    v_accvgpr_write_b32 a173, v138
    v_accvgpr_write_b32 a174, v137
    v_accvgpr_write_b32 a175, v139
    s_waitcnt vmcnt(18)
    ds_write_b128 v7, v[76:79] offset:0
    ds_write_b128 v7, v[80:83] offset:1280
    ds_read_b64_tr_b16 v[124:125], v8 offset:0
    ds_read_b64_tr_b16 v[128:129], v8 offset:640
    ds_read_b64_tr_b16 v[132:133], v8 offset:32
    ds_read_b64_tr_b16 v[136:137], v8 offset:672
    s_waitcnt vmcnt(16)
    ds_write_b128 v7, v[84:87] offset:0
    ds_write_b128 v7, v[88:91] offset:1280
    ds_read_b64_tr_b16 v[126:127], v8 offset:0
    ds_read_b64_tr_b16 v[130:131], v8 offset:640
    ds_read_b64_tr_b16 v[134:135], v8 offset:32
    ds_read_b64_tr_b16 v[138:139], v8 offset:672
    s_waitcnt lgkmcnt(0)
    v_accvgpr_write_b32 a176, v124
    v_accvgpr_write_b32 a177, v126
    v_accvgpr_write_b32 a178, v125
    v_accvgpr_write_b32 a179, v127
    v_accvgpr_write_b32 a180, v128
    v_accvgpr_write_b32 a181, v130
    v_accvgpr_write_b32 a182, v129
    v_accvgpr_write_b32 a183, v131
    v_accvgpr_write_b32 a184, v132
    v_accvgpr_write_b32 a185, v134
    v_accvgpr_write_b32 a186, v133
    v_accvgpr_write_b32 a187, v135
    v_accvgpr_write_b32 a188, v136
    v_accvgpr_write_b32 a189, v138
    v_accvgpr_write_b32 a190, v137
    v_accvgpr_write_b32 a191, v139
    s_waitcnt vmcnt(14)
    ds_write_b128 v7, v[92:95] offset:0
    ds_write_b128 v7, v[96:99] offset:1280
    ds_read_b64_tr_b16 v[124:125], v8 offset:0
    ds_read_b64_tr_b16 v[128:129], v8 offset:640
    ds_read_b64_tr_b16 v[132:133], v8 offset:32
    ds_read_b64_tr_b16 v[136:137], v8 offset:672
    s_waitcnt vmcnt(12)
    ds_write_b128 v7, v[100:103] offset:0
    ds_write_b128 v7, v[104:107] offset:1280
    ds_read_b64_tr_b16 v[126:127], v8 offset:0
    ds_read_b64_tr_b16 v[130:131], v8 offset:640
    ds_read_b64_tr_b16 v[134:135], v8 offset:32
    ds_read_b64_tr_b16 v[138:139], v8 offset:672
    s_waitcnt lgkmcnt(0)
    v_accvgpr_write_b32 a192, v124
    v_accvgpr_write_b32 a193, v126
    v_accvgpr_write_b32 a194, v125
    v_accvgpr_write_b32 a195, v127
    v_accvgpr_write_b32 a196, v128
    v_accvgpr_write_b32 a197, v130
    v_accvgpr_write_b32 a198, v129
    v_accvgpr_write_b32 a199, v131
    v_accvgpr_write_b32 a200, v132
    v_accvgpr_write_b32 a201, v134
    v_accvgpr_write_b32 a202, v133
    v_accvgpr_write_b32 a203, v135
    v_accvgpr_write_b32 a204, v136
    v_accvgpr_write_b32 a205, v138
    v_accvgpr_write_b32 a206, v137
    v_accvgpr_write_b32 a207, v139
    s_waitcnt vmcnt(10)
    ds_write_b128 v7, v[108:111] offset:0
    ds_write_b128 v7, v[112:115] offset:1280
    ds_read_b64_tr_b16 v[124:125], v8 offset:0
    ds_read_b64_tr_b16 v[128:129], v8 offset:640
    ds_read_b64_tr_b16 v[132:133], v8 offset:32
    ds_read_b64_tr_b16 v[136:137], v8 offset:672
    s_waitcnt vmcnt(8)
    ds_write_b128 v7, v[116:119] offset:0
    ds_write_b128 v7, v[120:123] offset:1280
    ds_read_b64_tr_b16 v[126:127], v8 offset:0
    ds_read_b64_tr_b16 v[130:131], v8 offset:640
    ds_read_b64_tr_b16 v[134:135], v8 offset:32
    ds_read_b64_tr_b16 v[138:139], v8 offset:672
    s_waitcnt lgkmcnt(0)
    v_accvgpr_write_b32 a208, v124
    v_accvgpr_write_b32 a209, v126
    v_accvgpr_write_b32 a210, v125
    v_accvgpr_write_b32 a211, v127
    v_accvgpr_write_b32 a212, v128
    v_accvgpr_write_b32 a213, v130
    v_accvgpr_write_b32 a214, v129
    v_accvgpr_write_b32 a215, v131
    v_accvgpr_write_b32 a216, v132
    v_accvgpr_write_b32 a217, v134
    v_accvgpr_write_b32 a218, v133
    v_accvgpr_write_b32 a219, v135
    v_accvgpr_write_b32 a220, v136
    v_accvgpr_write_b32 a221, v138
    v_accvgpr_write_b32 a222, v137
    v_accvgpr_write_b32 a223, v139
    s_waitcnt vmcnt(6)
    ds_write_b128 v7, v[12:15] offset:0
    ds_write_b128 v7, v[16:19] offset:1280
    ds_read_b64_tr_b16 v[124:125], v8 offset:0
    ds_read_b64_tr_b16 v[128:129], v8 offset:640
    ds_read_b64_tr_b16 v[132:133], v8 offset:32
    ds_read_b64_tr_b16 v[136:137], v8 offset:672
    s_waitcnt vmcnt(4)
    ds_write_b128 v7, v[20:23] offset:0
    ds_write_b128 v7, v[24:27] offset:1280
    ds_read_b64_tr_b16 v[126:127], v8 offset:0
    ds_read_b64_tr_b16 v[130:131], v8 offset:640
    ds_read_b64_tr_b16 v[134:135], v8 offset:32
    ds_read_b64_tr_b16 v[138:139], v8 offset:672
    s_waitcnt lgkmcnt(0)
    v_accvgpr_write_b32 a224, v124
    v_accvgpr_write_b32 a225, v126
    v_accvgpr_write_b32 a226, v125
    v_accvgpr_write_b32 a227, v127
    v_accvgpr_write_b32 a228, v128
    v_accvgpr_write_b32 a229, v130
    v_accvgpr_write_b32 a230, v129
    v_accvgpr_write_b32 a231, v131
    v_accvgpr_write_b32 a232, v132
    v_accvgpr_write_b32 a233, v134
    v_accvgpr_write_b32 a234, v133
    v_accvgpr_write_b32 a235, v135
    v_accvgpr_write_b32 a236, v136
    v_accvgpr_write_b32 a237, v138
    v_accvgpr_write_b32 a238, v137
    v_accvgpr_write_b32 a239, v139
    s_waitcnt vmcnt(2)
    ds_write_b128 v7, v[28:31] offset:0
    ds_write_b128 v7, v[32:35] offset:1280
    ds_read_b64_tr_b16 v[124:125], v8 offset:0
    ds_read_b64_tr_b16 v[128:129], v8 offset:640
    ds_read_b64_tr_b16 v[132:133], v8 offset:32
    ds_read_b64_tr_b16 v[136:137], v8 offset:672
    s_waitcnt vmcnt(0)
    ds_write_b128 v7, v[36:39] offset:0
    ds_write_b128 v7, v[40:43] offset:1280
    ds_read_b64_tr_b16 v[126:127], v8 offset:0
    ds_read_b64_tr_b16 v[130:131], v8 offset:640
    ds_read_b64_tr_b16 v[134:135], v8 offset:32
    ds_read_b64_tr_b16 v[138:139], v8 offset:672
    s_waitcnt lgkmcnt(0)
    v_accvgpr_write_b32 a240, v124
    v_accvgpr_write_b32 a241, v126
    v_accvgpr_write_b32 a242, v125
    v_accvgpr_write_b32 a243, v127
    v_accvgpr_write_b32 a244, v128
    v_accvgpr_write_b32 a245, v130
    v_accvgpr_write_b32 a246, v129
    v_accvgpr_write_b32 a247, v131
    v_accvgpr_write_b32 a248, v132
    v_accvgpr_write_b32 a249, v134
    v_accvgpr_write_b32 a250, v133
    v_accvgpr_write_b32 a251, v135
    v_accvgpr_write_b32 a252, v136
    v_accvgpr_write_b32 a253, v138
    v_accvgpr_write_b32 a254, v137
    v_accvgpr_write_b32 a255, v139
    s_barrier
    v_bfe_u32 v4, v0, 1, 3
    v_lshlrev_b32 v5, 7, v4
    v_lshrrev_b32 v4, 4, v0
    v_lshl_add_u32 v5, v4, 5, v5
    v_and_b32 v4, 1, v0
    v_lshl_add_u32 v5, v4, 4, v5
    v_mov_b32 v9, 0x4444
    v_mov_b32 v8, 0xeeee
    v_bfe_u32 v4, v0, 1, 1
    v_cmp_eq_u32 vcc, 1, v4
    s_nop 1
    v_cndmask_b32 v9, v9, v8, vcc
    v_lshrrev_b32 v4, 4, v0
    v_cmp_eq_u32 s[80:81], 1, v4
    v_cmp_eq_u32 s[82:83], 2, v4
    v_cmp_eq_u32 s[84:85], 3, v4
    s_lshl_b32 s47, s3, 8
    v_lshlrev_b32 v6, 2, v0
    v_add_u32 v6, s47, v6
    v_and_b32 v8, 1, v0
    v_lshlrev_b32 v7, 5, v4
    v_lshl_add_u32 v7, v8, 4, v7
    v_lshlrev_b32 v10, 4, v4
    v_lshl_add_u32 v10, v8, 6, v10
    v_and_b32 v4, 15, v0
    v_cmp_gt_u32 s[64:65], 2, v4
    s_lshl_b32 s51, s3, 12
    s_lshl_b32 s46, s59, 14
    s_add_u32 s51, s51, s46
    s_add_u32 s51, s51, 81225728
    s_lshl_b32 s53, s44, 9
    s_lshl_b32 s46, s59, 7
    s_add_u32 s53, s53, s46
    s_add_u32 s53, s53, 80570368
    s_mul_i32 s69, s2, 7
    s_and_b32 s69, s69, 31
    s_lshl_b32 s69, s69, 7
    v_mov_b32 v11, 0
    s_mov_b32 s50, 0
chain_wstep:
    v_mov_b32 v32, 0
    v_mov_b32 v33, 0
    v_mov_b32 v34, 0
    v_mov_b32 v35, 0
    v_mov_b32 v36, 0
    v_mov_b32 v37, 0
    v_mov_b32 v38, 0
    v_mov_b32 v39, 0
    v_mov_b32 v40, 0
    v_mov_b32 v41, 0
    v_mov_b32 v42, 0
    v_mov_b32 v43, 0
    v_mov_b32 v44, 0
    v_mov_b32 v45, 0
    v_mov_b32 v46, 0
    v_mov_b32 v47, 0
    v_mov_b32 v48, 0
    v_mov_b32 v49, 0
    v_mov_b32 v50, 0
    v_mov_b32 v51, 0
    v_mov_b32 v52, 0
    v_mov_b32 v53, 0
    v_mov_b32 v54, 0
    v_mov_b32 v55, 0
    v_mov_b32 v56, 0
    v_mov_b32 v57, 0
    v_mov_b32 v58, 0
    v_mov_b32 v59, 0
    v_mov_b32 v60, 0
    v_mov_b32 v61, 0
    v_mov_b32 v62, 0
    v_mov_b32 v63, 0
    s_cmp_eq_u32 s50, 0
    s_cbranch_scc1 chain_wnosleep
    s_sleep 60
chain_wnosleep:
    s_add_u32 s68, s51, s69
    s_mov_b32 s66, 0
    buffer_load_dword v64, v11, s[4:7], s68 offen sc1
chain_wind:
    s_add_u32 s66, s66, 1
    s_cmp_gt_u32 s66, 0x20000
    s_cbranch_scc1 chain_end
    buffer_load_dword v65, v11, s[4:7], s68 offen sc1
    s_waitcnt vmcnt(1)
    v_cmp_eq_u32 vcc, -1, v64
    s_cbranch_vccz chain_wind_ok
    buffer_load_dword v64, v11, s[4:7], s68 offen sc1
    s_waitcnt vmcnt(1)
    v_cmp_eq_u32 vcc, -1, v65
    s_cbranch_vccz chain_wind_ok
    s_branch chain_wind
chain_wind_ok:
    s_mov_b32 s66, 0
chain_wpoll:
    s_add_u32 s66, s66, 1
    s_cmp_gt_u32 s66, 0x20000
    s_cbranch_scc1 chain_end
    buffer_load_dwordx4 v[12:15], v5, s[4:7], s51 offen offset:0 sc1
    buffer_load_dwordx4 v[16:19], v5, s[4:7], s51 offen offset:1024 sc1
    buffer_load_dwordx4 v[20:23], v5, s[4:7], s51 offen offset:2048 sc1
    buffer_load_dwordx4 v[24:27], v5, s[4:7], s51 offen offset:3072 sc1
    s_waitcnt vmcnt(0)
    v_max3_u32 v4, v12, v13, v14
    v_max3_u32 v4, v4, v15, v16
    v_max3_u32 v4, v4, v17, v18
    v_max3_u32 v4, v4, v19, v20
    v_max3_u32 v4, v4, v21, v22
    v_max3_u32 v4, v4, v23, v24
    v_max3_u32 v4, v4, v25, v26
    v_max_u32 v4, v4, v27
    v_cmp_eq_u32 vcc, -1, v4
    s_cbranch_vccnz chain_wpoll
    v_smfmac_f32_16x16x64_bf16 v[32:35], v[12:15], a[0:7], v9
    v_smfmac_f32_16x16x64_bf16 v[48:51], v[12:15], a[8:15], v9
    v_smfmac_f32_16x16x64_bf16 v[36:39], v[12:15], a[16:23], v9
    v_smfmac_f32_16x16x64_bf16 v[52:55], v[12:15], a[24:31], v9
    v_smfmac_f32_16x16x64_bf16 v[40:43], v[12:15], a[32:39], v9
    v_smfmac_f32_16x16x64_bf16 v[56:59], v[12:15], a[40:47], v9
    v_smfmac_f32_16x16x64_bf16 v[44:47], v[12:15], a[48:55], v9
    v_smfmac_f32_16x16x64_bf16 v[60:63], v[12:15], a[56:63], v9
    v_smfmac_f32_16x16x64_bf16 v[32:35], v[16:19], a[64:71], v9
    v_smfmac_f32_16x16x64_bf16 v[48:51], v[16:19], a[72:79], v9
    v_smfmac_f32_16x16x64_bf16 v[36:39], v[16:19], a[80:87], v9
    v_smfmac_f32_16x16x64_bf16 v[52:55], v[16:19], a[88:95], v9
    v_smfmac_f32_16x16x64_bf16 v[40:43], v[16:19], a[96:103], v9
    v_smfmac_f32_16x16x64_bf16 v[56:59], v[16:19], a[104:111], v9
    v_smfmac_f32_16x16x64_bf16 v[44:47], v[16:19], a[112:119], v9
    v_smfmac_f32_16x16x64_bf16 v[60:63], v[16:19], a[120:127], v9
    v_smfmac_f32_16x16x64_bf16 v[32:35], v[20:23], a[128:135], v9
    v_smfmac_f32_16x16x64_bf16 v[48:51], v[20:23], a[136:143], v9
    v_smfmac_f32_16x16x64_bf16 v[36:39], v[20:23], a[144:151], v9
    v_smfmac_f32_16x16x64_bf16 v[52:55], v[20:23], a[152:159], v9
    v_smfmac_f32_16x16x64_bf16 v[40:43], v[20:23], a[160:167], v9
    v_smfmac_f32_16x16x64_bf16 v[56:59], v[20:23], a[168:175], v9
    v_smfmac_f32_16x16x64_bf16 v[44:47], v[20:23], a[176:183], v9
    v_smfmac_f32_16x16x64_bf16 v[60:63], v[20:23], a[184:191], v9
    v_smfmac_f32_16x16x64_bf16 v[32:35], v[24:27], a[192:199], v9
    v_smfmac_f32_16x16x64_bf16 v[48:51], v[24:27], a[200:207], v9
    v_smfmac_f32_16x16x64_bf16 v[36:39], v[24:27], a[208:215], v9
    v_smfmac_f32_16x16x64_bf16 v[52:55], v[24:27], a[216:223], v9
    v_smfmac_f32_16x16x64_bf16 v[40:43], v[24:27], a[224:231], v9
    v_smfmac_f32_16x16x64_bf16 v[56:59], v[24:27], a[232:239], v9
    v_smfmac_f32_16x16x64_bf16 v[44:47], v[24:27], a[240:247], v9
    v_smfmac_f32_16x16x64_bf16 v[60:63], v[24:27], a[248:255], v9
    s_nop 7
    v_cndmask_b32 v32, v32, v36, s[80:81]
    v_cndmask_b32 v33, v33, v37, s[80:81]
    v_cndmask_b32 v34, v34, v38, s[80:81]
    v_cndmask_b32 v35, v35, v39, s[80:81]
    v_cndmask_b32 v32, v32, v40, s[82:83]
    v_cndmask_b32 v33, v33, v41, s[82:83]
    v_cndmask_b32 v34, v34, v42, s[82:83]
    v_cndmask_b32 v35, v35, v43, s[82:83]
    v_cndmask_b32 v32, v32, v44, s[84:85]
    v_cndmask_b32 v33, v33, v45, s[84:85]
    v_cndmask_b32 v34, v34, v46, s[84:85]
    v_cndmask_b32 v35, v35, v47, s[84:85]
    v_add_f32 v32, v32, v34
    v_add_f32 v33, v33, v35
    v_cndmask_b32 v48, v48, v52, s[80:81]
    v_cndmask_b32 v49, v49, v53, s[80:81]
    v_cndmask_b32 v50, v50, v54, s[80:81]
    v_cndmask_b32 v51, v51, v55, s[80:81]
    v_cndmask_b32 v48, v48, v56, s[82:83]
    v_cndmask_b32 v49, v49, v57, s[82:83]
    v_cndmask_b32 v50, v50, v58, s[82:83]
    v_cndmask_b32 v51, v51, v59, s[82:83]
    v_cndmask_b32 v48, v48, v60, s[84:85]
    v_cndmask_b32 v49, v49, v61, s[84:85]
    v_cndmask_b32 v50, v50, v62, s[84:85]
    v_cndmask_b32 v51, v51, v63, s[84:85]
    v_add_f32 v48, v48, v50
    v_add_f32 v49, v49, v51
    s_nop 1
    v_permlane16_swap_b32 v32, v33
    v_permlane16_swap_b32 v48, v49
    s_nop 0
    v_add_f32 v32, v32, v33
    v_add_f32 v48, v48, v49
    s_nop 1
    v_permlane32_swap_b32 v32, v48
    s_nop 0
    v_add_f32 v32, v32, v48
    ds_write_b32 v6, v32
    s_waitcnt lgkmcnt(0)
    s_barrier
    s_cmp_eq_u32 s3, 0
    s_cbranch_scc1 chain_wred
    s_cmp_lg_u32 s3, 1
    s_cbranch_scc1 chain_wnext
    s_cmp_lg_u32 s2, 32
    s_cbranch_scc1 chain_wnext
    s_and_b32 s45, s50, 3
    s_cmp_lg_u32 s45, 0
    s_cbranch_scc1 chain_wnext
    s_cmp_eq_u32 s50, 0
    s_cbranch_scc1 chain_wnext
    s_lshl_b32 s45, s50, 7
    s_add_u32 s45, s45, 122916352
    v_mov_b32 v64, 1
    v_mov_b32 v65, 1
    v_lshlrev_b32 v4, 3, v0
    buffer_store_dwordx2 v[64:65], v4, s[4:7], s45 offen sc1
    s_branch chain_wnext
chain_wred:
    ds_read_b128 v[64:67], v10 offset:0
    ds_read_b128 v[68:71], v10 offset:128
    ds_read_b128 v[72:75], v10 offset:256
    ds_read_b128 v[76:79], v10 offset:384
    ds_read_b128 v[80:83], v10 offset:512
    ds_read_b128 v[84:87], v10 offset:640
    ds_read_b128 v[88:91], v10 offset:768
    ds_read_b128 v[92:95], v10 offset:896
    s_waitcnt lgkmcnt(0)
    v_add_f32 v64, v64, v72
    v_add_f32 v80, v80, v88
    v_add_f32 v65, v65, v73
    v_add_f32 v81, v81, v89
    v_add_f32 v66, v66, v74
    v_add_f32 v82, v82, v90
    v_add_f32 v67, v67, v75
    v_add_f32 v83, v83, v91
    v_add_f32 v68, v68, v76
    v_add_f32 v84, v84, v92
    v_add_f32 v69, v69, v77
    v_add_f32 v85, v85, v93
    v_add_f32 v70, v70, v78
    v_add_f32 v86, v86, v94
    v_add_f32 v71, v71, v79
    v_add_f32 v87, v87, v95
    v_add_f32 v64, v64, v80
    v_add_f32 v65, v65, v81
    v_add_f32 v66, v66, v82
    v_add_f32 v67, v67, v83
    v_add_f32 v68, v68, v84
    v_add_f32 v69, v69, v85
    v_add_f32 v70, v70, v86
    v_add_f32 v71, v71, v87
    v_cvt_pk_bf16_f32 v96, v64, v65
    v_cvt_pk_bf16_f32 v97, v66, v67
    v_cvt_pk_bf16_f32 v98, v68, v69
    v_cvt_pk_bf16_f32 v99, v70, v71
    v_min_u32 v96, -2, v96
    v_min_u32 v97, -2, v97
    v_min_u32 v98, -2, v98
    v_min_u32 v99, -2, v99
    s_mov_b64 exec, s[64:65]
    buffer_store_dwordx4 v[96:99], v7, s[4:7], s53 offen sc1
    s_mov_b64 exec, -1
chain_wnext:
    s_waitcnt vmcnt(0)
    s_add_u32 s50, s50, 1
    s_add_u32 s51, s51, 65536
    s_add_u32 s53, s53, 10240
    s_cmp_lt_u32 s50, 63
    s_cbranch_scc1 chain_wstep
    s_branch chain_end
chain_spare:
    s_sub_u32 s70, s2, 112
    s_and_b32 s75, s70, 7
    s_lshr_b32 s70, s70, 3
    s_cmp_lt_u32 s70, 14
    s_cbranch_scc1 chain_sploop
    s_sub_u32 s71, s2, 224
    s_lshl_b32 s71, s71, 2
    s_add_u32 s71, s71, s3
chain_rlloop:
    s_mov_b32 s14, s71
    s_cmp_ge_u32 s14, 1280
    s_cbranch_scc1 chrl_sp1
    s_sub_u32 s44, s14, 0
    s_mov_b32 s46, 0x1999999a
    s_mul_hi_u32 s45, s44, s46
    s_mul_i32 s46, s45, 10
    s_sub_u32 s46, s44, s46
    s_mov_b32 s8, s26
    s_and_b32 s9, s27, 0xffff
    s_mov_b32 s10, 0x500000
    s_mov_b32 s11, 0x00020000
    s_mul_i32 s12, s45, 40960
    s_lshl_b32 s47, s46, 7
    s_add_u32 s12, s12, s47
    s_mov_b32 s15, 1280
    s_add_u32 s46, s46, 0
    s_mul_i32 s13, s46, 128
    s_add_u32 s13, s13, s45
    s_lshl_b32 s13, s13, 12
    s_add_u32 s13, s13, 18350080
    s_branch chrl_relayout
chrl_sp1:
    s_cmp_ge_u32 s14, 1820
    s_cbranch_scc1 chrl_sp2
    s_sub_u32 s44, s14, 1280
    s_mov_b32 s46, 0x97b425f
    s_mul_hi_u32 s45, s44, s46
    s_mul_i32 s46, s45, 27
    s_sub_u32 s46, s44, s46
    s_mov_b32 s8, s32
    s_and_b32 s9, s33, 0xffff
    s_mov_b32 s10, 0x21c000
    s_mov_b32 s11, 0x00020000
    s_mul_i32 s12, s45, 110592
    s_lshl_b32 s47, s46, 7
    s_add_u32 s12, s12, s47
    s_mov_b32 s15, 3456
    s_add_u32 s46, s46, 0
    s_mul_i32 s13, s46, 20
    s_add_u32 s13, s13, s45
    s_lshl_b32 s13, s13, 12
    s_add_u32 s13, s13, 23592960
    s_branch chrl_relayout
chrl_sp2:
    s_cmp_ge_u32 s14, 2360
    s_cbranch_scc1 chrl_sp3
    s_sub_u32 s44, s14, 1820
    s_mov_b32 s46, 0x97b425f
    s_mul_hi_u32 s45, s44, s46
    s_mul_i32 s46, s45, 27
    s_sub_u32 s46, s44, s46
    s_mov_b32 s8, s34
    s_and_b32 s9, s35, 0xffff
    s_mov_b32 s10, 0x21c000
    s_mov_b32 s11, 0x00020000
    s_mul_i32 s12, s45, 110592
    s_lshl_b32 s47, s46, 7
    s_add_u32 s12, s12, s47
    s_mov_b32 s15, 3456
    s_add_u32 s46, s46, 27
    s_mul_i32 s13, s46, 20
    s_add_u32 s13, s13, s45
    s_lshl_b32 s13, s13, 12
    s_add_u32 s13, s13, 23592960
    s_branch chrl_relayout
chrl_sp3:
    s_sub_u32 s44, s14, 2360
    s_mov_b32 s46, 0x1999999a
    s_mul_hi_u32 s45, s44, s46
    s_mul_i32 s46, s45, 10
    s_sub_u32 s46, s44, s46
    s_mov_b32 s8, s36
    s_and_b32 s9, s37, 0xffff
    s_mov_b32 s10, 0x21c000
    s_mov_b32 s11, 0x00020000
    s_mul_i32 s12, s45, 40960
    s_lshl_b32 s47, s46, 7
    s_add_u32 s12, s12, s47
    s_mov_b32 s15, 1280
    s_add_u32 s46, s46, 0
    s_mul_i32 s13, s46, 54
    s_add_u32 s13, s13, s45
    s_lshl_b32 s13, s13, 12
    s_add_u32 s13, s13, 28016640
    s_branch chrl_relayout
chrl_relayout:
    v_lshrrev_b32 v1, 3, v0
    v_and_b32 v2, 7, v0
    v_mul_lo_u32 v3, v1, s15
    v_lshl_add_u32 v3, v2, 4, v3
    s_lshl_b32 s44, s15, 3
    buffer_load_dwordx4 v[16:19], v3, s[8:11], s12 offen
    s_add_u32 s12, s12, s44
    buffer_load_dwordx4 v[20:23], v3, s[8:11], s12 offen
    s_add_u32 s12, s12, s44
    buffer_load_dwordx4 v[24:27], v3, s[8:11], s12 offen
    s_add_u32 s12, s12, s44
    buffer_load_dwordx4 v[28:31], v3, s[8:11], s12 offen
    s_mul_i32 s45, s3, 4608
    v_mul_u32_u24 v4, 144, v1
    v_lshl_add_u32 v4, v2, 4, v4
    v_add_u32 v4, s45, v4
    v_lshrrev_b32 v5, 4, v0
    v_bfe_u32 v6, v0, 2, 2
    v_lshl_add_u32 v5, v5, 2, v6
    v_mul_u32_u24 v5, 144, v5
    v_and_b32 v6, 3, v0
    v_lshl_add_u32 v5, v6, 3, v5
    v_add_u32 v5, s45, v5
    v_lshlrev_b32 v7, 4, v0
    s_waitcnt vmcnt(3)
    ds_write_b128 v4, v[16:19] offset:0
    s_waitcnt vmcnt(2)
    ds_write_b128 v4, v[20:23] offset:1152
    s_waitcnt vmcnt(1)
    ds_write_b128 v4, v[24:27] offset:2304
    s_waitcnt vmcnt(0)
    ds_write_b128 v4, v[28:31] offset:3456
    s_waitcnt lgkmcnt(0)
    ds_read_b64_tr_b16 v[32:33], v5 offset:0
    ds_read_b64_tr_b16 v[34:35], v5 offset:2304
    ds_read_b64_tr_b16 v[36:37], v5 offset:32
    ds_read_b64_tr_b16 v[38:39], v5 offset:2336
    ds_read_b64_tr_b16 v[40:41], v5 offset:64
    ds_read_b64_tr_b16 v[42:43], v5 offset:2368
    ds_read_b64_tr_b16 v[44:45], v5 offset:96
    ds_read_b64_tr_b16 v[46:47], v5 offset:2400
    s_waitcnt lgkmcnt(0)
    buffer_store_dwordx4 v[32:35], v7, s[4:7], s13 offen offset:0 sc1
    buffer_store_dwordx4 v[36:39], v7, s[4:7], s13 offen offset:1024 sc1
    buffer_store_dwordx4 v[40:43], v7, s[4:7], s13 offen offset:2048 sc1
    buffer_store_dwordx4 v[44:47], v7, s[4:7], s13 offen offset:3072 sc1
    s_add_u32 s71, s71, 128
    s_cmp_lt_u32 s71, 2900
    s_cbranch_scc1 chain_rlloop
    s_mov_b32 s72, 122912768
    s_waitcnt vmcnt(0)
    s_barrier
    s_cmp_lg_u32 s3, 0
    s_cbranch_scc1 sig_2
    s_mov_b64 exec, 1
    v_mov_b32 v4, 1
    v_mov_b32 v5, 0
    buffer_atomic_add v4, v5, s[4:7], s72 offen sc1
    s_mov_b64 exec, -1
sig_2:
    s_branch chain_roles
chain_sploop:
    s_lshr_b32 s45, s70, 3
    s_and_b32 s44, s70, 7
    s_lshl_b32 s44, s44, 3
    s_add_u32 s44, s44, 32
    s_sub_u32 s46, s70, 128
    s_lshr_b32 s46, s46, 2
    s_and_b32 s47, s70, 3
    s_lshl_b32 s47, s47, 3
    s_cmp_lt_u32 s70, 128
    s_cselect_b32 s45, s45, s46
    s_cselect_b32 s44, s44, s47
    s_cselect_b32 s46, 0, 2048
    s_add_u32 s44, s44, s75
    s_lshl_b32 s72, s45, 7
    s_add_u32 s72, s72, s46
    s_add_u32 s72, s72, 122908672
    s_cmp_lt_u32 s44, 32
    s_cselect_b32 s12, s20, s22
    s_cselect_b32 s13, s21, s23
    s_cmp_lt_u32 s44, 64
    s_cselect_b32 s12, s12, s24
    s_cselect_b32 s13, s13, s25
    s_mov_b32 s8, s12
    s_and_b32 s9, s13, 0xffff
    s_mov_b32 s10, 0x500000
    s_mov_b32 s11, 0x00020000
    s_and_b32 s46, s44, 31
    s_lshl_b32 s46, s46, 8
    s_lshl_b32 s47, s3, 17
    s_add_u32 s46, s46, s47
    s_lshl_b32 s47, s45, 1
    s_add_u32 s47, s47, s3
    s_sub_u32 s47, s47, 2
    s_mul_i32 s47, s47, 81920
    s_add_u32 s47, s47, 0
    s_cmp_lt_u32 s3, 2
    s_cselect_b32 s48, s46, s47
    s_and_b32 s51, s3, 1
    s_lshr_b32 s52, s3, 1
    s_lshl_b32 s53, s51, 12
    s_lshl_b32 s54, s52, 12
    s_add_u32 s54, s54, 8192
    v_lshlrev_b32 v2, 4, v0
    v_add_u32 v3, s54, v2
    v_add_u32 v2, s53, v2
    v_lshrrev_b32 v4, 4, v0
    v_bfe_u32 v5, v0, 1, 3
    v_add_u32 v6, 0, v4
    v_xor_b32 v6, v6, v5
    v_lshlrev_b32 v6, 5, v6
    v_and_b32 v7, 1, v0
    v_lshl_add_u32 v6, v7, 4, v6
    v_lshl_add_u32 v140, v4, 13, v6
    v_add_u32 v6, 4, v4
    v_xor_b32 v6, v6, v5
    v_lshlrev_b32 v6, 5, v6
    v_and_b32 v7, 1, v0
    v_lshl_add_u32 v6, v7, 4, v6
    v_lshl_add_u32 v141, v4, 13, v6
    v_bfe_u32 v5, v0, 2, 2
    v_lshl_add_u32 v4, v4, 2, v5
    v_and_b32 v5, 7, v4
    v_lshlrev_b32 v4, 8, v4
    v_and_b32 v6, 3, v0
    v_lshl_add_u32 v4, v6, 3, v4
    s_lshl_b32 s55, s51, 2
    s_add_u32 s56, s55, 0
    v_xor_b32 v6, s56, v5
    v_lshl_add_u32 v142, v6, 5, v4
    v_add_u32 v146, 0x10000, v142
    s_add_u32 s56, s55, 1
    v_xor_b32 v6, s56, v5
    v_lshl_add_u32 v143, v6, 5, v4
    v_add_u32 v147, 0x10000, v143
    s_add_u32 s56, s55, 2
    v_xor_b32 v6, s56, v5
    v_lshl_add_u32 v144, v6, 5, v4
    v_add_u32 v148, 0x10000, v144
    s_add_u32 s56, s55, 3
    v_xor_b32 v6, s56, v5
    v_lshl_add_u32 v145, v6, 5, v4
    v_add_u32 v149, 0x10000, v145
    s_and_b32 s55, s44, 31
    s_lshl_b32 s57, s45, 2
    s_lshl_b32 s58, s52, 1
    s_add_u32 s57, s57, s58
    s_lshl_b32 s57, s57, 5
    s_add_u32 s57, s57, s55
    s_lshl_b32 s57, s57, 13
    s_cmp_ge_u32 s44, 64
    s_cbranch_scc1 qkvt_v_3
    s_lshl_b32 s49, s3, 12
    v_lshlrev_b32 v1, 4, v0
    v_add_u32 v6, 0x10000, v2
    v_add_u32 v7, 0x10000, v3
    v_mov_b32 v8, 0
    v_mov_b32 v9, 0
    v_mov_b32 v10, 0
    v_mov_b32 v11, 0
    v_mov_b32 v12, 0
    v_mov_b32 v13, 0
    v_mov_b32 v14, 0
    v_mov_b32 v15, 0
    v_mov_b32 v16, 0
    v_mov_b32 v17, 0
    v_mov_b32 v18, 0
    v_mov_b32 v19, 0
    v_mov_b32 v20, 0
    v_mov_b32 v21, 0
    v_mov_b32 v22, 0
    v_mov_b32 v23, 0
    v_mov_b32 v24, 0
    v_mov_b32 v25, 0
    v_mov_b32 v26, 0
    v_mov_b32 v27, 0
    v_mov_b32 v28, 0
    v_mov_b32 v29, 0
    v_mov_b32 v30, 0
    v_mov_b32 v31, 0
    v_mov_b32 v32, 0
    v_mov_b32 v33, 0
    v_mov_b32 v34, 0
    v_mov_b32 v35, 0
    v_mov_b32 v36, 0
    v_mov_b32 v37, 0
    v_mov_b32 v38, 0
    v_mov_b32 v39, 0
    v_mov_b32 v40, 0
    v_mov_b32 v41, 0
    v_mov_b32 v42, 0
    v_mov_b32 v43, 0
    v_mov_b32 v44, 0
    v_mov_b32 v45, 0
    v_mov_b32 v46, 0
    v_mov_b32 v47, 0
    v_mov_b32 v48, 0
    v_mov_b32 v49, 0
    v_mov_b32 v50, 0
    v_mov_b32 v51, 0
    v_mov_b32 v52, 0
    v_mov_b32 v53, 0
    v_mov_b32 v54, 0
    v_mov_b32 v55, 0
    v_mov_b32 v56, 0
    v_mov_b32 v57, 0
    v_mov_b32 v58, 0
    v_mov_b32 v59, 0
    v_mov_b32 v60, 0
    v_mov_b32 v61, 0
    v_mov_b32 v62, 0
    v_mov_b32 v63, 0
    v_mov_b32 v64, 0
    v_mov_b32 v65, 0
    v_mov_b32 v66, 0
    v_mov_b32 v67, 0
    v_mov_b32 v68, 0
    v_mov_b32 v69, 0
    v_mov_b32 v70, 0
    v_mov_b32 v71, 0
    s_cmp_ge_u32 s3, 2
    s_cbranch_scc1 gq_5
    s_add_u32 m0, s49, 0
    s_add_u32 s59, s48, 0
    buffer_load_dwordx4 v140, s[8:11], s59 offen lds
    s_add_u32 m0, s49, 1024
    s_add_u32 s59, s48, 32768
    buffer_load_dwordx4 v141, s[8:11], s59 offen lds
    s_add_u32 m0, s49, 2048
    s_add_u32 s59, s48, 65536
    buffer_load_dwordx4 v140, s[8:11], s59 offen lds
    s_add_u32 m0, s49, 3072
    s_add_u32 s59, s48, 98304
    buffer_load_dwordx4 v141, s[8:11], s59 offen lds
    s_add_u32 s48, s48, 262144
    s_branch ge_6
gq_5:
    s_add_u32 m0, s49, 0
    s_nop 0
    buffer_load_dwordx4 v1, s[4:7], s48 offen offset:0 lds
    buffer_load_dwordx4 v1, s[4:7], s48 offen offset:1024 lds
    buffer_load_dwordx4 v1, s[4:7], s48 offen offset:2048 lds
    buffer_load_dwordx4 v1, s[4:7], s48 offen offset:3072 lds
    s_add_u32 s48, s48, 4096
ge_6:
    s_cmp_ge_u32 s3, 2
    s_cbranch_scc1 gq_7
    s_add_u32 m0, s49, 16384
    s_add_u32 s59, s48, 0
    buffer_load_dwordx4 v140, s[8:11], s59 offen lds
    s_add_u32 m0, s49, 17408
    s_add_u32 s59, s48, 32768
    buffer_load_dwordx4 v141, s[8:11], s59 offen lds
    s_add_u32 m0, s49, 18432
    s_add_u32 s59, s48, 65536
    buffer_load_dwordx4 v140, s[8:11], s59 offen lds
    s_add_u32 m0, s49, 19456
    s_add_u32 s59, s48, 98304
    buffer_load_dwordx4 v141, s[8:11], s59 offen lds
    s_add_u32 s48, s48, 262144
    s_branch ge_8
gq_7:
    s_add_u32 m0, s49, 16384
    s_nop 0
    buffer_load_dwordx4 v1, s[4:7], s48 offen offset:0 lds
    buffer_load_dwordx4 v1, s[4:7], s48 offen offset:1024 lds
    buffer_load_dwordx4 v1, s[4:7], s48 offen offset:2048 lds
    buffer_load_dwordx4 v1, s[4:7], s48 offen offset:3072 lds
    s_add_u32 s48, s48, 4096
ge_8:
    s_cmp_ge_u32 s3, 2
    s_cbranch_scc1 gq_9
    s_add_u32 m0, s49, 32768
    s_add_u32 s59, s48, 0
    buffer_load_dwordx4 v140, s[8:11], s59 offen lds
    s_add_u32 m0, s49, 33792
    s_add_u32 s59, s48, 32768
    buffer_load_dwordx4 v141, s[8:11], s59 offen lds
    s_add_u32 m0, s49, 34816
    s_add_u32 s59, s48, 65536
    buffer_load_dwordx4 v140, s[8:11], s59 offen lds
    s_add_u32 m0, s49, 35840
    s_add_u32 s59, s48, 98304
    buffer_load_dwordx4 v141, s[8:11], s59 offen lds
    s_add_u32 s48, s48, 262144
    s_branch ge_10
gq_9:
    s_add_u32 m0, s49, 32768
    s_nop 0
    buffer_load_dwordx4 v1, s[4:7], s48 offen offset:0 lds
    buffer_load_dwordx4 v1, s[4:7], s48 offen offset:1024 lds
    buffer_load_dwordx4 v1, s[4:7], s48 offen offset:2048 lds
    buffer_load_dwordx4 v1, s[4:7], s48 offen offset:3072 lds
    s_add_u32 s48, s48, 4096
ge_10:
    s_cmp_ge_u32 s3, 2
    s_cbranch_scc1 gq_11
    s_add_u32 m0, s49, 49152
    s_add_u32 s59, s48, 0
    buffer_load_dwordx4 v140, s[8:11], s59 offen lds
    s_add_u32 m0, s49, 50176
    s_add_u32 s59, s48, 32768
    buffer_load_dwordx4 v141, s[8:11], s59 offen lds
    s_add_u32 m0, s49, 51200
    s_add_u32 s59, s48, 65536
    buffer_load_dwordx4 v140, s[8:11], s59 offen lds
    s_add_u32 m0, s49, 52224
    s_add_u32 s59, s48, 98304
    buffer_load_dwordx4 v141, s[8:11], s59 offen lds
    s_add_u32 s48, s48, 262144
    s_branch ge_12
gq_11:
    s_add_u32 m0, s49, 49152
    s_nop 0
    buffer_load_dwordx4 v1, s[4:7], s48 offen offset:0 lds
    buffer_load_dwordx4 v1, s[4:7], s48 offen offset:1024 lds
    buffer_load_dwordx4 v1, s[4:7], s48 offen offset:2048 lds
    buffer_load_dwordx4 v1, s[4:7], s48 offen offset:3072 lds
    s_add_u32 s48, s48, 4096
ge_12:
    s_cmp_ge_u32 s3, 2
    s_cbranch_scc1 gq_13
    s_add_u32 m0, s49, 65536
    s_add_u32 s59, s48, 0
    buffer_load_dwordx4 v140, s[8:11], s59 offen lds
    s_add_u32 m0, s49, 66560
    s_add_u32 s59, s48, 32768
    buffer_load_dwordx4 v141, s[8:11], s59 offen lds
    s_add_u32 m0, s49, 67584
    s_add_u32 s59, s48, 65536
    buffer_load_dwordx4 v140, s[8:11], s59 offen lds
    s_add_u32 m0, s49, 68608
    s_add_u32 s59, s48, 98304
    buffer_load_dwordx4 v141, s[8:11], s59 offen lds
    s_add_u32 s48, s48, 262144
    s_branch ge_14
gq_13:
    s_add_u32 m0, s49, 65536
    s_nop 0
    buffer_load_dwordx4 v1, s[4:7], s48 offen offset:0 lds
    buffer_load_dwordx4 v1, s[4:7], s48 offen offset:1024 lds
    buffer_load_dwordx4 v1, s[4:7], s48 offen offset:2048 lds
    buffer_load_dwordx4 v1, s[4:7], s48 offen offset:3072 lds
    s_add_u32 s48, s48, 4096
ge_14:
    s_cmp_ge_u32 s3, 2
    s_cbranch_scc1 gq_15
    s_add_u32 m0, s49, 81920
    s_add_u32 s59, s48, 0
    buffer_load_dwordx4 v140, s[8:11], s59 offen lds
    s_add_u32 m0, s49, 82944
    s_add_u32 s59, s48, 32768
    buffer_load_dwordx4 v141, s[8:11], s59 offen lds
    s_add_u32 m0, s49, 83968
    s_add_u32 s59, s48, 65536
    buffer_load_dwordx4 v140, s[8:11], s59 offen lds
    s_add_u32 m0, s49, 84992
    s_add_u32 s59, s48, 98304
    buffer_load_dwordx4 v141, s[8:11], s59 offen lds
    s_add_u32 s48, s48, 262144
    s_branch ge_16
gq_15:
    s_add_u32 m0, s49, 81920
    s_nop 0
    buffer_load_dwordx4 v1, s[4:7], s48 offen offset:0 lds
    buffer_load_dwordx4 v1, s[4:7], s48 offen offset:1024 lds
    buffer_load_dwordx4 v1, s[4:7], s48 offen offset:2048 lds
    buffer_load_dwordx4 v1, s[4:7], s48 offen offset:3072 lds
    s_add_u32 s48, s48, 4096
ge_16:
    s_cmp_ge_u32 s3, 2
    s_cbranch_scc1 gq_17
    s_add_u32 m0, s49, 98304
    s_add_u32 s59, s48, 0
    buffer_load_dwordx4 v140, s[8:11], s59 offen lds
    s_add_u32 m0, s49, 99328
    s_add_u32 s59, s48, 32768
    buffer_load_dwordx4 v141, s[8:11], s59 offen lds
    s_add_u32 m0, s49, 100352
    s_add_u32 s59, s48, 65536
    buffer_load_dwordx4 v140, s[8:11], s59 offen lds
    s_add_u32 m0, s49, 101376
    s_add_u32 s59, s48, 98304
    buffer_load_dwordx4 v141, s[8:11], s59 offen lds
    s_add_u32 s48, s48, 262144
    s_branch ge_18
gq_17:
    s_add_u32 m0, s49, 98304
    s_nop 0
    buffer_load_dwordx4 v1, s[4:7], s48 offen offset:0 lds
    buffer_load_dwordx4 v1, s[4:7], s48 offen offset:1024 lds
    buffer_load_dwordx4 v1, s[4:7], s48 offen offset:2048 lds
    buffer_load_dwordx4 v1, s[4:7], s48 offen offset:3072 lds
    s_add_u32 s48, s48, 4096
ge_18:
    s_waitcnt vmcnt(24)
    s_barrier
    ds_read_b64_tr_b16 v[72:73], v142 offset:0
    ds_read_b64_tr_b16 v[74:75], v142 offset:4096
    ds_read_b64_tr_b16 v[76:77], v143 offset:0
    ds_read_b64_tr_b16 v[78:79], v143 offset:4096
    ds_read_b64_tr_b16 v[80:81], v144 offset:0
    ds_read_b64_tr_b16 v[82:83], v144 offset:4096
    ds_read_b64_tr_b16 v[84:85], v145 offset:0
    ds_read_b64_tr_b16 v[86:87], v145 offset:4096
    ds_read_b128 v[88:91], v3 offset:0
    ds_read_b128 v[92:95], v3 offset:1024
    ds_read_b128 v[96:99], v3 offset:2048
    ds_read_b128 v[100:103], v3 offset:3072
    s_mov_b32 s50, 1
gloop_19:
    s_waitcnt vmcnt(20)
    s_barrier
    s_cmp_ge_u32 s3, 2
    s_cbranch_scc1 gq_20
    s_add_u32 m0, s49, 114688
    s_add_u32 s59, s48, 0
    buffer_load_dwordx4 v140, s[8:11], s59 offen lds
    s_add_u32 m0, s49, 115712
    s_add_u32 s59, s48, 32768
    buffer_load_dwordx4 v141, s[8:11], s59 offen lds
    s_add_u32 m0, s49, 116736
    s_add_u32 s59, s48, 65536
    buffer_load_dwordx4 v140, s[8:11], s59 offen lds
    s_add_u32 m0, s49, 117760
    s_add_u32 s59, s48, 98304
    buffer_load_dwordx4 v141, s[8:11], s59 offen lds
    s_add_u32 s48, s48, 262144
    s_branch ge_21
gq_20:
    s_add_u32 m0, s49, 114688
    s_nop 0
    buffer_load_dwordx4 v1, s[4:7], s48 offen offset:0 lds
    buffer_load_dwordx4 v1, s[4:7], s48 offen offset:1024 lds
    buffer_load_dwordx4 v1, s[4:7], s48 offen offset:2048 lds
    buffer_load_dwordx4 v1, s[4:7], s48 offen offset:3072 lds
    s_add_u32 s48, s48, 4096
ge_21:
    s_waitcnt lgkmcnt(0)
    ds_read_b64_tr_b16 v[104:105], v142 offset:16384
    ds_read_b64_tr_b16 v[106:107], v142 offset:20480
    ds_read_b64_tr_b16 v[108:109], v143 offset:16384
    ds_read_b64_tr_b16 v[110:111], v143 offset:20480
    ds_read_b64_tr_b16 v[112:113], v144 offset:16384
    ds_read_b64_tr_b16 v[114:115], v144 offset:20480
    ds_read_b64_tr_b16 v[116:117], v145 offset:16384
    ds_read_b64_tr_b16 v[118:119], v145 offset:20480
    ds_read_b128 v[120:123], v3 offset:16384
    ds_read_b128 v[124:127], v3 offset:17408
    ds_read_b128 v[128:131], v3 offset:18432
    ds_read_b128 v[132:135], v3 offset:19456
    v_mfma_f32_16x16x32_bf16 v[8:11], v[72:75], v[88:91], v[8:11]
    v_mfma_f32_16x16x32_bf16 v[12:15], v[72:75], v[92:95], v[12:15]
    v_mfma_f32_16x16x32_bf16 v[16:19], v[72:75], v[96:99], v[16:19]
    v_mfma_f32_16x16x32_bf16 v[20:23], v[72:75], v[100:103], v[20:23]
    v_mfma_f32_16x16x32_bf16 v[24:27], v[76:79], v[88:91], v[24:27]
    v_mfma_f32_16x16x32_bf16 v[28:31], v[76:79], v[92:95], v[28:31]
    v_mfma_f32_16x16x32_bf16 v[32:35], v[76:79], v[96:99], v[32:35]
    v_mfma_f32_16x16x32_bf16 v[36:39], v[76:79], v[100:103], v[36:39]
    v_mfma_f32_16x16x32_bf16 v[40:43], v[80:83], v[88:91], v[40:43]
    v_mfma_f32_16x16x32_bf16 v[44:47], v[80:83], v[92:95], v[44:47]
    v_mfma_f32_16x16x32_bf16 v[48:51], v[80:83], v[96:99], v[48:51]
    v_mfma_f32_16x16x32_bf16 v[52:55], v[80:83], v[100:103], v[52:55]
    v_mfma_f32_16x16x32_bf16 v[56:59], v[84:87], v[88:91], v[56:59]
    v_mfma_f32_16x16x32_bf16 v[60:63], v[84:87], v[92:95], v[60:63]
    v_mfma_f32_16x16x32_bf16 v[64:67], v[84:87], v[96:99], v[64:67]
    v_mfma_f32_16x16x32_bf16 v[68:71], v[84:87], v[100:103], v[68:71]
    s_waitcnt vmcnt(20)
    s_barrier
    s_cmp_ge_u32 s3, 2
    s_cbranch_scc1 gq_22
    s_add_u32 m0, s49, 0
    s_add_u32 s59, s48, 0
    buffer_load_dwordx4 v140, s[8:11], s59 offen lds
    s_add_u32 m0, s49, 1024
    s_add_u32 s59, s48, 32768
    buffer_load_dwordx4 v141, s[8:11], s59 offen lds
    s_add_u32 m0, s49, 2048
    s_add_u32 s59, s48, 65536
    buffer_load_dwordx4 v140, s[8:11], s59 offen lds
    s_add_u32 m0, s49, 3072
    s_add_u32 s59, s48, 98304
    buffer_load_dwordx4 v141, s[8:11], s59 offen lds
    s_add_u32 s48, s48, 262144
    s_branch ge_23
gq_22:
    s_add_u32 m0, s49, 0
    s_nop 0
    buffer_load_dwordx4 v1, s[4:7], s48 offen offset:0 lds
    buffer_load_dwordx4 v1, s[4:7], s48 offen offset:1024 lds
    buffer_load_dwordx4 v1, s[4:7], s48 offen offset:2048 lds
    buffer_load_dwordx4 v1, s[4:7], s48 offen offset:3072 lds
    s_add_u32 s48, s48, 4096
ge_23:
    s_waitcnt lgkmcnt(0)
    ds_read_b64_tr_b16 v[72:73], v142 offset:32768
    ds_read_b64_tr_b16 v[74:75], v142 offset:36864
    ds_read_b64_tr_b16 v[76:77], v143 offset:32768
    ds_read_b64_tr_b16 v[78:79], v143 offset:36864
    ds_read_b64_tr_b16 v[80:81], v144 offset:32768
    ds_read_b64_tr_b16 v[82:83], v144 offset:36864
    ds_read_b64_tr_b16 v[84:85], v145 offset:32768
    ds_read_b64_tr_b16 v[86:87], v145 offset:36864
    ds_read_b128 v[88:91], v3 offset:32768
    ds_read_b128 v[92:95], v3 offset:33792
    ds_read_b128 v[96:99], v3 offset:34816
    ds_read_b128 v[100:103], v3 offset:35840
    v_mfma_f32_16x16x32_bf16 v[8:11], v[104:107], v[120:123], v[8:11]
    v_mfma_f32_16x16x32_bf16 v[12:15], v[104:107], v[124:127], v[12:15]
    v_mfma_f32_16x16x32_bf16 v[16:19], v[104:107], v[128:131], v[16:19]
    v_mfma_f32_16x16x32_bf16 v[20:23], v[104:107], v[132:135], v[20:23]
    v_mfma_f32_16x16x32_bf16 v[24:27], v[108:111], v[120:123], v[24:27]
    v_mfma_f32_16x16x32_bf16 v[28:31], v[108:111], v[124:127], v[28:31]
    v_mfma_f32_16x16x32_bf16 v[32:35], v[108:111], v[128:131], v[32:35]
    v_mfma_f32_16x16x32_bf16 v[36:39], v[108:111], v[132:135], v[36:39]
    v_mfma_f32_16x16x32_bf16 v[40:43], v[112:115], v[120:123], v[40:43]
    v_mfma_f32_16x16x32_bf16 v[44:47], v[112:115], v[124:127], v[44:47]
    v_mfma_f32_16x16x32_bf16 v[48:51], v[112:115], v[128:131], v[48:51]
    v_mfma_f32_16x16x32_bf16 v[52:55], v[112:115], v[132:135], v[52:55]
    v_mfma_f32_16x16x32_bf16 v[56:59], v[116:119], v[120:123], v[56:59]
    v_mfma_f32_16x16x32_bf16 v[60:63], v[116:119], v[124:127], v[60:63]
    v_mfma_f32_16x16x32_bf16 v[64:67], v[116:119], v[128:131], v[64:67]
    v_mfma_f32_16x16x32_bf16 v[68:71], v[116:119], v[132:135], v[68:71]
    s_waitcnt vmcnt(20)
    s_barrier
    s_cmp_ge_u32 s3, 2
    s_cbranch_scc1 gq_24
    s_add_u32 m0, s49, 16384
    s_add_u32 s59, s48, 0
    buffer_load_dwordx4 v140, s[8:11], s59 offen lds
    s_add_u32 m0, s49, 17408
    s_add_u32 s59, s48, 32768
    buffer_load_dwordx4 v141, s[8:11], s59 offen lds
    s_add_u32 m0, s49, 18432
    s_add_u32 s59, s48, 65536
    buffer_load_dwordx4 v140, s[8:11], s59 offen lds
    s_add_u32 m0, s49, 19456
    s_add_u32 s59, s48, 98304
    buffer_load_dwordx4 v141, s[8:11], s59 offen lds
    s_add_u32 s48, s48, 262144
    s_branch ge_25
gq_24:
    s_add_u32 m0, s49, 16384
    s_nop 0
    buffer_load_dwordx4 v1, s[4:7], s48 offen offset:0 lds
    buffer_load_dwordx4 v1, s[4:7], s48 offen offset:1024 lds
    buffer_load_dwordx4 v1, s[4:7], s48 offen offset:2048 lds
    buffer_load_dwordx4 v1, s[4:7], s48 offen offset:3072 lds
    s_add_u32 s48, s48, 4096
ge_25:
    s_waitcnt lgkmcnt(0)
    ds_read_b64_tr_b16 v[104:105], v142 offset:49152
    ds_read_b64_tr_b16 v[106:107], v142 offset:53248
    ds_read_b64_tr_b16 v[108:109], v143 offset:49152
    ds_read_b64_tr_b16 v[110:111], v143 offset:53248
    ds_read_b64_tr_b16 v[112:113], v144 offset:49152
    ds_read_b64_tr_b16 v[114:115], v144 offset:53248
    ds_read_b64_tr_b16 v[116:117], v145 offset:49152
    ds_read_b64_tr_b16 v[118:119], v145 offset:53248
    ds_read_b128 v[120:123], v3 offset:49152
    ds_read_b128 v[124:127], v3 offset:50176
    ds_read_b128 v[128:131], v3 offset:51200
    ds_read_b128 v[132:135], v3 offset:52224
    v_mfma_f32_16x16x32_bf16 v[8:11], v[72:75], v[88:91], v[8:11]
    v_mfma_f32_16x16x32_bf16 v[12:15], v[72:75], v[92:95], v[12:15]
    v_mfma_f32_16x16x32_bf16 v[16:19], v[72:75], v[96:99], v[16:19]
    v_mfma_f32_16x16x32_bf16 v[20:23], v[72:75], v[100:103], v[20:23]
    v_mfma_f32_16x16x32_bf16 v[24:27], v[76:79], v[88:91], v[24:27]
    v_mfma_f32_16x16x32_bf16 v[28:31], v[76:79], v[92:95], v[28:31]
    v_mfma_f32_16x16x32_bf16 v[32:35], v[76:79], v[96:99], v[32:35]
    v_mfma_f32_16x16x32_bf16 v[36:39], v[76:79], v[100:103], v[36:39]
    v_mfma_f32_16x16x32_bf16 v[40:43], v[80:83], v[88:91], v[40:43]
    v_mfma_f32_16x16x32_bf16 v[44:47], v[80:83], v[92:95], v[44:47]
    v_mfma_f32_16x16x32_bf16 v[48:51], v[80:83], v[96:99], v[48:51]
    v_mfma_f32_16x16x32_bf16 v[52:55], v[80:83], v[100:103], v[52:55]
    v_mfma_f32_16x16x32_bf16 v[56:59], v[84:87], v[88:91], v[56:59]
    v_mfma_f32_16x16x32_bf16 v[60:63], v[84:87], v[92:95], v[60:63]
    v_mfma_f32_16x16x32_bf16 v[64:67], v[84:87], v[96:99], v[64:67]
    v_mfma_f32_16x16x32_bf16 v[68:71], v[84:87], v[100:103], v[68:71]
    s_waitcnt vmcnt(20)
    s_barrier
    s_cmp_ge_u32 s3, 2
    s_cbranch_scc1 gq_26
    s_add_u32 m0, s49, 32768
    s_add_u32 s59, s48, 0
    buffer_load_dwordx4 v140, s[8:11], s59 offen lds
    s_add_u32 m0, s49, 33792
    s_add_u32 s59, s48, 32768
    buffer_load_dwordx4 v141, s[8:11], s59 offen lds
    s_add_u32 m0, s49, 34816
    s_add_u32 s59, s48, 65536
    buffer_load_dwordx4 v140, s[8:11], s59 offen lds
    s_add_u32 m0, s49, 35840
    s_add_u32 s59, s48, 98304
    buffer_load_dwordx4 v141, s[8:11], s59 offen lds
    s_add_u32 s48, s48, 262144
    s_branch ge_27
gq_26:
    s_add_u32 m0, s49, 32768
    s_nop 0
    buffer_load_dwordx4 v1, s[4:7], s48 offen offset:0 lds
    buffer_load_dwordx4 v1, s[4:7], s48 offen offset:1024 lds
    buffer_load_dwordx4 v1, s[4:7], s48 offen offset:2048 lds
    buffer_load_dwordx4 v1, s[4:7], s48 offen offset:3072 lds
    s_add_u32 s48, s48, 4096
ge_27:
    s_waitcnt lgkmcnt(0)
    ds_read_b64_tr_b16 v[72:73], v146 offset:0
    ds_read_b64_tr_b16 v[74:75], v146 offset:4096
    ds_read_b64_tr_b16 v[76:77], v147 offset:0
    ds_read_b64_tr_b16 v[78:79], v147 offset:4096
    ds_read_b64_tr_b16 v[80:81], v148 offset:0
    ds_read_b64_tr_b16 v[82:83], v148 offset:4096
    ds_read_b64_tr_b16 v[84:85], v149 offset:0
    ds_read_b64_tr_b16 v[86:87], v149 offset:4096
    ds_read_b128 v[88:91], v7 offset:0
    ds_read_b128 v[92:95], v7 offset:1024
    ds_read_b128 v[96:99], v7 offset:2048
    ds_read_b128 v[100:103], v7 offset:3072
    v_mfma_f32_16x16x32_bf16 v[8:11], v[104:107], v[120:123], v[8:11]
    v_mfma_f32_16x16x32_bf16 v[12:15], v[104:107], v[124:127], v[12:15]
    v_mfma_f32_16x16x32_bf16 v[16:19], v[104:107], v[128:131], v[16:19]
    v_mfma_f32_16x16x32_bf16 v[20:23], v[104:107], v[132:135], v[20:23]
    v_mfma_f32_16x16x32_bf16 v[24:27], v[108:111], v[120:123], v[24:27]
    v_mfma_f32_16x16x32_bf16 v[28:31], v[108:111], v[124:127], v[28:31]
    v_mfma_f32_16x16x32_bf16 v[32:35], v[108:111], v[128:131], v[32:35]
    v_mfma_f32_16x16x32_bf16 v[36:39], v[108:111], v[132:135], v[36:39]
    v_mfma_f32_16x16x32_bf16 v[40:43], v[112:115], v[120:123], v[40:43]
    v_mfma_f32_16x16x32_bf16 v[44:47], v[112:115], v[124:127], v[44:47]
    v_mfma_f32_16x16x32_bf16 v[48:51], v[112:115], v[128:131], v[48:51]
    v_mfma_f32_16x16x32_bf16 v[52:55], v[112:115], v[132:135], v[52:55]
    v_mfma_f32_16x16x32_bf16 v[56:59], v[116:119], v[120:123], v[56:59]
    v_mfma_f32_16x16x32_bf16 v[60:63], v[116:119], v[124:127], v[60:63]
    v_mfma_f32_16x16x32_bf16 v[64:67], v[116:119], v[128:131], v[64:67]
    v_mfma_f32_16x16x32_bf16 v[68:71], v[116:119], v[132:135], v[68:71]
    s_waitcnt vmcnt(20)
    s_barrier
    s_cmp_ge_u32 s3, 2
    s_cbranch_scc1 gq_28
    s_add_u32 m0, s49, 49152
    s_add_u32 s59, s48, 0
    buffer_load_dwordx4 v140, s[8:11], s59 offen lds
    s_add_u32 m0, s49, 50176
    s_add_u32 s59, s48, 32768
    buffer_load_dwordx4 v141, s[8:11], s59 offen lds
    s_add_u32 m0, s49, 51200
    s_add_u32 s59, s48, 65536
    buffer_load_dwordx4 v140, s[8:11], s59 offen lds
    s_add_u32 m0, s49, 52224
    s_add_u32 s59, s48, 98304
    buffer_load_dwordx4 v141, s[8:11], s59 offen lds
    s_add_u32 s48, s48, 262144
    s_branch ge_29
gq_28:
    s_add_u32 m0, s49, 49152
    s_nop 0
    buffer_load_dwordx4 v1, s[4:7], s48 offen offset:0 lds
    buffer_load_dwordx4 v1, s[4:7], s48 offen offset:1024 lds
    buffer_load_dwordx4 v1, s[4:7], s48 offen offset:2048 lds
    buffer_load_dwordx4 v1, s[4:7], s48 offen offset:3072 lds
    s_add_u32 s48, s48, 4096
ge_29:
    s_waitcnt lgkmcnt(0)
    ds_read_b64_tr_b16 v[104:105], v146 offset:16384
    ds_read_b64_tr_b16 v[106:107], v146 offset:20480
    ds_read_b64_tr_b16 v[108:109], v147 offset:16384
    ds_read_b64_tr_b16 v[110:111], v147 offset:20480
    ds_read_b64_tr_b16 v[112:113], v148 offset:16384
    ds_read_b64_tr_b16 v[114:115], v148 offset:20480
    ds_read_b64_tr_b16 v[116:117], v149 offset:16384
    ds_read_b64_tr_b16 v[118:119], v149 offset:20480
    ds_read_b128 v[120:123], v7 offset:16384
    ds_read_b128 v[124:127], v7 offset:17408
    ds_read_b128 v[128:131], v7 offset:18432
    ds_read_b128 v[132:135], v7 offset:19456
    v_mfma_f32_16x16x32_bf16 v[8:11], v[72:75], v[88:91], v[8:11]
    v_mfma_f32_16x16x32_bf16 v[12:15], v[72:75], v[92:95], v[12:15]
    v_mfma_f32_16x16x32_bf16 v[16:19], v[72:75], v[96:99], v[16:19]
    v_mfma_f32_16x16x32_bf16 v[20:23], v[72:75], v[100:103], v[20:23]
    v_mfma_f32_16x16x32_bf16 v[24:27], v[76:79], v[88:91], v[24:27]
    v_mfma_f32_16x16x32_bf16 v[28:31], v[76:79], v[92:95], v[28:31]
    v_mfma_f32_16x16x32_bf16 v[32:35], v[76:79], v[96:99], v[32:35]
    v_mfma_f32_16x16x32_bf16 v[36:39], v[76:79], v[100:103], v[36:39]
    v_mfma_f32_16x16x32_bf16 v[40:43], v[80:83], v[88:91], v[40:43]
    v_mfma_f32_16x16x32_bf16 v[44:47], v[80:83], v[92:95], v[44:47]
    v_mfma_f32_16x16x32_bf16 v[48:51], v[80:83], v[96:99], v[48:51]
    v_mfma_f32_16x16x32_bf16 v[52:55], v[80:83], v[100:103], v[52:55]
    v_mfma_f32_16x16x32_bf16 v[56:59], v[84:87], v[88:91], v[56:59]
    v_mfma_f32_16x16x32_bf16 v[60:63], v[84:87], v[92:95], v[60:63]
    v_mfma_f32_16x16x32_bf16 v[64:67], v[84:87], v[96:99], v[64:67]
    v_mfma_f32_16x16x32_bf16 v[68:71], v[84:87], v[100:103], v[68:71]
    s_waitcnt vmcnt(20)
    s_barrier
    s_cmp_ge_u32 s3, 2
    s_cbranch_scc1 gq_30
    s_add_u32 m0, s49, 65536
    s_add_u32 s59, s48, 0
    buffer_load_dwordx4 v140, s[8:11], s59 offen lds
    s_add_u32 m0, s49, 66560
    s_add_u32 s59, s48, 32768
    buffer_load_dwordx4 v141, s[8:11], s59 offen lds
    s_add_u32 m0, s49, 67584
    s_add_u32 s59, s48, 65536
    buffer_load_dwordx4 v140, s[8:11], s59 offen lds
    s_add_u32 m0, s49, 68608
    s_add_u32 s59, s48, 98304
    buffer_load_dwordx4 v141, s[8:11], s59 offen lds
    s_add_u32 s48, s48, 262144
    s_branch ge_31
gq_30:
    s_add_u32 m0, s49, 65536
    s_nop 0
    buffer_load_dwordx4 v1, s[4:7], s48 offen offset:0 lds
    buffer_load_dwordx4 v1, s[4:7], s48 offen offset:1024 lds
    buffer_load_dwordx4 v1, s[4:7], s48 offen offset:2048 lds
    buffer_load_dwordx4 v1, s[4:7], s48 offen offset:3072 lds
    s_add_u32 s48, s48, 4096
ge_31:
    s_waitcnt lgkmcnt(0)
    ds_read_b64_tr_b16 v[72:73], v146 offset:32768
    ds_read_b64_tr_b16 v[74:75], v146 offset:36864
    ds_read_b64_tr_b16 v[76:77], v147 offset:32768
    ds_read_b64_tr_b16 v[78:79], v147 offset:36864
    ds_read_b64_tr_b16 v[80:81], v148 offset:32768
    ds_read_b64_tr_b16 v[82:83], v148 offset:36864
    ds_read_b64_tr_b16 v[84:85], v149 offset:32768
    ds_read_b64_tr_b16 v[86:87], v149 offset:36864
    ds_read_b128 v[88:91], v7 offset:32768
    ds_read_b128 v[92:95], v7 offset:33792
    ds_read_b128 v[96:99], v7 offset:34816
    ds_read_b128 v[100:103], v7 offset:35840
    v_mfma_f32_16x16x32_bf16 v[8:11], v[104:107], v[120:123], v[8:11]
    v_mfma_f32_16x16x32_bf16 v[12:15], v[104:107], v[124:127], v[12:15]
    v_mfma_f32_16x16x32_bf16 v[16:19], v[104:107], v[128:131], v[16:19]
    v_mfma_f32_16x16x32_bf16 v[20:23], v[104:107], v[132:135], v[20:23]
    v_mfma_f32_16x16x32_bf16 v[24:27], v[108:111], v[120:123], v[24:27]
    v_mfma_f32_16x16x32_bf16 v[28:31], v[108:111], v[124:127], v[28:31]
    v_mfma_f32_16x16x32_bf16 v[32:35], v[108:111], v[128:131], v[32:35]
    v_mfma_f32_16x16x32_bf16 v[36:39], v[108:111], v[132:135], v[36:39]
    v_mfma_f32_16x16x32_bf16 v[40:43], v[112:115], v[120:123], v[40:43]
    v_mfma_f32_16x16x32_bf16 v[44:47], v[112:115], v[124:127], v[44:47]
    v_mfma_f32_16x16x32_bf16 v[48:51], v[112:115], v[128:131], v[48:51]
    v_mfma_f32_16x16x32_bf16 v[52:55], v[112:115], v[132:135], v[52:55]
    v_mfma_f32_16x16x32_bf16 v[56:59], v[116:119], v[120:123], v[56:59]
    v_mfma_f32_16x16x32_bf16 v[60:63], v[116:119], v[124:127], v[60:63]
    v_mfma_f32_16x16x32_bf16 v[64:67], v[116:119], v[128:131], v[64:67]
    v_mfma_f32_16x16x32_bf16 v[68:71], v[116:119], v[132:135], v[68:71]
    s_waitcnt vmcnt(20)
    s_barrier
    s_cmp_ge_u32 s3, 2
    s_cbranch_scc1 gq_32
    s_add_u32 m0, s49, 81920
    s_add_u32 s59, s48, 0
    buffer_load_dwordx4 v140, s[8:11], s59 offen lds
    s_add_u32 m0, s49, 82944
    s_add_u32 s59, s48, 32768
    buffer_load_dwordx4 v141, s[8:11], s59 offen lds
    s_add_u32 m0, s49, 83968
    s_add_u32 s59, s48, 65536
    buffer_load_dwordx4 v140, s[8:11], s59 offen lds
    s_add_u32 m0, s49, 84992
    s_add_u32 s59, s48, 98304
    buffer_load_dwordx4 v141, s[8:11], s59 offen lds
    s_add_u32 s48, s48, 262144
    s_branch ge_33
gq_32:
    s_add_u32 m0, s49, 81920
    s_nop 0
    buffer_load_dwordx4 v1, s[4:7], s48 offen offset:0 lds
    buffer_load_dwordx4 v1, s[4:7], s48 offen offset:1024 lds
    buffer_load_dwordx4 v1, s[4:7], s48 offen offset:2048 lds
    buffer_load_dwordx4 v1, s[4:7], s48 offen offset:3072 lds
    s_add_u32 s48, s48, 4096
ge_33:
    s_waitcnt lgkmcnt(0)
    ds_read_b64_tr_b16 v[104:105], v146 offset:49152
    ds_read_b64_tr_b16 v[106:107], v146 offset:53248
    ds_read_b64_tr_b16 v[108:109], v147 offset:49152
    ds_read_b64_tr_b16 v[110:111], v147 offset:53248
    ds_read_b64_tr_b16 v[112:113], v148 offset:49152
    ds_read_b64_tr_b16 v[114:115], v148 offset:53248
    ds_read_b64_tr_b16 v[116:117], v149 offset:49152
    ds_read_b64_tr_b16 v[118:119], v149 offset:53248
    ds_read_b128 v[120:123], v7 offset:49152
    ds_read_b128 v[124:127], v7 offset:50176
    ds_read_b128 v[128:131], v7 offset:51200
    ds_read_b128 v[132:135], v7 offset:52224
    v_mfma_f32_16x16x32_bf16 v[8:11], v[72:75], v[88:91], v[8:11]
    v_mfma_f32_16x16x32_bf16 v[12:15], v[72:75], v[92:95], v[12:15]
    v_mfma_f32_16x16x32_bf16 v[16:19], v[72:75], v[96:99], v[16:19]
    v_mfma_f32_16x16x32_bf16 v[20:23], v[72:75], v[100:103], v[20:23]
    v_mfma_f32_16x16x32_bf16 v[24:27], v[76:79], v[88:91], v[24:27]
    v_mfma_f32_16x16x32_bf16 v[28:31], v[76:79], v[92:95], v[28:31]
    v_mfma_f32_16x16x32_bf16 v[32:35], v[76:79], v[96:99], v[32:35]
    v_mfma_f32_16x16x32_bf16 v[36:39], v[76:79], v[100:103], v[36:39]
    v_mfma_f32_16x16x32_bf16 v[40:43], v[80:83], v[88:91], v[40:43]
    v_mfma_f32_16x16x32_bf16 v[44:47], v[80:83], v[92:95], v[44:47]
    v_mfma_f32_16x16x32_bf16 v[48:51], v[80:83], v[96:99], v[48:51]
    v_mfma_f32_16x16x32_bf16 v[52:55], v[80:83], v[100:103], v[52:55]
    v_mfma_f32_16x16x32_bf16 v[56:59], v[84:87], v[88:91], v[56:59]
    v_mfma_f32_16x16x32_bf16 v[60:63], v[84:87], v[92:95], v[60:63]
    v_mfma_f32_16x16x32_bf16 v[64:67], v[84:87], v[96:99], v[64:67]
    v_mfma_f32_16x16x32_bf16 v[68:71], v[84:87], v[100:103], v[68:71]
    s_waitcnt vmcnt(20)
    s_barrier
    s_cmp_ge_u32 s3, 2
    s_cbranch_scc1 gq_34
    s_add_u32 m0, s49, 98304
    s_add_u32 s59, s48, 0
    buffer_load_dwordx4 v140, s[8:11], s59 offen lds
    s_add_u32 m0, s49, 99328
    s_add_u32 s59, s48, 32768
    buffer_load_dwordx4 v141, s[8:11], s59 offen lds
    s_add_u32 m0, s49, 100352
    s_add_u32 s59, s48, 65536
    buffer_load_dwordx4 v140, s[8:11], s59 offen lds
    s_add_u32 m0, s49, 101376
    s_add_u32 s59, s48, 98304
    buffer_load_dwordx4 v141, s[8:11], s59 offen lds
    s_add_u32 s48, s48, 262144
    s_branch ge_35
gq_34:
    s_add_u32 m0, s49, 98304
    s_nop 0
    buffer_load_dwordx4 v1, s[4:7], s48 offen offset:0 lds
    buffer_load_dwordx4 v1, s[4:7], s48 offen offset:1024 lds
    buffer_load_dwordx4 v1, s[4:7], s48 offen offset:2048 lds
    buffer_load_dwordx4 v1, s[4:7], s48 offen offset:3072 lds
    s_add_u32 s48, s48, 4096
ge_35:
    s_waitcnt lgkmcnt(0)
    ds_read_b64_tr_b16 v[72:73], v142 offset:0
    ds_read_b64_tr_b16 v[74:75], v142 offset:4096
    ds_read_b64_tr_b16 v[76:77], v143 offset:0
    ds_read_b64_tr_b16 v[78:79], v143 offset:4096
    ds_read_b64_tr_b16 v[80:81], v144 offset:0
    ds_read_b64_tr_b16 v[82:83], v144 offset:4096
    ds_read_b64_tr_b16 v[84:85], v145 offset:0
    ds_read_b64_tr_b16 v[86:87], v145 offset:4096
    ds_read_b128 v[88:91], v3 offset:0
    ds_read_b128 v[92:95], v3 offset:1024
    ds_read_b128 v[96:99], v3 offset:2048
    ds_read_b128 v[100:103], v3 offset:3072
    v_mfma_f32_16x16x32_bf16 v[8:11], v[104:107], v[120:123], v[8:11]
    v_mfma_f32_16x16x32_bf16 v[12:15], v[104:107], v[124:127], v[12:15]
    v_mfma_f32_16x16x32_bf16 v[16:19], v[104:107], v[128:131], v[16:19]
    v_mfma_f32_16x16x32_bf16 v[20:23], v[104:107], v[132:135], v[20:23]
    v_mfma_f32_16x16x32_bf16 v[24:27], v[108:111], v[120:123], v[24:27]
    v_mfma_f32_16x16x32_bf16 v[28:31], v[108:111], v[124:127], v[28:31]
    v_mfma_f32_16x16x32_bf16 v[32:35], v[108:111], v[128:131], v[32:35]
    v_mfma_f32_16x16x32_bf16 v[36:39], v[108:111], v[132:135], v[36:39]
    v_mfma_f32_16x16x32_bf16 v[40:43], v[112:115], v[120:123], v[40:43]
    v_mfma_f32_16x16x32_bf16 v[44:47], v[112:115], v[124:127], v[44:47]
    v_mfma_f32_16x16x32_bf16 v[48:51], v[112:115], v[128:131], v[48:51]
    v_mfma_f32_16x16x32_bf16 v[52:55], v[112:115], v[132:135], v[52:55]
    v_mfma_f32_16x16x32_bf16 v[56:59], v[116:119], v[120:123], v[56:59]
    v_mfma_f32_16x16x32_bf16 v[60:63], v[116:119], v[124:127], v[60:63]
    v_mfma_f32_16x16x32_bf16 v[64:67], v[116:119], v[128:131], v[64:67]
    v_mfma_f32_16x16x32_bf16 v[68:71], v[116:119], v[132:135], v[68:71]
    s_sub_u32 s50, s50, 1
    s_cmp_lg_u32 s50, 0
    s_cbranch_scc1 gloop_19
    s_waitcnt vmcnt(20)
    s_barrier
    s_cmp_ge_u32 s3, 2
    s_cbranch_scc1 gq_36
    s_add_u32 m0, s49, 114688
    s_add_u32 s59, s48, 0
    buffer_load_dwordx4 v140, s[8:11], s59 offen lds
    s_add_u32 m0, s49, 115712
    s_add_u32 s59, s48, 32768
    buffer_load_dwordx4 v141, s[8:11], s59 offen lds
    s_add_u32 m0, s49, 116736
    s_add_u32 s59, s48, 65536
    buffer_load_dwordx4 v140, s[8:11], s59 offen lds
    s_add_u32 m0, s49, 117760
    s_add_u32 s59, s48, 98304
    buffer_load_dwordx4 v141, s[8:11], s59 offen lds
    s_add_u32 s48, s48, 262144
    s_branch ge_37
gq_36:
    s_add_u32 m0, s49, 114688
    s_nop 0
    buffer_load_dwordx4 v1, s[4:7], s48 offen offset:0 lds
    buffer_load_dwordx4 v1, s[4:7], s48 offen offset:1024 lds
    buffer_load_dwordx4 v1, s[4:7], s48 offen offset:2048 lds
    buffer_load_dwordx4 v1, s[4:7], s48 offen offset:3072 lds
    s_add_u32 s48, s48, 4096
ge_37:
    s_waitcnt lgkmcnt(0)
    ds_read_b64_tr_b16 v[104:105], v142 offset:16384
    ds_read_b64_tr_b16 v[106:107], v142 offset:20480
    ds_read_b64_tr_b16 v[108:109], v143 offset:16384
    ds_read_b64_tr_b16 v[110:111], v143 offset:20480
    ds_read_b64_tr_b16 v[112:113], v144 offset:16384
    ds_read_b64_tr_b16 v[114:115], v144 offset:20480
    ds_read_b64_tr_b16 v[116:117], v145 offset:16384
    ds_read_b64_tr_b16 v[118:119], v145 offset:20480
    ds_read_b128 v[120:123], v3 offset:16384
    ds_read_b128 v[124:127], v3 offset:17408
    ds_read_b128 v[128:131], v3 offset:18432
    ds_read_b128 v[132:135], v3 offset:19456
    v_mfma_f32_16x16x32_bf16 v[8:11], v[72:75], v[88:91], v[8:11]
    v_mfma_f32_16x16x32_bf16 v[12:15], v[72:75], v[92:95], v[12:15]
    v_mfma_f32_16x16x32_bf16 v[16:19], v[72:75], v[96:99], v[16:19]
    v_mfma_f32_16x16x32_bf16 v[20:23], v[72:75], v[100:103], v[20:23]
    v_mfma_f32_16x16x32_bf16 v[24:27], v[76:79], v[88:91], v[24:27]
    v_mfma_f32_16x16x32_bf16 v[28:31], v[76:79], v[92:95], v[28:31]
    v_mfma_f32_16x16x32_bf16 v[32:35], v[76:79], v[96:99], v[32:35]
    v_mfma_f32_16x16x32_bf16 v[36:39], v[76:79], v[100:103], v[36:39]
    v_mfma_f32_16x16x32_bf16 v[40:43], v[80:83], v[88:91], v[40:43]
    v_mfma_f32_16x16x32_bf16 v[44:47], v[80:83], v[92:95], v[44:47]
    v_mfma_f32_16x16x32_bf16 v[48:51], v[80:83], v[96:99], v[48:51]
    v_mfma_f32_16x16x32_bf16 v[52:55], v[80:83], v[100:103], v[52:55]
    v_mfma_f32_16x16x32_bf16 v[56:59], v[84:87], v[88:91], v[56:59]
    v_mfma_f32_16x16x32_bf16 v[60:63], v[84:87], v[92:95], v[60:63]
    v_mfma_f32_16x16x32_bf16 v[64:67], v[84:87], v[96:99], v[64:67]
    v_mfma_f32_16x16x32_bf16 v[68:71], v[84:87], v[100:103], v[68:71]
    s_waitcnt vmcnt(20)
    s_barrier
    s_cmp_ge_u32 s3, 2
    s_cbranch_scc1 gq_38
    s_add_u32 m0, s49, 0
    s_add_u32 s59, s48, 0
    buffer_load_dwordx4 v140, s[8:11], s59 offen lds
    s_add_u32 m0, s49, 1024
    s_add_u32 s59, s48, 32768
    buffer_load_dwordx4 v141, s[8:11], s59 offen lds
    s_add_u32 m0, s49, 2048
    s_add_u32 s59, s48, 65536
    buffer_load_dwordx4 v140, s[8:11], s59 offen lds
    s_add_u32 m0, s49, 3072
    s_add_u32 s59, s48, 98304
    buffer_load_dwordx4 v141, s[8:11], s59 offen lds
    s_add_u32 s48, s48, 262144
    s_branch ge_39
gq_38:
    s_add_u32 m0, s49, 0
    s_nop 0
    buffer_load_dwordx4 v1, s[4:7], s48 offen offset:0 lds
    buffer_load_dwordx4 v1, s[4:7], s48 offen offset:1024 lds
    buffer_load_dwordx4 v1, s[4:7], s48 offen offset:2048 lds
    buffer_load_dwordx4 v1, s[4:7], s48 offen offset:3072 lds
    s_add_u32 s48, s48, 4096
ge_39:
    s_waitcnt lgkmcnt(0)
    ds_read_b64_tr_b16 v[72:73], v142 offset:32768
    ds_read_b64_tr_b16 v[74:75], v142 offset:36864
    ds_read_b64_tr_b16 v[76:77], v143 offset:32768
    ds_read_b64_tr_b16 v[78:79], v143 offset:36864
    ds_read_b64_tr_b16 v[80:81], v144 offset:32768
    ds_read_b64_tr_b16 v[82:83], v144 offset:36864
    ds_read_b64_tr_b16 v[84:85], v145 offset:32768
    ds_read_b64_tr_b16 v[86:87], v145 offset:36864
    ds_read_b128 v[88:91], v3 offset:32768
    ds_read_b128 v[92:95], v3 offset:33792
    ds_read_b128 v[96:99], v3 offset:34816
    ds_read_b128 v[100:103], v3 offset:35840
    v_mfma_f32_16x16x32_bf16 v[8:11], v[104:107], v[120:123], v[8:11]
    v_mfma_f32_16x16x32_bf16 v[12:15], v[104:107], v[124:127], v[12:15]
    v_mfma_f32_16x16x32_bf16 v[16:19], v[104:107], v[128:131], v[16:19]
    v_mfma_f32_16x16x32_bf16 v[20:23], v[104:107], v[132:135], v[20:23]
    v_mfma_f32_16x16x32_bf16 v[24:27], v[108:111], v[120:123], v[24:27]
    v_mfma_f32_16x16x32_bf16 v[28:31], v[108:111], v[124:127], v[28:31]
    v_mfma_f32_16x16x32_bf16 v[32:35], v[108:111], v[128:131], v[32:35]
    v_mfma_f32_16x16x32_bf16 v[36:39], v[108:111], v[132:135], v[36:39]
    v_mfma_f32_16x16x32_bf16 v[40:43], v[112:115], v[120:123], v[40:43]
    v_mfma_f32_16x16x32_bf16 v[44:47], v[112:115], v[124:127], v[44:47]
    v_mfma_f32_16x16x32_bf16 v[48:51], v[112:115], v[128:131], v[48:51]
    v_mfma_f32_16x16x32_bf16 v[52:55], v[112:115], v[132:135], v[52:55]
    v_mfma_f32_16x16x32_bf16 v[56:59], v[116:119], v[120:123], v[56:59]
    v_mfma_f32_16x16x32_bf16 v[60:63], v[116:119], v[124:127], v[60:63]
    v_mfma_f32_16x16x32_bf16 v[64:67], v[116:119], v[128:131], v[64:67]
    v_mfma_f32_16x16x32_bf16 v[68:71], v[116:119], v[132:135], v[68:71]
    s_waitcnt vmcnt(20)
    s_barrier
    s_cmp_ge_u32 s3, 2
    s_cbranch_scc1 gq_40
    s_add_u32 m0, s49, 16384
    s_add_u32 s59, s48, 0
    buffer_load_dwordx4 v140, s[8:11], s59 offen lds
    s_add_u32 m0, s49, 17408
    s_add_u32 s59, s48, 32768
    buffer_load_dwordx4 v141, s[8:11], s59 offen lds
    s_add_u32 m0, s49, 18432
    s_add_u32 s59, s48, 65536
    buffer_load_dwordx4 v140, s[8:11], s59 offen lds
    s_add_u32 m0, s49, 19456
    s_add_u32 s59, s48, 98304
    buffer_load_dwordx4 v141, s[8:11], s59 offen lds
    s_add_u32 s48, s48, 262144
    s_branch ge_41
gq_40:
    s_add_u32 m0, s49, 16384
    s_nop 0
    buffer_load_dwordx4 v1, s[4:7], s48 offen offset:0 lds
    buffer_load_dwordx4 v1, s[4:7], s48 offen offset:1024 lds
    buffer_load_dwordx4 v1, s[4:7], s48 offen offset:2048 lds
    buffer_load_dwordx4 v1, s[4:7], s48 offen offset:3072 lds
    s_add_u32 s48, s48, 4096
ge_41:
    s_waitcnt lgkmcnt(0)
    ds_read_b64_tr_b16 v[104:105], v142 offset:49152
    ds_read_b64_tr_b16 v[106:107], v142 offset:53248
    ds_read_b64_tr_b16 v[108:109], v143 offset:49152
    ds_read_b64_tr_b16 v[110:111], v143 offset:53248
    ds_read_b64_tr_b16 v[112:113], v144 offset:49152
    ds_read_b64_tr_b16 v[114:115], v144 offset:53248
    ds_read_b64_tr_b16 v[116:117], v145 offset:49152
    ds_read_b64_tr_b16 v[118:119], v145 offset:53248
    ds_read_b128 v[120:123], v3 offset:49152
    ds_read_b128 v[124:127], v3 offset:50176
    ds_read_b128 v[128:131], v3 offset:51200
    ds_read_b128 v[132:135], v3 offset:52224
    v_mfma_f32_16x16x32_bf16 v[8:11], v[72:75], v[88:91], v[8:11]
    v_mfma_f32_16x16x32_bf16 v[12:15], v[72:75], v[92:95], v[12:15]
    v_mfma_f32_16x16x32_bf16 v[16:19], v[72:75], v[96:99], v[16:19]
    v_mfma_f32_16x16x32_bf16 v[20:23], v[72:75], v[100:103], v[20:23]
    v_mfma_f32_16x16x32_bf16 v[24:27], v[76:79], v[88:91], v[24:27]
    v_mfma_f32_16x16x32_bf16 v[28:31], v[76:79], v[92:95], v[28:31]
    v_mfma_f32_16x16x32_bf16 v[32:35], v[76:79], v[96:99], v[32:35]
    v_mfma_f32_16x16x32_bf16 v[36:39], v[76:79], v[100:103], v[36:39]
    v_mfma_f32_16x16x32_bf16 v[40:43], v[80:83], v[88:91], v[40:43]
    v_mfma_f32_16x16x32_bf16 v[44:47], v[80:83], v[92:95], v[44:47]
    v_mfma_f32_16x16x32_bf16 v[48:51], v[80:83], v[96:99], v[48:51]
    v_mfma_f32_16x16x32_bf16 v[52:55], v[80:83], v[100:103], v[52:55]
    v_mfma_f32_16x16x32_bf16 v[56:59], v[84:87], v[88:91], v[56:59]
    v_mfma_f32_16x16x32_bf16 v[60:63], v[84:87], v[92:95], v[60:63]
    v_mfma_f32_16x16x32_bf16 v[64:67], v[84:87], v[96:99], v[64:67]
    v_mfma_f32_16x16x32_bf16 v[68:71], v[84:87], v[100:103], v[68:71]
    s_waitcnt vmcnt(20)
    s_barrier
    s_cmp_ge_u32 s3, 2
    s_cbranch_scc1 gq_42
    s_add_u32 m0, s49, 32768
    s_add_u32 s59, s48, 0
    buffer_load_dwordx4 v140, s[8:11], s59 offen lds
    s_add_u32 m0, s49, 33792
    s_add_u32 s59, s48, 32768
    buffer_load_dwordx4 v141, s[8:11], s59 offen lds
    s_add_u32 m0, s49, 34816
    s_add_u32 s59, s48, 65536
    buffer_load_dwordx4 v140, s[8:11], s59 offen lds
    s_add_u32 m0, s49, 35840
    s_add_u32 s59, s48, 98304
    buffer_load_dwordx4 v141, s[8:11], s59 offen lds
    s_add_u32 s48, s48, 262144
    s_branch ge_43
gq_42:
    s_add_u32 m0, s49, 32768
    s_nop 0
    buffer_load_dwordx4 v1, s[4:7], s48 offen offset:0 lds
    buffer_load_dwordx4 v1, s[4:7], s48 offen offset:1024 lds
    buffer_load_dwordx4 v1, s[4:7], s48 offen offset:2048 lds
    buffer_load_dwordx4 v1, s[4:7], s48 offen offset:3072 lds
    s_add_u32 s48, s48, 4096
ge_43:
    s_waitcnt lgkmcnt(0)
    ds_read_b64_tr_b16 v[72:73], v146 offset:0
    ds_read_b64_tr_b16 v[74:75], v146 offset:4096
    ds_read_b64_tr_b16 v[76:77], v147 offset:0
    ds_read_b64_tr_b16 v[78:79], v147 offset:4096
    ds_read_b64_tr_b16 v[80:81], v148 offset:0
    ds_read_b64_tr_b16 v[82:83], v148 offset:4096
    ds_read_b64_tr_b16 v[84:85], v149 offset:0
    ds_read_b64_tr_b16 v[86:87], v149 offset:4096
    ds_read_b128 v[88:91], v7 offset:0
    ds_read_b128 v[92:95], v7 offset:1024
    ds_read_b128 v[96:99], v7 offset:2048
    ds_read_b128 v[100:103], v7 offset:3072
    v_mfma_f32_16x16x32_bf16 v[8:11], v[104:107], v[120:123], v[8:11]
    v_mfma_f32_16x16x32_bf16 v[12:15], v[104:107], v[124:127], v[12:15]
    v_mfma_f32_16x16x32_bf16 v[16:19], v[104:107], v[128:131], v[16:19]
    v_mfma_f32_16x16x32_bf16 v[20:23], v[104:107], v[132:135], v[20:23]
    v_mfma_f32_16x16x32_bf16 v[24:27], v[108:111], v[120:123], v[24:27]
    v_mfma_f32_16x16x32_bf16 v[28:31], v[108:111], v[124:127], v[28:31]
    v_mfma_f32_16x16x32_bf16 v[32:35], v[108:111], v[128:131], v[32:35]
    v_mfma_f32_16x16x32_bf16 v[36:39], v[108:111], v[132:135], v[36:39]
    v_mfma_f32_16x16x32_bf16 v[40:43], v[112:115], v[120:123], v[40:43]
    v_mfma_f32_16x16x32_bf16 v[44:47], v[112:115], v[124:127], v[44:47]
    v_mfma_f32_16x16x32_bf16 v[48:51], v[112:115], v[128:131], v[48:51]
    v_mfma_f32_16x16x32_bf16 v[52:55], v[112:115], v[132:135], v[52:55]
    v_mfma_f32_16x16x32_bf16 v[56:59], v[116:119], v[120:123], v[56:59]
    v_mfma_f32_16x16x32_bf16 v[60:63], v[116:119], v[124:127], v[60:63]
    v_mfma_f32_16x16x32_bf16 v[64:67], v[116:119], v[128:131], v[64:67]
    v_mfma_f32_16x16x32_bf16 v[68:71], v[116:119], v[132:135], v[68:71]
    s_waitcnt vmcnt(20)
    s_barrier
    s_cmp_ge_u32 s3, 2
    s_cbranch_scc1 gq_44
    s_add_u32 m0, s49, 49152
    s_add_u32 s59, s48, 0
    buffer_load_dwordx4 v140, s[8:11], s59 offen lds
    s_add_u32 m0, s49, 50176
    s_add_u32 s59, s48, 32768
    buffer_load_dwordx4 v141, s[8:11], s59 offen lds
    s_add_u32 m0, s49, 51200
    s_add_u32 s59, s48, 65536
    buffer_load_dwordx4 v140, s[8:11], s59 offen lds
    s_add_u32 m0, s49, 52224
    s_add_u32 s59, s48, 98304
    buffer_load_dwordx4 v141, s[8:11], s59 offen lds
    s_add_u32 s48, s48, 262144
    s_branch ge_45
gq_44:
    s_add_u32 m0, s49, 49152
    s_nop 0
    buffer_load_dwordx4 v1, s[4:7], s48 offen offset:0 lds
    buffer_load_dwordx4 v1, s[4:7], s48 offen offset:1024 lds
    buffer_load_dwordx4 v1, s[4:7], s48 offen offset:2048 lds
    buffer_load_dwordx4 v1, s[4:7], s48 offen offset:3072 lds
    s_add_u32 s48, s48, 4096
ge_45:
    s_waitcnt lgkmcnt(0)
    ds_read_b64_tr_b16 v[104:105], v146 offset:16384
    ds_read_b64_tr_b16 v[106:107], v146 offset:20480
    ds_read_b64_tr_b16 v[108:109], v147 offset:16384
    ds_read_b64_tr_b16 v[110:111], v147 offset:20480
    ds_read_b64_tr_b16 v[112:113], v148 offset:16384
    ds_read_b64_tr_b16 v[114:115], v148 offset:20480
    ds_read_b64_tr_b16 v[116:117], v149 offset:16384
    ds_read_b64_tr_b16 v[118:119], v149 offset:20480
    ds_read_b128 v[120:123], v7 offset:16384
    ds_read_b128 v[124:127], v7 offset:17408
    ds_read_b128 v[128:131], v7 offset:18432
    ds_read_b128 v[132:135], v7 offset:19456
    v_mfma_f32_16x16x32_bf16 v[8:11], v[72:75], v[88:91], v[8:11]
    v_mfma_f32_16x16x32_bf16 v[12:15], v[72:75], v[92:95], v[12:15]
    v_mfma_f32_16x16x32_bf16 v[16:19], v[72:75], v[96:99], v[16:19]
    v_mfma_f32_16x16x32_bf16 v[20:23], v[72:75], v[100:103], v[20:23]
    v_mfma_f32_16x16x32_bf16 v[24:27], v[76:79], v[88:91], v[24:27]
    v_mfma_f32_16x16x32_bf16 v[28:31], v[76:79], v[92:95], v[28:31]
    v_mfma_f32_16x16x32_bf16 v[32:35], v[76:79], v[96:99], v[32:35]
    v_mfma_f32_16x16x32_bf16 v[36:39], v[76:79], v[100:103], v[36:39]
    v_mfma_f32_16x16x32_bf16 v[40:43], v[80:83], v[88:91], v[40:43]
    v_mfma_f32_16x16x32_bf16 v[44:47], v[80:83], v[92:95], v[44:47]
    v_mfma_f32_16x16x32_bf16 v[48:51], v[80:83], v[96:99], v[48:51]
    v_mfma_f32_16x16x32_bf16 v[52:55], v[80:83], v[100:103], v[52:55]
    v_mfma_f32_16x16x32_bf16 v[56:59], v[84:87], v[88:91], v[56:59]
    v_mfma_f32_16x16x32_bf16 v[60:63], v[84:87], v[92:95], v[60:63]
    v_mfma_f32_16x16x32_bf16 v[64:67], v[84:87], v[96:99], v[64:67]
    v_mfma_f32_16x16x32_bf16 v[68:71], v[84:87], v[100:103], v[68:71]
    s_waitcnt vmcnt(20)
    s_barrier
    s_waitcnt lgkmcnt(0)
    ds_read_b64_tr_b16 v[72:73], v146 offset:32768
    ds_read_b64_tr_b16 v[74:75], v146 offset:36864
    ds_read_b64_tr_b16 v[76:77], v147 offset:32768
    ds_read_b64_tr_b16 v[78:79], v147 offset:36864
    ds_read_b64_tr_b16 v[80:81], v148 offset:32768
    ds_read_b64_tr_b16 v[82:83], v148 offset:36864
    ds_read_b64_tr_b16 v[84:85], v149 offset:32768
    ds_read_b64_tr_b16 v[86:87], v149 offset:36864
    ds_read_b128 v[88:91], v7 offset:32768
    ds_read_b128 v[92:95], v7 offset:33792
    ds_read_b128 v[96:99], v7 offset:34816
    ds_read_b128 v[100:103], v7 offset:35840
    v_mfma_f32_16x16x32_bf16 v[8:11], v[104:107], v[120:123], v[8:11]
    v_mfma_f32_16x16x32_bf16 v[12:15], v[104:107], v[124:127], v[12:15]
    v_mfma_f32_16x16x32_bf16 v[16:19], v[104:107], v[128:131], v[16:19]
    v_mfma_f32_16x16x32_bf16 v[20:23], v[104:107], v[132:135], v[20:23]
    v_mfma_f32_16x16x32_bf16 v[24:27], v[108:111], v[120:123], v[24:27]
    v_mfma_f32_16x16x32_bf16 v[28:31], v[108:111], v[124:127], v[28:31]
    v_mfma_f32_16x16x32_bf16 v[32:35], v[108:111], v[128:131], v[32:35]
    v_mfma_f32_16x16x32_bf16 v[36:39], v[108:111], v[132:135], v[36:39]
    v_mfma_f32_16x16x32_bf16 v[40:43], v[112:115], v[120:123], v[40:43]
    v_mfma_f32_16x16x32_bf16 v[44:47], v[112:115], v[124:127], v[44:47]
    v_mfma_f32_16x16x32_bf16 v[48:51], v[112:115], v[128:131], v[48:51]
    v_mfma_f32_16x16x32_bf16 v[52:55], v[112:115], v[132:135], v[52:55]
    v_mfma_f32_16x16x32_bf16 v[56:59], v[116:119], v[120:123], v[56:59]
    v_mfma_f32_16x16x32_bf16 v[60:63], v[116:119], v[124:127], v[60:63]
    v_mfma_f32_16x16x32_bf16 v[64:67], v[116:119], v[128:131], v[64:67]
    v_mfma_f32_16x16x32_bf16 v[68:71], v[116:119], v[132:135], v[68:71]
    s_waitcnt vmcnt(16)
    s_barrier
    s_waitcnt lgkmcnt(0)
    ds_read_b64_tr_b16 v[104:105], v146 offset:49152
    ds_read_b64_tr_b16 v[106:107], v146 offset:53248
    ds_read_b64_tr_b16 v[108:109], v147 offset:49152
    ds_read_b64_tr_b16 v[110:111], v147 offset:53248
    ds_read_b64_tr_b16 v[112:113], v148 offset:49152
    ds_read_b64_tr_b16 v[114:115], v148 offset:53248
    ds_read_b64_tr_b16 v[116:117], v149 offset:49152
    ds_read_b64_tr_b16 v[118:119], v149 offset:53248
    ds_read_b128 v[120:123], v7 offset:49152
    ds_read_b128 v[124:127], v7 offset:50176
    ds_read_b128 v[128:131], v7 offset:51200
    ds_read_b128 v[132:135], v7 offset:52224
    v_mfma_f32_16x16x32_bf16 v[8:11], v[72:75], v[88:91], v[8:11]
    v_mfma_f32_16x16x32_bf16 v[12:15], v[72:75], v[92:95], v[12:15]
    v_mfma_f32_16x16x32_bf16 v[16:19], v[72:75], v[96:99], v[16:19]
    v_mfma_f32_16x16x32_bf16 v[20:23], v[72:75], v[100:103], v[20:23]
    v_mfma_f32_16x16x32_bf16 v[24:27], v[76:79], v[88:91], v[24:27]
    v_mfma_f32_16x16x32_bf16 v[28:31], v[76:79], v[92:95], v[28:31]
    v_mfma_f32_16x16x32_bf16 v[32:35], v[76:79], v[96:99], v[32:35]
    v_mfma_f32_16x16x32_bf16 v[36:39], v[76:79], v[100:103], v[36:39]
    v_mfma_f32_16x16x32_bf16 v[40:43], v[80:83], v[88:91], v[40:43]
    v_mfma_f32_16x16x32_bf16 v[44:47], v[80:83], v[92:95], v[44:47]
    v_mfma_f32_16x16x32_bf16 v[48:51], v[80:83], v[96:99], v[48:51]
    v_mfma_f32_16x16x32_bf16 v[52:55], v[80:83], v[100:103], v[52:55]
    v_mfma_f32_16x16x32_bf16 v[56:59], v[84:87], v[88:91], v[56:59]
    v_mfma_f32_16x16x32_bf16 v[60:63], v[84:87], v[92:95], v[60:63]
    v_mfma_f32_16x16x32_bf16 v[64:67], v[84:87], v[96:99], v[64:67]
    v_mfma_f32_16x16x32_bf16 v[68:71], v[84:87], v[100:103], v[68:71]
    s_waitcnt vmcnt(12)
    s_barrier
    s_waitcnt lgkmcnt(0)
    ds_read_b64_tr_b16 v[72:73], v142 offset:0
    ds_read_b64_tr_b16 v[74:75], v142 offset:4096
    ds_read_b64_tr_b16 v[76:77], v143 offset:0
    ds_read_b64_tr_b16 v[78:79], v143 offset:4096
    ds_read_b64_tr_b16 v[80:81], v144 offset:0
    ds_read_b64_tr_b16 v[82:83], v144 offset:4096
    ds_read_b64_tr_b16 v[84:85], v145 offset:0
    ds_read_b64_tr_b16 v[86:87], v145 offset:4096
    ds_read_b128 v[88:91], v3 offset:0
    ds_read_b128 v[92:95], v3 offset:1024
    ds_read_b128 v[96:99], v3 offset:2048
    ds_read_b128 v[100:103], v3 offset:3072
    v_mfma_f32_16x16x32_bf16 v[8:11], v[104:107], v[120:123], v[8:11]
    v_mfma_f32_16x16x32_bf16 v[12:15], v[104:107], v[124:127], v[12:15]
    v_mfma_f32_16x16x32_bf16 v[16:19], v[104:107], v[128:131], v[16:19]
    v_mfma_f32_16x16x32_bf16 v[20:23], v[104:107], v[132:135], v[20:23]
    v_mfma_f32_16x16x32_bf16 v[24:27], v[108:111], v[120:123], v[24:27]
    v_mfma_f32_16x16x32_bf16 v[28:31], v[108:111], v[124:127], v[28:31]
    v_mfma_f32_16x16x32_bf16 v[32:35], v[108:111], v[128:131], v[32:35]
    v_mfma_f32_16x16x32_bf16 v[36:39], v[108:111], v[132:135], v[36:39]
    v_mfma_f32_16x16x32_bf16 v[40:43], v[112:115], v[120:123], v[40:43]
    v_mfma_f32_16x16x32_bf16 v[44:47], v[112:115], v[124:127], v[44:47]
    v_mfma_f32_16x16x32_bf16 v[48:51], v[112:115], v[128:131], v[48:51]
    v_mfma_f32_16x16x32_bf16 v[52:55], v[112:115], v[132:135], v[52:55]
    v_mfma_f32_16x16x32_bf16 v[56:59], v[116:119], v[120:123], v[56:59]
    v_mfma_f32_16x16x32_bf16 v[60:63], v[116:119], v[124:127], v[60:63]
    v_mfma_f32_16x16x32_bf16 v[64:67], v[116:119], v[128:131], v[64:67]
    v_mfma_f32_16x16x32_bf16 v[68:71], v[116:119], v[132:135], v[68:71]
    s_waitcnt vmcnt(8)
    s_barrier
    s_waitcnt lgkmcnt(0)
    ds_read_b64_tr_b16 v[104:105], v142 offset:16384
    ds_read_b64_tr_b16 v[106:107], v142 offset:20480
    ds_read_b64_tr_b16 v[108:109], v143 offset:16384
    ds_read_b64_tr_b16 v[110:111], v143 offset:20480
    ds_read_b64_tr_b16 v[112:113], v144 offset:16384
    ds_read_b64_tr_b16 v[114:115], v144 offset:20480
    ds_read_b64_tr_b16 v[116:117], v145 offset:16384
    ds_read_b64_tr_b16 v[118:119], v145 offset:20480
    ds_read_b128 v[120:123], v3 offset:16384
    ds_read_b128 v[124:127], v3 offset:17408
    ds_read_b128 v[128:131], v3 offset:18432
    ds_read_b128 v[132:135], v3 offset:19456
    v_mfma_f32_16x16x32_bf16 v[8:11], v[72:75], v[88:91], v[8:11]
    v_mfma_f32_16x16x32_bf16 v[12:15], v[72:75], v[92:95], v[12:15]
    v_mfma_f32_16x16x32_bf16 v[16:19], v[72:75], v[96:99], v[16:19]
    v_mfma_f32_16x16x32_bf16 v[20:23], v[72:75], v[100:103], v[20:23]
    v_mfma_f32_16x16x32_bf16 v[24:27], v[76:79], v[88:91], v[24:27]
    v_mfma_f32_16x16x32_bf16 v[28:31], v[76:79], v[92:95], v[28:31]
    v_mfma_f32_16x16x32_bf16 v[32:35], v[76:79], v[96:99], v[32:35]
    v_mfma_f32_16x16x32_bf16 v[36:39], v[76:79], v[100:103], v[36:39]
    v_mfma_f32_16x16x32_bf16 v[40:43], v[80:83], v[88:91], v[40:43]
    v_mfma_f32_16x16x32_bf16 v[44:47], v[80:83], v[92:95], v[44:47]
    v_mfma_f32_16x16x32_bf16 v[48:51], v[80:83], v[96:99], v[48:51]
    v_mfma_f32_16x16x32_bf16 v[52:55], v[80:83], v[100:103], v[52:55]
    v_mfma_f32_16x16x32_bf16 v[56:59], v[84:87], v[88:91], v[56:59]
    v_mfma_f32_16x16x32_bf16 v[60:63], v[84:87], v[92:95], v[60:63]
    v_mfma_f32_16x16x32_bf16 v[64:67], v[84:87], v[96:99], v[64:67]
    v_mfma_f32_16x16x32_bf16 v[68:71], v[84:87], v[100:103], v[68:71]
    s_waitcnt vmcnt(4)
    s_barrier
    s_waitcnt lgkmcnt(0)
    ds_read_b64_tr_b16 v[72:73], v142 offset:32768
    ds_read_b64_tr_b16 v[74:75], v142 offset:36864
    ds_read_b64_tr_b16 v[76:77], v143 offset:32768
    ds_read_b64_tr_b16 v[78:79], v143 offset:36864
    ds_read_b64_tr_b16 v[80:81], v144 offset:32768
    ds_read_b64_tr_b16 v[82:83], v144 offset:36864
    ds_read_b64_tr_b16 v[84:85], v145 offset:32768
    ds_read_b64_tr_b16 v[86:87], v145 offset:36864
    ds_read_b128 v[88:91], v3 offset:32768
    ds_read_b128 v[92:95], v3 offset:33792
    ds_read_b128 v[96:99], v3 offset:34816
    ds_read_b128 v[100:103], v3 offset:35840
    v_mfma_f32_16x16x32_bf16 v[8:11], v[104:107], v[120:123], v[8:11]
    v_mfma_f32_16x16x32_bf16 v[12:15], v[104:107], v[124:127], v[12:15]
    v_mfma_f32_16x16x32_bf16 v[16:19], v[104:107], v[128:131], v[16:19]
    v_mfma_f32_16x16x32_bf16 v[20:23], v[104:107], v[132:135], v[20:23]
    v_mfma_f32_16x16x32_bf16 v[24:27], v[108:111], v[120:123], v[24:27]
    v_mfma_f32_16x16x32_bf16 v[28:31], v[108:111], v[124:127], v[28:31]
    v_mfma_f32_16x16x32_bf16 v[32:35], v[108:111], v[128:131], v[32:35]
    v_mfma_f32_16x16x32_bf16 v[36:39], v[108:111], v[132:135], v[36:39]
    v_mfma_f32_16x16x32_bf16 v[40:43], v[112:115], v[120:123], v[40:43]
    v_mfma_f32_16x16x32_bf16 v[44:47], v[112:115], v[124:127], v[44:47]
    v_mfma_f32_16x16x32_bf16 v[48:51], v[112:115], v[128:131], v[48:51]
    v_mfma_f32_16x16x32_bf16 v[52:55], v[112:115], v[132:135], v[52:55]
    v_mfma_f32_16x16x32_bf16 v[56:59], v[116:119], v[120:123], v[56:59]
    v_mfma_f32_16x16x32_bf16 v[60:63], v[116:119], v[124:127], v[60:63]
    v_mfma_f32_16x16x32_bf16 v[64:67], v[116:119], v[128:131], v[64:67]
    v_mfma_f32_16x16x32_bf16 v[68:71], v[116:119], v[132:135], v[68:71]
    s_waitcnt vmcnt(0)
    s_barrier
    s_waitcnt lgkmcnt(0)
    ds_read_b64_tr_b16 v[104:105], v142 offset:49152
    ds_read_b64_tr_b16 v[106:107], v142 offset:53248
    ds_read_b64_tr_b16 v[108:109], v143 offset:49152
    ds_read_b64_tr_b16 v[110:111], v143 offset:53248
    ds_read_b64_tr_b16 v[112:113], v144 offset:49152
    ds_read_b64_tr_b16 v[114:115], v144 offset:53248
    ds_read_b64_tr_b16 v[116:117], v145 offset:49152
    ds_read_b64_tr_b16 v[118:119], v145 offset:53248
    ds_read_b128 v[120:123], v3 offset:49152
    ds_read_b128 v[124:127], v3 offset:50176
    ds_read_b128 v[128:131], v3 offset:51200
    ds_read_b128 v[132:135], v3 offset:52224
    v_mfma_f32_16x16x32_bf16 v[8:11], v[72:75], v[88:91], v[8:11]
    v_mfma_f32_16x16x32_bf16 v[12:15], v[72:75], v[92:95], v[12:15]
    v_mfma_f32_16x16x32_bf16 v[16:19], v[72:75], v[96:99], v[16:19]
    v_mfma_f32_16x16x32_bf16 v[20:23], v[72:75], v[100:103], v[20:23]
    v_mfma_f32_16x16x32_bf16 v[24:27], v[76:79], v[88:91], v[24:27]
    v_mfma_f32_16x16x32_bf16 v[28:31], v[76:79], v[92:95], v[28:31]
    v_mfma_f32_16x16x32_bf16 v[32:35], v[76:79], v[96:99], v[32:35]
    v_mfma_f32_16x16x32_bf16 v[36:39], v[76:79], v[100:103], v[36:39]
    v_mfma_f32_16x16x32_bf16 v[40:43], v[80:83], v[88:91], v[40:43]
    v_mfma_f32_16x16x32_bf16 v[44:47], v[80:83], v[92:95], v[44:47]
    v_mfma_f32_16x16x32_bf16 v[48:51], v[80:83], v[96:99], v[48:51]
    v_mfma_f32_16x16x32_bf16 v[52:55], v[80:83], v[100:103], v[52:55]
    v_mfma_f32_16x16x32_bf16 v[56:59], v[84:87], v[88:91], v[56:59]
    v_mfma_f32_16x16x32_bf16 v[60:63], v[84:87], v[92:95], v[60:63]
    v_mfma_f32_16x16x32_bf16 v[64:67], v[84:87], v[96:99], v[64:67]
    v_mfma_f32_16x16x32_bf16 v[68:71], v[84:87], v[100:103], v[68:71]
    s_waitcnt lgkmcnt(0)
    v_mfma_f32_16x16x32_bf16 v[8:11], v[104:107], v[120:123], v[8:11]
    v_mfma_f32_16x16x32_bf16 v[12:15], v[104:107], v[124:127], v[12:15]
    v_mfma_f32_16x16x32_bf16 v[16:19], v[104:107], v[128:131], v[16:19]
    v_mfma_f32_16x16x32_bf16 v[20:23], v[104:107], v[132:135], v[20:23]
    v_mfma_f32_16x16x32_bf16 v[24:27], v[108:111], v[120:123], v[24:27]
    v_mfma_f32_16x16x32_bf16 v[28:31], v[108:111], v[124:127], v[28:31]
    v_mfma_f32_16x16x32_bf16 v[32:35], v[108:111], v[128:131], v[32:35]
    v_mfma_f32_16x16x32_bf16 v[36:39], v[108:111], v[132:135], v[36:39]
    v_mfma_f32_16x16x32_bf16 v[40:43], v[112:115], v[120:123], v[40:43]
    v_mfma_f32_16x16x32_bf16 v[44:47], v[112:115], v[124:127], v[44:47]
    v_mfma_f32_16x16x32_bf16 v[48:51], v[112:115], v[128:131], v[48:51]
    v_mfma_f32_16x16x32_bf16 v[52:55], v[112:115], v[132:135], v[52:55]
    v_mfma_f32_16x16x32_bf16 v[56:59], v[116:119], v[120:123], v[56:59]
    v_mfma_f32_16x16x32_bf16 v[60:63], v[116:119], v[124:127], v[60:63]
    v_mfma_f32_16x16x32_bf16 v[64:67], v[116:119], v[128:131], v[64:67]
    v_mfma_f32_16x16x32_bf16 v[68:71], v[116:119], v[132:135], v[68:71]
    s_nop 7
    s_cmp_lt_u32 s44, 32
    s_mov_b32 s56, 30228480
    s_cselect_b32 s56, s56, 47005696
    s_lshl_b32 s58, s51, 11
    s_add_u32 s57, s57, s58
    s_add_u32 s57, s57, s56
    v_cvt_pk_bf16_f32 v72, v8, v9
    v_cvt_pk_bf16_f32 v73, v10, v11
    v_cvt_pk_bf16_f32 v74, v24, v25
    v_cvt_pk_bf16_f32 v75, v26, v27
    buffer_store_dwordx4 v[72:75], v1, s[4:7], s57 offen offset:0 sc1
    v_cvt_pk_bf16_f32 v76, v40, v41
    v_cvt_pk_bf16_f32 v77, v42, v43
    v_cvt_pk_bf16_f32 v78, v56, v57
    v_cvt_pk_bf16_f32 v79, v58, v59
    buffer_store_dwordx4 v[76:79], v1, s[4:7], s57 offen offset:1024 sc1
    v_cvt_pk_bf16_f32 v80, v12, v13
    v_cvt_pk_bf16_f32 v81, v14, v15
    v_cvt_pk_bf16_f32 v82, v28, v29
    v_cvt_pk_bf16_f32 v83, v30, v31
    s_add_u32 s58, s57, 4096
    buffer_store_dwordx4 v[80:83], v1, s[4:7], s58 offen offset:0 sc1
    v_cvt_pk_bf16_f32 v84, v44, v45
    v_cvt_pk_bf16_f32 v85, v46, v47
    v_cvt_pk_bf16_f32 v86, v60, v61
    v_cvt_pk_bf16_f32 v87, v62, v63
    s_add_u32 s58, s57, 4096
    buffer_store_dwordx4 v[84:87], v1, s[4:7], s58 offen offset:1024 sc1
    v_cvt_pk_bf16_f32 v72, v16, v17
    v_cvt_pk_bf16_f32 v73, v18, v19
    v_cvt_pk_bf16_f32 v74, v32, v33
    v_cvt_pk_bf16_f32 v75, v34, v35
    s_add_u32 s57, s57, 262144
    buffer_store_dwordx4 v[72:75], v1, s[4:7], s57 offen offset:0 sc1
    v_cvt_pk_bf16_f32 v76, v48, v49
    v_cvt_pk_bf16_f32 v77, v50, v51
    v_cvt_pk_bf16_f32 v78, v64, v65
    v_cvt_pk_bf16_f32 v79, v66, v67
    buffer_store_dwordx4 v[76:79], v1, s[4:7], s57 offen offset:1024 sc1
    v_cvt_pk_bf16_f32 v80, v20, v21
    v_cvt_pk_bf16_f32 v81, v22, v23
    v_cvt_pk_bf16_f32 v82, v36, v37
    v_cvt_pk_bf16_f32 v83, v38, v39
    s_add_u32 s58, s57, 4096
    buffer_store_dwordx4 v[80:83], v1, s[4:7], s58 offen offset:0 sc1
    v_cvt_pk_bf16_f32 v84, v52, v53
    v_cvt_pk_bf16_f32 v85, v54, v55
    v_cvt_pk_bf16_f32 v86, v68, v69
    v_cvt_pk_bf16_f32 v87, v70, v71
    s_add_u32 s58, s57, 4096
    buffer_store_dwordx4 v[84:87], v1, s[4:7], s58 offen offset:1024 sc1
    s_branch qkvt_e_4
qkvt_v_3:
    s_lshl_b32 s49, s3, 12
    v_lshlrev_b32 v1, 4, v0
    v_add_u32 v6, 0x10000, v2
    v_add_u32 v7, 0x10000, v3
    v_mov_b32 v8, 0
    v_mov_b32 v9, 0
    v_mov_b32 v10, 0
    v_mov_b32 v11, 0
    v_mov_b32 v12, 0
    v_mov_b32 v13, 0
    v_mov_b32 v14, 0
    v_mov_b32 v15, 0
    v_mov_b32 v16, 0
    v_mov_b32 v17, 0
    v_mov_b32 v18, 0
    v_mov_b32 v19, 0
    v_mov_b32 v20, 0
    v_mov_b32 v21, 0
    v_mov_b32 v22, 0
    v_mov_b32 v23, 0
    v_mov_b32 v24, 0
    v_mov_b32 v25, 0
    v_mov_b32 v26, 0
    v_mov_b32 v27, 0
    v_mov_b32 v28, 0
    v_mov_b32 v29, 0
    v_mov_b32 v30, 0
    v_mov_b32 v31, 0
    v_mov_b32 v32, 0
    v_mov_b32 v33, 0
    v_mov_b32 v34, 0
    v_mov_b32 v35, 0
    v_mov_b32 v36, 0
    v_mov_b32 v37, 0
    v_mov_b32 v38, 0
    v_mov_b32 v39, 0
    v_mov_b32 v40, 0
    v_mov_b32 v41, 0
    v_mov_b32 v42, 0
    v_mov_b32 v43, 0
    v_mov_b32 v44, 0
    v_mov_b32 v45, 0
    v_mov_b32 v46, 0
    v_mov_b32 v47, 0
    v_mov_b32 v48, 0
    v_mov_b32 v49, 0
    v_mov_b32 v50, 0
    v_mov_b32 v51, 0
    v_mov_b32 v52, 0
    v_mov_b32 v53, 0
    v_mov_b32 v54, 0
    v_mov_b32 v55, 0
    v_mov_b32 v56, 0
    v_mov_b32 v57, 0
    v_mov_b32 v58, 0
    v_mov_b32 v59, 0
    v_mov_b32 v60, 0
    v_mov_b32 v61, 0
    v_mov_b32 v62, 0
    v_mov_b32 v63, 0
    v_mov_b32 v64, 0
    v_mov_b32 v65, 0
    v_mov_b32 v66, 0
    v_mov_b32 v67, 0
    v_mov_b32 v68, 0
    v_mov_b32 v69, 0
    v_mov_b32 v70, 0
    v_mov_b32 v71, 0
    s_cmp_ge_u32 s3, 2
    s_cbranch_scc1 gq_46
    s_add_u32 m0, s49, 0
    s_add_u32 s59, s48, 0
    buffer_load_dwordx4 v140, s[8:11], s59 offen lds
    s_add_u32 m0, s49, 1024
    s_add_u32 s59, s48, 32768
    buffer_load_dwordx4 v141, s[8:11], s59 offen lds
    s_add_u32 m0, s49, 2048
    s_add_u32 s59, s48, 65536
    buffer_load_dwordx4 v140, s[8:11], s59 offen lds
    s_add_u32 m0, s49, 3072
    s_add_u32 s59, s48, 98304
    buffer_load_dwordx4 v141, s[8:11], s59 offen lds
    s_add_u32 s48, s48, 262144
    s_branch ge_47
gq_46:
    s_add_u32 m0, s49, 0
    s_nop 0
    buffer_load_dwordx4 v1, s[4:7], s48 offen offset:0 lds
    buffer_load_dwordx4 v1, s[4:7], s48 offen offset:1024 lds
    buffer_load_dwordx4 v1, s[4:7], s48 offen offset:2048 lds
    buffer_load_dwordx4 v1, s[4:7], s48 offen offset:3072 lds
    s_add_u32 s48, s48, 4096
ge_47:
    s_cmp_ge_u32 s3, 2
    s_cbranch_scc1 gq_48
    s_add_u32 m0, s49, 16384
    s_add_u32 s59, s48, 0
    buffer_load_dwordx4 v140, s[8:11], s59 offen lds
    s_add_u32 m0, s49, 17408
    s_add_u32 s59, s48, 32768
    buffer_load_dwordx4 v141, s[8:11], s59 offen lds
    s_add_u32 m0, s49, 18432
    s_add_u32 s59, s48, 65536
    buffer_load_dwordx4 v140, s[8:11], s59 offen lds
    s_add_u32 m0, s49, 19456
    s_add_u32 s59, s48, 98304
    buffer_load_dwordx4 v141, s[8:11], s59 offen lds
    s_add_u32 s48, s48, 262144
    s_branch ge_49
gq_48:
    s_add_u32 m0, s49, 16384
    s_nop 0
    buffer_load_dwordx4 v1, s[4:7], s48 offen offset:0 lds
    buffer_load_dwordx4 v1, s[4:7], s48 offen offset:1024 lds
    buffer_load_dwordx4 v1, s[4:7], s48 offen offset:2048 lds
    buffer_load_dwordx4 v1, s[4:7], s48 offen offset:3072 lds
    s_add_u32 s48, s48, 4096
ge_49:
    s_cmp_ge_u32 s3, 2
    s_cbranch_scc1 gq_50
    s_add_u32 m0, s49, 32768
    s_add_u32 s59, s48, 0
    buffer_load_dwordx4 v140, s[8:11], s59 offen lds
    s_add_u32 m0, s49, 33792
    s_add_u32 s59, s48, 32768
    buffer_load_dwordx4 v141, s[8:11], s59 offen lds
    s_add_u32 m0, s49, 34816
    s_add_u32 s59, s48, 65536
    buffer_load_dwordx4 v140, s[8:11], s59 offen lds
    s_add_u32 m0, s49, 35840
    s_add_u32 s59, s48, 98304
    buffer_load_dwordx4 v141, s[8:11], s59 offen lds
    s_add_u32 s48, s48, 262144
    s_branch ge_51
gq_50:
    s_add_u32 m0, s49, 32768
    s_nop 0
    buffer_load_dwordx4 v1, s[4:7], s48 offen offset:0 lds
    buffer_load_dwordx4 v1, s[4:7], s48 offen offset:1024 lds
    buffer_load_dwordx4 v1, s[4:7], s48 offen offset:2048 lds
    buffer_load_dwordx4 v1, s[4:7], s48 offen offset:3072 lds
    s_add_u32 s48, s48, 4096
ge_51:
    s_cmp_ge_u32 s3, 2
    s_cbranch_scc1 gq_52
    s_add_u32 m0, s49, 49152
    s_add_u32 s59, s48, 0
    buffer_load_dwordx4 v140, s[8:11], s59 offen lds
    s_add_u32 m0, s49, 50176
    s_add_u32 s59, s48, 32768
    buffer_load_dwordx4 v141, s[8:11], s59 offen lds
    s_add_u32 m0, s49, 51200
    s_add_u32 s59, s48, 65536
    buffer_load_dwordx4 v140, s[8:11], s59 offen lds
    s_add_u32 m0, s49, 52224
    s_add_u32 s59, s48, 98304
    buffer_load_dwordx4 v141, s[8:11], s59 offen lds
    s_add_u32 s48, s48, 262144
    s_branch ge_53
gq_52:
    s_add_u32 m0, s49, 49152
    s_nop 0
    buffer_load_dwordx4 v1, s[4:7], s48 offen offset:0 lds
    buffer_load_dwordx4 v1, s[4:7], s48 offen offset:1024 lds
    buffer_load_dwordx4 v1, s[4:7], s48 offen offset:2048 lds
    buffer_load_dwordx4 v1, s[4:7], s48 offen offset:3072 lds
    s_add_u32 s48, s48, 4096
ge_53:
    s_cmp_ge_u32 s3, 2
    s_cbranch_scc1 gq_54
    s_add_u32 m0, s49, 65536
    s_add_u32 s59, s48, 0
    buffer_load_dwordx4 v140, s[8:11], s59 offen lds
    s_add_u32 m0, s49, 66560
    s_add_u32 s59, s48, 32768
    buffer_load_dwordx4 v141, s[8:11], s59 offen lds
    s_add_u32 m0, s49, 67584
    s_add_u32 s59, s48, 65536
    buffer_load_dwordx4 v140, s[8:11], s59 offen lds
    s_add_u32 m0, s49, 68608
    s_add_u32 s59, s48, 98304
    buffer_load_dwordx4 v141, s[8:11], s59 offen lds
    s_add_u32 s48, s48, 262144
    s_branch ge_55
gq_54:
    s_add_u32 m0, s49, 65536
    s_nop 0
    buffer_load_dwordx4 v1, s[4:7], s48 offen offset:0 lds
    buffer_load_dwordx4 v1, s[4:7], s48 offen offset:1024 lds
    buffer_load_dwordx4 v1, s[4:7], s48 offen offset:2048 lds
    buffer_load_dwordx4 v1, s[4:7], s48 offen offset:3072 lds
    s_add_u32 s48, s48, 4096
ge_55:
    s_cmp_ge_u32 s3, 2
    s_cbranch_scc1 gq_56
    s_add_u32 m0, s49, 81920
    s_add_u32 s59, s48, 0
    buffer_load_dwordx4 v140, s[8:11], s59 offen lds
    s_add_u32 m0, s49, 82944
    s_add_u32 s59, s48, 32768
    buffer_load_dwordx4 v141, s[8:11], s59 offen lds
    s_add_u32 m0, s49, 83968
    s_add_u32 s59, s48, 65536
    buffer_load_dwordx4 v140, s[8:11], s59 offen lds
    s_add_u32 m0, s49, 84992
    s_add_u32 s59, s48, 98304
    buffer_load_dwordx4 v141, s[8:11], s59 offen lds
    s_add_u32 s48, s48, 262144
    s_branch ge_57
gq_56:
    s_add_u32 m0, s49, 81920
    s_nop 0
    buffer_load_dwordx4 v1, s[4:7], s48 offen offset:0 lds
    buffer_load_dwordx4 v1, s[4:7], s48 offen offset:1024 lds
    buffer_load_dwordx4 v1, s[4:7], s48 offen offset:2048 lds
    buffer_load_dwordx4 v1, s[4:7], s48 offen offset:3072 lds
    s_add_u32 s48, s48, 4096
ge_57:
    s_cmp_ge_u32 s3, 2
    s_cbranch_scc1 gq_58
    s_add_u32 m0, s49, 98304
    s_add_u32 s59, s48, 0
    buffer_load_dwordx4 v140, s[8:11], s59 offen lds
    s_add_u32 m0, s49, 99328
    s_add_u32 s59, s48, 32768
    buffer_load_dwordx4 v141, s[8:11], s59 offen lds
    s_add_u32 m0, s49, 100352
    s_add_u32 s59, s48, 65536
    buffer_load_dwordx4 v140, s[8:11], s59 offen lds
    s_add_u32 m0, s49, 101376
    s_add_u32 s59, s48, 98304
    buffer_load_dwordx4 v141, s[8:11], s59 offen lds
    s_add_u32 s48, s48, 262144
    s_branch ge_59
gq_58:
    s_add_u32 m0, s49, 98304
    s_nop 0
    buffer_load_dwordx4 v1, s[4:7], s48 offen offset:0 lds
    buffer_load_dwordx4 v1, s[4:7], s48 offen offset:1024 lds
    buffer_load_dwordx4 v1, s[4:7], s48 offen offset:2048 lds
    buffer_load_dwordx4 v1, s[4:7], s48 offen offset:3072 lds
    s_add_u32 s48, s48, 4096
ge_59:
    s_waitcnt vmcnt(24)
    s_barrier
    ds_read_b64_tr_b16 v[72:73], v142 offset:0
    ds_read_b64_tr_b16 v[74:75], v142 offset:4096
    ds_read_b64_tr_b16 v[76:77], v143 offset:0
    ds_read_b64_tr_b16 v[78:79], v143 offset:4096
    ds_read_b64_tr_b16 v[80:81], v144 offset:0
    ds_read_b64_tr_b16 v[82:83], v144 offset:4096
    ds_read_b64_tr_b16 v[84:85], v145 offset:0
    ds_read_b64_tr_b16 v[86:87], v145 offset:4096
    ds_read_b128 v[88:91], v3 offset:0
    ds_read_b128 v[92:95], v3 offset:1024
    ds_read_b128 v[96:99], v3 offset:2048
    ds_read_b128 v[100:103], v3 offset:3072
    s_mov_b32 s50, 1
gloop_60:
    s_waitcnt vmcnt(20)
    s_barrier
    s_cmp_ge_u32 s3, 2
    s_cbranch_scc1 gq_61
    s_add_u32 m0, s49, 114688
    s_add_u32 s59, s48, 0
    buffer_load_dwordx4 v140, s[8:11], s59 offen lds
    s_add_u32 m0, s49, 115712
    s_add_u32 s59, s48, 32768
    buffer_load_dwordx4 v141, s[8:11], s59 offen lds
    s_add_u32 m0, s49, 116736
    s_add_u32 s59, s48, 65536
    buffer_load_dwordx4 v140, s[8:11], s59 offen lds
    s_add_u32 m0, s49, 117760
    s_add_u32 s59, s48, 98304
    buffer_load_dwordx4 v141, s[8:11], s59 offen lds
    s_add_u32 s48, s48, 262144
    s_branch ge_62
gq_61:
    s_add_u32 m0, s49, 114688
    s_nop 0
    buffer_load_dwordx4 v1, s[4:7], s48 offen offset:0 lds
    buffer_load_dwordx4 v1, s[4:7], s48 offen offset:1024 lds
    buffer_load_dwordx4 v1, s[4:7], s48 offen offset:2048 lds
    buffer_load_dwordx4 v1, s[4:7], s48 offen offset:3072 lds
    s_add_u32 s48, s48, 4096
ge_62:
    s_waitcnt lgkmcnt(0)
    ds_read_b64_tr_b16 v[104:105], v142 offset:16384
    ds_read_b64_tr_b16 v[106:107], v142 offset:20480
    ds_read_b64_tr_b16 v[108:109], v143 offset:16384
    ds_read_b64_tr_b16 v[110:111], v143 offset:20480
    ds_read_b64_tr_b16 v[112:113], v144 offset:16384
    ds_read_b64_tr_b16 v[114:115], v144 offset:20480
    ds_read_b64_tr_b16 v[116:117], v145 offset:16384
    ds_read_b64_tr_b16 v[118:119], v145 offset:20480
    ds_read_b128 v[120:123], v3 offset:16384
    ds_read_b128 v[124:127], v3 offset:17408
    ds_read_b128 v[128:131], v3 offset:18432
    ds_read_b128 v[132:135], v3 offset:19456
    v_mfma_f32_16x16x32_bf16 v[8:11], v[88:91], v[72:75], v[8:11]
    v_mfma_f32_16x16x32_bf16 v[12:15], v[92:95], v[72:75], v[12:15]
    v_mfma_f32_16x16x32_bf16 v[16:19], v[96:99], v[72:75], v[16:19]
    v_mfma_f32_16x16x32_bf16 v[20:23], v[100:103], v[72:75], v[20:23]
    v_mfma_f32_16x16x32_bf16 v[24:27], v[88:91], v[76:79], v[24:27]
    v_mfma_f32_16x16x32_bf16 v[28:31], v[92:95], v[76:79], v[28:31]
    v_mfma_f32_16x16x32_bf16 v[32:35], v[96:99], v[76:79], v[32:35]
    v_mfma_f32_16x16x32_bf16 v[36:39], v[100:103], v[76:79], v[36:39]
    v_mfma_f32_16x16x32_bf16 v[40:43], v[88:91], v[80:83], v[40:43]
    v_mfma_f32_16x16x32_bf16 v[44:47], v[92:95], v[80:83], v[44:47]
    v_mfma_f32_16x16x32_bf16 v[48:51], v[96:99], v[80:83], v[48:51]
    v_mfma_f32_16x16x32_bf16 v[52:55], v[100:103], v[80:83], v[52:55]
    v_mfma_f32_16x16x32_bf16 v[56:59], v[88:91], v[84:87], v[56:59]
    v_mfma_f32_16x16x32_bf16 v[60:63], v[92:95], v[84:87], v[60:63]
    v_mfma_f32_16x16x32_bf16 v[64:67], v[96:99], v[84:87], v[64:67]
    v_mfma_f32_16x16x32_bf16 v[68:71], v[100:103], v[84:87], v[68:71]
    s_waitcnt vmcnt(20)
    s_barrier
    s_cmp_ge_u32 s3, 2
    s_cbranch_scc1 gq_63
    s_add_u32 m0, s49, 0
    s_add_u32 s59, s48, 0
    buffer_load_dwordx4 v140, s[8:11], s59 offen lds
    s_add_u32 m0, s49, 1024
    s_add_u32 s59, s48, 32768
    buffer_load_dwordx4 v141, s[8:11], s59 offen lds
    s_add_u32 m0, s49, 2048
    s_add_u32 s59, s48, 65536
    buffer_load_dwordx4 v140, s[8:11], s59 offen lds
    s_add_u32 m0, s49, 3072
    s_add_u32 s59, s48, 98304
    buffer_load_dwordx4 v141, s[8:11], s59 offen lds
    s_add_u32 s48, s48, 262144
    s_branch ge_64
gq_63:
    s_add_u32 m0, s49, 0
    s_nop 0
    buffer_load_dwordx4 v1, s[4:7], s48 offen offset:0 lds
    buffer_load_dwordx4 v1, s[4:7], s48 offen offset:1024 lds
    buffer_load_dwordx4 v1, s[4:7], s48 offen offset:2048 lds
    buffer_load_dwordx4 v1, s[4:7], s48 offen offset:3072 lds
    s_add_u32 s48, s48, 4096
ge_64:
    s_waitcnt lgkmcnt(0)
    ds_read_b64_tr_b16 v[72:73], v142 offset:32768
    ds_read_b64_tr_b16 v[74:75], v142 offset:36864
    ds_read_b64_tr_b16 v[76:77], v143 offset:32768
    ds_read_b64_tr_b16 v[78:79], v143 offset:36864
    ds_read_b64_tr_b16 v[80:81], v144 offset:32768
    ds_read_b64_tr_b16 v[82:83], v144 offset:36864
    ds_read_b64_tr_b16 v[84:85], v145 offset:32768
    ds_read_b64_tr_b16 v[86:87], v145 offset:36864
    ds_read_b128 v[88:91], v3 offset:32768
    ds_read_b128 v[92:95], v3 offset:33792
    ds_read_b128 v[96:99], v3 offset:34816
    ds_read_b128 v[100:103], v3 offset:35840
    v_mfma_f32_16x16x32_bf16 v[8:11], v[120:123], v[104:107], v[8:11]
    v_mfma_f32_16x16x32_bf16 v[12:15], v[124:127], v[104:107], v[12:15]
    v_mfma_f32_16x16x32_bf16 v[16:19], v[128:131], v[104:107], v[16:19]
    v_mfma_f32_16x16x32_bf16 v[20:23], v[132:135], v[104:107], v[20:23]
    v_mfma_f32_16x16x32_bf16 v[24:27], v[120:123], v[108:111], v[24:27]
    v_mfma_f32_16x16x32_bf16 v[28:31], v[124:127], v[108:111], v[28:31]
    v_mfma_f32_16x16x32_bf16 v[32:35], v[128:131], v[108:111], v[32:35]
    v_mfma_f32_16x16x32_bf16 v[36:39], v[132:135], v[108:111], v[36:39]
    v_mfma_f32_16x16x32_bf16 v[40:43], v[120:123], v[112:115], v[40:43]
    v_mfma_f32_16x16x32_bf16 v[44:47], v[124:127], v[112:115], v[44:47]
    v_mfma_f32_16x16x32_bf16 v[48:51], v[128:131], v[112:115], v[48:51]
    v_mfma_f32_16x16x32_bf16 v[52:55], v[132:135], v[112:115], v[52:55]
    v_mfma_f32_16x16x32_bf16 v[56:59], v[120:123], v[116:119], v[56:59]
    v_mfma_f32_16x16x32_bf16 v[60:63], v[124:127], v[116:119], v[60:63]
    v_mfma_f32_16x16x32_bf16 v[64:67], v[128:131], v[116:119], v[64:67]
    v_mfma_f32_16x16x32_bf16 v[68:71], v[132:135], v[116:119], v[68:71]
    s_waitcnt vmcnt(20)
    s_barrier
    s_cmp_ge_u32 s3, 2
    s_cbranch_scc1 gq_65
    s_add_u32 m0, s49, 16384
    s_add_u32 s59, s48, 0
    buffer_load_dwordx4 v140, s[8:11], s59 offen lds
    s_add_u32 m0, s49, 17408
    s_add_u32 s59, s48, 32768
    buffer_load_dwordx4 v141, s[8:11], s59 offen lds
    s_add_u32 m0, s49, 18432
    s_add_u32 s59, s48, 65536
    buffer_load_dwordx4 v140, s[8:11], s59 offen lds
    s_add_u32 m0, s49, 19456
    s_add_u32 s59, s48, 98304
    buffer_load_dwordx4 v141, s[8:11], s59 offen lds
    s_add_u32 s48, s48, 262144
    s_branch ge_66
gq_65:
    s_add_u32 m0, s49, 16384
    s_nop 0
    buffer_load_dwordx4 v1, s[4:7], s48 offen offset:0 lds
    buffer_load_dwordx4 v1, s[4:7], s48 offen offset:1024 lds
    buffer_load_dwordx4 v1, s[4:7], s48 offen offset:2048 lds
    buffer_load_dwordx4 v1, s[4:7], s48 offen offset:3072 lds
    s_add_u32 s48, s48, 4096
ge_66:
    s_waitcnt lgkmcnt(0)
    ds_read_b64_tr_b16 v[104:105], v142 offset:49152
    ds_read_b64_tr_b16 v[106:107], v142 offset:53248
    ds_read_b64_tr_b16 v[108:109], v143 offset:49152
    ds_read_b64_tr_b16 v[110:111], v143 offset:53248
    ds_read_b64_tr_b16 v[112:113], v144 offset:49152
    ds_read_b64_tr_b16 v[114:115], v144 offset:53248
    ds_read_b64_tr_b16 v[116:117], v145 offset:49152
    ds_read_b64_tr_b16 v[118:119], v145 offset:53248
    ds_read_b128 v[120:123], v3 offset:49152
    ds_read_b128 v[124:127], v3 offset:50176
    ds_read_b128 v[128:131], v3 offset:51200
    ds_read_b128 v[132:135], v3 offset:52224
    v_mfma_f32_16x16x32_bf16 v[8:11], v[88:91], v[72:75], v[8:11]
    v_mfma_f32_16x16x32_bf16 v[12:15], v[92:95], v[72:75], v[12:15]
    v_mfma_f32_16x16x32_bf16 v[16:19], v[96:99], v[72:75], v[16:19]
    v_mfma_f32_16x16x32_bf16 v[20:23], v[100:103], v[72:75], v[20:23]
    v_mfma_f32_16x16x32_bf16 v[24:27], v[88:91], v[76:79], v[24:27]
    v_mfma_f32_16x16x32_bf16 v[28:31], v[92:95], v[76:79], v[28:31]
    v_mfma_f32_16x16x32_bf16 v[32:35], v[96:99], v[76:79], v[32:35]
    v_mfma_f32_16x16x32_bf16 v[36:39], v[100:103], v[76:79], v[36:39]
    v_mfma_f32_16x16x32_bf16 v[40:43], v[88:91], v[80:83], v[40:43]
    v_mfma_f32_16x16x32_bf16 v[44:47], v[92:95], v[80:83], v[44:47]
    v_mfma_f32_16x16x32_bf16 v[48:51], v[96:99], v[80:83], v[48:51]
    v_mfma_f32_16x16x32_bf16 v[52:55], v[100:103], v[80:83], v[52:55]
    v_mfma_f32_16x16x32_bf16 v[56:59], v[88:91], v[84:87], v[56:59]
    v_mfma_f32_16x16x32_bf16 v[60:63], v[92:95], v[84:87], v[60:63]
    v_mfma_f32_16x16x32_bf16 v[64:67], v[96:99], v[84:87], v[64:67]
    v_mfma_f32_16x16x32_bf16 v[68:71], v[100:103], v[84:87], v[68:71]
    s_waitcnt vmcnt(20)
    s_barrier
    s_cmp_ge_u32 s3, 2
    s_cbranch_scc1 gq_67
    s_add_u32 m0, s49, 32768
    s_add_u32 s59, s48, 0
    buffer_load_dwordx4 v140, s[8:11], s59 offen lds
    s_add_u32 m0, s49, 33792
    s_add_u32 s59, s48, 32768
    buffer_load_dwordx4 v141, s[8:11], s59 offen lds
    s_add_u32 m0, s49, 34816
    s_add_u32 s59, s48, 65536
    buffer_load_dwordx4 v140, s[8:11], s59 offen lds
    s_add_u32 m0, s49, 35840
    s_add_u32 s59, s48, 98304
    buffer_load_dwordx4 v141, s[8:11], s59 offen lds
    s_add_u32 s48, s48, 262144
    s_branch ge_68
gq_67:
    s_add_u32 m0, s49, 32768
    s_nop 0
    buffer_load_dwordx4 v1, s[4:7], s48 offen offset:0 lds
    buffer_load_dwordx4 v1, s[4:7], s48 offen offset:1024 lds
    buffer_load_dwordx4 v1, s[4:7], s48 offen offset:2048 lds
    buffer_load_dwordx4 v1, s[4:7], s48 offen offset:3072 lds
    s_add_u32 s48, s48, 4096
ge_68:
    s_waitcnt lgkmcnt(0)
    ds_read_b64_tr_b16 v[72:73], v146 offset:0
    ds_read_b64_tr_b16 v[74:75], v146 offset:4096
    ds_read_b64_tr_b16 v[76:77], v147 offset:0
    ds_read_b64_tr_b16 v[78:79], v147 offset:4096
    ds_read_b64_tr_b16 v[80:81], v148 offset:0
    ds_read_b64_tr_b16 v[82:83], v148 offset:4096
    ds_read_b64_tr_b16 v[84:85], v149 offset:0
    ds_read_b64_tr_b16 v[86:87], v149 offset:4096
    ds_read_b128 v[88:91], v7 offset:0
    ds_read_b128 v[92:95], v7 offset:1024
    ds_read_b128 v[96:99], v7 offset:2048
    ds_read_b128 v[100:103], v7 offset:3072
    v_mfma_f32_16x16x32_bf16 v[8:11], v[120:123], v[104:107], v[8:11]
    v_mfma_f32_16x16x32_bf16 v[12:15], v[124:127], v[104:107], v[12:15]
    v_mfma_f32_16x16x32_bf16 v[16:19], v[128:131], v[104:107], v[16:19]
    v_mfma_f32_16x16x32_bf16 v[20:23], v[132:135], v[104:107], v[20:23]
    v_mfma_f32_16x16x32_bf16 v[24:27], v[120:123], v[108:111], v[24:27]
    v_mfma_f32_16x16x32_bf16 v[28:31], v[124:127], v[108:111], v[28:31]
    v_mfma_f32_16x16x32_bf16 v[32:35], v[128:131], v[108:111], v[32:35]
    v_mfma_f32_16x16x32_bf16 v[36:39], v[132:135], v[108:111], v[36:39]
    v_mfma_f32_16x16x32_bf16 v[40:43], v[120:123], v[112:115], v[40:43]
    v_mfma_f32_16x16x32_bf16 v[44:47], v[124:127], v[112:115], v[44:47]
    v_mfma_f32_16x16x32_bf16 v[48:51], v[128:131], v[112:115], v[48:51]
    v_mfma_f32_16x16x32_bf16 v[52:55], v[132:135], v[112:115], v[52:55]
    v_mfma_f32_16x16x32_bf16 v[56:59], v[120:123], v[116:119], v[56:59]
    v_mfma_f32_16x16x32_bf16 v[60:63], v[124:127], v[116:119], v[60:63]
    v_mfma_f32_16x16x32_bf16 v[64:67], v[128:131], v[116:119], v[64:67]
    v_mfma_f32_16x16x32_bf16 v[68:71], v[132:135], v[116:119], v[68:71]
    s_waitcnt vmcnt(20)
    s_barrier
    s_cmp_ge_u32 s3, 2
    s_cbranch_scc1 gq_69
    s_add_u32 m0, s49, 49152
    s_add_u32 s59, s48, 0
    buffer_load_dwordx4 v140, s[8:11], s59 offen lds
    s_add_u32 m0, s49, 50176
    s_add_u32 s59, s48, 32768
    buffer_load_dwordx4 v141, s[8:11], s59 offen lds
    s_add_u32 m0, s49, 51200
    s_add_u32 s59, s48, 65536
    buffer_load_dwordx4 v140, s[8:11], s59 offen lds
    s_add_u32 m0, s49, 52224
    s_add_u32 s59, s48, 98304
    buffer_load_dwordx4 v141, s[8:11], s59 offen lds
    s_add_u32 s48, s48, 262144
    s_branch ge_70
gq_69:
    s_add_u32 m0, s49, 49152
    s_nop 0
    buffer_load_dwordx4 v1, s[4:7], s48 offen offset:0 lds
    buffer_load_dwordx4 v1, s[4:7], s48 offen offset:1024 lds
    buffer_load_dwordx4 v1, s[4:7], s48 offen offset:2048 lds
    buffer_load_dwordx4 v1, s[4:7], s48 offen offset:3072 lds
    s_add_u32 s48, s48, 4096
ge_70:
    s_waitcnt lgkmcnt(0)
    ds_read_b64_tr_b16 v[104:105], v146 offset:16384
    ds_read_b64_tr_b16 v[106:107], v146 offset:20480
    ds_read_b64_tr_b16 v[108:109], v147 offset:16384
    ds_read_b64_tr_b16 v[110:111], v147 offset:20480
    ds_read_b64_tr_b16 v[112:113], v148 offset:16384
    ds_read_b64_tr_b16 v[114:115], v148 offset:20480
    ds_read_b64_tr_b16 v[116:117], v149 offset:16384
    ds_read_b64_tr_b16 v[118:119], v149 offset:20480
    ds_read_b128 v[120:123], v7 offset:16384
    ds_read_b128 v[124:127], v7 offset:17408
    ds_read_b128 v[128:131], v7 offset:18432
    ds_read_b128 v[132:135], v7 offset:19456
    v_mfma_f32_16x16x32_bf16 v[8:11], v[88:91], v[72:75], v[8:11]
    v_mfma_f32_16x16x32_bf16 v[12:15], v[92:95], v[72:75], v[12:15]
    v_mfma_f32_16x16x32_bf16 v[16:19], v[96:99], v[72:75], v[16:19]
    v_mfma_f32_16x16x32_bf16 v[20:23], v[100:103], v[72:75], v[20:23]
    v_mfma_f32_16x16x32_bf16 v[24:27], v[88:91], v[76:79], v[24:27]
    v_mfma_f32_16x16x32_bf16 v[28:31], v[92:95], v[76:79], v[28:31]
    v_mfma_f32_16x16x32_bf16 v[32:35], v[96:99], v[76:79], v[32:35]
    v_mfma_f32_16x16x32_bf16 v[36:39], v[100:103], v[76:79], v[36:39]
    v_mfma_f32_16x16x32_bf16 v[40:43], v[88:91], v[80:83], v[40:43]
    v_mfma_f32_16x16x32_bf16 v[44:47], v[92:95], v[80:83], v[44:47]
    v_mfma_f32_16x16x32_bf16 v[48:51], v[96:99], v[80:83], v[48:51]
    v_mfma_f32_16x16x32_bf16 v[52:55], v[100:103], v[80:83], v[52:55]
    v_mfma_f32_16x16x32_bf16 v[56:59], v[88:91], v[84:87], v[56:59]
    v_mfma_f32_16x16x32_bf16 v[60:63], v[92:95], v[84:87], v[60:63]
    v_mfma_f32_16x16x32_bf16 v[64:67], v[96:99], v[84:87], v[64:67]
    v_mfma_f32_16x16x32_bf16 v[68:71], v[100:103], v[84:87], v[68:71]
    s_waitcnt vmcnt(20)
    s_barrier
    s_cmp_ge_u32 s3, 2
    s_cbranch_scc1 gq_71
    s_add_u32 m0, s49, 65536
    s_add_u32 s59, s48, 0
    buffer_load_dwordx4 v140, s[8:11], s59 offen lds
    s_add_u32 m0, s49, 66560
    s_add_u32 s59, s48, 32768
    buffer_load_dwordx4 v141, s[8:11], s59 offen lds
    s_add_u32 m0, s49, 67584
    s_add_u32 s59, s48, 65536
    buffer_load_dwordx4 v140, s[8:11], s59 offen lds
    s_add_u32 m0, s49, 68608
    s_add_u32 s59, s48, 98304
    buffer_load_dwordx4 v141, s[8:11], s59 offen lds
    s_add_u32 s48, s48, 262144
    s_branch ge_72
gq_71:
    s_add_u32 m0, s49, 65536
    s_nop 0
    buffer_load_dwordx4 v1, s[4:7], s48 offen offset:0 lds
    buffer_load_dwordx4 v1, s[4:7], s48 offen offset:1024 lds
    buffer_load_dwordx4 v1, s[4:7], s48 offen offset:2048 lds
    buffer_load_dwordx4 v1, s[4:7], s48 offen offset:3072 lds
    s_add_u32 s48, s48, 4096
ge_72:
    s_waitcnt lgkmcnt(0)
    ds_read_b64_tr_b16 v[72:73], v146 offset:32768
    ds_read_b64_tr_b16 v[74:75], v146 offset:36864
    ds_read_b64_tr_b16 v[76:77], v147 offset:32768
    ds_read_b64_tr_b16 v[78:79], v147 offset:36864
    ds_read_b64_tr_b16 v[80:81], v148 offset:32768
    ds_read_b64_tr_b16 v[82:83], v148 offset:36864
    ds_read_b64_tr_b16 v[84:85], v149 offset:32768
    ds_read_b64_tr_b16 v[86:87], v149 offset:36864
    ds_read_b128 v[88:91], v7 offset:32768
    ds_read_b128 v[92:95], v7 offset:33792
    ds_read_b128 v[96:99], v7 offset:34816
    ds_read_b128 v[100:103], v7 offset:35840
    v_mfma_f32_16x16x32_bf16 v[8:11], v[120:123], v[104:107], v[8:11]
    v_mfma_f32_16x16x32_bf16 v[12:15], v[124:127], v[104:107], v[12:15]
    v_mfma_f32_16x16x32_bf16 v[16:19], v[128:131], v[104:107], v[16:19]
    v_mfma_f32_16x16x32_bf16 v[20:23], v[132:135], v[104:107], v[20:23]
    v_mfma_f32_16x16x32_bf16 v[24:27], v[120:123], v[108:111], v[24:27]
    v_mfma_f32_16x16x32_bf16 v[28:31], v[124:127], v[108:111], v[28:31]
    v_mfma_f32_16x16x32_bf16 v[32:35], v[128:131], v[108:111], v[32:35]
    v_mfma_f32_16x16x32_bf16 v[36:39], v[132:135], v[108:111], v[36:39]
    v_mfma_f32_16x16x32_bf16 v[40:43], v[120:123], v[112:115], v[40:43]
    v_mfma_f32_16x16x32_bf16 v[44:47], v[124:127], v[112:115], v[44:47]
    v_mfma_f32_16x16x32_bf16 v[48:51], v[128:131], v[112:115], v[48:51]
    v_mfma_f32_16x16x32_bf16 v[52:55], v[132:135], v[112:115], v[52:55]
    v_mfma_f32_16x16x32_bf16 v[56:59], v[120:123], v[116:119], v[56:59]
    v_mfma_f32_16x16x32_bf16 v[60:63], v[124:127], v[116:119], v[60:63]
    v_mfma_f32_16x16x32_bf16 v[64:67], v[128:131], v[116:119], v[64:67]
    v_mfma_f32_16x16x32_bf16 v[68:71], v[132:135], v[116:119], v[68:71]
    s_waitcnt vmcnt(20)
    s_barrier
    s_cmp_ge_u32 s3, 2
    s_cbranch_scc1 gq_73
    s_add_u32 m0, s49, 81920
    s_add_u32 s59, s48, 0
    buffer_load_dwordx4 v140, s[8:11], s59 offen lds
    s_add_u32 m0, s49, 82944
    s_add_u32 s59, s48, 32768
    buffer_load_dwordx4 v141, s[8:11], s59 offen lds
    s_add_u32 m0, s49, 83968
    s_add_u32 s59, s48, 65536
    buffer_load_dwordx4 v140, s[8:11], s59 offen lds
    s_add_u32 m0, s49, 84992
    s_add_u32 s59, s48, 98304
    buffer_load_dwordx4 v141, s[8:11], s59 offen lds
    s_add_u32 s48, s48, 262144
    s_branch ge_74
gq_73:
    s_add_u32 m0, s49, 81920
    s_nop 0
    buffer_load_dwordx4 v1, s[4:7], s48 offen offset:0 lds
    buffer_load_dwordx4 v1, s[4:7], s48 offen offset:1024 lds
    buffer_load_dwordx4 v1, s[4:7], s48 offen offset:2048 lds
    buffer_load_dwordx4 v1, s[4:7], s48 offen offset:3072 lds
    s_add_u32 s48, s48, 4096
ge_74:
    s_waitcnt lgkmcnt(0)
    ds_read_b64_tr_b16 v[104:105], v146 offset:49152
    ds_read_b64_tr_b16 v[106:107], v146 offset:53248
    ds_read_b64_tr_b16 v[108:109], v147 offset:49152
    ds_read_b64_tr_b16 v[110:111], v147 offset:53248
    ds_read_b64_tr_b16 v[112:113], v148 offset:49152
    ds_read_b64_tr_b16 v[114:115], v148 offset:53248
    ds_read_b64_tr_b16 v[116:117], v149 offset:49152
    ds_read_b64_tr_b16 v[118:119], v149 offset:53248
    ds_read_b128 v[120:123], v7 offset:49152
    ds_read_b128 v[124:127], v7 offset:50176
    ds_read_b128 v[128:131], v7 offset:51200
    ds_read_b128 v[132:135], v7 offset:52224
    v_mfma_f32_16x16x32_bf16 v[8:11], v[88:91], v[72:75], v[8:11]
    v_mfma_f32_16x16x32_bf16 v[12:15], v[92:95], v[72:75], v[12:15]
    v_mfma_f32_16x16x32_bf16 v[16:19], v[96:99], v[72:75], v[16:19]
    v_mfma_f32_16x16x32_bf16 v[20:23], v[100:103], v[72:75], v[20:23]
    v_mfma_f32_16x16x32_bf16 v[24:27], v[88:91], v[76:79], v[24:27]
    v_mfma_f32_16x16x32_bf16 v[28:31], v[92:95], v[76:79], v[28:31]
    v_mfma_f32_16x16x32_bf16 v[32:35], v[96:99], v[76:79], v[32:35]
    v_mfma_f32_16x16x32_bf16 v[36:39], v[100:103], v[76:79], v[36:39]
    v_mfma_f32_16x16x32_bf16 v[40:43], v[88:91], v[80:83], v[40:43]
    v_mfma_f32_16x16x32_bf16 v[44:47], v[92:95], v[80:83], v[44:47]
    v_mfma_f32_16x16x32_bf16 v[48:51], v[96:99], v[80:83], v[48:51]
    v_mfma_f32_16x16x32_bf16 v[52:55], v[100:103], v[80:83], v[52:55]
    v_mfma_f32_16x16x32_bf16 v[56:59], v[88:91], v[84:87], v[56:59]
    v_mfma_f32_16x16x32_bf16 v[60:63], v[92:95], v[84:87], v[60:63]
    v_mfma_f32_16x16x32_bf16 v[64:67], v[96:99], v[84:87], v[64:67]
    v_mfma_f32_16x16x32_bf16 v[68:71], v[100:103], v[84:87], v[68:71]
    s_waitcnt vmcnt(20)
    s_barrier
    s_cmp_ge_u32 s3, 2
    s_cbranch_scc1 gq_75
    s_add_u32 m0, s49, 98304
    s_add_u32 s59, s48, 0
    buffer_load_dwordx4 v140, s[8:11], s59 offen lds
    s_add_u32 m0, s49, 99328
    s_add_u32 s59, s48, 32768
    buffer_load_dwordx4 v141, s[8:11], s59 offen lds
    s_add_u32 m0, s49, 100352
    s_add_u32 s59, s48, 65536
    buffer_load_dwordx4 v140, s[8:11], s59 offen lds
    s_add_u32 m0, s49, 101376
    s_add_u32 s59, s48, 98304
    buffer_load_dwordx4 v141, s[8:11], s59 offen lds
    s_add_u32 s48, s48, 262144
    s_branch ge_76
gq_75:
    s_add_u32 m0, s49, 98304
    s_nop 0
    buffer_load_dwordx4 v1, s[4:7], s48 offen offset:0 lds
    buffer_load_dwordx4 v1, s[4:7], s48 offen offset:1024 lds
    buffer_load_dwordx4 v1, s[4:7], s48 offen offset:2048 lds
    buffer_load_dwordx4 v1, s[4:7], s48 offen offset:3072 lds
    s_add_u32 s48, s48, 4096
ge_76:
    s_waitcnt lgkmcnt(0)
    ds_read_b64_tr_b16 v[72:73], v142 offset:0
    ds_read_b64_tr_b16 v[74:75], v142 offset:4096
    ds_read_b64_tr_b16 v[76:77], v143 offset:0
    ds_read_b64_tr_b16 v[78:79], v143 offset:4096
    ds_read_b64_tr_b16 v[80:81], v144 offset:0
    ds_read_b64_tr_b16 v[82:83], v144 offset:4096
    ds_read_b64_tr_b16 v[84:85], v145 offset:0
    ds_read_b64_tr_b16 v[86:87], v145 offset:4096
    ds_read_b128 v[88:91], v3 offset:0
    ds_read_b128 v[92:95], v3 offset:1024
    ds_read_b128 v[96:99], v3 offset:2048
    ds_read_b128 v[100:103], v3 offset:3072
    v_mfma_f32_16x16x32_bf16 v[8:11], v[120:123], v[104:107], v[8:11]
    v_mfma_f32_16x16x32_bf16 v[12:15], v[124:127], v[104:107], v[12:15]
    v_mfma_f32_16x16x32_bf16 v[16:19], v[128:131], v[104:107], v[16:19]
    v_mfma_f32_16x16x32_bf16 v[20:23], v[132:135], v[104:107], v[20:23]
    v_mfma_f32_16x16x32_bf16 v[24:27], v[120:123], v[108:111], v[24:27]
    v_mfma_f32_16x16x32_bf16 v[28:31], v[124:127], v[108:111], v[28:31]
    v_mfma_f32_16x16x32_bf16 v[32:35], v[128:131], v[108:111], v[32:35]
    v_mfma_f32_16x16x32_bf16 v[36:39], v[132:135], v[108:111], v[36:39]
    v_mfma_f32_16x16x32_bf16 v[40:43], v[120:123], v[112:115], v[40:43]
    v_mfma_f32_16x16x32_bf16 v[44:47], v[124:127], v[112:115], v[44:47]
    v_mfma_f32_16x16x32_bf16 v[48:51], v[128:131], v[112:115], v[48:51]
    v_mfma_f32_16x16x32_bf16 v[52:55], v[132:135], v[112:115], v[52:55]
    v_mfma_f32_16x16x32_bf16 v[56:59], v[120:123], v[116:119], v[56:59]
    v_mfma_f32_16x16x32_bf16 v[60:63], v[124:127], v[116:119], v[60:63]
    v_mfma_f32_16x16x32_bf16 v[64:67], v[128:131], v[116:119], v[64:67]
    v_mfma_f32_16x16x32_bf16 v[68:71], v[132:135], v[116:119], v[68:71]
    s_sub_u32 s50, s50, 1
    s_cmp_lg_u32 s50, 0
    s_cbranch_scc1 gloop_60
    s_waitcnt vmcnt(20)
    s_barrier
    s_cmp_ge_u32 s3, 2
    s_cbranch_scc1 gq_77
    s_add_u32 m0, s49, 114688
    s_add_u32 s59, s48, 0
    buffer_load_dwordx4 v140, s[8:11], s59 offen lds
    s_add_u32 m0, s49, 115712
    s_add_u32 s59, s48, 32768
    buffer_load_dwordx4 v141, s[8:11], s59 offen lds
    s_add_u32 m0, s49, 116736
    s_add_u32 s59, s48, 65536
    buffer_load_dwordx4 v140, s[8:11], s59 offen lds
    s_add_u32 m0, s49, 117760
    s_add_u32 s59, s48, 98304
    buffer_load_dwordx4 v141, s[8:11], s59 offen lds
    s_add_u32 s48, s48, 262144
    s_branch ge_78
gq_77:
    s_add_u32 m0, s49, 114688
    s_nop 0
    buffer_load_dwordx4 v1, s[4:7], s48 offen offset:0 lds
    buffer_load_dwordx4 v1, s[4:7], s48 offen offset:1024 lds
    buffer_load_dwordx4 v1, s[4:7], s48 offen offset:2048 lds
    buffer_load_dwordx4 v1, s[4:7], s48 offen offset:3072 lds
    s_add_u32 s48, s48, 4096
ge_78:
    s_waitcnt lgkmcnt(0)
    ds_read_b64_tr_b16 v[104:105], v142 offset:16384
    ds_read_b64_tr_b16 v[106:107], v142 offset:20480
    ds_read_b64_tr_b16 v[108:109], v143 offset:16384
    ds_read_b64_tr_b16 v[110:111], v143 offset:20480
    ds_read_b64_tr_b16 v[112:113], v144 offset:16384
    ds_read_b64_tr_b16 v[114:115], v144 offset:20480
    ds_read_b64_tr_b16 v[116:117], v145 offset:16384
    ds_read_b64_tr_b16 v[118:119], v145 offset:20480
    ds_read_b128 v[120:123], v3 offset:16384
    ds_read_b128 v[124:127], v3 offset:17408
    ds_read_b128 v[128:131], v3 offset:18432
    ds_read_b128 v[132:135], v3 offset:19456
    v_mfma_f32_16x16x32_bf16 v[8:11], v[88:91], v[72:75], v[8:11]
    v_mfma_f32_16x16x32_bf16 v[12:15], v[92:95], v[72:75], v[12:15]
    v_mfma_f32_16x16x32_bf16 v[16:19], v[96:99], v[72:75], v[16:19]
    v_mfma_f32_16x16x32_bf16 v[20:23], v[100:103], v[72:75], v[20:23]
    v_mfma_f32_16x16x32_bf16 v[24:27], v[88:91], v[76:79], v[24:27]
    v_mfma_f32_16x16x32_bf16 v[28:31], v[92:95], v[76:79], v[28:31]
    v_mfma_f32_16x16x32_bf16 v[32:35], v[96:99], v[76:79], v[32:35]
    v_mfma_f32_16x16x32_bf16 v[36:39], v[100:103], v[76:79], v[36:39]
    v_mfma_f32_16x16x32_bf16 v[40:43], v[88:91], v[80:83], v[40:43]
    v_mfma_f32_16x16x32_bf16 v[44:47], v[92:95], v[80:83], v[44:47]
    v_mfma_f32_16x16x32_bf16 v[48:51], v[96:99], v[80:83], v[48:51]
    v_mfma_f32_16x16x32_bf16 v[52:55], v[100:103], v[80:83], v[52:55]
    v_mfma_f32_16x16x32_bf16 v[56:59], v[88:91], v[84:87], v[56:59]
    v_mfma_f32_16x16x32_bf16 v[60:63], v[92:95], v[84:87], v[60:63]
    v_mfma_f32_16x16x32_bf16 v[64:67], v[96:99], v[84:87], v[64:67]
    v_mfma_f32_16x16x32_bf16 v[68:71], v[100:103], v[84:87], v[68:71]
    s_waitcnt vmcnt(20)
    s_barrier
    s_cmp_ge_u32 s3, 2
    s_cbranch_scc1 gq_79
    s_add_u32 m0, s49, 0
    s_add_u32 s59, s48, 0
    buffer_load_dwordx4 v140, s[8:11], s59 offen lds
    s_add_u32 m0, s49, 1024
    s_add_u32 s59, s48, 32768
    buffer_load_dwordx4 v141, s[8:11], s59 offen lds
    s_add_u32 m0, s49, 2048
    s_add_u32 s59, s48, 65536
    buffer_load_dwordx4 v140, s[8:11], s59 offen lds
    s_add_u32 m0, s49, 3072
    s_add_u32 s59, s48, 98304
    buffer_load_dwordx4 v141, s[8:11], s59 offen lds
    s_add_u32 s48, s48, 262144
    s_branch ge_80
gq_79:
    s_add_u32 m0, s49, 0
    s_nop 0
    buffer_load_dwordx4 v1, s[4:7], s48 offen offset:0 lds
    buffer_load_dwordx4 v1, s[4:7], s48 offen offset:1024 lds
    buffer_load_dwordx4 v1, s[4:7], s48 offen offset:2048 lds
    buffer_load_dwordx4 v1, s[4:7], s48 offen offset:3072 lds
    s_add_u32 s48, s48, 4096
ge_80:
    s_waitcnt lgkmcnt(0)
    ds_read_b64_tr_b16 v[72:73], v142 offset:32768
    ds_read_b64_tr_b16 v[74:75], v142 offset:36864
    ds_read_b64_tr_b16 v[76:77], v143 offset:32768
    ds_read_b64_tr_b16 v[78:79], v143 offset:36864
    ds_read_b64_tr_b16 v[80:81], v144 offset:32768
    ds_read_b64_tr_b16 v[82:83], v144 offset:36864
    ds_read_b64_tr_b16 v[84:85], v145 offset:32768
    ds_read_b64_tr_b16 v[86:87], v145 offset:36864
    ds_read_b128 v[88:91], v3 offset:32768
    ds_read_b128 v[92:95], v3 offset:33792
    ds_read_b128 v[96:99], v3 offset:34816
    ds_read_b128 v[100:103], v3 offset:35840
    v_mfma_f32_16x16x32_bf16 v[8:11], v[120:123], v[104:107], v[8:11]
    v_mfma_f32_16x16x32_bf16 v[12:15], v[124:127], v[104:107], v[12:15]
    v_mfma_f32_16x16x32_bf16 v[16:19], v[128:131], v[104:107], v[16:19]
    v_mfma_f32_16x16x32_bf16 v[20:23], v[132:135], v[104:107], v[20:23]
    v_mfma_f32_16x16x32_bf16 v[24:27], v[120:123], v[108:111], v[24:27]
    v_mfma_f32_16x16x32_bf16 v[28:31], v[124:127], v[108:111], v[28:31]
    v_mfma_f32_16x16x32_bf16 v[32:35], v[128:131], v[108:111], v[32:35]
    v_mfma_f32_16x16x32_bf16 v[36:39], v[132:135], v[108:111], v[36:39]
    v_mfma_f32_16x16x32_bf16 v[40:43], v[120:123], v[112:115], v[40:43]
    v_mfma_f32_16x16x32_bf16 v[44:47], v[124:127], v[112:115], v[44:47]
    v_mfma_f32_16x16x32_bf16 v[48:51], v[128:131], v[112:115], v[48:51]
    v_mfma_f32_16x16x32_bf16 v[52:55], v[132:135], v[112:115], v[52:55]
    v_mfma_f32_16x16x32_bf16 v[56:59], v[120:123], v[116:119], v[56:59]
    v_mfma_f32_16x16x32_bf16 v[60:63], v[124:127], v[116:119], v[60:63]
    v_mfma_f32_16x16x32_bf16 v[64:67], v[128:131], v[116:119], v[64:67]
    v_mfma_f32_16x16x32_bf16 v[68:71], v[132:135], v[116:119], v[68:71]
    s_waitcnt vmcnt(20)
    s_barrier
    s_cmp_ge_u32 s3, 2
    s_cbranch_scc1 gq_81
    s_add_u32 m0, s49, 16384
    s_add_u32 s59, s48, 0
    buffer_load_dwordx4 v140, s[8:11], s59 offen lds
    s_add_u32 m0, s49, 17408
    s_add_u32 s59, s48, 32768
    buffer_load_dwordx4 v141, s[8:11], s59 offen lds
    s_add_u32 m0, s49, 18432
    s_add_u32 s59, s48, 65536
    buffer_load_dwordx4 v140, s[8:11], s59 offen lds
    s_add_u32 m0, s49, 19456
    s_add_u32 s59, s48, 98304
    buffer_load_dwordx4 v141, s[8:11], s59 offen lds
    s_add_u32 s48, s48, 262144
    s_branch ge_82
gq_81:
    s_add_u32 m0, s49, 16384
    s_nop 0
    buffer_load_dwordx4 v1, s[4:7], s48 offen offset:0 lds
    buffer_load_dwordx4 v1, s[4:7], s48 offen offset:1024 lds
    buffer_load_dwordx4 v1, s[4:7], s48 offen offset:2048 lds
    buffer_load_dwordx4 v1, s[4:7], s48 offen offset:3072 lds
    s_add_u32 s48, s48, 4096
ge_82:
    s_waitcnt lgkmcnt(0)
    ds_read_b64_tr_b16 v[104:105], v142 offset:49152
    ds_read_b64_tr_b16 v[106:107], v142 offset:53248
    ds_read_b64_tr_b16 v[108:109], v143 offset:49152
    ds_read_b64_tr_b16 v[110:111], v143 offset:53248
    ds_read_b64_tr_b16 v[112:113], v144 offset:49152
    ds_read_b64_tr_b16 v[114:115], v144 offset:53248
    ds_read_b64_tr_b16 v[116:117], v145 offset:49152
    ds_read_b64_tr_b16 v[118:119], v145 offset:53248
    ds_read_b128 v[120:123], v3 offset:49152
    ds_read_b128 v[124:127], v3 offset:50176
    ds_read_b128 v[128:131], v3 offset:51200
    ds_read_b128 v[132:135], v3 offset:52224
    v_mfma_f32_16x16x32_bf16 v[8:11], v[88:91], v[72:75], v[8:11]
    v_mfma_f32_16x16x32_bf16 v[12:15], v[92:95], v[72:75], v[12:15]
    v_mfma_f32_16x16x32_bf16 v[16:19], v[96:99], v[72:75], v[16:19]
    v_mfma_f32_16x16x32_bf16 v[20:23], v[100:103], v[72:75], v[20:23]
    v_mfma_f32_16x16x32_bf16 v[24:27], v[88:91], v[76:79], v[24:27]
    v_mfma_f32_16x16x32_bf16 v[28:31], v[92:95], v[76:79], v[28:31]
    v_mfma_f32_16x16x32_bf16 v[32:35], v[96:99], v[76:79], v[32:35]
    v_mfma_f32_16x16x32_bf16 v[36:39], v[100:103], v[76:79], v[36:39]
    v_mfma_f32_16x16x32_bf16 v[40:43], v[88:91], v[80:83], v[40:43]
    v_mfma_f32_16x16x32_bf16 v[44:47], v[92:95], v[80:83], v[44:47]
    v_mfma_f32_16x16x32_bf16 v[48:51], v[96:99], v[80:83], v[48:51]
    v_mfma_f32_16x16x32_bf16 v[52:55], v[100:103], v[80:83], v[52:55]
    v_mfma_f32_16x16x32_bf16 v[56:59], v[88:91], v[84:87], v[56:59]
    v_mfma_f32_16x16x32_bf16 v[60:63], v[92:95], v[84:87], v[60:63]
    v_mfma_f32_16x16x32_bf16 v[64:67], v[96:99], v[84:87], v[64:67]
    v_mfma_f32_16x16x32_bf16 v[68:71], v[100:103], v[84:87], v[68:71]
    s_waitcnt vmcnt(20)
    s_barrier
    s_cmp_ge_u32 s3, 2
    s_cbranch_scc1 gq_83
    s_add_u32 m0, s49, 32768
    s_add_u32 s59, s48, 0
    buffer_load_dwordx4 v140, s[8:11], s59 offen lds
    s_add_u32 m0, s49, 33792
    s_add_u32 s59, s48, 32768
    buffer_load_dwordx4 v141, s[8:11], s59 offen lds
    s_add_u32 m0, s49, 34816
    s_add_u32 s59, s48, 65536
    buffer_load_dwordx4 v140, s[8:11], s59 offen lds
    s_add_u32 m0, s49, 35840
    s_add_u32 s59, s48, 98304
    buffer_load_dwordx4 v141, s[8:11], s59 offen lds
    s_add_u32 s48, s48, 262144
    s_branch ge_84
gq_83:
    s_add_u32 m0, s49, 32768
    s_nop 0
    buffer_load_dwordx4 v1, s[4:7], s48 offen offset:0 lds
    buffer_load_dwordx4 v1, s[4:7], s48 offen offset:1024 lds
    buffer_load_dwordx4 v1, s[4:7], s48 offen offset:2048 lds
    buffer_load_dwordx4 v1, s[4:7], s48 offen offset:3072 lds
    s_add_u32 s48, s48, 4096
ge_84:
    s_waitcnt lgkmcnt(0)
    ds_read_b64_tr_b16 v[72:73], v146 offset:0
    ds_read_b64_tr_b16 v[74:75], v146 offset:4096
    ds_read_b64_tr_b16 v[76:77], v147 offset:0
    ds_read_b64_tr_b16 v[78:79], v147 offset:4096
    ds_read_b64_tr_b16 v[80:81], v148 offset:0
    ds_read_b64_tr_b16 v[82:83], v148 offset:4096
    ds_read_b64_tr_b16 v[84:85], v149 offset:0
    ds_read_b64_tr_b16 v[86:87], v149 offset:4096
    ds_read_b128 v[88:91], v7 offset:0
    ds_read_b128 v[92:95], v7 offset:1024
    ds_read_b128 v[96:99], v7 offset:2048
    ds_read_b128 v[100:103], v7 offset:3072
    v_mfma_f32_16x16x32_bf16 v[8:11], v[120:123], v[104:107], v[8:11]
    v_mfma_f32_16x16x32_bf16 v[12:15], v[124:127], v[104:107], v[12:15]
    v_mfma_f32_16x16x32_bf16 v[16:19], v[128:131], v[104:107], v[16:19]
    v_mfma_f32_16x16x32_bf16 v[20:23], v[132:135], v[104:107], v[20:23]
    v_mfma_f32_16x16x32_bf16 v[24:27], v[120:123], v[108:111], v[24:27]
    v_mfma_f32_16x16x32_bf16 v[28:31], v[124:127], v[108:111], v[28:31]
    v_mfma_f32_16x16x32_bf16 v[32:35], v[128:131], v[108:111], v[32:35]
    v_mfma_f32_16x16x32_bf16 v[36:39], v[132:135], v[108:111], v[36:39]
    v_mfma_f32_16x16x32_bf16 v[40:43], v[120:123], v[112:115], v[40:43]
    v_mfma_f32_16x16x32_bf16 v[44:47], v[124:127], v[112:115], v[44:47]
    v_mfma_f32_16x16x32_bf16 v[48:51], v[128:131], v[112:115], v[48:51]
    v_mfma_f32_16x16x32_bf16 v[52:55], v[132:135], v[112:115], v[52:55]
    v_mfma_f32_16x16x32_bf16 v[56:59], v[120:123], v[116:119], v[56:59]
    v_mfma_f32_16x16x32_bf16 v[60:63], v[124:127], v[116:119], v[60:63]
    v_mfma_f32_16x16x32_bf16 v[64:67], v[128:131], v[116:119], v[64:67]
    v_mfma_f32_16x16x32_bf16 v[68:71], v[132:135], v[116:119], v[68:71]
    s_waitcnt vmcnt(20)
    s_barrier
    s_cmp_ge_u32 s3, 2
    s_cbranch_scc1 gq_85
    s_add_u32 m0, s49, 49152
    s_add_u32 s59, s48, 0
    buffer_load_dwordx4 v140, s[8:11], s59 offen lds
    s_add_u32 m0, s49, 50176
    s_add_u32 s59, s48, 32768
    buffer_load_dwordx4 v141, s[8:11], s59 offen lds
    s_add_u32 m0, s49, 51200
    s_add_u32 s59, s48, 65536
    buffer_load_dwordx4 v140, s[8:11], s59 offen lds
    s_add_u32 m0, s49, 52224
    s_add_u32 s59, s48, 98304
    buffer_load_dwordx4 v141, s[8:11], s59 offen lds
    s_add_u32 s48, s48, 262144
    s_branch ge_86
gq_85:
    s_add_u32 m0, s49, 49152
    s_nop 0
    buffer_load_dwordx4 v1, s[4:7], s48 offen offset:0 lds
    buffer_load_dwordx4 v1, s[4:7], s48 offen offset:1024 lds
    buffer_load_dwordx4 v1, s[4:7], s48 offen offset:2048 lds
    buffer_load_dwordx4 v1, s[4:7], s48 offen offset:3072 lds
    s_add_u32 s48, s48, 4096
ge_86:
    s_waitcnt lgkmcnt(0)
    ds_read_b64_tr_b16 v[104:105], v146 offset:16384
    ds_read_b64_tr_b16 v[106:107], v146 offset:20480
    ds_read_b64_tr_b16 v[108:109], v147 offset:16384
    ds_read_b64_tr_b16 v[110:111], v147 offset:20480
    ds_read_b64_tr_b16 v[112:113], v148 offset:16384
    ds_read_b64_tr_b16 v[114:115], v148 offset:20480
    ds_read_b64_tr_b16 v[116:117], v149 offset:16384
    ds_read_b64_tr_b16 v[118:119], v149 offset:20480
    ds_read_b128 v[120:123], v7 offset:16384
    ds_read_b128 v[124:127], v7 offset:17408
    ds_read_b128 v[128:131], v7 offset:18432
    ds_read_b128 v[132:135], v7 offset:19456
    v_mfma_f32_16x16x32_bf16 v[8:11], v[88:91], v[72:75], v[8:11]
    v_mfma_f32_16x16x32_bf16 v[12:15], v[92:95], v[72:75], v[12:15]
    v_mfma_f32_16x16x32_bf16 v[16:19], v[96:99], v[72:75], v[16:19]
    v_mfma_f32_16x16x32_bf16 v[20:23], v[100:103], v[72:75], v[20:23]
    v_mfma_f32_16x16x32_bf16 v[24:27], v[88:91], v[76:79], v[24:27]
    v_mfma_f32_16x16x32_bf16 v[28:31], v[92:95], v[76:79], v[28:31]
    v_mfma_f32_16x16x32_bf16 v[32:35], v[96:99], v[76:79], v[32:35]
    v_mfma_f32_16x16x32_bf16 v[36:39], v[100:103], v[76:79], v[36:39]
    v_mfma_f32_16x16x32_bf16 v[40:43], v[88:91], v[80:83], v[40:43]
    v_mfma_f32_16x16x32_bf16 v[44:47], v[92:95], v[80:83], v[44:47]
    v_mfma_f32_16x16x32_bf16 v[48:51], v[96:99], v[80:83], v[48:51]
    v_mfma_f32_16x16x32_bf16 v[52:55], v[100:103], v[80:83], v[52:55]
    v_mfma_f32_16x16x32_bf16 v[56:59], v[88:91], v[84:87], v[56:59]
    v_mfma_f32_16x16x32_bf16 v[60:63], v[92:95], v[84:87], v[60:63]
    v_mfma_f32_16x16x32_bf16 v[64:67], v[96:99], v[84:87], v[64:67]
    v_mfma_f32_16x16x32_bf16 v[68:71], v[100:103], v[84:87], v[68:71]
    s_waitcnt vmcnt(20)
    s_barrier
    s_waitcnt lgkmcnt(0)
    ds_read_b64_tr_b16 v[72:73], v146 offset:32768
    ds_read_b64_tr_b16 v[74:75], v146 offset:36864
    ds_read_b64_tr_b16 v[76:77], v147 offset:32768
    ds_read_b64_tr_b16 v[78:79], v147 offset:36864
    ds_read_b64_tr_b16 v[80:81], v148 offset:32768
    ds_read_b64_tr_b16 v[82:83], v148 offset:36864
    ds_read_b64_tr_b16 v[84:85], v149 offset:32768
    ds_read_b64_tr_b16 v[86:87], v149 offset:36864
    ds_read_b128 v[88:91], v7 offset:32768
    ds_read_b128 v[92:95], v7 offset:33792
    ds_read_b128 v[96:99], v7 offset:34816
    ds_read_b128 v[100:103], v7 offset:35840
    v_mfma_f32_16x16x32_bf16 v[8:11], v[120:123], v[104:107], v[8:11]
    v_mfma_f32_16x16x32_bf16 v[12:15], v[124:127], v[104:107], v[12:15]
    v_mfma_f32_16x16x32_bf16 v[16:19], v[128:131], v[104:107], v[16:19]
    v_mfma_f32_16x16x32_bf16 v[20:23], v[132:135], v[104:107], v[20:23]
    v_mfma_f32_16x16x32_bf16 v[24:27], v[120:123], v[108:111], v[24:27]
    v_mfma_f32_16x16x32_bf16 v[28:31], v[124:127], v[108:111], v[28:31]
    v_mfma_f32_16x16x32_bf16 v[32:35], v[128:131], v[108:111], v[32:35]
    v_mfma_f32_16x16x32_bf16 v[36:39], v[132:135], v[108:111], v[36:39]
    v_mfma_f32_16x16x32_bf16 v[40:43], v[120:123], v[112:115], v[40:43]
    v_mfma_f32_16x16x32_bf16 v[44:47], v[124:127], v[112:115], v[44:47]
    v_mfma_f32_16x16x32_bf16 v[48:51], v[128:131], v[112:115], v[48:51]
    v_mfma_f32_16x16x32_bf16 v[52:55], v[132:135], v[112:115], v[52:55]
    v_mfma_f32_16x16x32_bf16 v[56:59], v[120:123], v[116:119], v[56:59]
    v_mfma_f32_16x16x32_bf16 v[60:63], v[124:127], v[116:119], v[60:63]
    v_mfma_f32_16x16x32_bf16 v[64:67], v[128:131], v[116:119], v[64:67]
    v_mfma_f32_16x16x32_bf16 v[68:71], v[132:135], v[116:119], v[68:71]
    s_waitcnt vmcnt(16)
    s_barrier
    s_waitcnt lgkmcnt(0)
    ds_read_b64_tr_b16 v[104:105], v146 offset:49152
    ds_read_b64_tr_b16 v[106:107], v146 offset:53248
    ds_read_b64_tr_b16 v[108:109], v147 offset:49152
    ds_read_b64_tr_b16 v[110:111], v147 offset:53248
    ds_read_b64_tr_b16 v[112:113], v148 offset:49152
    ds_read_b64_tr_b16 v[114:115], v148 offset:53248
    ds_read_b64_tr_b16 v[116:117], v149 offset:49152
    ds_read_b64_tr_b16 v[118:119], v149 offset:53248
    ds_read_b128 v[120:123], v7 offset:49152
    ds_read_b128 v[124:127], v7 offset:50176
    ds_read_b128 v[128:131], v7 offset:51200
    ds_read_b128 v[132:135], v7 offset:52224
    v_mfma_f32_16x16x32_bf16 v[8:11], v[88:91], v[72:75], v[8:11]
    v_mfma_f32_16x16x32_bf16 v[12:15], v[92:95], v[72:75], v[12:15]
    v_mfma_f32_16x16x32_bf16 v[16:19], v[96:99], v[72:75], v[16:19]
    v_mfma_f32_16x16x32_bf16 v[20:23], v[100:103], v[72:75], v[20:23]
    v_mfma_f32_16x16x32_bf16 v[24:27], v[88:91], v[76:79], v[24:27]
    v_mfma_f32_16x16x32_bf16 v[28:31], v[92:95], v[76:79], v[28:31]
    v_mfma_f32_16x16x32_bf16 v[32:35], v[96:99], v[76:79], v[32:35]
    v_mfma_f32_16x16x32_bf16 v[36:39], v[100:103], v[76:79], v[36:39]
    v_mfma_f32_16x16x32_bf16 v[40:43], v[88:91], v[80:83], v[40:43]
    v_mfma_f32_16x16x32_bf16 v[44:47], v[92:95], v[80:83], v[44:47]
    v_mfma_f32_16x16x32_bf16 v[48:51], v[96:99], v[80:83], v[48:51]
    v_mfma_f32_16x16x32_bf16 v[52:55], v[100:103], v[80:83], v[52:55]
    v_mfma_f32_16x16x32_bf16 v[56:59], v[88:91], v[84:87], v[56:59]
    v_mfma_f32_16x16x32_bf16 v[60:63], v[92:95], v[84:87], v[60:63]
    v_mfma_f32_16x16x32_bf16 v[64:67], v[96:99], v[84:87], v[64:67]
    v_mfma_f32_16x16x32_bf16 v[68:71], v[100:103], v[84:87], v[68:71]
    s_waitcnt vmcnt(12)
    s_barrier
    s_waitcnt lgkmcnt(0)
    ds_read_b64_tr_b16 v[72:73], v142 offset:0
    ds_read_b64_tr_b16 v[74:75], v142 offset:4096
    ds_read_b64_tr_b16 v[76:77], v143 offset:0
    ds_read_b64_tr_b16 v[78:79], v143 offset:4096
    ds_read_b64_tr_b16 v[80:81], v144 offset:0
    ds_read_b64_tr_b16 v[82:83], v144 offset:4096
    ds_read_b64_tr_b16 v[84:85], v145 offset:0
    ds_read_b64_tr_b16 v[86:87], v145 offset:4096
    ds_read_b128 v[88:91], v3 offset:0
    ds_read_b128 v[92:95], v3 offset:1024
    ds_read_b128 v[96:99], v3 offset:2048
    ds_read_b128 v[100:103], v3 offset:3072
    v_mfma_f32_16x16x32_bf16 v[8:11], v[120:123], v[104:107], v[8:11]
    v_mfma_f32_16x16x32_bf16 v[12:15], v[124:127], v[104:107], v[12:15]
    v_mfma_f32_16x16x32_bf16 v[16:19], v[128:131], v[104:107], v[16:19]
    v_mfma_f32_16x16x32_bf16 v[20:23], v[132:135], v[104:107], v[20:23]
    v_mfma_f32_16x16x32_bf16 v[24:27], v[120:123], v[108:111], v[24:27]
    v_mfma_f32_16x16x32_bf16 v[28:31], v[124:127], v[108:111], v[28:31]
    v_mfma_f32_16x16x32_bf16 v[32:35], v[128:131], v[108:111], v[32:35]
    v_mfma_f32_16x16x32_bf16 v[36:39], v[132:135], v[108:111], v[36:39]
    v_mfma_f32_16x16x32_bf16 v[40:43], v[120:123], v[112:115], v[40:43]
    v_mfma_f32_16x16x32_bf16 v[44:47], v[124:127], v[112:115], v[44:47]
    v_mfma_f32_16x16x32_bf16 v[48:51], v[128:131], v[112:115], v[48:51]
    v_mfma_f32_16x16x32_bf16 v[52:55], v[132:135], v[112:115], v[52:55]
    v_mfma_f32_16x16x32_bf16 v[56:59], v[120:123], v[116:119], v[56:59]
    v_mfma_f32_16x16x32_bf16 v[60:63], v[124:127], v[116:119], v[60:63]
    v_mfma_f32_16x16x32_bf16 v[64:67], v[128:131], v[116:119], v[64:67]
    v_mfma_f32_16x16x32_bf16 v[68:71], v[132:135], v[116:119], v[68:71]
    s_waitcnt vmcnt(8)
    s_barrier
    s_waitcnt lgkmcnt(0)
    ds_read_b64_tr_b16 v[104:105], v142 offset:16384
    ds_read_b64_tr_b16 v[106:107], v142 offset:20480
    ds_read_b64_tr_b16 v[108:109], v143 offset:16384
    ds_read_b64_tr_b16 v[110:111], v143 offset:20480
    ds_read_b64_tr_b16 v[112:113], v144 offset:16384
    ds_read_b64_tr_b16 v[114:115], v144 offset:20480
    ds_read_b64_tr_b16 v[116:117], v145 offset:16384
    ds_read_b64_tr_b16 v[118:119], v145 offset:20480
    ds_read_b128 v[120:123], v3 offset:16384
    ds_read_b128 v[124:127], v3 offset:17408
    ds_read_b128 v[128:131], v3 offset:18432
    ds_read_b128 v[132:135], v3 offset:19456
    v_mfma_f32_16x16x32_bf16 v[8:11], v[88:91], v[72:75], v[8:11]
    v_mfma_f32_16x16x32_bf16 v[12:15], v[92:95], v[72:75], v[12:15]
    v_mfma_f32_16x16x32_bf16 v[16:19], v[96:99], v[72:75], v[16:19]
    v_mfma_f32_16x16x32_bf16 v[20:23], v[100:103], v[72:75], v[20:23]
    v_mfma_f32_16x16x32_bf16 v[24:27], v[88:91], v[76:79], v[24:27]
    v_mfma_f32_16x16x32_bf16 v[28:31], v[92:95], v[76:79], v[28:31]
    v_mfma_f32_16x16x32_bf16 v[32:35], v[96:99], v[76:79], v[32:35]
    v_mfma_f32_16x16x32_bf16 v[36:39], v[100:103], v[76:79], v[36:39]
    v_mfma_f32_16x16x32_bf16 v[40:43], v[88:91], v[80:83], v[40:43]
    v_mfma_f32_16x16x32_bf16 v[44:47], v[92:95], v[80:83], v[44:47]
    v_mfma_f32_16x16x32_bf16 v[48:51], v[96:99], v[80:83], v[48:51]
    v_mfma_f32_16x16x32_bf16 v[52:55], v[100:103], v[80:83], v[52:55]
    v_mfma_f32_16x16x32_bf16 v[56:59], v[88:91], v[84:87], v[56:59]
    v_mfma_f32_16x16x32_bf16 v[60:63], v[92:95], v[84:87], v[60:63]
    v_mfma_f32_16x16x32_bf16 v[64:67], v[96:99], v[84:87], v[64:67]
    v_mfma_f32_16x16x32_bf16 v[68:71], v[100:103], v[84:87], v[68:71]
    s_waitcnt vmcnt(4)
    s_barrier
    s_waitcnt lgkmcnt(0)
    ds_read_b64_tr_b16 v[72:73], v142 offset:32768
    ds_read_b64_tr_b16 v[74:75], v142 offset:36864
    ds_read_b64_tr_b16 v[76:77], v143 offset:32768
    ds_read_b64_tr_b16 v[78:79], v143 offset:36864
    ds_read_b64_tr_b16 v[80:81], v144 offset:32768
    ds_read_b64_tr_b16 v[82:83], v144 offset:36864
    ds_read_b64_tr_b16 v[84:85], v145 offset:32768
    ds_read_b64_tr_b16 v[86:87], v145 offset:36864
    ds_read_b128 v[88:91], v3 offset:32768
    ds_read_b128 v[92:95], v3 offset:33792
    ds_read_b128 v[96:99], v3 offset:34816
    ds_read_b128 v[100:103], v3 offset:35840
    v_mfma_f32_16x16x32_bf16 v[8:11], v[120:123], v[104:107], v[8:11]
    v_mfma_f32_16x16x32_bf16 v[12:15], v[124:127], v[104:107], v[12:15]
    v_mfma_f32_16x16x32_bf16 v[16:19], v[128:131], v[104:107], v[16:19]
    v_mfma_f32_16x16x32_bf16 v[20:23], v[132:135], v[104:107], v[20:23]
    v_mfma_f32_16x16x32_bf16 v[24:27], v[120:123], v[108:111], v[24:27]
    v_mfma_f32_16x16x32_bf16 v[28:31], v[124:127], v[108:111], v[28:31]
    v_mfma_f32_16x16x32_bf16 v[32:35], v[128:131], v[108:111], v[32:35]
    v_mfma_f32_16x16x32_bf16 v[36:39], v[132:135], v[108:111], v[36:39]
    v_mfma_f32_16x16x32_bf16 v[40:43], v[120:123], v[112:115], v[40:43]
    v_mfma_f32_16x16x32_bf16 v[44:47], v[124:127], v[112:115], v[44:47]
    v_mfma_f32_16x16x32_bf16 v[48:51], v[128:131], v[112:115], v[48:51]
    v_mfma_f32_16x16x32_bf16 v[52:55], v[132:135], v[112:115], v[52:55]
    v_mfma_f32_16x16x32_bf16 v[56:59], v[120:123], v[116:119], v[56:59]
    v_mfma_f32_16x16x32_bf16 v[60:63], v[124:127], v[116:119], v[60:63]
    v_mfma_f32_16x16x32_bf16 v[64:67], v[128:131], v[116:119], v[64:67]
    v_mfma_f32_16x16x32_bf16 v[68:71], v[132:135], v[116:119], v[68:71]
    s_waitcnt vmcnt(0)
    s_barrier
    s_waitcnt lgkmcnt(0)
    ds_read_b64_tr_b16 v[104:105], v142 offset:49152
    ds_read_b64_tr_b16 v[106:107], v142 offset:53248
    ds_read_b64_tr_b16 v[108:109], v143 offset:49152
    ds_read_b64_tr_b16 v[110:111], v143 offset:53248
    ds_read_b64_tr_b16 v[112:113], v144 offset:49152
    ds_read_b64_tr_b16 v[114:115], v144 offset:53248
    ds_read_b64_tr_b16 v[116:117], v145 offset:49152
    ds_read_b64_tr_b16 v[118:119], v145 offset:53248
    ds_read_b128 v[120:123], v3 offset:49152
    ds_read_b128 v[124:127], v3 offset:50176
    ds_read_b128 v[128:131], v3 offset:51200
    ds_read_b128 v[132:135], v3 offset:52224
    v_mfma_f32_16x16x32_bf16 v[8:11], v[88:91], v[72:75], v[8:11]
    v_mfma_f32_16x16x32_bf16 v[12:15], v[92:95], v[72:75], v[12:15]
    v_mfma_f32_16x16x32_bf16 v[16:19], v[96:99], v[72:75], v[16:19]
    v_mfma_f32_16x16x32_bf16 v[20:23], v[100:103], v[72:75], v[20:23]
    v_mfma_f32_16x16x32_bf16 v[24:27], v[88:91], v[76:79], v[24:27]
    v_mfma_f32_16x16x32_bf16 v[28:31], v[92:95], v[76:79], v[28:31]
    v_mfma_f32_16x16x32_bf16 v[32:35], v[96:99], v[76:79], v[32:35]
    v_mfma_f32_16x16x32_bf16 v[36:39], v[100:103], v[76:79], v[36:39]
    v_mfma_f32_16x16x32_bf16 v[40:43], v[88:91], v[80:83], v[40:43]
    v_mfma_f32_16x16x32_bf16 v[44:47], v[92:95], v[80:83], v[44:47]
    v_mfma_f32_16x16x32_bf16 v[48:51], v[96:99], v[80:83], v[48:51]
    v_mfma_f32_16x16x32_bf16 v[52:55], v[100:103], v[80:83], v[52:55]
    v_mfma_f32_16x16x32_bf16 v[56:59], v[88:91], v[84:87], v[56:59]
    v_mfma_f32_16x16x32_bf16 v[60:63], v[92:95], v[84:87], v[60:63]
    v_mfma_f32_16x16x32_bf16 v[64:67], v[96:99], v[84:87], v[64:67]
    v_mfma_f32_16x16x32_bf16 v[68:71], v[100:103], v[84:87], v[68:71]
    s_waitcnt lgkmcnt(0)
    v_mfma_f32_16x16x32_bf16 v[8:11], v[120:123], v[104:107], v[8:11]
    v_mfma_f32_16x16x32_bf16 v[12:15], v[124:127], v[104:107], v[12:15]
    v_mfma_f32_16x16x32_bf16 v[16:19], v[128:131], v[104:107], v[16:19]
    v_mfma_f32_16x16x32_bf16 v[20:23], v[132:135], v[104:107], v[20:23]
    v_mfma_f32_16x16x32_bf16 v[24:27], v[120:123], v[108:111], v[24:27]
    v_mfma_f32_16x16x32_bf16 v[28:31], v[124:127], v[108:111], v[28:31]
    v_mfma_f32_16x16x32_bf16 v[32:35], v[128:131], v[108:111], v[32:35]
    v_mfma_f32_16x16x32_bf16 v[36:39], v[132:135], v[108:111], v[36:39]
    v_mfma_f32_16x16x32_bf16 v[40:43], v[120:123], v[112:115], v[40:43]
    v_mfma_f32_16x16x32_bf16 v[44:47], v[124:127], v[112:115], v[44:47]
    v_mfma_f32_16x16x32_bf16 v[48:51], v[128:131], v[112:115], v[48:51]
    v_mfma_f32_16x16x32_bf16 v[52:55], v[132:135], v[112:115], v[52:55]
    v_mfma_f32_16x16x32_bf16 v[56:59], v[120:123], v[116:119], v[56:59]
    v_mfma_f32_16x16x32_bf16 v[60:63], v[124:127], v[116:119], v[60:63]
    v_mfma_f32_16x16x32_bf16 v[64:67], v[128:131], v[116:119], v[64:67]
    v_mfma_f32_16x16x32_bf16 v[68:71], v[132:135], v[116:119], v[68:71]
    s_nop 7
    s_lshl_b32 s58, s51, 12
    s_add_u32 s57, s57, s58
    s_add_u32 s57, s57, 63782912
    v_cvt_pk_bf16_f32 v72, v8, v9
    v_cvt_pk_bf16_f32 v73, v10, v11
    v_cvt_pk_bf16_f32 v74, v12, v13
    v_cvt_pk_bf16_f32 v75, v14, v15
    buffer_store_dwordx4 v[72:75], v1, s[4:7], s57 offen offset:0 sc1
    v_cvt_pk_bf16_f32 v76, v24, v25
    v_cvt_pk_bf16_f32 v77, v26, v27
    v_cvt_pk_bf16_f32 v78, v28, v29
    v_cvt_pk_bf16_f32 v79, v30, v31
    buffer_store_dwordx4 v[76:79], v1, s[4:7], s57 offen offset:1024 sc1
    v_cvt_pk_bf16_f32 v80, v40, v41
    v_cvt_pk_bf16_f32 v81, v42, v43
    v_cvt_pk_bf16_f32 v82, v44, v45
    v_cvt_pk_bf16_f32 v83, v46, v47
    buffer_store_dwordx4 v[80:83], v1, s[4:7], s57 offen offset:2048 sc1
    v_cvt_pk_bf16_f32 v84, v56, v57
    v_cvt_pk_bf16_f32 v85, v58, v59
    v_cvt_pk_bf16_f32 v86, v60, v61
    v_cvt_pk_bf16_f32 v87, v62, v63
    buffer_store_dwordx4 v[84:87], v1, s[4:7], s57 offen offset:3072 sc1
    s_add_u32 s57, s57, 262144
    v_cvt_pk_bf16_f32 v88, v16, v17
    v_cvt_pk_bf16_f32 v89, v18, v19
    v_cvt_pk_bf16_f32 v90, v20, v21
    v_cvt_pk_bf16_f32 v91, v22, v23
    buffer_store_dwordx4 v[88:91], v1, s[4:7], s57 offen offset:0 sc1
    v_cvt_pk_bf16_f32 v92, v32, v33
    v_cvt_pk_bf16_f32 v93, v34, v35
    v_cvt_pk_bf16_f32 v94, v36, v37
    v_cvt_pk_bf16_f32 v95, v38, v39
    buffer_store_dwordx4 v[92:95], v1, s[4:7], s57 offen offset:1024 sc1
    v_cvt_pk_bf16_f32 v96, v48, v49
    v_cvt_pk_bf16_f32 v97, v50, v51
    v_cvt_pk_bf16_f32 v98, v52, v53
    v_cvt_pk_bf16_f32 v99, v54, v55
    buffer_store_dwordx4 v[96:99], v1, s[4:7], s57 offen offset:2048 sc1
    v_cvt_pk_bf16_f32 v100, v64, v65
    v_cvt_pk_bf16_f32 v101, v66, v67
    v_cvt_pk_bf16_f32 v102, v68, v69
    v_cvt_pk_bf16_f32 v103, v70, v71
    buffer_store_dwordx4 v[100:103], v1, s[4:7], s57 offen offset:3072 sc1
qkvt_e_4:
    s_waitcnt vmcnt(0)
    s_barrier
    s_cmp_lg_u32 s3, 0
    s_cbranch_scc1 sig_87
    s_mov_b64 exec, 1
    v_mov_b32 v4, 1
    v_mov_b32 v5, 0
    buffer_atomic_add v4, v5, s[4:7], s72 offen sc1
    s_mov_b64 exec, -1
sig_87:
    s_add_u32 s70, s70, 14
    s_cmp_lt_u32 s70, 192
    s_cbranch_scc1 chain_sploop
chain_roles:
    s_sub_u32 s73, s2, 112
    s_cmp_ge_u32 s73, 131
    s_cbranch_scc1 chain_end
    s_cmp_ge_u32 s73, 115
    s_cbranch_scc1 chain_rdp
    s_cmp_ge_u32 s73, 88
    s_cbranch_scc1 chain_rgu
    s_cmp_ge_u32 s73, 80
    s_cbranch_scc1 chain_rln
    s_cmp_ge_u32 s73, 32
    s_cbranch_scc1 chain_rop
    s_mov_b32 s74, 0
chain_xaloop:
    s_lshl_b32 s72, s74, 7
    s_add_u32 s72, s72, 122908672
    v_mov_b32 v9, 0
    s_mov_b32 s66, 0
wt_88:
    s_add_u32 s66, s66, 1
    s_cmp_gt_u32 s66, 0x40000
    s_cbranch_scc1 chain_end
    buffer_load_dword v8, v9, s[4:7], s72 offen sc1
    s_waitcnt vmcnt(0)
    v_cmp_gt_u32 vcc, 64, v8
    s_cbranch_vccz wd_89
    s_sleep 64
    s_branch wt_88
wd_89:
    s_add_u32 s72, s72, 2048
    v_mov_b32 v9, 0
    s_mov_b32 s66, 0
wt_90:
    s_add_u32 s66, s66, 1
    s_cmp_gt_u32 s66, 0x40000
    s_cbranch_scc1 chain_end
    buffer_load_dword v8, v9, s[4:7], s72 offen sc1
    s_waitcnt vmcnt(0)
    v_cmp_gt_u32 vcc, 32, v8
    s_cbranch_vccz wd_91
    s_sleep 64
    s_branch wt_90
wd_91:
    s_lshl_b32 s72, s74, 9
    s_add_u32 s72, s72, 122916864
    v_lshlrev_b32 v10, 3, v0
    s_mov_b32 s66, 0
chain_xaw:
    s_add_u32 s66, s66, 1
    s_cmp_gt_u32 s66, 0x40000
    s_cbranch_scc1 chain_end
    buffer_load_dwordx2 v[8:9], v10, s[4:7], s72 offen sc1
    s_waitcnt vmcnt(0)
    v_and_b32 v8, v8, v9
    v_cmp_ne_u32 vcc, 1, v8
    s_cbranch_vccz chain_xago
    s_sleep 16
    s_branch chain_xaw
chain_xago:
    s_lshl_b32 s44, s74, 5
    s_add_u32 s44, s44, s73
    s_lshl_b32 s44, s44, 2
    s_add_u32 s44, s44, s3
    v_lshlrev_b32 v1, 4, v0
    v_lshrrev_b32 v3, 4, v0
    v_and_b32 v4, 7, v0
    v_lshlrev_b32 v2, 7, v3
    v_lshl_add_u32 v2, v4, 4, v2
    v_and_b32 v5, 31, v0
    v_lshlrev_b32 v5, 3, v5
    v_cmp_gt_u32 s[62:63], 32, v0
    v_and_b32 v4, 15, v0
    v_lshlrev_b32 v6, 2, v3
    v_add_u32 v7, 0, v6
    v_cmp_le_u32 s[80:81], v7, v4
    v_add_u32 v7, 1, v6
    v_cmp_le_u32 s[82:83], v7, v4
    v_add_u32 v7, 2, v6
    v_cmp_le_u32 s[84:85], v7, v4
    v_add_u32 v7, 3, v6
    v_cmp_le_u32 s[86:87], v7, v4
    s_lshl_b32 s45, s44, 13
    s_add_u32 s46, s45, 30228480
    s_add_u32 s47, s46, 4096
    buffer_load_dwordx4 v[8:11], v1, s[4:7], s46 offen offset:0
    buffer_load_dwordx4 v[12:15], v1, s[4:7], s46 offen offset:1024
    buffer_load_dwordx4 v[16:19], v1, s[4:7], s46 offen offset:2048
    buffer_load_dwordx4 v[20:23], v1, s[4:7], s46 offen offset:3072
    buffer_load_dwordx4 v[24:27], v1, s[4:7], s47 offen offset:0
    buffer_load_dwordx4 v[28:31], v1, s[4:7], s47 offen offset:1024
    buffer_load_dwordx4 v[32:35], v1, s[4:7], s47 offen offset:2048
    buffer_load_dwordx4 v[36:39], v1, s[4:7], s47 offen offset:3072
    s_add_u32 s46, s45, 47005696
    s_add_u32 s47, s46, 4096
    buffer_load_dwordx4 v[40:43], v1, s[4:7], s46 offen offset:0
    buffer_load_dwordx4 v[44:47], v1, s[4:7], s46 offen offset:1024
    buffer_load_dwordx4 v[48:51], v1, s[4:7], s46 offen offset:2048
    buffer_load_dwordx4 v[52:55], v1, s[4:7], s46 offen offset:3072
    buffer_load_dwordx4 v[56:59], v1, s[4:7], s47 offen offset:0
    buffer_load_dwordx4 v[60:63], v1, s[4:7], s47 offen offset:1024
    buffer_load_dwordx4 v[64:67], v1, s[4:7], s47 offen offset:2048
    buffer_load_dwordx4 v[68:71], v1, s[4:7], s47 offen offset:3072
    s_lshl_b32 s48, s44, 11
    s_add_u32 s46, s48, 85422080
    buffer_load_dwordx4 v[72:75], v2, s[4:7], s46 offen offset:0
    buffer_load_dwordx4 v[76:79], v2, s[4:7], s46 offen offset:512
    buffer_load_dwordx4 v[80:83], v2, s[4:7], s46 offen offset:1024
    buffer_load_dwordx4 v[84:87], v2, s[4:7], s46 offen offset:1536
    s_add_u32 s46, s45, 63782912
    s_add_u32 s47, s46, 4096
    buffer_load_dwordx4 v[88:91], v1, s[4:7], s46 offen offset:0
    buffer_load_dwordx4 v[92:95], v1, s[4:7], s46 offen offset:1024
    buffer_load_dwordx4 v[96:99], v1, s[4:7], s46 offen offset:2048
    buffer_load_dwordx4 v[100:103], v1, s[4:7], s46 offen offset:3072
    buffer_load_dwordx4 v[104:107], v1, s[4:7], s47 offen offset:0
    buffer_load_dwordx4 v[108:111], v1, s[4:7], s47 offen offset:1024
    buffer_load_dwordx4 v[112:115], v1, s[4:7], s47 offen offset:2048
    buffer_load_dwordx4 v[116:119], v1, s[4:7], s47 offen offset:3072
    s_add_u32 s46, s48, 89616384
    buffer_load_dwordx2 v[120:121], v5, s[4:7], s46 offen offset:0
    buffer_load_dwordx2 v[122:123], v5, s[4:7], s46 offen offset:256
    buffer_load_dwordx2 v[124:125], v5, s[4:7], s46 offen offset:512
    buffer_load_dwordx2 v[126:127], v5, s[4:7], s46 offen offset:768
    buffer_load_dwordx2 v[128:129], v5, s[4:7], s46 offen offset:1024
    buffer_load_dwordx2 v[130:131], v5, s[4:7], s46 offen offset:1280
    buffer_load_dwordx2 v[132:133], v5, s[4:7], s46 offen offset:1536
    buffer_load_dwordx2 v[134:135], v5, s[4:7], s46 offen offset:1792
    s_waitcnt vmcnt(16)
    v_mfma_f32_16x16x32_bf16 v[136:139], v[72:75], v[8:11], 0
    v_mfma_f32_16x16x32_bf16 v[136:139], v[76:79], v[12:15], v[136:139]
    v_mfma_f32_16x16x32_bf16 v[136:139], v[80:83], v[16:19], v[136:139]
    v_mfma_f32_16x16x32_bf16 v[136:139], v[84:87], v[20:23], v[136:139]
    v_mfma_f32_16x16x32_bf16 v[140:143], v[40:43], v[8:11], 0
    v_mfma_f32_16x16x32_bf16 v[140:143], v[44:47], v[12:15], v[140:143]
    v_mfma_f32_16x16x32_bf16 v[140:143], v[48:51], v[16:19], v[140:143]
    v_mfma_f32_16x16x32_bf16 v[140:143], v[52:55], v[20:23], v[140:143]
    v_mfma_f32_16x16x32_bf16 v[148:151], v[72:75], v[24:27], 0
    v_mfma_f32_16x16x32_bf16 v[148:151], v[76:79], v[28:31], v[148:151]
    v_mfma_f32_16x16x32_bf16 v[148:151], v[80:83], v[32:35], v[148:151]
    v_mfma_f32_16x16x32_bf16 v[148:151], v[84:87], v[36:39], v[148:151]
    v_mfma_f32_16x16x32_bf16 v[152:155], v[40:43], v[24:27], 0
    v_mfma_f32_16x16x32_bf16 v[152:155], v[44:47], v[28:31], v[152:155]
    v_mfma_f32_16x16x32_bf16 v[152:155], v[48:51], v[32:35], v[152:155]
    v_mfma_f32_16x16x32_bf16 v[152:155], v[52:55], v[36:39], v[152:155]
    v_mfma_f32_16x16x32_bf16 v[156:159], v[56:59], v[24:27], 0
    v_mfma_f32_16x16x32_bf16 v[156:159], v[60:63], v[28:31], v[156:159]
    v_mfma_f32_16x16x32_bf16 v[156:159], v[64:67], v[32:35], v[156:159]
    v_mfma_f32_16x16x32_bf16 v[156:159], v[68:71], v[36:39], v[156:159]
    s_nop 7
    v_mov_b32 v174, 0xff800000
    v_cvt_pk_bf16_f32 v136, v136, v137
    v_and_b32 v137, 0xffff0000, v136
    v_lshlrev_b32 v136, 16, v136
    v_mul_f32 v136, 0x3db504f3, v136
    v_mul_f32 v137, 0x3db504f3, v137
    v_cvt_pk_bf16_f32 v136, v136, v137
    v_and_b32 v137, 0xffff0000, v136
    v_lshlrev_b32 v136, 16, v136
    v_cvt_pk_bf16_f32 v138, v138, v139
    v_and_b32 v139, 0xffff0000, v138
    v_lshlrev_b32 v138, 16, v138
    v_mul_f32 v138, 0x3db504f3, v138
    v_mul_f32 v139, 0x3db504f3, v139
    v_cvt_pk_bf16_f32 v138, v138, v139
    v_and_b32 v139, 0xffff0000, v138
    v_lshlrev_b32 v138, 16, v138
    v_cvt_pk_bf16_f32 v140, v140, v141
    v_and_b32 v141, 0xffff0000, v140
    v_lshlrev_b32 v140, 16, v140
    v_mul_f32 v140, 0x3db504f3, v140
    v_mul_f32 v141, 0x3db504f3, v141
    v_cvt_pk_bf16_f32 v140, v140, v141
    v_and_b32 v141, 0xffff0000, v140
    v_lshlrev_b32 v140, 16, v140
    v_cvt_pk_bf16_f32 v142, v142, v143
    v_and_b32 v143, 0xffff0000, v142
    v_lshlrev_b32 v142, 16, v142
    v_mul_f32 v142, 0x3db504f3, v142
    v_mul_f32 v143, 0x3db504f3, v143
    v_cvt_pk_bf16_f32 v142, v142, v143
    v_and_b32 v143, 0xffff0000, v142
    v_lshlrev_b32 v142, 16, v142
    v_mov_b32 v144, 0xff800000
    v_mov_b32 v145, 0xff800000
    v_mov_b32 v146, 0xff800000
    v_mov_b32 v147, 0xff800000
    v_cndmask_b32 v136, v174, v136, s[62:63]
    v_cndmask_b32 v137, v174, v137, s[62:63]
    v_cndmask_b32 v138, v174, v138, s[62:63]
    v_cndmask_b32 v139, v174, v139, s[62:63]
    v_cndmask_b32 v140, v174, v140, s[80:81]
    v_cndmask_b32 v141, v174, v141, s[82:83]
    v_cndmask_b32 v142, v174, v142, s[84:85]
    v_cndmask_b32 v143, v174, v143, s[86:87]
    v_max3_f32 v172, v136, v137, v138
    v_max3_f32 v172, v172, v139, v140
    v_max3_f32 v172, v172, v141, v142
    v_max3_f32 v172, v172, v143, v144
    v_max3_f32 v172, v172, v145, v146
    v_max_f32 v172, v172, v147
    v_mov_b32 v173, v172
    s_nop 1
    v_permlane16_swap_b32 v172, v173
    s_nop 0
    v_max_f32 v172, v172, v173
    v_mov_b32 v173, v172
    s_nop 1
    v_permlane32_swap_b32 v172, v173
    s_nop 0
    v_max_f32 v172, v172, v173
    v_sub_f32 v136, v136, v172
    v_sub_f32 v137, v137, v172
    v_sub_f32 v138, v138, v172
    v_sub_f32 v139, v139, v172
    v_sub_f32 v140, v140, v172
    v_sub_f32 v141, v141, v172
    v_sub_f32 v142, v142, v172
    v_sub_f32 v143, v143, v172
    v_sub_f32 v144, v144, v172
    v_sub_f32 v145, v145, v172
    v_sub_f32 v146, v146, v172
    v_sub_f32 v147, v147, v172
    v_mul_f32 v136, 0x3fb8aa3b, v136
    v_mul_f32 v137, 0x3fb8aa3b, v137
    v_mul_f32 v138, 0x3fb8aa3b, v138
    v_mul_f32 v139, 0x3fb8aa3b, v139
    v_mul_f32 v140, 0x3fb8aa3b, v140
    v_mul_f32 v141, 0x3fb8aa3b, v141
    v_mul_f32 v142, 0x3fb8aa3b, v142
    v_mul_f32 v143, 0x3fb8aa3b, v143
    v_mul_f32 v144, 0x3fb8aa3b, v144
    v_mul_f32 v145, 0x3fb8aa3b, v145
    v_mul_f32 v146, 0x3fb8aa3b, v146
    v_mul_f32 v147, 0x3fb8aa3b, v147
    v_exp_f32 v136, v136
    v_exp_f32 v137, v137
    v_exp_f32 v138, v138
    v_exp_f32 v139, v139
    v_exp_f32 v140, v140
    v_exp_f32 v141, v141
    v_exp_f32 v142, v142
    v_exp_f32 v143, v143
    v_exp_f32 v144, v144
    v_exp_f32 v145, v145
    v_exp_f32 v146, v146
    v_exp_f32 v147, v147
    s_nop 0
    v_add_f32 v172, v136, v137
    v_add_f32 v172, v172, v138
    v_add_f32 v172, v172, v139
    v_add_f32 v172, v172, v140
    v_add_f32 v172, v172, v141
    v_add_f32 v172, v172, v142
    v_add_f32 v172, v172, v143
    v_add_f32 v172, v172, v144
    v_add_f32 v172, v172, v145
    v_add_f32 v172, v172, v146
    v_add_f32 v172, v172, v147
    v_mov_b32 v173, v172
    s_nop 1
    v_permlane16_swap_b32 v172, v173
    s_nop 0
    v_add_f32 v172, v172, v173
    v_mov_b32 v173, v172
    s_nop 1
    v_permlane32_swap_b32 v172, v173
    s_nop 0
    v_add_f32 v172, v172, v173
    v_rcp_f32 v172, v172
    s_nop 0
    v_mul_f32 v136, v136, v172
    v_mul_f32 v137, v137, v172
    v_mul_f32 v138, v138, v172
    v_mul_f32 v139, v139, v172
    v_mul_f32 v140, v140, v172
    v_mul_f32 v141, v141, v172
    v_mul_f32 v142, v142, v172
    v_mul_f32 v143, v143, v172
    v_mul_f32 v144, v144, v172
    v_mul_f32 v145, v145, v172
    v_mul_f32 v146, v146, v172
    v_mul_f32 v147, v147, v172
    v_cvt_pk_bf16_f32 v160, v136, v137
    v_cvt_pk_bf16_f32 v161, v138, v139
    v_cvt_pk_bf16_f32 v164, v140, v141
    v_cvt_pk_bf16_f32 v165, v142, v143
    v_cvt_pk_bf16_f32 v166, v144, v145
    v_cvt_pk_bf16_f32 v167, v146, v147
    v_cvt_pk_bf16_f32 v148, v148, v149
    v_and_b32 v149, 0xffff0000, v148
    v_lshlrev_b32 v148, 16, v148
    v_mul_f32 v148, 0x3db504f3, v148
    v_mul_f32 v149, 0x3db504f3, v149
    v_cvt_pk_bf16_f32 v148, v148, v149
    v_and_b32 v149, 0xffff0000, v148
    v_lshlrev_b32 v148, 16, v148
    v_cvt_pk_bf16_f32 v150, v150, v151
    v_and_b32 v151, 0xffff0000, v150
    v_lshlrev_b32 v150, 16, v150
    v_mul_f32 v150, 0x3db504f3, v150
    v_mul_f32 v151, 0x3db504f3, v151
    v_cvt_pk_bf16_f32 v150, v150, v151
    v_and_b32 v151, 0xffff0000, v150
    v_lshlrev_b32 v150, 16, v150
    v_cvt_pk_bf16_f32 v152, v152, v153
    v_and_b32 v153, 0xffff0000, v152
    v_lshlrev_b32 v152, 16, v152
    v_mul_f32 v152, 0x3db504f3, v152
    v_mul_f32 v153, 0x3db504f3, v153
    v_cvt_pk_bf16_f32 v152, v152, v153
    v_and_b32 v153, 0xffff0000, v152
    v_lshlrev_b32 v152, 16, v152
    v_cvt_pk_bf16_f32 v154, v154, v155
    v_and_b32 v155, 0xffff0000, v154
    v_lshlrev_b32 v154, 16, v154
    v_mul_f32 v154, 0x3db504f3, v154
    v_mul_f32 v155, 0x3db504f3, v155
    v_cvt_pk_bf16_f32 v154, v154, v155
    v_and_b32 v155, 0xffff0000, v154
    v_lshlrev_b32 v154, 16, v154
    v_cvt_pk_bf16_f32 v156, v156, v157
    v_and_b32 v157, 0xffff0000, v156
    v_lshlrev_b32 v156, 16, v156
    v_mul_f32 v156, 0x3db504f3, v156
    v_mul_f32 v157, 0x3db504f3, v157
    v_cvt_pk_bf16_f32 v156, v156, v157
    v_and_b32 v157, 0xffff0000, v156
    v_lshlrev_b32 v156, 16, v156
    v_cvt_pk_bf16_f32 v158, v158, v159
    v_and_b32 v159, 0xffff0000, v158
    v_lshlrev_b32 v158, 16, v158
    v_mul_f32 v158, 0x3db504f3, v158
    v_mul_f32 v159, 0x3db504f3, v159
    v_cvt_pk_bf16_f32 v158, v158, v159
    v_and_b32 v159, 0xffff0000, v158
    v_lshlrev_b32 v158, 16, v158
    v_cndmask_b32 v148, v174, v148, s[62:63]
    v_cndmask_b32 v149, v174, v149, s[62:63]
    v_cndmask_b32 v150, v174, v150, s[62:63]
    v_cndmask_b32 v151, v174, v151, s[62:63]
    v_cndmask_b32 v156, v174, v156, s[80:81]
    v_cndmask_b32 v157, v174, v157, s[82:83]
    v_cndmask_b32 v158, v174, v158, s[84:85]
    v_cndmask_b32 v159, v174, v159, s[86:87]
    v_max3_f32 v172, v148, v149, v150
    v_max3_f32 v172, v172, v151, v152
    v_max3_f32 v172, v172, v153, v154
    v_max3_f32 v172, v172, v155, v156
    v_max3_f32 v172, v172, v157, v158
    v_max_f32 v172, v172, v159
    v_mov_b32 v173, v172
    s_nop 1
    v_permlane16_swap_b32 v172, v173
    s_nop 0
    v_max_f32 v172, v172, v173
    v_mov_b32 v173, v172
    s_nop 1
    v_permlane32_swap_b32 v172, v173
    s_nop 0
    v_max_f32 v172, v172, v173
    v_sub_f32 v148, v148, v172
    v_sub_f32 v149, v149, v172
    v_sub_f32 v150, v150, v172
    v_sub_f32 v151, v151, v172
    v_sub_f32 v152, v152, v172
    v_sub_f32 v153, v153, v172
    v_sub_f32 v154, v154, v172
    v_sub_f32 v155, v155, v172
    v_sub_f32 v156, v156, v172
    v_sub_f32 v157, v157, v172
    v_sub_f32 v158, v158, v172
    v_sub_f32 v159, v159, v172
    v_mul_f32 v148, 0x3fb8aa3b, v148
    v_mul_f32 v149, 0x3fb8aa3b, v149
    v_mul_f32 v150, 0x3fb8aa3b, v150
    v_mul_f32 v151, 0x3fb8aa3b, v151
    v_mul_f32 v152, 0x3fb8aa3b, v152
    v_mul_f32 v153, 0x3fb8aa3b, v153
    v_mul_f32 v154, 0x3fb8aa3b, v154
    v_mul_f32 v155, 0x3fb8aa3b, v155
    v_mul_f32 v156, 0x3fb8aa3b, v156
    v_mul_f32 v157, 0x3fb8aa3b, v157
    v_mul_f32 v158, 0x3fb8aa3b, v158
    v_mul_f32 v159, 0x3fb8aa3b, v159
    v_exp_f32 v148, v148
    v_exp_f32 v149, v149
    v_exp_f32 v150, v150
    v_exp_f32 v151, v151
    v_exp_f32 v152, v152
    v_exp_f32 v153, v153
    v_exp_f32 v154, v154
    v_exp_f32 v155, v155
    v_exp_f32 v156, v156
    v_exp_f32 v157, v157
    v_exp_f32 v158, v158
    v_exp_f32 v159, v159
    s_nop 0
    v_add_f32 v172, v148, v149
    v_add_f32 v172, v172, v150
    v_add_f32 v172, v172, v151
    v_add_f32 v172, v172, v152
    v_add_f32 v172, v172, v153
    v_add_f32 v172, v172, v154
    v_add_f32 v172, v172, v155
    v_add_f32 v172, v172, v156
    v_add_f32 v172, v172, v157
    v_add_f32 v172, v172, v158
    v_add_f32 v172, v172, v159
    v_mov_b32 v173, v172
    s_nop 1
    v_permlane16_swap_b32 v172, v173
    s_nop 0
    v_add_f32 v172, v172, v173
    v_mov_b32 v173, v172
    s_nop 1
    v_permlane32_swap_b32 v172, v173
    s_nop 0
    v_add_f32 v172, v172, v173
    v_rcp_f32 v172, v172
    s_nop 0
    v_mul_f32 v148, v148, v172
    v_mul_f32 v149, v149, v172
    v_mul_f32 v150, v150, v172
    v_mul_f32 v151, v151, v172
    v_mul_f32 v152, v152, v172
    v_mul_f32 v153, v153, v172
    v_mul_f32 v154, v154, v172
    v_mul_f32 v155, v155, v172
    v_mul_f32 v156, v156, v172
    v_mul_f32 v157, v157, v172
    v_mul_f32 v158, v158, v172
    v_mul_f32 v159, v159, v172
    v_cvt_pk_bf16_f32 v162, v148, v149
    v_cvt_pk_bf16_f32 v163, v150, v151
    v_cvt_pk_bf16_f32 v168, v152, v153
    v_cvt_pk_bf16_f32 v169, v154, v155
    v_cvt_pk_bf16_f32 v170, v156, v157
    v_cvt_pk_bf16_f32 v171, v158, v159
    s_waitcnt vmcnt(0)
    s_nop 1
    v_mfma_f32_16x16x32_bf16 v[176:179], v[88:91], v[164:167], 0
    v_mfma_f32_16x16x32_bf16 v[180:183], v[92:95], v[164:167], 0
    v_mfma_f32_16x16x32_bf16 v[184:187], v[96:99], v[164:167], 0
    v_mfma_f32_16x16x32_bf16 v[188:191], v[100:103], v[164:167], 0
    v_mfma_f32_16x16x32_bf16 v[192:195], v[104:107], v[164:167], 0
    v_mfma_f32_16x16x32_bf16 v[196:199], v[108:111], v[164:167], 0
    v_mfma_f32_16x16x32_bf16 v[200:203], v[112:115], v[164:167], 0
    v_mfma_f32_16x16x32_bf16 v[204:207], v[116:119], v[164:167], 0
    v_mfma_f32_16x16x16_bf16 v[176:179], v[120:121], v[160:161], v[176:179]
    v_mfma_f32_16x16x16_bf16 v[180:183], v[122:123], v[160:161], v[180:183]
    v_mfma_f32_16x16x16_bf16 v[184:187], v[124:125], v[160:161], v[184:187]
    v_mfma_f32_16x16x16_bf16 v[188:191], v[126:127], v[160:161], v[188:191]
    v_mfma_f32_16x16x16_bf16 v[192:195], v[128:129], v[160:161], v[192:195]
    v_mfma_f32_16x16x16_bf16 v[196:199], v[130:131], v[160:161], v[196:199]
    v_mfma_f32_16x16x16_bf16 v[200:203], v[132:133], v[160:161], v[200:203]
    v_mfma_f32_16x16x16_bf16 v[204:207], v[134:135], v[160:161], v[204:207]
    v_mfma_f32_16x16x32_bf16 v[208:211], v[88:91], v[168:171], 0
    v_mfma_f32_16x16x32_bf16 v[212:215], v[92:95], v[168:171], 0
    v_mfma_f32_16x16x32_bf16 v[216:219], v[96:99], v[168:171], 0
    v_mfma_f32_16x16x32_bf16 v[220:223], v[100:103], v[168:171], 0
    v_mfma_f32_16x16x32_bf16 v[224:227], v[104:107], v[168:171], 0
    v_mfma_f32_16x16x32_bf16 v[228:231], v[108:111], v[168:171], 0
    v_mfma_f32_16x16x32_bf16 v[232:235], v[112:115], v[168:171], 0
    v_mfma_f32_16x16x32_bf16 v[236:239], v[116:119], v[168:171], 0
    v_mfma_f32_16x16x16_bf16 v[208:211], v[120:121], v[162:163], v[208:211]
    v_mfma_f32_16x16x16_bf16 v[212:215], v[122:123], v[162:163], v[212:215]
    v_mfma_f32_16x16x16_bf16 v[216:219], v[124:125], v[162:163], v[216:219]
    v_mfma_f32_16x16x16_bf16 v[220:223], v[126:127], v[162:163], v[220:223]
    v_mfma_f32_16x16x16_bf16 v[224:227], v[128:129], v[162:163], v[224:227]
    v_mfma_f32_16x16x16_bf16 v[228:231], v[130:131], v[162:163], v[228:231]
    v_mfma_f32_16x16x16_bf16 v[232:235], v[132:133], v[162:163], v[232:235]
    v_mfma_f32_16x16x16_bf16 v[236:239], v[134:135], v[162:163], v[236:239]
    s_nop 7
    s_lshr_b32 s45, s44, 6
    s_lshl_b32 s45, s45, 7
    s_and_b32 s46, s44, 31
    s_lshl_b32 s46, s46, 2
    s_add_u32 s45, s45, s46
    s_lshl_b32 s45, s45, 12
    s_bfe_u32 s46, s44, 0x10005
    s_lshl_b32 s46, s46, 11
    s_add_u32 s45, s45, s46
    s_add_u32 s45, s45, 93810688
    v_cvt_pk_bf16_f32 v8, v176, v177
    v_cvt_pk_bf16_f32 v9, v178, v179
    v_cvt_pk_bf16_f32 v10, v180, v181
    v_cvt_pk_bf16_f32 v11, v182, v183
    buffer_store_dwordx4 v[8:11], v1, s[4:7], s45 offen offset:0 sc1
    v_cvt_pk_bf16_f32 v12, v208, v209
    v_cvt_pk_bf16_f32 v13, v210, v211
    v_cvt_pk_bf16_f32 v14, v212, v213
    v_cvt_pk_bf16_f32 v15, v214, v215
    buffer_store_dwordx4 v[12:15], v1, s[4:7], s45 offen offset:1024 sc1
    s_add_u32 s45, s45, 4096
    v_cvt_pk_bf16_f32 v16, v184, v185
    v_cvt_pk_bf16_f32 v17, v186, v187
    v_cvt_pk_bf16_f32 v18, v188, v189
    v_cvt_pk_bf16_f32 v19, v190, v191
    buffer_store_dwordx4 v[16:19], v1, s[4:7], s45 offen offset:0 sc1
    v_cvt_pk_bf16_f32 v20, v216, v217
    v_cvt_pk_bf16_f32 v21, v218, v219
    v_cvt_pk_bf16_f32 v22, v220, v221
    v_cvt_pk_bf16_f32 v23, v222, v223
    buffer_store_dwordx4 v[20:23], v1, s[4:7], s45 offen offset:1024 sc1
    s_add_u32 s45, s45, 4096
    v_cvt_pk_bf16_f32 v24, v192, v193
    v_cvt_pk_bf16_f32 v25, v194, v195
    v_cvt_pk_bf16_f32 v26, v196, v197
    v_cvt_pk_bf16_f32 v27, v198, v199
    buffer_store_dwordx4 v[24:27], v1, s[4:7], s45 offen offset:0 sc1
    v_cvt_pk_bf16_f32 v28, v224, v225
    v_cvt_pk_bf16_f32 v29, v226, v227
    v_cvt_pk_bf16_f32 v30, v228, v229
    v_cvt_pk_bf16_f32 v31, v230, v231
    buffer_store_dwordx4 v[28:31], v1, s[4:7], s45 offen offset:1024 sc1
    s_add_u32 s45, s45, 4096
    v_cvt_pk_bf16_f32 v32, v200, v201
    v_cvt_pk_bf16_f32 v33, v202, v203
    v_cvt_pk_bf16_f32 v34, v204, v205
    v_cvt_pk_bf16_f32 v35, v206, v207
    buffer_store_dwordx4 v[32:35], v1, s[4:7], s45 offen offset:0 sc1
    v_cvt_pk_bf16_f32 v36, v232, v233
    v_cvt_pk_bf16_f32 v37, v234, v235
    v_cvt_pk_bf16_f32 v38, v236, v237
    v_cvt_pk_bf16_f32 v39, v238, v239
    buffer_store_dwordx4 v[36:39], v1, s[4:7], s45 offen offset:1024 sc1
    s_add_u32 s45, s45, 4096
    s_lshl_b32 s72, s74, 7
    s_add_u32 s72, s72, 122925056
    s_waitcnt vmcnt(0)
    s_barrier
    s_cmp_lg_u32 s3, 0
    s_cbranch_scc1 sig_92
    s_mov_b64 exec, 1
    v_mov_b32 v4, 1
    v_mov_b32 v5, 0
    buffer_atomic_add v4, v5, s[4:7], s72 offen sc1
    s_mov_b64 exec, -1
sig_92:
    s_add_u32 s74, s74, 1
    s_cmp_lt_u32 s74, 16
    s_cbranch_scc1 chain_xaloop
    s_branch chain_end
chain_rop:
    s_mov_b32 s72, 122912768
    v_mov_b32 v9, 0
    s_mov_b32 s66, 0
wt_93:
    s_add_u32 s66, s66, 1
    s_cmp_gt_u32 s66, 0x40000
    s_cbranch_scc1 chain_end
    buffer_load_dword v8, v9, s[4:7], s72 offen sc1
    s_waitcnt vmcnt(0)
    v_cmp_gt_u32 vcc, 32, v8
    s_cbranch_vccz wd_94
    s_sleep 64
    s_branch wt_93
wd_94:
    s_sub_u32 s73, s73, 32
    s_lshr_b32 s74, s73, 4
    s_and_b32 s73, s73, 15
chain_oploop:
    s_lshl_b32 s72, s74, 7
    s_add_u32 s72, s72, 122925056
    v_mov_b32 v9, 0
    s_mov_b32 s66, 0
wt_95:
    s_add_u32 s66, s66, 1
    s_cmp_gt_u32 s66, 0x40000
    s_cbranch_scc1 chain_end
    buffer_load_dword v8, v9, s[4:7], s72 offen sc1
    s_waitcnt vmcnt(0)
    v_cmp_gt_u32 vcc, 32, v8
    s_cbranch_vccz wd_96
    s_sleep 64
    s_branch wt_95
wd_96:
    s_and_b32 s66, s73, 7
    s_lshr_b32 s67, s73, 3
    s_lshl_b32 s46, s74, 1
    s_add_u32 s67, s67, s46
    s_mul_i32 s44, s66, 5
    s_lshl_b32 s45, s67, 2
    s_mov_b32 s51, 0
    s_mov_b32 s52, s3
    s_add_u32 s46, s3, 0
    s_min_u32 s46, s46, 8
    s_lshl_b32 s59, s46, 10
    s_add_u32 s47, s44, s46
    s_add_u32 s48, s45, s46
    s_sub_u32 s48, s48, 5
    s_cmp_lt_u32 s46, 5
    s_cselect_b32 s47, s47, s48
    s_mov_b32 s48, 18350080
    s_cselect_b32 s48, s48, 93810688
    s_lshr_b32 s49, s47, 2
    s_mul_i32 s49, s49, 524288
    s_and_b32 s47, s47, 3
    s_lshl_b32 s47, s47, 10
    s_add_u32 s48, s48, s49
    s_add_u32 s53, s48, s47
    s_add_u32 s46, s3, 4
    s_min_u32 s46, s46, 8
    s_lshl_b32 s60, s46, 10
    s_add_u32 s47, s44, s46
    s_add_u32 s48, s45, s46
    s_sub_u32 s48, s48, 5
    s_cmp_lt_u32 s46, 5
    s_cselect_b32 s47, s47, s48
    s_mov_b32 s48, 18350080
    s_cselect_b32 s48, s48, 93810688
    s_lshr_b32 s49, s47, 2
    s_mul_i32 s49, s49, 524288
    s_and_b32 s47, s47, 3
    s_lshl_b32 s47, s47, 10
    s_add_u32 s48, s48, s49
    s_add_u32 s54, s48, s47
    s_add_u32 s46, s3, 8
    s_min_u32 s46, s46, 8
    s_lshl_b32 s61, s46, 10
    s_add_u32 s47, s44, s46
    s_add_u32 s48, s45, s46
    s_sub_u32 s48, s48, 5
    s_cmp_lt_u32 s46, 5
    s_cselect_b32 s47, s47, s48
    s_mov_b32 s48, 18350080
    s_cselect_b32 s48, s48, 93810688
    s_lshr_b32 s49, s47, 2
    s_mul_i32 s49, s49, 524288
    s_and_b32 s47, s47, 3
    s_lshl_b32 s47, s47, 10
    s_add_u32 s48, s48, s49
    s_add_u32 s55, s48, s47
    v_lshlrev_b32 v1, 4, v0
    s_lshl_b32 s46, s51, 10
    v_add_u32 v2, s46, v1
    s_lshl_b32 s46, s52, 10
    s_add_u32 s46, s46, 5120
    v_add_u32 v3, s46, v1
    v_add_u32 v6, 0x10000, v2
    v_add_u32 v7, 0x10000, v3
    v_mov_b32 v8, 0
    v_mov_b32 v9, 0
    v_mov_b32 v10, 0
    v_mov_b32 v11, 0
    v_mov_b32 v12, 0
    v_mov_b32 v13, 0
    v_mov_b32 v14, 0
    v_mov_b32 v15, 0
    v_mov_b32 v16, 0
    v_mov_b32 v17, 0
    v_mov_b32 v18, 0
    v_mov_b32 v19, 0
    v_mov_b32 v20, 0
    v_mov_b32 v21, 0
    v_mov_b32 v22, 0
    v_mov_b32 v23, 0
    v_mov_b32 v24, 0
    v_mov_b32 v25, 0
    v_mov_b32 v26, 0
    v_mov_b32 v27, 0
    s_cmp_ge_u32 s3, 1
    s_cbranch_scc1 gb2_97
    s_add_u32 m0, s59, 0
    s_nop 0
    buffer_load_dwordx4 v1, s[4:7], s53 offen lds
    s_add_u32 s53, s53, 4096
    s_add_u32 m0, s60, 0
    s_nop 0
    buffer_load_dwordx4 v1, s[4:7], s54 offen lds
    s_add_u32 s54, s54, 4096
    s_add_u32 m0, s61, 0
    s_nop 0
    buffer_load_dwordx4 v1, s[4:7], s55 offen lds
    s_add_u32 s55, s55, 4096
    s_add_u32 m0, s59, 9216
    s_nop 0
    buffer_load_dwordx4 v1, s[4:7], s53 offen lds
    s_add_u32 s53, s53, 4096
    s_add_u32 m0, s60, 9216
    s_nop 0
    buffer_load_dwordx4 v1, s[4:7], s54 offen lds
    s_add_u32 s54, s54, 4096
    s_add_u32 m0, s61, 9216
    s_nop 0
    buffer_load_dwordx4 v1, s[4:7], s55 offen lds
    s_add_u32 s55, s55, 4096
    s_add_u32 m0, s59, 18432
    s_nop 0
    buffer_load_dwordx4 v1, s[4:7], s53 offen lds
    s_add_u32 s53, s53, 4096
    s_add_u32 m0, s60, 18432
    s_nop 0
    buffer_load_dwordx4 v1, s[4:7], s54 offen lds
    s_add_u32 s54, s54, 4096
    s_add_u32 m0, s61, 18432
    s_nop 0
    buffer_load_dwordx4 v1, s[4:7], s55 offen lds
    s_add_u32 s55, s55, 4096
    s_add_u32 m0, s59, 27648
    s_nop 0
    buffer_load_dwordx4 v1, s[4:7], s53 offen lds
    s_add_u32 s53, s53, 4096
    s_add_u32 m0, s60, 27648
    s_nop 0
    buffer_load_dwordx4 v1, s[4:7], s54 offen lds
    s_add_u32 s54, s54, 4096
    s_add_u32 m0, s61, 27648
    s_nop 0
    buffer_load_dwordx4 v1, s[4:7], s55 offen lds
    s_add_u32 s55, s55, 4096
    s_add_u32 m0, s59, 36864
    s_nop 0
    buffer_load_dwordx4 v1, s[4:7], s53 offen lds
    s_add_u32 s53, s53, 4096
    s_add_u32 m0, s60, 36864
    s_nop 0
    buffer_load_dwordx4 v1, s[4:7], s54 offen lds
    s_add_u32 s54, s54, 4096
    s_add_u32 m0, s61, 36864
    s_nop 0
    buffer_load_dwordx4 v1, s[4:7], s55 offen lds
    s_add_u32 s55, s55, 4096
    s_add_u32 m0, s59, 46080
    s_nop 0
    buffer_load_dwordx4 v1, s[4:7], s53 offen lds
    s_add_u32 s53, s53, 4096
    s_add_u32 m0, s60, 46080
    s_nop 0
    buffer_load_dwordx4 v1, s[4:7], s54 offen lds
    s_add_u32 s54, s54, 4096
    s_add_u32 m0, s61, 46080
    s_nop 0
    buffer_load_dwordx4 v1, s[4:7], s55 offen lds
    s_add_u32 s55, s55, 4096
    s_add_u32 m0, s59, 55296
    s_nop 0
    buffer_load_dwordx4 v1, s[4:7], s53 offen lds
    s_add_u32 s53, s53, 4096
    s_add_u32 m0, s60, 55296
    s_nop 0
    buffer_load_dwordx4 v1, s[4:7], s54 offen lds
    s_add_u32 s54, s54, 4096
    s_add_u32 m0, s61, 55296
    s_nop 0
    buffer_load_dwordx4 v1, s[4:7], s55 offen lds
    s_add_u32 s55, s55, 4096
    s_add_u32 m0, s59, 64512
    s_nop 0
    buffer_load_dwordx4 v1, s[4:7], s53 offen lds
    s_add_u32 s53, s53, 4096
    s_add_u32 m0, s60, 64512
    s_nop 0
    buffer_load_dwordx4 v1, s[4:7], s54 offen lds
    s_add_u32 s54, s54, 4096
    s_add_u32 m0, s61, 64512
    s_nop 0
    buffer_load_dwordx4 v1, s[4:7], s55 offen lds
    s_add_u32 s55, s55, 4096
    s_add_u32 m0, s59, 73728
    s_nop 0
    buffer_load_dwordx4 v1, s[4:7], s53 offen lds
    s_add_u32 s53, s53, 4096
    s_add_u32 m0, s60, 73728
    s_nop 0
    buffer_load_dwordx4 v1, s[4:7], s54 offen lds
    s_add_u32 s54, s54, 4096
    s_add_u32 m0, s61, 73728
    s_nop 0
    buffer_load_dwordx4 v1, s[4:7], s55 offen lds
    s_add_u32 s55, s55, 4096
    s_add_u32 m0, s59, 82944
    s_nop 0
    buffer_load_dwordx4 v1, s[4:7], s53 offen lds
    s_add_u32 s53, s53, 4096
    s_add_u32 m0, s60, 82944
    s_nop 0
    buffer_load_dwordx4 v1, s[4:7], s54 offen lds
    s_add_u32 s54, s54, 4096
    s_add_u32 m0, s61, 82944
    s_nop 0
    buffer_load_dwordx4 v1, s[4:7], s55 offen lds
    s_add_u32 s55, s55, 4096
    s_add_u32 m0, s59, 92160
    s_nop 0
    buffer_load_dwordx4 v1, s[4:7], s53 offen lds
    s_add_u32 s53, s53, 4096
    s_add_u32 m0, s60, 92160
    s_nop 0
    buffer_load_dwordx4 v1, s[4:7], s54 offen lds
    s_add_u32 s54, s54, 4096
    s_add_u32 m0, s61, 92160
    s_nop 0
    buffer_load_dwordx4 v1, s[4:7], s55 offen lds
    s_add_u32 s55, s55, 4096
    s_waitcnt vmcnt(30)
    s_barrier
    ds_read_b128 v[28:31], v2 offset:0
    ds_read_b128 v[32:35], v2 offset:1024
    ds_read_b128 v[36:39], v2 offset:2048
    ds_read_b128 v[40:43], v2 offset:3072
    ds_read_b128 v[44:47], v2 offset:4096
    ds_read_b128 v[48:51], v3 offset:0
    s_mov_b32 s50, 9
gloop_99:
    s_waitcnt vmcnt(27)
    s_barrier
    s_add_u32 m0, s59, 101376
    s_nop 0
    buffer_load_dwordx4 v1, s[4:7], s53 offen lds
    s_add_u32 s53, s53, 4096
    s_add_u32 m0, s60, 101376
    s_nop 0
    buffer_load_dwordx4 v1, s[4:7], s54 offen lds
    s_add_u32 s54, s54, 4096
    s_add_u32 m0, s61, 101376
    s_nop 0
    buffer_load_dwordx4 v1, s[4:7], s55 offen lds
    s_add_u32 s55, s55, 4096
    s_waitcnt lgkmcnt(0)
    ds_read_b128 v[52:55], v2 offset:9216
    ds_read_b128 v[56:59], v2 offset:10240
    ds_read_b128 v[60:63], v2 offset:11264
    ds_read_b128 v[64:67], v2 offset:12288
    ds_read_b128 v[68:71], v2 offset:13312
    ds_read_b128 v[72:75], v3 offset:9216
    v_mfma_f32_16x16x32_bf16 v[8:11], v[28:31], v[48:51], v[8:11]
    v_mfma_f32_16x16x32_bf16 v[12:15], v[32:35], v[48:51], v[12:15]
    v_mfma_f32_16x16x32_bf16 v[16:19], v[36:39], v[48:51], v[16:19]
    v_mfma_f32_16x16x32_bf16 v[20:23], v[40:43], v[48:51], v[20:23]
    v_mfma_f32_16x16x32_bf16 v[24:27], v[44:47], v[48:51], v[24:27]
    s_waitcnt vmcnt(27)
    s_barrier
    s_add_u32 m0, s59, 0
    s_nop 0
    buffer_load_dwordx4 v1, s[4:7], s53 offen lds
    s_add_u32 s53, s53, 4096
    s_add_u32 m0, s60, 0
    s_nop 0
    buffer_load_dwordx4 v1, s[4:7], s54 offen lds
    s_add_u32 s54, s54, 4096
    s_add_u32 m0, s61, 0
    s_nop 0
    buffer_load_dwordx4 v1, s[4:7], s55 offen lds
    s_add_u32 s55, s55, 4096
    s_waitcnt lgkmcnt(0)
    ds_read_b128 v[28:31], v2 offset:18432
    ds_read_b128 v[32:35], v2 offset:19456
    ds_read_b128 v[36:39], v2 offset:20480
    ds_read_b128 v[40:43], v2 offset:21504
    ds_read_b128 v[44:47], v2 offset:22528
    ds_read_b128 v[48:51], v3 offset:18432
    v_mfma_f32_16x16x32_bf16 v[8:11], v[52:55], v[72:75], v[8:11]
    v_mfma_f32_16x16x32_bf16 v[12:15], v[56:59], v[72:75], v[12:15]
    v_mfma_f32_16x16x32_bf16 v[16:19], v[60:63], v[72:75], v[16:19]
    v_mfma_f32_16x16x32_bf16 v[20:23], v[64:67], v[72:75], v[20:23]
    v_mfma_f32_16x16x32_bf16 v[24:27], v[68:71], v[72:75], v[24:27]
    s_waitcnt vmcnt(27)
    s_barrier
    s_add_u32 m0, s59, 9216
    s_nop 0
    buffer_load_dwordx4 v1, s[4:7], s53 offen lds
    s_add_u32 s53, s53, 4096
    s_add_u32 m0, s60, 9216
    s_nop 0
    buffer_load_dwordx4 v1, s[4:7], s54 offen lds
    s_add_u32 s54, s54, 4096
    s_add_u32 m0, s61, 9216
    s_nop 0
    buffer_load_dwordx4 v1, s[4:7], s55 offen lds
    s_add_u32 s55, s55, 4096
    s_waitcnt lgkmcnt(0)
    ds_read_b128 v[52:55], v2 offset:27648
    ds_read_b128 v[56:59], v2 offset:28672
    ds_read_b128 v[60:63], v2 offset:29696
    ds_read_b128 v[64:67], v2 offset:30720
    ds_read_b128 v[68:71], v2 offset:31744
    ds_read_b128 v[72:75], v3 offset:27648
    v_mfma_f32_16x16x32_bf16 v[8:11], v[28:31], v[48:51], v[8:11]
    v_mfma_f32_16x16x32_bf16 v[12:15], v[32:35], v[48:51], v[12:15]
    v_mfma_f32_16x16x32_bf16 v[16:19], v[36:39], v[48:51], v[16:19]
    v_mfma_f32_16x16x32_bf16 v[20:23], v[40:43], v[48:51], v[20:23]
    v_mfma_f32_16x16x32_bf16 v[24:27], v[44:47], v[48:51], v[24:27]
    s_waitcnt vmcnt(27)
    s_barrier
    s_add_u32 m0, s59, 18432
    s_nop 0
    buffer_load_dwordx4 v1, s[4:7], s53 offen lds
    s_add_u32 s53, s53, 4096
    s_add_u32 m0, s60, 18432
    s_nop 0
    buffer_load_dwordx4 v1, s[4:7], s54 offen lds
    s_add_u32 s54, s54, 4096
    s_add_u32 m0, s61, 18432
    s_nop 0
    buffer_load_dwordx4 v1, s[4:7], s55 offen lds
    s_add_u32 s55, s55, 4096
    s_waitcnt lgkmcnt(0)
    ds_read_b128 v[28:31], v2 offset:36864
    ds_read_b128 v[32:35], v2 offset:37888
    ds_read_b128 v[36:39], v2 offset:38912
    ds_read_b128 v[40:43], v2 offset:39936
    ds_read_b128 v[44:47], v2 offset:40960
    ds_read_b128 v[48:51], v3 offset:36864
    v_mfma_f32_16x16x32_bf16 v[8:11], v[52:55], v[72:75], v[8:11]
    v_mfma_f32_16x16x32_bf16 v[12:15], v[56:59], v[72:75], v[12:15]
    v_mfma_f32_16x16x32_bf16 v[16:19], v[60:63], v[72:75], v[16:19]
    v_mfma_f32_16x16x32_bf16 v[20:23], v[64:67], v[72:75], v[20:23]
    v_mfma_f32_16x16x32_bf16 v[24:27], v[68:71], v[72:75], v[24:27]
    s_waitcnt vmcnt(27)
    s_barrier
    s_add_u32 m0, s59, 27648
    s_nop 0
    buffer_load_dwordx4 v1, s[4:7], s53 offen lds
    s_add_u32 s53, s53, 4096
    s_add_u32 m0, s60, 27648
    s_nop 0
    buffer_load_dwordx4 v1, s[4:7], s54 offen lds
    s_add_u32 s54, s54, 4096
    s_add_u32 m0, s61, 27648
    s_nop 0
    buffer_load_dwordx4 v1, s[4:7], s55 offen lds
    s_add_u32 s55, s55, 4096
    s_waitcnt lgkmcnt(0)
    ds_read_b128 v[52:55], v2 offset:46080
    ds_read_b128 v[56:59], v2 offset:47104
    ds_read_b128 v[60:63], v2 offset:48128
    ds_read_b128 v[64:67], v2 offset:49152
    ds_read_b128 v[68:71], v2 offset:50176
    ds_read_b128 v[72:75], v3 offset:46080
    v_mfma_f32_16x16x32_bf16 v[8:11], v[28:31], v[48:51], v[8:11]
    v_mfma_f32_16x16x32_bf16 v[12:15], v[32:35], v[48:51], v[12:15]
    v_mfma_f32_16x16x32_bf16 v[16:19], v[36:39], v[48:51], v[16:19]
    v_mfma_f32_16x16x32_bf16 v[20:23], v[40:43], v[48:51], v[20:23]
    v_mfma_f32_16x16x32_bf16 v[24:27], v[44:47], v[48:51], v[24:27]
    s_waitcnt vmcnt(27)
    s_barrier
    s_add_u32 m0, s59, 36864
    s_nop 0
    buffer_load_dwordx4 v1, s[4:7], s53 offen lds
    s_add_u32 s53, s53, 4096
    s_add_u32 m0, s60, 36864
    s_nop 0
    buffer_load_dwordx4 v1, s[4:7], s54 offen lds
    s_add_u32 s54, s54, 4096
    s_add_u32 m0, s61, 36864
    s_nop 0
    buffer_load_dwordx4 v1, s[4:7], s55 offen lds
    s_add_u32 s55, s55, 4096
    s_waitcnt lgkmcnt(0)
    ds_read_b128 v[28:31], v2 offset:55296
    ds_read_b128 v[32:35], v2 offset:56320
    ds_read_b128 v[36:39], v2 offset:57344
    ds_read_b128 v[40:43], v2 offset:58368
    ds_read_b128 v[44:47], v2 offset:59392
    ds_read_b128 v[48:51], v3 offset:55296
    v_mfma_f32_16x16x32_bf16 v[8:11], v[52:55], v[72:75], v[8:11]
    v_mfma_f32_16x16x32_bf16 v[12:15], v[56:59], v[72:75], v[12:15]
    v_mfma_f32_16x16x32_bf16 v[16:19], v[60:63], v[72:75], v[16:19]
    v_mfma_f32_16x16x32_bf16 v[20:23], v[64:67], v[72:75], v[20:23]
    v_mfma_f32_16x16x32_bf16 v[24:27], v[68:71], v[72:75], v[24:27]
    s_waitcnt vmcnt(27)
    s_barrier
    s_add_u32 m0, s59, 46080
    s_nop 0
    buffer_load_dwordx4 v1, s[4:7], s53 offen lds
    s_add_u32 s53, s53, 4096
    s_add_u32 m0, s60, 46080
    s_nop 0
    buffer_load_dwordx4 v1, s[4:7], s54 offen lds
    s_add_u32 s54, s54, 4096
    s_add_u32 m0, s61, 46080
    s_nop 0
    buffer_load_dwordx4 v1, s[4:7], s55 offen lds
    s_add_u32 s55, s55, 4096
    s_waitcnt lgkmcnt(0)
    ds_read_b128 v[52:55], v2 offset:64512
    ds_read_b128 v[56:59], v6 offset:0
    ds_read_b128 v[60:63], v6 offset:1024
    ds_read_b128 v[64:67], v6 offset:2048
    ds_read_b128 v[68:71], v6 offset:3072
    ds_read_b128 v[72:75], v3 offset:64512
    v_mfma_f32_16x16x32_bf16 v[8:11], v[28:31], v[48:51], v[8:11]
    v_mfma_f32_16x16x32_bf16 v[12:15], v[32:35], v[48:51], v[12:15]
    v_mfma_f32_16x16x32_bf16 v[16:19], v[36:39], v[48:51], v[16:19]
    v_mfma_f32_16x16x32_bf16 v[20:23], v[40:43], v[48:51], v[20:23]
    v_mfma_f32_16x16x32_bf16 v[24:27], v[44:47], v[48:51], v[24:27]
    s_waitcnt vmcnt(27)
    s_barrier
    s_add_u32 m0, s59, 55296
    s_nop 0
    buffer_load_dwordx4 v1, s[4:7], s53 offen lds
    s_add_u32 s53, s53, 4096
    s_add_u32 m0, s60, 55296
    s_nop 0
    buffer_load_dwordx4 v1, s[4:7], s54 offen lds
    s_add_u32 s54, s54, 4096
    s_add_u32 m0, s61, 55296
    s_nop 0
    buffer_load_dwordx4 v1, s[4:7], s55 offen lds
    s_add_u32 s55, s55, 4096
    s_waitcnt lgkmcnt(0)
    ds_read_b128 v[28:31], v6 offset:8192
    ds_read_b128 v[32:35], v6 offset:9216
    ds_read_b128 v[36:39], v6 offset:10240
    ds_read_b128 v[40:43], v6 offset:11264
    ds_read_b128 v[44:47], v6 offset:12288
    ds_read_b128 v[48:51], v7 offset:8192
    v_mfma_f32_16x16x32_bf16 v[8:11], v[52:55], v[72:75], v[8:11]
    v_mfma_f32_16x16x32_bf16 v[12:15], v[56:59], v[72:75], v[12:15]
    v_mfma_f32_16x16x32_bf16 v[16:19], v[60:63], v[72:75], v[16:19]
    v_mfma_f32_16x16x32_bf16 v[20:23], v[64:67], v[72:75], v[20:23]
    v_mfma_f32_16x16x32_bf16 v[24:27], v[68:71], v[72:75], v[24:27]
    s_waitcnt vmcnt(27)
    s_barrier
    s_add_u32 m0, s59, 64512
    s_nop 0
    buffer_load_dwordx4 v1, s[4:7], s53 offen lds
    s_add_u32 s53, s53, 4096
    s_add_u32 m0, s60, 64512
    s_nop 0
    buffer_load_dwordx4 v1, s[4:7], s54 offen lds
    s_add_u32 s54, s54, 4096
    s_add_u32 m0, s61, 64512
    s_nop 0
    buffer_load_dwordx4 v1, s[4:7], s55 offen lds
    s_add_u32 s55, s55, 4096
    s_waitcnt lgkmcnt(0)
    ds_read_b128 v[52:55], v6 offset:17408
    ds_read_b128 v[56:59], v6 offset:18432
    ds_read_b128 v[60:63], v6 offset:19456
    ds_read_b128 v[64:67], v6 offset:20480
    ds_read_b128 v[68:71], v6 offset:21504
    ds_read_b128 v[72:75], v7 offset:17408
    v_mfma_f32_16x16x32_bf16 v[8:11], v[28:31], v[48:51], v[8:11]
    v_mfma_f32_16x16x32_bf16 v[12:15], v[32:35], v[48:51], v[12:15]
    v_mfma_f32_16x16x32_bf16 v[16:19], v[36:39], v[48:51], v[16:19]
    v_mfma_f32_16x16x32_bf16 v[20:23], v[40:43], v[48:51], v[20:23]
    v_mfma_f32_16x16x32_bf16 v[24:27], v[44:47], v[48:51], v[24:27]
    s_waitcnt vmcnt(27)
    s_barrier
    s_add_u32 m0, s59, 73728
    s_nop 0
    buffer_load_dwordx4 v1, s[4:7], s53 offen lds
    s_add_u32 s53, s53, 4096
    s_add_u32 m0, s60, 73728
    s_nop 0
    buffer_load_dwordx4 v1, s[4:7], s54 offen lds
    s_add_u32 s54, s54, 4096
    s_add_u32 m0, s61, 73728
    s_nop 0
    buffer_load_dwordx4 v1, s[4:7], s55 offen lds
    s_add_u32 s55, s55, 4096
    s_waitcnt lgkmcnt(0)
    ds_read_b128 v[28:31], v6 offset:26624
    ds_read_b128 v[32:35], v6 offset:27648
    ds_read_b128 v[36:39], v6 offset:28672
    ds_read_b128 v[40:43], v6 offset:29696
    ds_read_b128 v[44:47], v6 offset:30720
    ds_read_b128 v[48:51], v7 offset:26624
    v_mfma_f32_16x16x32_bf16 v[8:11], v[52:55], v[72:75], v[8:11]
    v_mfma_f32_16x16x32_bf16 v[12:15], v[56:59], v[72:75], v[12:15]
    v_mfma_f32_16x16x32_bf16 v[16:19], v[60:63], v[72:75], v[16:19]
    v_mfma_f32_16x16x32_bf16 v[20:23], v[64:67], v[72:75], v[20:23]
    v_mfma_f32_16x16x32_bf16 v[24:27], v[68:71], v[72:75], v[24:27]
    s_waitcnt vmcnt(27)
    s_barrier
    s_add_u32 m0, s59, 82944
    s_nop 0
    buffer_load_dwordx4 v1, s[4:7], s53 offen lds
    s_add_u32 s53, s53, 4096
    s_add_u32 m0, s60, 82944
    s_nop 0
    buffer_load_dwordx4 v1, s[4:7], s54 offen lds
    s_add_u32 s54, s54, 4096
    s_add_u32 m0, s61, 82944
    s_nop 0
    buffer_load_dwordx4 v1, s[4:7], s55 offen lds
    s_add_u32 s55, s55, 4096
    s_waitcnt lgkmcnt(0)
    ds_read_b128 v[52:55], v6 offset:35840
    ds_read_b128 v[56:59], v6 offset:36864
    ds_read_b128 v[60:63], v6 offset:37888
    ds_read_b128 v[64:67], v6 offset:38912
    ds_read_b128 v[68:71], v6 offset:39936
    ds_read_b128 v[72:75], v7 offset:35840
    v_mfma_f32_16x16x32_bf16 v[8:11], v[28:31], v[48:51], v[8:11]
    v_mfma_f32_16x16x32_bf16 v[12:15], v[32:35], v[48:51], v[12:15]
    v_mfma_f32_16x16x32_bf16 v[16:19], v[36:39], v[48:51], v[16:19]
    v_mfma_f32_16x16x32_bf16 v[20:23], v[40:43], v[48:51], v[20:23]
    v_mfma_f32_16x16x32_bf16 v[24:27], v[44:47], v[48:51], v[24:27]
    s_waitcnt vmcnt(27)
    s_barrier
    s_add_u32 m0, s59, 92160
    s_nop 0
    buffer_load_dwordx4 v1, s[4:7], s53 offen lds
    s_add_u32 s53, s53, 4096
    s_add_u32 m0, s60, 92160
    s_nop 0
    buffer_load_dwordx4 v1, s[4:7], s54 offen lds
    s_add_u32 s54, s54, 4096
    s_add_u32 m0, s61, 92160
    s_nop 0
    buffer_load_dwordx4 v1, s[4:7], s55 offen lds
    s_add_u32 s55, s55, 4096
    s_waitcnt lgkmcnt(0)
    ds_read_b128 v[28:31], v2 offset:0
    ds_read_b128 v[32:35], v2 offset:1024
    ds_read_b128 v[36:39], v2 offset:2048
    ds_read_b128 v[40:43], v2 offset:3072
    ds_read_b128 v[44:47], v2 offset:4096
    ds_read_b128 v[48:51], v3 offset:0
    v_mfma_f32_16x16x32_bf16 v[8:11], v[52:55], v[72:75], v[8:11]
    v_mfma_f32_16x16x32_bf16 v[12:15], v[56:59], v[72:75], v[12:15]
    v_mfma_f32_16x16x32_bf16 v[16:19], v[60:63], v[72:75], v[16:19]
    v_mfma_f32_16x16x32_bf16 v[20:23], v[64:67], v[72:75], v[20:23]
    v_mfma_f32_16x16x32_bf16 v[24:27], v[68:71], v[72:75], v[24:27]
    s_sub_u32 s50, s50, 1
    s_cmp_lg_u32 s50, 0
    s_cbranch_scc1 gloop_99
    s_waitcnt vmcnt(27)
    s_barrier
    s_add_u32 m0, s59, 101376
    s_nop 0
    buffer_load_dwordx4 v1, s[4:7], s53 offen lds
    s_add_u32 s53, s53, 4096
    s_add_u32 m0, s60, 101376
    s_nop 0
    buffer_load_dwordx4 v1, s[4:7], s54 offen lds
    s_add_u32 s54, s54, 4096
    s_add_u32 m0, s61, 101376
    s_nop 0
    buffer_load_dwordx4 v1, s[4:7], s55 offen lds
    s_add_u32 s55, s55, 4096
    s_waitcnt lgkmcnt(0)
    ds_read_b128 v[52:55], v2 offset:9216
    ds_read_b128 v[56:59], v2 offset:10240
    ds_read_b128 v[60:63], v2 offset:11264
    ds_read_b128 v[64:67], v2 offset:12288
    ds_read_b128 v[68:71], v2 offset:13312
    ds_read_b128 v[72:75], v3 offset:9216
    v_mfma_f32_16x16x32_bf16 v[8:11], v[28:31], v[48:51], v[8:11]
    v_mfma_f32_16x16x32_bf16 v[12:15], v[32:35], v[48:51], v[12:15]
    v_mfma_f32_16x16x32_bf16 v[16:19], v[36:39], v[48:51], v[16:19]
    v_mfma_f32_16x16x32_bf16 v[20:23], v[40:43], v[48:51], v[20:23]
    v_mfma_f32_16x16x32_bf16 v[24:27], v[44:47], v[48:51], v[24:27]
    s_waitcnt vmcnt(27)
    s_barrier
    s_add_u32 m0, s59, 0
    s_nop 0
    buffer_load_dwordx4 v1, s[4:7], s53 offen lds
    s_add_u32 s53, s53, 4096
    s_add_u32 m0, s60, 0
    s_nop 0
    buffer_load_dwordx4 v1, s[4:7], s54 offen lds
    s_add_u32 s54, s54, 4096
    s_add_u32 m0, s61, 0
    s_nop 0
    buffer_load_dwordx4 v1, s[4:7], s55 offen lds
    s_add_u32 s55, s55, 4096
    s_waitcnt lgkmcnt(0)
    ds_read_b128 v[28:31], v2 offset:18432
    ds_read_b128 v[32:35], v2 offset:19456
    ds_read_b128 v[36:39], v2 offset:20480
    ds_read_b128 v[40:43], v2 offset:21504
    ds_read_b128 v[44:47], v2 offset:22528
    ds_read_b128 v[48:51], v3 offset:18432
    v_mfma_f32_16x16x32_bf16 v[8:11], v[52:55], v[72:75], v[8:11]
    v_mfma_f32_16x16x32_bf16 v[12:15], v[56:59], v[72:75], v[12:15]
    v_mfma_f32_16x16x32_bf16 v[16:19], v[60:63], v[72:75], v[16:19]
    v_mfma_f32_16x16x32_bf16 v[20:23], v[64:67], v[72:75], v[20:23]
    v_mfma_f32_16x16x32_bf16 v[24:27], v[68:71], v[72:75], v[24:27]
    s_waitcnt vmcnt(27)
    s_barrier
    s_add_u32 m0, s59, 9216
    s_nop 0
    buffer_load_dwordx4 v1, s[4:7], s53 offen lds
    s_add_u32 s53, s53, 4096
    s_add_u32 m0, s60, 9216
    s_nop 0
    buffer_load_dwordx4 v1, s[4:7], s54 offen lds
    s_add_u32 s54, s54, 4096
    s_add_u32 m0, s61, 9216
    s_nop 0
    buffer_load_dwordx4 v1, s[4:7], s55 offen lds
    s_add_u32 s55, s55, 4096
    s_waitcnt lgkmcnt(0)
    ds_read_b128 v[52:55], v2 offset:27648
    ds_read_b128 v[56:59], v2 offset:28672
    ds_read_b128 v[60:63], v2 offset:29696
    ds_read_b128 v[64:67], v2 offset:30720
    ds_read_b128 v[68:71], v2 offset:31744
    ds_read_b128 v[72:75], v3 offset:27648
    v_mfma_f32_16x16x32_bf16 v[8:11], v[28:31], v[48:51], v[8:11]
    v_mfma_f32_16x16x32_bf16 v[12:15], v[32:35], v[48:51], v[12:15]
    v_mfma_f32_16x16x32_bf16 v[16:19], v[36:39], v[48:51], v[16:19]
    v_mfma_f32_16x16x32_bf16 v[20:23], v[40:43], v[48:51], v[20:23]
    v_mfma_f32_16x16x32_bf16 v[24:27], v[44:47], v[48:51], v[24:27]
    s_waitcnt vmcnt(27)
    s_barrier
    s_add_u32 m0, s59, 18432
    s_nop 0
    buffer_load_dwordx4 v1, s[4:7], s53 offen lds
    s_add_u32 s53, s53, 4096
    s_add_u32 m0, s60, 18432
    s_nop 0
    buffer_load_dwordx4 v1, s[4:7], s54 offen lds
    s_add_u32 s54, s54, 4096
    s_add_u32 m0, s61, 18432
    s_nop 0
    buffer_load_dwordx4 v1, s[4:7], s55 offen lds
    s_add_u32 s55, s55, 4096
    s_waitcnt lgkmcnt(0)
    ds_read_b128 v[28:31], v2 offset:36864
    ds_read_b128 v[32:35], v2 offset:37888
    ds_read_b128 v[36:39], v2 offset:38912
    ds_read_b128 v[40:43], v2 offset:39936
    ds_read_b128 v[44:47], v2 offset:40960
    ds_read_b128 v[48:51], v3 offset:36864
    v_mfma_f32_16x16x32_bf16 v[8:11], v[52:55], v[72:75], v[8:11]
    v_mfma_f32_16x16x32_bf16 v[12:15], v[56:59], v[72:75], v[12:15]
    v_mfma_f32_16x16x32_bf16 v[16:19], v[60:63], v[72:75], v[16:19]
    v_mfma_f32_16x16x32_bf16 v[20:23], v[64:67], v[72:75], v[20:23]
    v_mfma_f32_16x16x32_bf16 v[24:27], v[68:71], v[72:75], v[24:27]
    s_waitcnt vmcnt(27)
    s_barrier
    s_add_u32 m0, s59, 27648
    s_nop 0
    buffer_load_dwordx4 v1, s[4:7], s53 offen lds
    s_add_u32 s53, s53, 4096
    s_add_u32 m0, s60, 27648
    s_nop 0
    buffer_load_dwordx4 v1, s[4:7], s54 offen lds
    s_add_u32 s54, s54, 4096
    s_add_u32 m0, s61, 27648
    s_nop 0
    buffer_load_dwordx4 v1, s[4:7], s55 offen lds
    s_add_u32 s55, s55, 4096
    s_waitcnt lgkmcnt(0)
    ds_read_b128 v[52:55], v2 offset:46080
    ds_read_b128 v[56:59], v2 offset:47104
    ds_read_b128 v[60:63], v2 offset:48128
    ds_read_b128 v[64:67], v2 offset:49152
    ds_read_b128 v[68:71], v2 offset:50176
    ds_read_b128 v[72:75], v3 offset:46080
    v_mfma_f32_16x16x32_bf16 v[8:11], v[28:31], v[48:51], v[8:11]
    v_mfma_f32_16x16x32_bf16 v[12:15], v[32:35], v[48:51], v[12:15]
    v_mfma_f32_16x16x32_bf16 v[16:19], v[36:39], v[48:51], v[16:19]
    v_mfma_f32_16x16x32_bf16 v[20:23], v[40:43], v[48:51], v[20:23]
    v_mfma_f32_16x16x32_bf16 v[24:27], v[44:47], v[48:51], v[24:27]
    s_waitcnt vmcnt(27)
    s_barrier
    s_add_u32 m0, s59, 36864
    s_nop 0
    buffer_load_dwordx4 v1, s[4:7], s53 offen lds
    s_add_u32 s53, s53, 4096
    s_add_u32 m0, s60, 36864
    s_nop 0
    buffer_load_dwordx4 v1, s[4:7], s54 offen lds
    s_add_u32 s54, s54, 4096
    s_add_u32 m0, s61, 36864
    s_nop 0
    buffer_load_dwordx4 v1, s[4:7], s55 offen lds
    s_add_u32 s55, s55, 4096
    s_waitcnt lgkmcnt(0)
    ds_read_b128 v[28:31], v2 offset:55296
    ds_read_b128 v[32:35], v2 offset:56320
    ds_read_b128 v[36:39], v2 offset:57344
    ds_read_b128 v[40:43], v2 offset:58368
    ds_read_b128 v[44:47], v2 offset:59392
    ds_read_b128 v[48:51], v3 offset:55296
    v_mfma_f32_16x16x32_bf16 v[8:11], v[52:55], v[72:75], v[8:11]
    v_mfma_f32_16x16x32_bf16 v[12:15], v[56:59], v[72:75], v[12:15]
    v_mfma_f32_16x16x32_bf16 v[16:19], v[60:63], v[72:75], v[16:19]
    v_mfma_f32_16x16x32_bf16 v[20:23], v[64:67], v[72:75], v[20:23]
    v_mfma_f32_16x16x32_bf16 v[24:27], v[68:71], v[72:75], v[24:27]
    s_waitcnt vmcnt(27)
    s_barrier
    s_add_u32 m0, s59, 46080
    s_nop 0
    buffer_load_dwordx4 v1, s[4:7], s53 offen lds
    s_add_u32 s53, s53, 4096
    s_add_u32 m0, s60, 46080
    s_nop 0
    buffer_load_dwordx4 v1, s[4:7], s54 offen lds
    s_add_u32 s54, s54, 4096
    s_add_u32 m0, s61, 46080
    s_nop 0
    buffer_load_dwordx4 v1, s[4:7], s55 offen lds
    s_add_u32 s55, s55, 4096
    s_waitcnt lgkmcnt(0)
    ds_read_b128 v[52:55], v2 offset:64512
    ds_read_b128 v[56:59], v6 offset:0
    ds_read_b128 v[60:63], v6 offset:1024
    ds_read_b128 v[64:67], v6 offset:2048
    ds_read_b128 v[68:71], v6 offset:3072
    ds_read_b128 v[72:75], v3 offset:64512
    v_mfma_f32_16x16x32_bf16 v[8:11], v[28:31], v[48:51], v[8:11]
    v_mfma_f32_16x16x32_bf16 v[12:15], v[32:35], v[48:51], v[12:15]
    v_mfma_f32_16x16x32_bf16 v[16:19], v[36:39], v[48:51], v[16:19]
    v_mfma_f32_16x16x32_bf16 v[20:23], v[40:43], v[48:51], v[20:23]
    v_mfma_f32_16x16x32_bf16 v[24:27], v[44:47], v[48:51], v[24:27]
    s_waitcnt vmcnt(27)
    s_barrier
    s_add_u32 m0, s59, 55296
    s_nop 0
    buffer_load_dwordx4 v1, s[4:7], s53 offen lds
    s_add_u32 s53, s53, 4096
    s_add_u32 m0, s60, 55296
    s_nop 0
    buffer_load_dwordx4 v1, s[4:7], s54 offen lds
    s_add_u32 s54, s54, 4096
    s_add_u32 m0, s61, 55296
    s_nop 0
    buffer_load_dwordx4 v1, s[4:7], s55 offen lds
    s_add_u32 s55, s55, 4096
    s_waitcnt lgkmcnt(0)
    ds_read_b128 v[28:31], v6 offset:8192
    ds_read_b128 v[32:35], v6 offset:9216
    ds_read_b128 v[36:39], v6 offset:10240
    ds_read_b128 v[40:43], v6 offset:11264
    ds_read_b128 v[44:47], v6 offset:12288
    ds_read_b128 v[48:51], v7 offset:8192
    v_mfma_f32_16x16x32_bf16 v[8:11], v[52:55], v[72:75], v[8:11]
    v_mfma_f32_16x16x32_bf16 v[12:15], v[56:59], v[72:75], v[12:15]
    v_mfma_f32_16x16x32_bf16 v[16:19], v[60:63], v[72:75], v[16:19]
    v_mfma_f32_16x16x32_bf16 v[20:23], v[64:67], v[72:75], v[20:23]
    v_mfma_f32_16x16x32_bf16 v[24:27], v[68:71], v[72:75], v[24:27]
    s_waitcnt vmcnt(27)
    s_barrier
    s_add_u32 m0, s59, 64512
    s_nop 0
    buffer_load_dwordx4 v1, s[4:7], s53 offen lds
    s_add_u32 s53, s53, 4096
    s_add_u32 m0, s60, 64512
    s_nop 0
    buffer_load_dwordx4 v1, s[4:7], s54 offen lds
    s_add_u32 s54, s54, 4096
    s_add_u32 m0, s61, 64512
    s_nop 0
    buffer_load_dwordx4 v1, s[4:7], s55 offen lds
    s_add_u32 s55, s55, 4096
    s_waitcnt lgkmcnt(0)
    ds_read_b128 v[52:55], v6 offset:17408
    ds_read_b128 v[56:59], v6 offset:18432
    ds_read_b128 v[60:63], v6 offset:19456
    ds_read_b128 v[64:67], v6 offset:20480
    ds_read_b128 v[68:71], v6 offset:21504
    ds_read_b128 v[72:75], v7 offset:17408
    v_mfma_f32_16x16x32_bf16 v[8:11], v[28:31], v[48:51], v[8:11]
    v_mfma_f32_16x16x32_bf16 v[12:15], v[32:35], v[48:51], v[12:15]
    v_mfma_f32_16x16x32_bf16 v[16:19], v[36:39], v[48:51], v[16:19]
    v_mfma_f32_16x16x32_bf16 v[20:23], v[40:43], v[48:51], v[20:23]
    v_mfma_f32_16x16x32_bf16 v[24:27], v[44:47], v[48:51], v[24:27]
    s_waitcnt vmcnt(27)
    s_barrier
    s_waitcnt lgkmcnt(0)
    ds_read_b128 v[28:31], v6 offset:26624
    ds_read_b128 v[32:35], v6 offset:27648
    ds_read_b128 v[36:39], v6 offset:28672
    ds_read_b128 v[40:43], v6 offset:29696
    ds_read_b128 v[44:47], v6 offset:30720
    ds_read_b128 v[48:51], v7 offset:26624
    v_mfma_f32_16x16x32_bf16 v[8:11], v[52:55], v[72:75], v[8:11]
    v_mfma_f32_16x16x32_bf16 v[12:15], v[56:59], v[72:75], v[12:15]
    v_mfma_f32_16x16x32_bf16 v[16:19], v[60:63], v[72:75], v[16:19]
    v_mfma_f32_16x16x32_bf16 v[20:23], v[64:67], v[72:75], v[20:23]
    v_mfma_f32_16x16x32_bf16 v[24:27], v[68:71], v[72:75], v[24:27]
    s_waitcnt vmcnt(24)
    s_barrier
    s_waitcnt lgkmcnt(0)
    ds_read_b128 v[52:55], v6 offset:35840
    ds_read_b128 v[56:59], v6 offset:36864
    ds_read_b128 v[60:63], v6 offset:37888
    ds_read_b128 v[64:67], v6 offset:38912
    ds_read_b128 v[68:71], v6 offset:39936
    ds_read_b128 v[72:75], v7 offset:35840
    v_mfma_f32_16x16x32_bf16 v[8:11], v[28:31], v[48:51], v[8:11]
    v_mfma_f32_16x16x32_bf16 v[12:15], v[32:35], v[48:51], v[12:15]
    v_mfma_f32_16x16x32_bf16 v[16:19], v[36:39], v[48:51], v[16:19]
    v_mfma_f32_16x16x32_bf16 v[20:23], v[40:43], v[48:51], v[20:23]
    v_mfma_f32_16x16x32_bf16 v[24:27], v[44:47], v[48:51], v[24:27]
    s_waitcnt vmcnt(21)
    s_barrier
    s_waitcnt lgkmcnt(0)
    ds_read_b128 v[28:31], v2 offset:0
    ds_read_b128 v[32:35], v2 offset:1024
    ds_read_b128 v[36:39], v2 offset:2048
    ds_read_b128 v[40:43], v2 offset:3072
    ds_read_b128 v[44:47], v2 offset:4096
    ds_read_b128 v[48:51], v3 offset:0
    v_mfma_f32_16x16x32_bf16 v[8:11], v[52:55], v[72:75], v[8:11]
    v_mfma_f32_16x16x32_bf16 v[12:15], v[56:59], v[72:75], v[12:15]
    v_mfma_f32_16x16x32_bf16 v[16:19], v[60:63], v[72:75], v[16:19]
    v_mfma_f32_16x16x32_bf16 v[20:23], v[64:67], v[72:75], v[20:23]
    v_mfma_f32_16x16x32_bf16 v[24:27], v[68:71], v[72:75], v[24:27]
    s_waitcnt vmcnt(18)
    s_barrier
    s_waitcnt lgkmcnt(0)
    ds_read_b128 v[52:55], v2 offset:9216
    ds_read_b128 v[56:59], v2 offset:10240
    ds_read_b128 v[60:63], v2 offset:11264
    ds_read_b128 v[64:67], v2 offset:12288
    ds_read_b128 v[68:71], v2 offset:13312
    ds_read_b128 v[72:75], v3 offset:9216
    v_mfma_f32_16x16x32_bf16 v[8:11], v[28:31], v[48:51], v[8:11]
    v_mfma_f32_16x16x32_bf16 v[12:15], v[32:35], v[48:51], v[12:15]
    v_mfma_f32_16x16x32_bf16 v[16:19], v[36:39], v[48:51], v[16:19]
    v_mfma_f32_16x16x32_bf16 v[20:23], v[40:43], v[48:51], v[20:23]
    v_mfma_f32_16x16x32_bf16 v[24:27], v[44:47], v[48:51], v[24:27]
    s_waitcnt vmcnt(15)
    s_barrier
    s_waitcnt lgkmcnt(0)
    ds_read_b128 v[28:31], v2 offset:18432
    ds_read_b128 v[32:35], v2 offset:19456
    ds_read_b128 v[36:39], v2 offset:20480
    ds_read_b128 v[40:43], v2 offset:21504
    ds_read_b128 v[44:47], v2 offset:22528
    ds_read_b128 v[48:51], v3 offset:18432
    v_mfma_f32_16x16x32_bf16 v[8:11], v[52:55], v[72:75], v[8:11]
    v_mfma_f32_16x16x32_bf16 v[12:15], v[56:59], v[72:75], v[12:15]
    v_mfma_f32_16x16x32_bf16 v[16:19], v[60:63], v[72:75], v[16:19]
    v_mfma_f32_16x16x32_bf16 v[20:23], v[64:67], v[72:75], v[20:23]
    v_mfma_f32_16x16x32_bf16 v[24:27], v[68:71], v[72:75], v[24:27]
    s_waitcnt vmcnt(12)
    s_barrier
    s_waitcnt lgkmcnt(0)
    ds_read_b128 v[52:55], v2 offset:27648
    ds_read_b128 v[56:59], v2 offset:28672
    ds_read_b128 v[60:63], v2 offset:29696
    ds_read_b128 v[64:67], v2 offset:30720
    ds_read_b128 v[68:71], v2 offset:31744
    ds_read_b128 v[72:75], v3 offset:27648
    v_mfma_f32_16x16x32_bf16 v[8:11], v[28:31], v[48:51], v[8:11]
    v_mfma_f32_16x16x32_bf16 v[12:15], v[32:35], v[48:51], v[12:15]
    v_mfma_f32_16x16x32_bf16 v[16:19], v[36:39], v[48:51], v[16:19]
    v_mfma_f32_16x16x32_bf16 v[20:23], v[40:43], v[48:51], v[20:23]
    v_mfma_f32_16x16x32_bf16 v[24:27], v[44:47], v[48:51], v[24:27]
    s_waitcnt vmcnt(9)
    s_barrier
    s_waitcnt lgkmcnt(0)
    ds_read_b128 v[28:31], v2 offset:36864
    ds_read_b128 v[32:35], v2 offset:37888
    ds_read_b128 v[36:39], v2 offset:38912
    ds_read_b128 v[40:43], v2 offset:39936
    ds_read_b128 v[44:47], v2 offset:40960
    ds_read_b128 v[48:51], v3 offset:36864
    v_mfma_f32_16x16x32_bf16 v[8:11], v[52:55], v[72:75], v[8:11]
    v_mfma_f32_16x16x32_bf16 v[12:15], v[56:59], v[72:75], v[12:15]
    v_mfma_f32_16x16x32_bf16 v[16:19], v[60:63], v[72:75], v[16:19]
    v_mfma_f32_16x16x32_bf16 v[20:23], v[64:67], v[72:75], v[20:23]
    v_mfma_f32_16x16x32_bf16 v[24:27], v[68:71], v[72:75], v[24:27]
    s_waitcnt vmcnt(6)
    s_barrier
    s_waitcnt lgkmcnt(0)
    ds_read_b128 v[52:55], v2 offset:46080
    ds_read_b128 v[56:59], v2 offset:47104
    ds_read_b128 v[60:63], v2 offset:48128
    ds_read_b128 v[64:67], v2 offset:49152
    ds_read_b128 v[68:71], v2 offset:50176
    ds_read_b128 v[72:75], v3 offset:46080
    v_mfma_f32_16x16x32_bf16 v[8:11], v[28:31], v[48:51], v[8:11]
    v_mfma_f32_16x16x32_bf16 v[12:15], v[32:35], v[48:51], v[12:15]
    v_mfma_f32_16x16x32_bf16 v[16:19], v[36:39], v[48:51], v[16:19]
    v_mfma_f32_16x16x32_bf16 v[20:23], v[40:43], v[48:51], v[20:23]
    v_mfma_f32_16x16x32_bf16 v[24:27], v[44:47], v[48:51], v[24:27]
    s_waitcnt vmcnt(3)
    s_barrier
    s_waitcnt lgkmcnt(0)
    ds_read_b128 v[28:31], v2 offset:55296
    ds_read_b128 v[32:35], v2 offset:56320
    ds_read_b128 v[36:39], v2 offset:57344
    ds_read_b128 v[40:43], v2 offset:58368
    ds_read_b128 v[44:47], v2 offset:59392
    ds_read_b128 v[48:51], v3 offset:55296
    v_mfma_f32_16x16x32_bf16 v[8:11], v[52:55], v[72:75], v[8:11]
    v_mfma_f32_16x16x32_bf16 v[12:15], v[56:59], v[72:75], v[12:15]
    v_mfma_f32_16x16x32_bf16 v[16:19], v[60:63], v[72:75], v[16:19]
    v_mfma_f32_16x16x32_bf16 v[20:23], v[64:67], v[72:75], v[20:23]
    v_mfma_f32_16x16x32_bf16 v[24:27], v[68:71], v[72:75], v[24:27]
    s_waitcnt vmcnt(0)
    s_barrier
    s_waitcnt lgkmcnt(0)
    ds_read_b128 v[52:55], v2 offset:64512
    ds_read_b128 v[56:59], v6 offset:0
    ds_read_b128 v[60:63], v6 offset:1024
    ds_read_b128 v[64:67], v6 offset:2048
    ds_read_b128 v[68:71], v6 offset:3072
    ds_read_b128 v[72:75], v3 offset:64512
    v_mfma_f32_16x16x32_bf16 v[8:11], v[28:31], v[48:51], v[8:11]
    v_mfma_f32_16x16x32_bf16 v[12:15], v[32:35], v[48:51], v[12:15]
    v_mfma_f32_16x16x32_bf16 v[16:19], v[36:39], v[48:51], v[16:19]
    v_mfma_f32_16x16x32_bf16 v[20:23], v[40:43], v[48:51], v[20:23]
    v_mfma_f32_16x16x32_bf16 v[24:27], v[44:47], v[48:51], v[24:27]
    s_waitcnt lgkmcnt(0)
    v_mfma_f32_16x16x32_bf16 v[8:11], v[52:55], v[72:75], v[8:11]
    v_mfma_f32_16x16x32_bf16 v[12:15], v[56:59], v[72:75], v[12:15]
    v_mfma_f32_16x16x32_bf16 v[16:19], v[60:63], v[72:75], v[16:19]
    v_mfma_f32_16x16x32_bf16 v[20:23], v[64:67], v[72:75], v[20:23]
    v_mfma_f32_16x16x32_bf16 v[24:27], v[68:71], v[72:75], v[24:27]
    s_branch gbe_98
gb2_97:
    s_add_u32 m0, s59, 0
    s_nop 0
    buffer_load_dwordx4 v1, s[4:7], s53 offen lds
    s_add_u32 s53, s53, 4096
    s_add_u32 m0, s60, 0
    s_nop 0
    buffer_load_dwordx4 v1, s[4:7], s54 offen lds
    s_add_u32 s54, s54, 4096
    s_add_u32 m0, s59, 9216
    s_nop 0
    buffer_load_dwordx4 v1, s[4:7], s53 offen lds
    s_add_u32 s53, s53, 4096
    s_add_u32 m0, s60, 9216
    s_nop 0
    buffer_load_dwordx4 v1, s[4:7], s54 offen lds
    s_add_u32 s54, s54, 4096
    s_add_u32 m0, s59, 18432
    s_nop 0
    buffer_load_dwordx4 v1, s[4:7], s53 offen lds
    s_add_u32 s53, s53, 4096
    s_add_u32 m0, s60, 18432
    s_nop 0
    buffer_load_dwordx4 v1, s[4:7], s54 offen lds
    s_add_u32 s54, s54, 4096
    s_add_u32 m0, s59, 27648
    s_nop 0
    buffer_load_dwordx4 v1, s[4:7], s53 offen lds
    s_add_u32 s53, s53, 4096
    s_add_u32 m0, s60, 27648
    s_nop 0
    buffer_load_dwordx4 v1, s[4:7], s54 offen lds
    s_add_u32 s54, s54, 4096
    s_add_u32 m0, s59, 36864
    s_nop 0
    buffer_load_dwordx4 v1, s[4:7], s53 offen lds
    s_add_u32 s53, s53, 4096
    s_add_u32 m0, s60, 36864
    s_nop 0
    buffer_load_dwordx4 v1, s[4:7], s54 offen lds
    s_add_u32 s54, s54, 4096
    s_add_u32 m0, s59, 46080
    s_nop 0
    buffer_load_dwordx4 v1, s[4:7], s53 offen lds
    s_add_u32 s53, s53, 4096
    s_add_u32 m0, s60, 46080
    s_nop 0
    buffer_load_dwordx4 v1, s[4:7], s54 offen lds
    s_add_u32 s54, s54, 4096
    s_add_u32 m0, s59, 55296
    s_nop 0
    buffer_load_dwordx4 v1, s[4:7], s53 offen lds
    s_add_u32 s53, s53, 4096
    s_add_u32 m0, s60, 55296
    s_nop 0
    buffer_load_dwordx4 v1, s[4:7], s54 offen lds
    s_add_u32 s54, s54, 4096
    s_add_u32 m0, s59, 64512
    s_nop 0
    buffer_load_dwordx4 v1, s[4:7], s53 offen lds
    s_add_u32 s53, s53, 4096
    s_add_u32 m0, s60, 64512
    s_nop 0
    buffer_load_dwordx4 v1, s[4:7], s54 offen lds
    s_add_u32 s54, s54, 4096
    s_add_u32 m0, s59, 73728
    s_nop 0
    buffer_load_dwordx4 v1, s[4:7], s53 offen lds
    s_add_u32 s53, s53, 4096
    s_add_u32 m0, s60, 73728
    s_nop 0
    buffer_load_dwordx4 v1, s[4:7], s54 offen lds
    s_add_u32 s54, s54, 4096
    s_add_u32 m0, s59, 82944
    s_nop 0
    buffer_load_dwordx4 v1, s[4:7], s53 offen lds
    s_add_u32 s53, s53, 4096
    s_add_u32 m0, s60, 82944
    s_nop 0
    buffer_load_dwordx4 v1, s[4:7], s54 offen lds
    s_add_u32 s54, s54, 4096
    s_add_u32 m0, s59, 92160
    s_nop 0
    buffer_load_dwordx4 v1, s[4:7], s53 offen lds
    s_add_u32 s53, s53, 4096
    s_add_u32 m0, s60, 92160
    s_nop 0
    buffer_load_dwordx4 v1, s[4:7], s54 offen lds
    s_add_u32 s54, s54, 4096
    s_waitcnt vmcnt(20)
    s_barrier
    ds_read_b128 v[28:31], v2 offset:0
    ds_read_b128 v[32:35], v2 offset:1024
    ds_read_b128 v[36:39], v2 offset:2048
    ds_read_b128 v[40:43], v2 offset:3072
    ds_read_b128 v[44:47], v2 offset:4096
    ds_read_b128 v[48:51], v3 offset:0
    s_mov_b32 s50, 9
gloop_100:
    s_waitcnt vmcnt(18)
    s_barrier
    s_add_u32 m0, s59, 101376
    s_nop 0
    buffer_load_dwordx4 v1, s[4:7], s53 offen lds
    s_add_u32 s53, s53, 4096
    s_add_u32 m0, s60, 101376
    s_nop 0
    buffer_load_dwordx4 v1, s[4:7], s54 offen lds
    s_add_u32 s54, s54, 4096
    s_waitcnt lgkmcnt(0)
    ds_read_b128 v[52:55], v2 offset:9216
    ds_read_b128 v[56:59], v2 offset:10240
    ds_read_b128 v[60:63], v2 offset:11264
    ds_read_b128 v[64:67], v2 offset:12288
    ds_read_b128 v[68:71], v2 offset:13312
    ds_read_b128 v[72:75], v3 offset:9216
    v_mfma_f32_16x16x32_bf16 v[8:11], v[28:31], v[48:51], v[8:11]
    v_mfma_f32_16x16x32_bf16 v[12:15], v[32:35], v[48:51], v[12:15]
    v_mfma_f32_16x16x32_bf16 v[16:19], v[36:39], v[48:51], v[16:19]
    v_mfma_f32_16x16x32_bf16 v[20:23], v[40:43], v[48:51], v[20:23]
    v_mfma_f32_16x16x32_bf16 v[24:27], v[44:47], v[48:51], v[24:27]
    s_waitcnt vmcnt(18)
    s_barrier
    s_add_u32 m0, s59, 0
    s_nop 0
    buffer_load_dwordx4 v1, s[4:7], s53 offen lds
    s_add_u32 s53, s53, 4096
    s_add_u32 m0, s60, 0
    s_nop 0
    buffer_load_dwordx4 v1, s[4:7], s54 offen lds
    s_add_u32 s54, s54, 4096
    s_waitcnt lgkmcnt(0)
    ds_read_b128 v[28:31], v2 offset:18432
    ds_read_b128 v[32:35], v2 offset:19456
    ds_read_b128 v[36:39], v2 offset:20480
    ds_read_b128 v[40:43], v2 offset:21504
    ds_read_b128 v[44:47], v2 offset:22528
    ds_read_b128 v[48:51], v3 offset:18432
    v_mfma_f32_16x16x32_bf16 v[8:11], v[52:55], v[72:75], v[8:11]
    v_mfma_f32_16x16x32_bf16 v[12:15], v[56:59], v[72:75], v[12:15]
    v_mfma_f32_16x16x32_bf16 v[16:19], v[60:63], v[72:75], v[16:19]
    v_mfma_f32_16x16x32_bf16 v[20:23], v[64:67], v[72:75], v[20:23]
    v_mfma_f32_16x16x32_bf16 v[24:27], v[68:71], v[72:75], v[24:27]
    s_waitcnt vmcnt(18)
    s_barrier
    s_add_u32 m0, s59, 9216
    s_nop 0
    buffer_load_dwordx4 v1, s[4:7], s53 offen lds
    s_add_u32 s53, s53, 4096
    s_add_u32 m0, s60, 9216
    s_nop 0
    buffer_load_dwordx4 v1, s[4:7], s54 offen lds
    s_add_u32 s54, s54, 4096
    s_waitcnt lgkmcnt(0)
    ds_read_b128 v[52:55], v2 offset:27648
    ds_read_b128 v[56:59], v2 offset:28672
    ds_read_b128 v[60:63], v2 offset:29696
    ds_read_b128 v[64:67], v2 offset:30720
    ds_read_b128 v[68:71], v2 offset:31744
    ds_read_b128 v[72:75], v3 offset:27648
    v_mfma_f32_16x16x32_bf16 v[8:11], v[28:31], v[48:51], v[8:11]
    v_mfma_f32_16x16x32_bf16 v[12:15], v[32:35], v[48:51], v[12:15]
    v_mfma_f32_16x16x32_bf16 v[16:19], v[36:39], v[48:51], v[16:19]
    v_mfma_f32_16x16x32_bf16 v[20:23], v[40:43], v[48:51], v[20:23]
    v_mfma_f32_16x16x32_bf16 v[24:27], v[44:47], v[48:51], v[24:27]
    s_waitcnt vmcnt(18)
    s_barrier
    s_add_u32 m0, s59, 18432
    s_nop 0
    buffer_load_dwordx4 v1, s[4:7], s53 offen lds
    s_add_u32 s53, s53, 4096
    s_add_u32 m0, s60, 18432
    s_nop 0
    buffer_load_dwordx4 v1, s[4:7], s54 offen lds
    s_add_u32 s54, s54, 4096
    s_waitcnt lgkmcnt(0)
    ds_read_b128 v[28:31], v2 offset:36864
    ds_read_b128 v[32:35], v2 offset:37888
    ds_read_b128 v[36:39], v2 offset:38912
    ds_read_b128 v[40:43], v2 offset:39936
    ds_read_b128 v[44:47], v2 offset:40960
    ds_read_b128 v[48:51], v3 offset:36864
    v_mfma_f32_16x16x32_bf16 v[8:11], v[52:55], v[72:75], v[8:11]
    v_mfma_f32_16x16x32_bf16 v[12:15], v[56:59], v[72:75], v[12:15]
    v_mfma_f32_16x16x32_bf16 v[16:19], v[60:63], v[72:75], v[16:19]
    v_mfma_f32_16x16x32_bf16 v[20:23], v[64:67], v[72:75], v[20:23]
    v_mfma_f32_16x16x32_bf16 v[24:27], v[68:71], v[72:75], v[24:27]
    s_waitcnt vmcnt(18)
    s_barrier
    s_add_u32 m0, s59, 27648
    s_nop 0
    buffer_load_dwordx4 v1, s[4:7], s53 offen lds
    s_add_u32 s53, s53, 4096
    s_add_u32 m0, s60, 27648
    s_nop 0
    buffer_load_dwordx4 v1, s[4:7], s54 offen lds
    s_add_u32 s54, s54, 4096
    s_waitcnt lgkmcnt(0)
    ds_read_b128 v[52:55], v2 offset:46080
    ds_read_b128 v[56:59], v2 offset:47104
    ds_read_b128 v[60:63], v2 offset:48128
    ds_read_b128 v[64:67], v2 offset:49152
    ds_read_b128 v[68:71], v2 offset:50176
    ds_read_b128 v[72:75], v3 offset:46080
    v_mfma_f32_16x16x32_bf16 v[8:11], v[28:31], v[48:51], v[8:11]
    v_mfma_f32_16x16x32_bf16 v[12:15], v[32:35], v[48:51], v[12:15]
    v_mfma_f32_16x16x32_bf16 v[16:19], v[36:39], v[48:51], v[16:19]
    v_mfma_f32_16x16x32_bf16 v[20:23], v[40:43], v[48:51], v[20:23]
    v_mfma_f32_16x16x32_bf16 v[24:27], v[44:47], v[48:51], v[24:27]
    s_waitcnt vmcnt(18)
    s_barrier
    s_add_u32 m0, s59, 36864
    s_nop 0
    buffer_load_dwordx4 v1, s[4:7], s53 offen lds
    s_add_u32 s53, s53, 4096
    s_add_u32 m0, s60, 36864
    s_nop 0
    buffer_load_dwordx4 v1, s[4:7], s54 offen lds
    s_add_u32 s54, s54, 4096
    s_waitcnt lgkmcnt(0)
    ds_read_b128 v[28:31], v2 offset:55296
    ds_read_b128 v[32:35], v2 offset:56320
    ds_read_b128 v[36:39], v2 offset:57344
    ds_read_b128 v[40:43], v2 offset:58368
    ds_read_b128 v[44:47], v2 offset:59392
    ds_read_b128 v[48:51], v3 offset:55296
    v_mfma_f32_16x16x32_bf16 v[8:11], v[52:55], v[72:75], v[8:11]
    v_mfma_f32_16x16x32_bf16 v[12:15], v[56:59], v[72:75], v[12:15]
    v_mfma_f32_16x16x32_bf16 v[16:19], v[60:63], v[72:75], v[16:19]
    v_mfma_f32_16x16x32_bf16 v[20:23], v[64:67], v[72:75], v[20:23]
    v_mfma_f32_16x16x32_bf16 v[24:27], v[68:71], v[72:75], v[24:27]
    s_waitcnt vmcnt(18)
    s_barrier
    s_add_u32 m0, s59, 46080
    s_nop 0
    buffer_load_dwordx4 v1, s[4:7], s53 offen lds
    s_add_u32 s53, s53, 4096
    s_add_u32 m0, s60, 46080
    s_nop 0
    buffer_load_dwordx4 v1, s[4:7], s54 offen lds
    s_add_u32 s54, s54, 4096
    s_waitcnt lgkmcnt(0)
    ds_read_b128 v[52:55], v2 offset:64512
    ds_read_b128 v[56:59], v6 offset:0
    ds_read_b128 v[60:63], v6 offset:1024
    ds_read_b128 v[64:67], v6 offset:2048
    ds_read_b128 v[68:71], v6 offset:3072
    ds_read_b128 v[72:75], v3 offset:64512
    v_mfma_f32_16x16x32_bf16 v[8:11], v[28:31], v[48:51], v[8:11]
    v_mfma_f32_16x16x32_bf16 v[12:15], v[32:35], v[48:51], v[12:15]
    v_mfma_f32_16x16x32_bf16 v[16:19], v[36:39], v[48:51], v[16:19]
    v_mfma_f32_16x16x32_bf16 v[20:23], v[40:43], v[48:51], v[20:23]
    v_mfma_f32_16x16x32_bf16 v[24:27], v[44:47], v[48:51], v[24:27]
    s_waitcnt vmcnt(18)
    s_barrier
    s_add_u32 m0, s59, 55296
    s_nop 0
    buffer_load_dwordx4 v1, s[4:7], s53 offen lds
    s_add_u32 s53, s53, 4096
    s_add_u32 m0, s60, 55296
    s_nop 0
    buffer_load_dwordx4 v1, s[4:7], s54 offen lds
    s_add_u32 s54, s54, 4096
    s_waitcnt lgkmcnt(0)
    ds_read_b128 v[28:31], v6 offset:8192
    ds_read_b128 v[32:35], v6 offset:9216
    ds_read_b128 v[36:39], v6 offset:10240
    ds_read_b128 v[40:43], v6 offset:11264
    ds_read_b128 v[44:47], v6 offset:12288
    ds_read_b128 v[48:51], v7 offset:8192
    v_mfma_f32_16x16x32_bf16 v[8:11], v[52:55], v[72:75], v[8:11]
    v_mfma_f32_16x16x32_bf16 v[12:15], v[56:59], v[72:75], v[12:15]
    v_mfma_f32_16x16x32_bf16 v[16:19], v[60:63], v[72:75], v[16:19]
    v_mfma_f32_16x16x32_bf16 v[20:23], v[64:67], v[72:75], v[20:23]
    v_mfma_f32_16x16x32_bf16 v[24:27], v[68:71], v[72:75], v[24:27]
    s_waitcnt vmcnt(18)
    s_barrier
    s_add_u32 m0, s59, 64512
    s_nop 0
    buffer_load_dwordx4 v1, s[4:7], s53 offen lds
    s_add_u32 s53, s53, 4096
    s_add_u32 m0, s60, 64512
    s_nop 0
    buffer_load_dwordx4 v1, s[4:7], s54 offen lds
    s_add_u32 s54, s54, 4096
    s_waitcnt lgkmcnt(0)
    ds_read_b128 v[52:55], v6 offset:17408
    ds_read_b128 v[56:59], v6 offset:18432
    ds_read_b128 v[60:63], v6 offset:19456
    ds_read_b128 v[64:67], v6 offset:20480
    ds_read_b128 v[68:71], v6 offset:21504
    ds_read_b128 v[72:75], v7 offset:17408
    v_mfma_f32_16x16x32_bf16 v[8:11], v[28:31], v[48:51], v[8:11]
    v_mfma_f32_16x16x32_bf16 v[12:15], v[32:35], v[48:51], v[12:15]
    v_mfma_f32_16x16x32_bf16 v[16:19], v[36:39], v[48:51], v[16:19]
    v_mfma_f32_16x16x32_bf16 v[20:23], v[40:43], v[48:51], v[20:23]
    v_mfma_f32_16x16x32_bf16 v[24:27], v[44:47], v[48:51], v[24:27]
    s_waitcnt vmcnt(18)
    s_barrier
    s_add_u32 m0, s59, 73728
    s_nop 0
    buffer_load_dwordx4 v1, s[4:7], s53 offen lds
    s_add_u32 s53, s53, 4096
    s_add_u32 m0, s60, 73728
    s_nop 0
    buffer_load_dwordx4 v1, s[4:7], s54 offen lds
    s_add_u32 s54, s54, 4096
    s_waitcnt lgkmcnt(0)
    ds_read_b128 v[28:31], v6 offset:26624
    ds_read_b128 v[32:35], v6 offset:27648
    ds_read_b128 v[36:39], v6 offset:28672
    ds_read_b128 v[40:43], v6 offset:29696
    ds_read_b128 v[44:47], v6 offset:30720
    ds_read_b128 v[48:51], v7 offset:26624
    v_mfma_f32_16x16x32_bf16 v[8:11], v[52:55], v[72:75], v[8:11]
    v_mfma_f32_16x16x32_bf16 v[12:15], v[56:59], v[72:75], v[12:15]
    v_mfma_f32_16x16x32_bf16 v[16:19], v[60:63], v[72:75], v[16:19]
    v_mfma_f32_16x16x32_bf16 v[20:23], v[64:67], v[72:75], v[20:23]
    v_mfma_f32_16x16x32_bf16 v[24:27], v[68:71], v[72:75], v[24:27]
    s_waitcnt vmcnt(18)
    s_barrier
    s_add_u32 m0, s59, 82944
    s_nop 0
    buffer_load_dwordx4 v1, s[4:7], s53 offen lds
    s_add_u32 s53, s53, 4096
    s_add_u32 m0, s60, 82944
    s_nop 0
    buffer_load_dwordx4 v1, s[4:7], s54 offen lds
    s_add_u32 s54, s54, 4096
    s_waitcnt lgkmcnt(0)
    ds_read_b128 v[52:55], v6 offset:35840
    ds_read_b128 v[56:59], v6 offset:36864
    ds_read_b128 v[60:63], v6 offset:37888
    ds_read_b128 v[64:67], v6 offset:38912
    ds_read_b128 v[68:71], v6 offset:39936
    ds_read_b128 v[72:75], v7 offset:35840
    v_mfma_f32_16x16x32_bf16 v[8:11], v[28:31], v[48:51], v[8:11]
    v_mfma_f32_16x16x32_bf16 v[12:15], v[32:35], v[48:51], v[12:15]
    v_mfma_f32_16x16x32_bf16 v[16:19], v[36:39], v[48:51], v[16:19]
    v_mfma_f32_16x16x32_bf16 v[20:23], v[40:43], v[48:51], v[20:23]
    v_mfma_f32_16x16x32_bf16 v[24:27], v[44:47], v[48:51], v[24:27]
    s_waitcnt vmcnt(18)
    s_barrier
    s_add_u32 m0, s59, 92160
    s_nop 0
    buffer_load_dwordx4 v1, s[4:7], s53 offen lds
    s_add_u32 s53, s53, 4096
    s_add_u32 m0, s60, 92160
    s_nop 0
    buffer_load_dwordx4 v1, s[4:7], s54 offen lds
    s_add_u32 s54, s54, 4096
    s_waitcnt lgkmcnt(0)
    ds_read_b128 v[28:31], v2 offset:0
    ds_read_b128 v[32:35], v2 offset:1024
    ds_read_b128 v[36:39], v2 offset:2048
    ds_read_b128 v[40:43], v2 offset:3072
    ds_read_b128 v[44:47], v2 offset:4096
    ds_read_b128 v[48:51], v3 offset:0
    v_mfma_f32_16x16x32_bf16 v[8:11], v[52:55], v[72:75], v[8:11]
    v_mfma_f32_16x16x32_bf16 v[12:15], v[56:59], v[72:75], v[12:15]
    v_mfma_f32_16x16x32_bf16 v[16:19], v[60:63], v[72:75], v[16:19]
    v_mfma_f32_16x16x32_bf16 v[20:23], v[64:67], v[72:75], v[20:23]
    v_mfma_f32_16x16x32_bf16 v[24:27], v[68:71], v[72:75], v[24:27]
    s_sub_u32 s50, s50, 1
    s_cmp_lg_u32 s50, 0
    s_cbranch_scc1 gloop_100
    s_waitcnt vmcnt(18)
    s_barrier
    s_add_u32 m0, s59, 101376
    s_nop 0
    buffer_load_dwordx4 v1, s[4:7], s53 offen lds
    s_add_u32 s53, s53, 4096
    s_add_u32 m0, s60, 101376
    s_nop 0
    buffer_load_dwordx4 v1, s[4:7], s54 offen lds
    s_add_u32 s54, s54, 4096
    s_waitcnt lgkmcnt(0)
    ds_read_b128 v[52:55], v2 offset:9216
    ds_read_b128 v[56:59], v2 offset:10240
    ds_read_b128 v[60:63], v2 offset:11264
    ds_read_b128 v[64:67], v2 offset:12288
    ds_read_b128 v[68:71], v2 offset:13312
    ds_read_b128 v[72:75], v3 offset:9216
    v_mfma_f32_16x16x32_bf16 v[8:11], v[28:31], v[48:51], v[8:11]
    v_mfma_f32_16x16x32_bf16 v[12:15], v[32:35], v[48:51], v[12:15]
    v_mfma_f32_16x16x32_bf16 v[16:19], v[36:39], v[48:51], v[16:19]
    v_mfma_f32_16x16x32_bf16 v[20:23], v[40:43], v[48:51], v[20:23]
    v_mfma_f32_16x16x32_bf16 v[24:27], v[44:47], v[48:51], v[24:27]
    s_waitcnt vmcnt(18)
    s_barrier
    s_add_u32 m0, s59, 0
    s_nop 0
    buffer_load_dwordx4 v1, s[4:7], s53 offen lds
    s_add_u32 s53, s53, 4096
    s_add_u32 m0, s60, 0
    s_nop 0
    buffer_load_dwordx4 v1, s[4:7], s54 offen lds
    s_add_u32 s54, s54, 4096
    s_waitcnt lgkmcnt(0)
    ds_read_b128 v[28:31], v2 offset:18432
    ds_read_b128 v[32:35], v2 offset:19456
    ds_read_b128 v[36:39], v2 offset:20480
    ds_read_b128 v[40:43], v2 offset:21504
    ds_read_b128 v[44:47], v2 offset:22528
    ds_read_b128 v[48:51], v3 offset:18432
    v_mfma_f32_16x16x32_bf16 v[8:11], v[52:55], v[72:75], v[8:11]
    v_mfma_f32_16x16x32_bf16 v[12:15], v[56:59], v[72:75], v[12:15]
    v_mfma_f32_16x16x32_bf16 v[16:19], v[60:63], v[72:75], v[16:19]
    v_mfma_f32_16x16x32_bf16 v[20:23], v[64:67], v[72:75], v[20:23]
    v_mfma_f32_16x16x32_bf16 v[24:27], v[68:71], v[72:75], v[24:27]
    s_waitcnt vmcnt(18)
    s_barrier
    s_add_u32 m0, s59, 9216
    s_nop 0
    buffer_load_dwordx4 v1, s[4:7], s53 offen lds
    s_add_u32 s53, s53, 4096
    s_add_u32 m0, s60, 9216
    s_nop 0
    buffer_load_dwordx4 v1, s[4:7], s54 offen lds
    s_add_u32 s54, s54, 4096
    s_waitcnt lgkmcnt(0)
    ds_read_b128 v[52:55], v2 offset:27648
    ds_read_b128 v[56:59], v2 offset:28672
    ds_read_b128 v[60:63], v2 offset:29696
    ds_read_b128 v[64:67], v2 offset:30720
    ds_read_b128 v[68:71], v2 offset:31744
    ds_read_b128 v[72:75], v3 offset:27648
    v_mfma_f32_16x16x32_bf16 v[8:11], v[28:31], v[48:51], v[8:11]
    v_mfma_f32_16x16x32_bf16 v[12:15], v[32:35], v[48:51], v[12:15]
    v_mfma_f32_16x16x32_bf16 v[16:19], v[36:39], v[48:51], v[16:19]
    v_mfma_f32_16x16x32_bf16 v[20:23], v[40:43], v[48:51], v[20:23]
    v_mfma_f32_16x16x32_bf16 v[24:27], v[44:47], v[48:51], v[24:27]
    s_waitcnt vmcnt(18)
    s_barrier
    s_add_u32 m0, s59, 18432
    s_nop 0
    buffer_load_dwordx4 v1, s[4:7], s53 offen lds
    s_add_u32 s53, s53, 4096
    s_add_u32 m0, s60, 18432
    s_nop 0
    buffer_load_dwordx4 v1, s[4:7], s54 offen lds
    s_add_u32 s54, s54, 4096
    s_waitcnt lgkmcnt(0)
    ds_read_b128 v[28:31], v2 offset:36864
    ds_read_b128 v[32:35], v2 offset:37888
    ds_read_b128 v[36:39], v2 offset:38912
    ds_read_b128 v[40:43], v2 offset:39936
    ds_read_b128 v[44:47], v2 offset:40960
    ds_read_b128 v[48:51], v3 offset:36864
    v_mfma_f32_16x16x32_bf16 v[8:11], v[52:55], v[72:75], v[8:11]
    v_mfma_f32_16x16x32_bf16 v[12:15], v[56:59], v[72:75], v[12:15]
    v_mfma_f32_16x16x32_bf16 v[16:19], v[60:63], v[72:75], v[16:19]
    v_mfma_f32_16x16x32_bf16 v[20:23], v[64:67], v[72:75], v[20:23]
    v_mfma_f32_16x16x32_bf16 v[24:27], v[68:71], v[72:75], v[24:27]
    s_waitcnt vmcnt(18)
    s_barrier
    s_add_u32 m0, s59, 27648
    s_nop 0
    buffer_load_dwordx4 v1, s[4:7], s53 offen lds
    s_add_u32 s53, s53, 4096
    s_add_u32 m0, s60, 27648
    s_nop 0
    buffer_load_dwordx4 v1, s[4:7], s54 offen lds
    s_add_u32 s54, s54, 4096
    s_waitcnt lgkmcnt(0)
    ds_read_b128 v[52:55], v2 offset:46080
    ds_read_b128 v[56:59], v2 offset:47104
    ds_read_b128 v[60:63], v2 offset:48128
    ds_read_b128 v[64:67], v2 offset:49152
    ds_read_b128 v[68:71], v2 offset:50176
    ds_read_b128 v[72:75], v3 offset:46080
    v_mfma_f32_16x16x32_bf16 v[8:11], v[28:31], v[48:51], v[8:11]
    v_mfma_f32_16x16x32_bf16 v[12:15], v[32:35], v[48:51], v[12:15]
    v_mfma_f32_16x16x32_bf16 v[16:19], v[36:39], v[48:51], v[16:19]
    v_mfma_f32_16x16x32_bf16 v[20:23], v[40:43], v[48:51], v[20:23]
    v_mfma_f32_16x16x32_bf16 v[24:27], v[44:47], v[48:51], v[24:27]
    s_waitcnt vmcnt(18)
    s_barrier
    s_add_u32 m0, s59, 36864
    s_nop 0
    buffer_load_dwordx4 v1, s[4:7], s53 offen lds
    s_add_u32 s53, s53, 4096
    s_add_u32 m0, s60, 36864
    s_nop 0
    buffer_load_dwordx4 v1, s[4:7], s54 offen lds
    s_add_u32 s54, s54, 4096
    s_waitcnt lgkmcnt(0)
    ds_read_b128 v[28:31], v2 offset:55296
    ds_read_b128 v[32:35], v2 offset:56320
    ds_read_b128 v[36:39], v2 offset:57344
    ds_read_b128 v[40:43], v2 offset:58368
    ds_read_b128 v[44:47], v2 offset:59392
    ds_read_b128 v[48:51], v3 offset:55296
    v_mfma_f32_16x16x32_bf16 v[8:11], v[52:55], v[72:75], v[8:11]
    v_mfma_f32_16x16x32_bf16 v[12:15], v[56:59], v[72:75], v[12:15]
    v_mfma_f32_16x16x32_bf16 v[16:19], v[60:63], v[72:75], v[16:19]
    v_mfma_f32_16x16x32_bf16 v[20:23], v[64:67], v[72:75], v[20:23]
    v_mfma_f32_16x16x32_bf16 v[24:27], v[68:71], v[72:75], v[24:27]
    s_waitcnt vmcnt(18)
    s_barrier
    s_add_u32 m0, s59, 46080
    s_nop 0
    buffer_load_dwordx4 v1, s[4:7], s53 offen lds
    s_add_u32 s53, s53, 4096
    s_add_u32 m0, s60, 46080
    s_nop 0
    buffer_load_dwordx4 v1, s[4:7], s54 offen lds
    s_add_u32 s54, s54, 4096
    s_waitcnt lgkmcnt(0)
    ds_read_b128 v[52:55], v2 offset:64512
    ds_read_b128 v[56:59], v6 offset:0
    ds_read_b128 v[60:63], v6 offset:1024
    ds_read_b128 v[64:67], v6 offset:2048
    ds_read_b128 v[68:71], v6 offset:3072
    ds_read_b128 v[72:75], v3 offset:64512
    v_mfma_f32_16x16x32_bf16 v[8:11], v[28:31], v[48:51], v[8:11]
    v_mfma_f32_16x16x32_bf16 v[12:15], v[32:35], v[48:51], v[12:15]
    v_mfma_f32_16x16x32_bf16 v[16:19], v[36:39], v[48:51], v[16:19]
    v_mfma_f32_16x16x32_bf16 v[20:23], v[40:43], v[48:51], v[20:23]
    v_mfma_f32_16x16x32_bf16 v[24:27], v[44:47], v[48:51], v[24:27]
    s_waitcnt vmcnt(18)
    s_barrier
    s_add_u32 m0, s59, 55296
    s_nop 0
    buffer_load_dwordx4 v1, s[4:7], s53 offen lds
    s_add_u32 s53, s53, 4096
    s_add_u32 m0, s60, 55296
    s_nop 0
    buffer_load_dwordx4 v1, s[4:7], s54 offen lds
    s_add_u32 s54, s54, 4096
    s_waitcnt lgkmcnt(0)
    ds_read_b128 v[28:31], v6 offset:8192
    ds_read_b128 v[32:35], v6 offset:9216
    ds_read_b128 v[36:39], v6 offset:10240
    ds_read_b128 v[40:43], v6 offset:11264
    ds_read_b128 v[44:47], v6 offset:12288
    ds_read_b128 v[48:51], v7 offset:8192
    v_mfma_f32_16x16x32_bf16 v[8:11], v[52:55], v[72:75], v[8:11]
    v_mfma_f32_16x16x32_bf16 v[12:15], v[56:59], v[72:75], v[12:15]
    v_mfma_f32_16x16x32_bf16 v[16:19], v[60:63], v[72:75], v[16:19]
    v_mfma_f32_16x16x32_bf16 v[20:23], v[64:67], v[72:75], v[20:23]
    v_mfma_f32_16x16x32_bf16 v[24:27], v[68:71], v[72:75], v[24:27]
    s_waitcnt vmcnt(18)
    s_barrier
    s_add_u32 m0, s59, 64512
    s_nop 0
    buffer_load_dwordx4 v1, s[4:7], s53 offen lds
    s_add_u32 s53, s53, 4096
    s_add_u32 m0, s60, 64512
    s_nop 0
    buffer_load_dwordx4 v1, s[4:7], s54 offen lds
    s_add_u32 s54, s54, 4096
    s_waitcnt lgkmcnt(0)
    ds_read_b128 v[52:55], v6 offset:17408
    ds_read_b128 v[56:59], v6 offset:18432
    ds_read_b128 v[60:63], v6 offset:19456
    ds_read_b128 v[64:67], v6 offset:20480
    ds_read_b128 v[68:71], v6 offset:21504
    ds_read_b128 v[72:75], v7 offset:17408
    v_mfma_f32_16x16x32_bf16 v[8:11], v[28:31], v[48:51], v[8:11]
    v_mfma_f32_16x16x32_bf16 v[12:15], v[32:35], v[48:51], v[12:15]
    v_mfma_f32_16x16x32_bf16 v[16:19], v[36:39], v[48:51], v[16:19]
    v_mfma_f32_16x16x32_bf16 v[20:23], v[40:43], v[48:51], v[20:23]
    v_mfma_f32_16x16x32_bf16 v[24:27], v[44:47], v[48:51], v[24:27]
    s_waitcnt vmcnt(18)
    s_barrier
    s_waitcnt lgkmcnt(0)
    ds_read_b128 v[28:31], v6 offset:26624
    ds_read_b128 v[32:35], v6 offset:27648
    ds_read_b128 v[36:39], v6 offset:28672
    ds_read_b128 v[40:43], v6 offset:29696
    ds_read_b128 v[44:47], v6 offset:30720
    ds_read_b128 v[48:51], v7 offset:26624
    v_mfma_f32_16x16x32_bf16 v[8:11], v[52:55], v[72:75], v[8:11]
    v_mfma_f32_16x16x32_bf16 v[12:15], v[56:59], v[72:75], v[12:15]
    v_mfma_f32_16x16x32_bf16 v[16:19], v[60:63], v[72:75], v[16:19]
    v_mfma_f32_16x16x32_bf16 v[20:23], v[64:67], v[72:75], v[20:23]
    v_mfma_f32_16x16x32_bf16 v[24:27], v[68:71], v[72:75], v[24:27]
    s_waitcnt vmcnt(16)
    s_barrier
    s_waitcnt lgkmcnt(0)
    ds_read_b128 v[52:55], v6 offset:35840
    ds_read_b128 v[56:59], v6 offset:36864
    ds_read_b128 v[60:63], v6 offset:37888
    ds_read_b128 v[64:67], v6 offset:38912
    ds_read_b128 v[68:71], v6 offset:39936
    ds_read_b128 v[72:75], v7 offset:35840
    v_mfma_f32_16x16x32_bf16 v[8:11], v[28:31], v[48:51], v[8:11]
    v_mfma_f32_16x16x32_bf16 v[12:15], v[32:35], v[48:51], v[12:15]
    v_mfma_f32_16x16x32_bf16 v[16:19], v[36:39], v[48:51], v[16:19]
    v_mfma_f32_16x16x32_bf16 v[20:23], v[40:43], v[48:51], v[20:23]
    v_mfma_f32_16x16x32_bf16 v[24:27], v[44:47], v[48:51], v[24:27]
    s_waitcnt vmcnt(14)
    s_barrier
    s_waitcnt lgkmcnt(0)
    ds_read_b128 v[28:31], v2 offset:0
    ds_read_b128 v[32:35], v2 offset:1024
    ds_read_b128 v[36:39], v2 offset:2048
    ds_read_b128 v[40:43], v2 offset:3072
    ds_read_b128 v[44:47], v2 offset:4096
    ds_read_b128 v[48:51], v3 offset:0
    v_mfma_f32_16x16x32_bf16 v[8:11], v[52:55], v[72:75], v[8:11]
    v_mfma_f32_16x16x32_bf16 v[12:15], v[56:59], v[72:75], v[12:15]
    v_mfma_f32_16x16x32_bf16 v[16:19], v[60:63], v[72:75], v[16:19]
    v_mfma_f32_16x16x32_bf16 v[20:23], v[64:67], v[72:75], v[20:23]
    v_mfma_f32_16x16x32_bf16 v[24:27], v[68:71], v[72:75], v[24:27]
    s_waitcnt vmcnt(12)
    s_barrier
    s_waitcnt lgkmcnt(0)
    ds_read_b128 v[52:55], v2 offset:9216
    ds_read_b128 v[56:59], v2 offset:10240
    ds_read_b128 v[60:63], v2 offset:11264
    ds_read_b128 v[64:67], v2 offset:12288
    ds_read_b128 v[68:71], v2 offset:13312
    ds_read_b128 v[72:75], v3 offset:9216
    v_mfma_f32_16x16x32_bf16 v[8:11], v[28:31], v[48:51], v[8:11]
    v_mfma_f32_16x16x32_bf16 v[12:15], v[32:35], v[48:51], v[12:15]
    v_mfma_f32_16x16x32_bf16 v[16:19], v[36:39], v[48:51], v[16:19]
    v_mfma_f32_16x16x32_bf16 v[20:23], v[40:43], v[48:51], v[20:23]
    v_mfma_f32_16x16x32_bf16 v[24:27], v[44:47], v[48:51], v[24:27]
    s_waitcnt vmcnt(10)
    s_barrier
    s_waitcnt lgkmcnt(0)
    ds_read_b128 v[28:31], v2 offset:18432
    ds_read_b128 v[32:35], v2 offset:19456
    ds_read_b128 v[36:39], v2 offset:20480
    ds_read_b128 v[40:43], v2 offset:21504
    ds_read_b128 v[44:47], v2 offset:22528
    ds_read_b128 v[48:51], v3 offset:18432
    v_mfma_f32_16x16x32_bf16 v[8:11], v[52:55], v[72:75], v[8:11]
    v_mfma_f32_16x16x32_bf16 v[12:15], v[56:59], v[72:75], v[12:15]
    v_mfma_f32_16x16x32_bf16 v[16:19], v[60:63], v[72:75], v[16:19]
    v_mfma_f32_16x16x32_bf16 v[20:23], v[64:67], v[72:75], v[20:23]
    v_mfma_f32_16x16x32_bf16 v[24:27], v[68:71], v[72:75], v[24:27]
    s_waitcnt vmcnt(8)
    s_barrier
    s_waitcnt lgkmcnt(0)
    ds_read_b128 v[52:55], v2 offset:27648
    ds_read_b128 v[56:59], v2 offset:28672
    ds_read_b128 v[60:63], v2 offset:29696
    ds_read_b128 v[64:67], v2 offset:30720
    ds_read_b128 v[68:71], v2 offset:31744
    ds_read_b128 v[72:75], v3 offset:27648
    v_mfma_f32_16x16x32_bf16 v[8:11], v[28:31], v[48:51], v[8:11]
    v_mfma_f32_16x16x32_bf16 v[12:15], v[32:35], v[48:51], v[12:15]
    v_mfma_f32_16x16x32_bf16 v[16:19], v[36:39], v[48:51], v[16:19]
    v_mfma_f32_16x16x32_bf16 v[20:23], v[40:43], v[48:51], v[20:23]
    v_mfma_f32_16x16x32_bf16 v[24:27], v[44:47], v[48:51], v[24:27]
    s_waitcnt vmcnt(6)
    s_barrier
    s_waitcnt lgkmcnt(0)
    ds_read_b128 v[28:31], v2 offset:36864
    ds_read_b128 v[32:35], v2 offset:37888
    ds_read_b128 v[36:39], v2 offset:38912
    ds_read_b128 v[40:43], v2 offset:39936
    ds_read_b128 v[44:47], v2 offset:40960
    ds_read_b128 v[48:51], v3 offset:36864
    v_mfma_f32_16x16x32_bf16 v[8:11], v[52:55], v[72:75], v[8:11]
    v_mfma_f32_16x16x32_bf16 v[12:15], v[56:59], v[72:75], v[12:15]
    v_mfma_f32_16x16x32_bf16 v[16:19], v[60:63], v[72:75], v[16:19]
    v_mfma_f32_16x16x32_bf16 v[20:23], v[64:67], v[72:75], v[20:23]
    v_mfma_f32_16x16x32_bf16 v[24:27], v[68:71], v[72:75], v[24:27]
    s_waitcnt vmcnt(4)
    s_barrier
    s_waitcnt lgkmcnt(0)
    ds_read_b128 v[52:55], v2 offset:46080
    ds_read_b128 v[56:59], v2 offset:47104
    ds_read_b128 v[60:63], v2 offset:48128
    ds_read_b128 v[64:67], v2 offset:49152
    ds_read_b128 v[68:71], v2 offset:50176
    ds_read_b128 v[72:75], v3 offset:46080
    v_mfma_f32_16x16x32_bf16 v[8:11], v[28:31], v[48:51], v[8:11]
    v_mfma_f32_16x16x32_bf16 v[12:15], v[32:35], v[48:51], v[12:15]
    v_mfma_f32_16x16x32_bf16 v[16:19], v[36:39], v[48:51], v[16:19]
    v_mfma_f32_16x16x32_bf16 v[20:23], v[40:43], v[48:51], v[20:23]
    v_mfma_f32_16x16x32_bf16 v[24:27], v[44:47], v[48:51], v[24:27]
    s_waitcnt vmcnt(2)
    s_barrier
    s_waitcnt lgkmcnt(0)
    ds_read_b128 v[28:31], v2 offset:55296
    ds_read_b128 v[32:35], v2 offset:56320
    ds_read_b128 v[36:39], v2 offset:57344
    ds_read_b128 v[40:43], v2 offset:58368
    ds_read_b128 v[44:47], v2 offset:59392
    ds_read_b128 v[48:51], v3 offset:55296
    v_mfma_f32_16x16x32_bf16 v[8:11], v[52:55], v[72:75], v[8:11]
    v_mfma_f32_16x16x32_bf16 v[12:15], v[56:59], v[72:75], v[12:15]
    v_mfma_f32_16x16x32_bf16 v[16:19], v[60:63], v[72:75], v[16:19]
    v_mfma_f32_16x16x32_bf16 v[20:23], v[64:67], v[72:75], v[20:23]
    v_mfma_f32_16x16x32_bf16 v[24:27], v[68:71], v[72:75], v[24:27]
    s_waitcnt vmcnt(0)
    s_barrier
    s_waitcnt lgkmcnt(0)
    ds_read_b128 v[52:55], v2 offset:64512
    ds_read_b128 v[56:59], v6 offset:0
    ds_read_b128 v[60:63], v6 offset:1024
    ds_read_b128 v[64:67], v6 offset:2048
    ds_read_b128 v[68:71], v6 offset:3072
    ds_read_b128 v[72:75], v3 offset:64512
    v_mfma_f32_16x16x32_bf16 v[8:11], v[28:31], v[48:51], v[8:11]
    v_mfma_f32_16x16x32_bf16 v[12:15], v[32:35], v[48:51], v[12:15]
    v_mfma_f32_16x16x32_bf16 v[16:19], v[36:39], v[48:51], v[16:19]
    v_mfma_f32_16x16x32_bf16 v[20:23], v[40:43], v[48:51], v[20:23]
    v_mfma_f32_16x16x32_bf16 v[24:27], v[44:47], v[48:51], v[24:27]
    s_waitcnt lgkmcnt(0)
    v_mfma_f32_16x16x32_bf16 v[8:11], v[52:55], v[72:75], v[8:11]
    v_mfma_f32_16x16x32_bf16 v[12:15], v[56:59], v[72:75], v[12:15]
    v_mfma_f32_16x16x32_bf16 v[16:19], v[60:63], v[72:75], v[16:19]
    v_mfma_f32_16x16x32_bf16 v[20:23], v[64:67], v[72:75], v[20:23]
    v_mfma_f32_16x16x32_bf16 v[24:27], v[68:71], v[72:75], v[24:27]
gbe_98:
    s_nop 7
    s_lshl_b32 s58, s67, 6
    s_lshl_b32 s59, s3, 4
    s_add_u32 s58, s58, s59
    s_mul_i32 s59, s66, 160
    s_mov_b32 s8, s16
    s_and_b32 s9, s17, 0xffff
    s_mov_b32 s10, 0x280000
    s_mov_b32 s11, 0x00020000
    s_mov_b32 s55, 0
    s_mov_b32 s12, s42
    s_and_b32 s13, s43, 0xffff
    s_mov_b32 s14, 0x10000000
    s_mov_b32 s15, 0x00020000
    s_mov_b32 s56, 110587904
    s_mul_i32 s57, s58, 1280
    s_add_u32 s57, s57, s59
    s_add_u32 s55, s55, s57
    s_add_u32 s56, s56, s57
    v_and_b32 v4, 15, v0
    v_lshrrev_b32 v5, 4, v0
    v_mul_u32_u24 v4, 1280, v4
    v_lshl_add_u32 v4, v5, 3, v4
    buffer_load_dwordx2 v[28:29], v4, s[8:11], s55 offen offset:0
    buffer_load_dwordx2 v[30:31], v4, s[8:11], s55 offen offset:32
    buffer_load_dwordx2 v[32:33], v4, s[8:11], s55 offen offset:64
    buffer_load_dwordx2 v[34:35], v4, s[8:11], s55 offen offset:96
    buffer_load_dwordx2 v[36:37], v4, s[8:11], s55 offen offset:128
    s_waitcnt vmcnt(0)
    v_cvt_pk_bf16_f32 v8, v8, v9
    v_and_b32 v9, 0xffff0000, v8
    v_lshlrev_b32 v8, 16, v8
    v_lshlrev_b32 v6, 16, v28
    v_and_b32 v7, 0xffff0000, v28
    v_add_f32 v6, v6, v8
    v_add_f32 v7, v7, v9
    v_cvt_pk_bf16_f32 v28, v6, v7
    v_cvt_pk_bf16_f32 v10, v10, v11
    v_and_b32 v11, 0xffff0000, v10
    v_lshlrev_b32 v10, 16, v10
    v_lshlrev_b32 v6, 16, v29
    v_and_b32 v7, 0xffff0000, v29
    v_add_f32 v6, v6, v10
    v_add_f32 v7, v7, v11
    v_cvt_pk_bf16_f32 v29, v6, v7
    buffer_store_dwordx2 v[28:29], v4, s[12:15], s56 offen offset:0 sc1
    v_cvt_pk_bf16_f32 v12, v12, v13
    v_and_b32 v13, 0xffff0000, v12
    v_lshlrev_b32 v12, 16, v12
    v_lshlrev_b32 v6, 16, v30
    v_and_b32 v7, 0xffff0000, v30
    v_add_f32 v6, v6, v12
    v_add_f32 v7, v7, v13
    v_cvt_pk_bf16_f32 v30, v6, v7
    v_cvt_pk_bf16_f32 v14, v14, v15
    v_and_b32 v15, 0xffff0000, v14
    v_lshlrev_b32 v14, 16, v14
    v_lshlrev_b32 v6, 16, v31
    v_and_b32 v7, 0xffff0000, v31
    v_add_f32 v6, v6, v14
    v_add_f32 v7, v7, v15
    v_cvt_pk_bf16_f32 v31, v6, v7
    buffer_store_dwordx2 v[30:31], v4, s[12:15], s56 offen offset:32 sc1
    v_cvt_pk_bf16_f32 v16, v16, v17
    v_and_b32 v17, 0xffff0000, v16
    v_lshlrev_b32 v16, 16, v16
    v_lshlrev_b32 v6, 16, v32
    v_and_b32 v7, 0xffff0000, v32
    v_add_f32 v6, v6, v16
    v_add_f32 v7, v7, v17
    v_cvt_pk_bf16_f32 v32, v6, v7
    v_cvt_pk_bf16_f32 v18, v18, v19
    v_and_b32 v19, 0xffff0000, v18
    v_lshlrev_b32 v18, 16, v18
    v_lshlrev_b32 v6, 16, v33
    v_and_b32 v7, 0xffff0000, v33
    v_add_f32 v6, v6, v18
    v_add_f32 v7, v7, v19
    v_cvt_pk_bf16_f32 v33, v6, v7
    buffer_store_dwordx2 v[32:33], v4, s[12:15], s56 offen offset:64 sc1
    v_cvt_pk_bf16_f32 v20, v20, v21
    v_and_b32 v21, 0xffff0000, v20
    v_lshlrev_b32 v20, 16, v20
    v_lshlrev_b32 v6, 16, v34
    v_and_b32 v7, 0xffff0000, v34
    v_add_f32 v6, v6, v20
    v_add_f32 v7, v7, v21
    v_cvt_pk_bf16_f32 v34, v6, v7
    v_cvt_pk_bf16_f32 v22, v22, v23
    v_and_b32 v23, 0xffff0000, v22
    v_lshlrev_b32 v22, 16, v22
    v_lshlrev_b32 v6, 16, v35
    v_and_b32 v7, 0xffff0000, v35
    v_add_f32 v6, v6, v22
    v_add_f32 v7, v7, v23
    v_cvt_pk_bf16_f32 v35, v6, v7
    buffer_store_dwordx2 v[34:35], v4, s[12:15], s56 offen offset:96 sc1
    v_cvt_pk_bf16_f32 v24, v24, v25
    v_and_b32 v25, 0xffff0000, v24
    v_lshlrev_b32 v24, 16, v24
    v_lshlrev_b32 v6, 16, v36
    v_and_b32 v7, 0xffff0000, v36
    v_add_f32 v6, v6, v24
    v_add_f32 v7, v7, v25
    v_cvt_pk_bf16_f32 v36, v6, v7
    v_cvt_pk_bf16_f32 v26, v26, v27
    v_and_b32 v27, 0xffff0000, v26
    v_lshlrev_b32 v26, 16, v26
    v_lshlrev_b32 v6, 16, v37
    v_and_b32 v7, 0xffff0000, v37
    v_add_f32 v6, v6, v26
    v_add_f32 v7, v7, v27
    v_cvt_pk_bf16_f32 v37, v6, v7
    buffer_store_dwordx2 v[36:37], v4, s[12:15], s56 offen offset:128 sc1
    s_lshl_b32 s72, s74, 7
    s_add_u32 s72, s72, 122927104
    s_waitcnt vmcnt(0)
    s_barrier
    s_cmp_lg_u32 s3, 0
    s_cbranch_scc1 sig_101
    s_mov_b64 exec, 1
    v_mov_b32 v4, 1
    v_mov_b32 v5, 0
    buffer_atomic_add v4, v5, s[4:7], s72 offen sc1
    s_mov_b64 exec, -1
sig_101:
    s_add_u32 s74, s74, 3
    s_cmp_lt_u32 s74, 14
    s_cbranch_scc1 chain_oploop
    s_branch chain_end
chain_rln:
    s_sub_u32 s73, s73, 80
    s_mov_b32 s74, 0
    s_mov_b32 s8, s42
    s_and_b32 s9, s43, 0xffff
    s_mov_b32 s10, 0x10000000
    s_mov_b32 s11, 0x00020000
chain_lnloop:
    s_lshl_b32 s72, s74, 7
    s_add_u32 s72, s72, 122927104
    v_mov_b32 v9, 0
    s_mov_b32 s66, 0
wt_102:
    s_add_u32 s66, s66, 1
    s_cmp_gt_u32 s66, 0x40000
    s_cbranch_scc1 chain_end
    buffer_load_dword v8, v9, s[4:7], s72 offen sc1
    s_waitcnt vmcnt(0)
    v_cmp_gt_u32 vcc, 16, v8
    s_cbranch_vccz wd_103
    s_sleep 64
    s_branch wt_102
wd_103:
    s_lshl_b32 s44, s74, 5
    s_lshl_b32 s46, s73, 2
    s_add_u32 s44, s44, s46
    s_add_u32 s44, s44, s3
    s_mul_i32 s12, s44, 5120
    s_add_u32 s12, s12, 110587904
    s_lshr_b32 s45, s44, 4
    s_mul_i32 s13, s45, 81920
    s_bfe_u32 s46, s44, 0x20002
    s_lshl_b32 s46, s46, 10
    s_add_u32 s13, s13, s46
    s_and_b32 s46, s44, 3
    s_lshl_b32 s46, s46, 6
    s_add_u32 s13, s13, s46
    s_add_u32 s13, s13, 113209344
    v_lshrrev_b32 v1, 4, v0
    v_and_b32 v2, 3, v0
    v_bfe_u32 v3, v0, 2, 2
    v_mul_u32_u24 v4, 1280, v1
    v_lshl_add_u32 v4, v2, 3, v4
    v_mul_u32_u24 v5, 320, v3
    v_add_u32 v4, v4, v5
    buffer_load_dwordx2 v[16:17], v4, s[8:11], s12 offen offset:0
    buffer_load_dwordx2 v[18:19], v4, s[8:11], s12 offen offset:32
    buffer_load_dwordx2 v[20:21], v4, s[8:11], s12 offen offset:64
    buffer_load_dwordx2 v[22:23], v4, s[8:11], s12 offen offset:96
    buffer_load_dwordx2 v[24:25], v4, s[8:11], s12 offen offset:128
    buffer_load_dwordx2 v[26:27], v4, s[8:11], s12 offen offset:160
    buffer_load_dwordx2 v[28:29], v4, s[8:11], s12 offen offset:192
    buffer_load_dwordx2 v[30:31], v4, s[8:11], s12 offen offset:224
    buffer_load_dwordx2 v[32:33], v4, s[8:11], s12 offen offset:256
    buffer_load_dwordx2 v[34:35], v4, s[8:11], s12 offen offset:288
    v_mul_u32_u24 v10, 20480, v3
    v_lshl_add_u32 v10, v2, 8, v10
    v_lshl_add_u32 v10, v1, 4, v10
    v_mov_b32 v4, 0
    v_mov_b32 v5, 0
    s_waitcnt vmcnt(0)
    v_lshlrev_b32 v40, 16, v16
    v_and_b32 v41, 0xffff0000, v16
    v_add_f32 v4, v4, v40
    v_add_f32 v5, v5, v41
    v_lshlrev_b32 v42, 16, v17
    v_and_b32 v43, 0xffff0000, v17
    v_add_f32 v4, v4, v42
    v_add_f32 v5, v5, v43
    v_lshlrev_b32 v44, 16, v18
    v_and_b32 v45, 0xffff0000, v18
    v_add_f32 v4, v4, v44
    v_add_f32 v5, v5, v45
    v_lshlrev_b32 v46, 16, v19
    v_and_b32 v47, 0xffff0000, v19
    v_add_f32 v4, v4, v46
    v_add_f32 v5, v5, v47
    v_lshlrev_b32 v48, 16, v20
    v_and_b32 v49, 0xffff0000, v20
    v_add_f32 v4, v4, v48
    v_add_f32 v5, v5, v49
    v_lshlrev_b32 v50, 16, v21
    v_and_b32 v51, 0xffff0000, v21
    v_add_f32 v4, v4, v50
    v_add_f32 v5, v5, v51
    v_lshlrev_b32 v52, 16, v22
    v_and_b32 v53, 0xffff0000, v22
    v_add_f32 v4, v4, v52
    v_add_f32 v5, v5, v53
    v_lshlrev_b32 v54, 16, v23
    v_and_b32 v55, 0xffff0000, v23
    v_add_f32 v4, v4, v54
    v_add_f32 v5, v5, v55
    v_lshlrev_b32 v56, 16, v24
    v_and_b32 v57, 0xffff0000, v24
    v_add_f32 v4, v4, v56
    v_add_f32 v5, v5, v57
    v_lshlrev_b32 v58, 16, v25
    v_and_b32 v59, 0xffff0000, v25
    v_add_f32 v4, v4, v58
    v_add_f32 v5, v5, v59
    v_lshlrev_b32 v60, 16, v26
    v_and_b32 v61, 0xffff0000, v26
    v_add_f32 v4, v4, v60
    v_add_f32 v5, v5, v61
    v_lshlrev_b32 v62, 16, v27
    v_and_b32 v63, 0xffff0000, v27
    v_add_f32 v4, v4, v62
    v_add_f32 v5, v5, v63
    v_lshlrev_b32 v64, 16, v28
    v_and_b32 v65, 0xffff0000, v28
    v_add_f32 v4, v4, v64
    v_add_f32 v5, v5, v65
    v_lshlrev_b32 v66, 16, v29
    v_and_b32 v67, 0xffff0000, v29
    v_add_f32 v4, v4, v66
    v_add_f32 v5, v5, v67
    v_lshlrev_b32 v68, 16, v30
    v_and_b32 v69, 0xffff0000, v30
    v_add_f32 v4, v4, v68
    v_add_f32 v5, v5, v69
    v_lshlrev_b32 v70, 16, v31
    v_and_b32 v71, 0xffff0000, v31
    v_add_f32 v4, v4, v70
    v_add_f32 v5, v5, v71
    v_lshlrev_b32 v72, 16, v32
    v_and_b32 v73, 0xffff0000, v32
    v_add_f32 v4, v4, v72
    v_add_f32 v5, v5, v73
    v_lshlrev_b32 v74, 16, v33
    v_and_b32 v75, 0xffff0000, v33
    v_add_f32 v4, v4, v74
    v_add_f32 v5, v5, v75
    v_lshlrev_b32 v76, 16, v34
    v_and_b32 v77, 0xffff0000, v34
    v_add_f32 v4, v4, v76
    v_add_f32 v5, v5, v77
    v_lshlrev_b32 v78, 16, v35
    v_and_b32 v79, 0xffff0000, v35
    v_add_f32 v4, v4, v78
    v_add_f32 v5, v5, v79
    v_add_f32 v4, v4, v5
    s_nop 1
    v_add_f32_dpp v4, v4, v4 row_ror:8 row_mask:0xf bank_mask:0xf
    s_nop 1
    v_add_f32_dpp v4, v4, v4 row_ror:4 row_mask:0xf bank_mask:0xf
    s_nop 1
    v_add_f32_dpp v4, v4, v4 row_ror:2 row_mask:0xf bank_mask:0xf
    s_nop 1
    v_add_f32_dpp v4, v4, v4 row_ror:1 row_mask:0xf bank_mask:0xf
    v_mul_f32 v4, 0x3acccccd, v4
    v_mov_b32 v8, 0
    v_mov_b32 v9, 0
    v_sub_f32 v6, v40, v4
    v_sub_f32 v7, v41, v4
    v_fmac_f32 v8, v6, v6
    v_fmac_f32 v9, v7, v7
    v_sub_f32 v6, v42, v4
    v_sub_f32 v7, v43, v4
    v_fmac_f32 v8, v6, v6
    v_fmac_f32 v9, v7, v7
    v_sub_f32 v6, v44, v4
    v_sub_f32 v7, v45, v4
    v_fmac_f32 v8, v6, v6
    v_fmac_f32 v9, v7, v7
    v_sub_f32 v6, v46, v4
    v_sub_f32 v7, v47, v4
    v_fmac_f32 v8, v6, v6
    v_fmac_f32 v9, v7, v7
    v_sub_f32 v6, v48, v4
    v_sub_f32 v7, v49, v4
    v_fmac_f32 v8, v6, v6
    v_fmac_f32 v9, v7, v7
    v_sub_f32 v6, v50, v4
    v_sub_f32 v7, v51, v4
    v_fmac_f32 v8, v6, v6
    v_fmac_f32 v9, v7, v7
    v_sub_f32 v6, v52, v4
    v_sub_f32 v7, v53, v4
    v_fmac_f32 v8, v6, v6
    v_fmac_f32 v9, v7, v7
    v_sub_f32 v6, v54, v4
    v_sub_f32 v7, v55, v4
    v_fmac_f32 v8, v6, v6
    v_fmac_f32 v9, v7, v7
    v_sub_f32 v6, v56, v4
    v_sub_f32 v7, v57, v4
    v_fmac_f32 v8, v6, v6
    v_fmac_f32 v9, v7, v7
    v_sub_f32 v6, v58, v4
    v_sub_f32 v7, v59, v4
    v_fmac_f32 v8, v6, v6
    v_fmac_f32 v9, v7, v7
    v_sub_f32 v6, v60, v4
    v_sub_f32 v7, v61, v4
    v_fmac_f32 v8, v6, v6
    v_fmac_f32 v9, v7, v7
    v_sub_f32 v6, v62, v4
    v_sub_f32 v7, v63, v4
    v_fmac_f32 v8, v6, v6
    v_fmac_f32 v9, v7, v7
    v_sub_f32 v6, v64, v4
    v_sub_f32 v7, v65, v4
    v_fmac_f32 v8, v6, v6
    v_fmac_f32 v9, v7, v7
    v_sub_f32 v6, v66, v4
    v_sub_f32 v7, v67, v4
    v_fmac_f32 v8, v6, v6
    v_fmac_f32 v9, v7, v7
    v_sub_f32 v6, v68, v4
    v_sub_f32 v7, v69, v4
    v_fmac_f32 v8, v6, v6
    v_fmac_f32 v9, v7, v7
    v_sub_f32 v6, v70, v4
    v_sub_f32 v7, v71, v4
    v_fmac_f32 v8, v6, v6
    v_fmac_f32 v9, v7, v7
    v_sub_f32 v6, v72, v4
    v_sub_f32 v7, v73, v4
    v_fmac_f32 v8, v6, v6
    v_fmac_f32 v9, v7, v7
    v_sub_f32 v6, v74, v4
    v_sub_f32 v7, v75, v4
    v_fmac_f32 v8, v6, v6
    v_fmac_f32 v9, v7, v7
    v_sub_f32 v6, v76, v4
    v_sub_f32 v7, v77, v4
    v_fmac_f32 v8, v6, v6
    v_fmac_f32 v9, v7, v7
    v_sub_f32 v6, v78, v4
    v_sub_f32 v7, v79, v4
    v_fmac_f32 v8, v6, v6
    v_fmac_f32 v9, v7, v7
    v_add_f32 v8, v8, v9
    s_nop 1
    v_add_f32_dpp v8, v8, v8 row_ror:8 row_mask:0xf bank_mask:0xf
    s_nop 1
    v_add_f32_dpp v8, v8, v8 row_ror:4 row_mask:0xf bank_mask:0xf
    s_nop 1
    v_add_f32_dpp v8, v8, v8 row_ror:2 row_mask:0xf bank_mask:0xf
    s_nop 1
    v_add_f32_dpp v8, v8, v8 row_ror:1 row_mask:0xf bank_mask:0xf
    v_mul_f32 v8, 0x3acccccd, v8
    v_cvt_pk_bf16_f32 v4, v4, v8
    v_and_b32 v8, 0xffff0000, v4
    v_lshlrev_b32 v4, 16, v4
    v_add_f32 v8, 0x3727c5ac, v8
    v_cvt_pk_bf16_f32 v8, v8, v8
    v_lshlrev_b32 v8, 16, v8
    v_sqrt_f32 v8, v8
    s_nop 0
    v_cvt_pk_bf16_f32 v8, v8, v8
    v_lshlrev_b32 v8, 16, v8
    v_rcp_f32 v8, v8
    s_nop 0
    v_sub_f32 v6, v40, v4
    v_sub_f32 v7, v41, v4
    v_cvt_pk_bf16_f32 v6, v6, v7
    v_and_b32 v7, 0xffff0000, v6
    v_lshlrev_b32 v6, 16, v6
    v_mul_f32 v6, v6, v8
    v_mul_f32 v7, v7, v8
    v_cvt_pk_bf16_f32 v16, v6, v7
    v_sub_f32 v6, v42, v4
    v_sub_f32 v7, v43, v4
    v_cvt_pk_bf16_f32 v6, v6, v7
    v_and_b32 v7, 0xffff0000, v6
    v_lshlrev_b32 v6, 16, v6
    v_mul_f32 v6, v6, v8
    v_mul_f32 v7, v7, v8
    v_cvt_pk_bf16_f32 v17, v6, v7
    v_sub_f32 v6, v44, v4
    v_sub_f32 v7, v45, v4
    v_cvt_pk_bf16_f32 v6, v6, v7
    v_and_b32 v7, 0xffff0000, v6
    v_lshlrev_b32 v6, 16, v6
    v_mul_f32 v6, v6, v8
    v_mul_f32 v7, v7, v8
    v_cvt_pk_bf16_f32 v18, v6, v7
    v_sub_f32 v6, v46, v4
    v_sub_f32 v7, v47, v4
    v_cvt_pk_bf16_f32 v6, v6, v7
    v_and_b32 v7, 0xffff0000, v6
    v_lshlrev_b32 v6, 16, v6
    v_mul_f32 v6, v6, v8
    v_mul_f32 v7, v7, v8
    v_cvt_pk_bf16_f32 v19, v6, v7
    v_sub_f32 v6, v48, v4
    v_sub_f32 v7, v49, v4
    v_cvt_pk_bf16_f32 v6, v6, v7
    v_and_b32 v7, 0xffff0000, v6
    v_lshlrev_b32 v6, 16, v6
    v_mul_f32 v6, v6, v8
    v_mul_f32 v7, v7, v8
    v_cvt_pk_bf16_f32 v20, v6, v7
    v_sub_f32 v6, v50, v4
    v_sub_f32 v7, v51, v4
    v_cvt_pk_bf16_f32 v6, v6, v7
    v_and_b32 v7, 0xffff0000, v6
    v_lshlrev_b32 v6, 16, v6
    v_mul_f32 v6, v6, v8
    v_mul_f32 v7, v7, v8
    v_cvt_pk_bf16_f32 v21, v6, v7
    v_sub_f32 v6, v52, v4
    v_sub_f32 v7, v53, v4
    v_cvt_pk_bf16_f32 v6, v6, v7
    v_and_b32 v7, 0xffff0000, v6
    v_lshlrev_b32 v6, 16, v6
    v_mul_f32 v6, v6, v8
    v_mul_f32 v7, v7, v8
    v_cvt_pk_bf16_f32 v22, v6, v7
    v_sub_f32 v6, v54, v4
    v_sub_f32 v7, v55, v4
    v_cvt_pk_bf16_f32 v6, v6, v7
    v_and_b32 v7, 0xffff0000, v6
    v_lshlrev_b32 v6, 16, v6
    v_mul_f32 v6, v6, v8
    v_mul_f32 v7, v7, v8
    v_cvt_pk_bf16_f32 v23, v6, v7
    v_sub_f32 v6, v56, v4
    v_sub_f32 v7, v57, v4
    v_cvt_pk_bf16_f32 v6, v6, v7
    v_and_b32 v7, 0xffff0000, v6
    v_lshlrev_b32 v6, 16, v6
    v_mul_f32 v6, v6, v8
    v_mul_f32 v7, v7, v8
    v_cvt_pk_bf16_f32 v24, v6, v7
    v_sub_f32 v6, v58, v4
    v_sub_f32 v7, v59, v4
    v_cvt_pk_bf16_f32 v6, v6, v7
    v_and_b32 v7, 0xffff0000, v6
    v_lshlrev_b32 v6, 16, v6
    v_mul_f32 v6, v6, v8
    v_mul_f32 v7, v7, v8
    v_cvt_pk_bf16_f32 v25, v6, v7
    v_sub_f32 v6, v60, v4
    v_sub_f32 v7, v61, v4
    v_cvt_pk_bf16_f32 v6, v6, v7
    v_and_b32 v7, 0xffff0000, v6
    v_lshlrev_b32 v6, 16, v6
    v_mul_f32 v6, v6, v8
    v_mul_f32 v7, v7, v8
    v_cvt_pk_bf16_f32 v26, v6, v7
    v_sub_f32 v6, v62, v4
    v_sub_f32 v7, v63, v4
    v_cvt_pk_bf16_f32 v6, v6, v7
    v_and_b32 v7, 0xffff0000, v6
    v_lshlrev_b32 v6, 16, v6
    v_mul_f32 v6, v6, v8
    v_mul_f32 v7, v7, v8
    v_cvt_pk_bf16_f32 v27, v6, v7
    v_sub_f32 v6, v64, v4
    v_sub_f32 v7, v65, v4
    v_cvt_pk_bf16_f32 v6, v6, v7
    v_and_b32 v7, 0xffff0000, v6
    v_lshlrev_b32 v6, 16, v6
    v_mul_f32 v6, v6, v8
    v_mul_f32 v7, v7, v8
    v_cvt_pk_bf16_f32 v28, v6, v7
    v_sub_f32 v6, v66, v4
    v_sub_f32 v7, v67, v4
    v_cvt_pk_bf16_f32 v6, v6, v7
    v_and_b32 v7, 0xffff0000, v6
    v_lshlrev_b32 v6, 16, v6
    v_mul_f32 v6, v6, v8
    v_mul_f32 v7, v7, v8
    v_cvt_pk_bf16_f32 v29, v6, v7
    v_sub_f32 v6, v68, v4
    v_sub_f32 v7, v69, v4
    v_cvt_pk_bf16_f32 v6, v6, v7
    v_and_b32 v7, 0xffff0000, v6
    v_lshlrev_b32 v6, 16, v6
    v_mul_f32 v6, v6, v8
    v_mul_f32 v7, v7, v8
    v_cvt_pk_bf16_f32 v30, v6, v7
    v_sub_f32 v6, v70, v4
    v_sub_f32 v7, v71, v4
    v_cvt_pk_bf16_f32 v6, v6, v7
    v_and_b32 v7, 0xffff0000, v6
    v_lshlrev_b32 v6, 16, v6
    v_mul_f32 v6, v6, v8
    v_mul_f32 v7, v7, v8
    v_cvt_pk_bf16_f32 v31, v6, v7
    v_sub_f32 v6, v72, v4
    v_sub_f32 v7, v73, v4
    v_cvt_pk_bf16_f32 v6, v6, v7
    v_and_b32 v7, 0xffff0000, v6
    v_lshlrev_b32 v6, 16, v6
    v_mul_f32 v6, v6, v8
    v_mul_f32 v7, v7, v8
    v_cvt_pk_bf16_f32 v32, v6, v7
    v_sub_f32 v6, v74, v4
    v_sub_f32 v7, v75, v4
    v_cvt_pk_bf16_f32 v6, v6, v7
    v_and_b32 v7, 0xffff0000, v6
    v_lshlrev_b32 v6, 16, v6
    v_mul_f32 v6, v6, v8
    v_mul_f32 v7, v7, v8
    v_cvt_pk_bf16_f32 v33, v6, v7
    v_sub_f32 v6, v76, v4
    v_sub_f32 v7, v77, v4
    v_cvt_pk_bf16_f32 v6, v6, v7
    v_and_b32 v7, 0xffff0000, v6
    v_lshlrev_b32 v6, 16, v6
    v_mul_f32 v6, v6, v8
    v_mul_f32 v7, v7, v8
    v_cvt_pk_bf16_f32 v34, v6, v7
    v_sub_f32 v6, v78, v4
    v_sub_f32 v7, v79, v4
    v_cvt_pk_bf16_f32 v6, v6, v7
    v_and_b32 v7, 0xffff0000, v6
    v_lshlrev_b32 v6, 16, v6
    v_mul_f32 v6, v6, v8
    v_mul_f32 v7, v7, v8
    v_cvt_pk_bf16_f32 v35, v6, v7
    buffer_store_dwordx4 v[16:19], v10, s[4:7], s13 offen sc1
    s_add_u32 s13, s13, 4096
    buffer_store_dwordx4 v[20:23], v10, s[4:7], s13 offen sc1
    s_add_u32 s13, s13, 4096
    buffer_store_dwordx4 v[24:27], v10, s[4:7], s13 offen sc1
    s_add_u32 s13, s13, 4096
    buffer_store_dwordx4 v[28:31], v10, s[4:7], s13 offen sc1
    s_add_u32 s13, s13, 4096
    buffer_store_dwordx4 v[32:35], v10, s[4:7], s13 offen sc1
    s_lshl_b32 s72, s74, 7
    s_add_u32 s72, s72, 122929152
    s_waitcnt vmcnt(0)
    s_barrier
    s_cmp_lg_u32 s3, 0
    s_cbranch_scc1 sig_104
    s_mov_b64 exec, 1
    v_mov_b32 v4, 1
    v_mov_b32 v5, 0
    buffer_atomic_add v4, v5, s[4:7], s72 offen sc1
    s_mov_b64 exec, -1
sig_104:
    s_add_u32 s74, s74, 1
    s_cmp_lt_u32 s74, 14
    s_cbranch_scc1 chain_lnloop
    s_branch chain_end
chain_rgu:
    s_mov_b32 s72, 122912768
    v_mov_b32 v9, 0
    s_mov_b32 s66, 0
wt_105:
    s_add_u32 s66, s66, 1
    s_cmp_gt_u32 s66, 0x40000
    s_cbranch_scc1 chain_end
    buffer_load_dword v8, v9, s[4:7], s72 offen sc1
    s_waitcnt vmcnt(0)
    v_cmp_gt_u32 vcc, 32, v8
    s_cbranch_vccz wd_106
    s_sleep 64
    s_branch wt_105
wd_106:
    s_sub_u32 s73, s73, 88
    s_mov_b32 s74, 0
chain_guloop:
    s_lshl_b32 s72, s74, 7
    s_add_u32 s72, s72, 122929152
    v_mov_b32 v9, 0
    s_mov_b32 s66, 0
wt_107:
    s_add_u32 s66, s66, 1
    s_cmp_gt_u32 s66, 0x40000
    s_cbranch_scc1 chain_end
    buffer_load_dword v8, v9, s[4:7], s72 offen sc1
    s_waitcnt vmcnt(0)
    v_cmp_gt_u32 vcc, 8, v8
    s_cbranch_vccz wd_108
    s_sleep 64
    s_branch wt_107
wd_108:
    s_mov_b32 s66, s73
    s_mov_b32 s67, s74
    s_lshl_b32 s44, s66, 2
    s_lshl_b32 s45, s67, 3
    s_and_b32 s68, s3, 1
    s_lshr_b32 s69, s3, 1
    s_lshl_b32 s51, s68, 1
    s_lshl_b32 s52, s69, 2
    s_add_u32 s46, s3, 0
    s_min_u32 s46, s46, 15
    s_lshl_b32 s59, s46, 10
    s_add_u32 s47, s44, s46
    s_cmp_ge_u32 s46, 4
    s_cselect_b32 s48, 104, 0
    s_add_u32 s47, s47, s48
    s_add_u32 s48, s45, s46
    s_sub_u32 s48, s48, 8
    s_cmp_lt_u32 s46, 8
    s_cselect_b32 s47, s47, s48
    s_mov_b32 s48, 23592960
    s_cselect_b32 s48, s48, 113209344
    s_lshr_b32 s49, s47, 2
    s_mul_i32 s49, s49, 81920
    s_and_b32 s47, s47, 3
    s_lshl_b32 s47, s47, 10
    s_add_u32 s48, s48, s49
    s_add_u32 s53, s48, s47
    s_add_u32 s46, s3, 4
    s_min_u32 s46, s46, 15
    s_lshl_b32 s60, s46, 10
    s_add_u32 s47, s44, s46
    s_cmp_ge_u32 s46, 4
    s_cselect_b32 s48, 104, 0
    s_add_u32 s47, s47, s48
    s_add_u32 s48, s45, s46
    s_sub_u32 s48, s48, 8
    s_cmp_lt_u32 s46, 8
    s_cselect_b32 s47, s47, s48
    s_mov_b32 s48, 23592960
    s_cselect_b32 s48, s48, 113209344
    s_lshr_b32 s49, s47, 2
    s_mul_i32 s49, s49, 81920
    s_and_b32 s47, s47, 3
    s_lshl_b32 s47, s47, 10
    s_add_u32 s48, s48, s49
    s_add_u32 s54, s48, s47
    s_add_u32 s46, s3, 8
    s_min_u32 s46, s46, 15
    s_lshl_b32 s61, s46, 10
    s_add_u32 s47, s44, s46
    s_cmp_ge_u32 s46, 4
    s_cselect_b32 s48, 104, 0
    s_add_u32 s47, s47, s48
    s_add_u32 s48, s45, s46
    s_sub_u32 s48, s48, 8
    s_cmp_lt_u32 s46, 8
    s_cselect_b32 s47, s47, s48
    s_mov_b32 s48, 23592960
    s_cselect_b32 s48, s48, 113209344
    s_lshr_b32 s49, s47, 2
    s_mul_i32 s49, s49, 81920
    s_and_b32 s47, s47, 3
    s_lshl_b32 s47, s47, 10
    s_add_u32 s48, s48, s49
    s_add_u32 s55, s48, s47
    s_add_u32 s46, s3, 12
    s_min_u32 s46, s46, 15
    s_lshl_b32 s62, s46, 10
    s_add_u32 s47, s44, s46
    s_cmp_ge_u32 s46, 4
    s_cselect_b32 s48, 104, 0
    s_add_u32 s47, s47, s48
    s_add_u32 s48, s45, s46
    s_sub_u32 s48, s48, 8
    s_cmp_lt_u32 s46, 8
    s_cselect_b32 s47, s47, s48
    s_mov_b32 s48, 23592960
    s_cselect_b32 s48, s48, 113209344
    s_lshr_b32 s49, s47, 2
    s_mul_i32 s49, s49, 81920
    s_and_b32 s47, s47, 3
    s_lshl_b32 s47, s47, 10
    s_add_u32 s48, s48, s49
    s_add_u32 s56, s48, s47
    v_lshlrev_b32 v1, 4, v0
    s_lshl_b32 s46, s51, 10
    v_add_u32 v2, s46, v1
    s_lshl_b32 s46, s52, 10
    s_add_u32 s46, s46, 8192
    v_add_u32 v3, s46, v1
    v_add_u32 v6, 0x10000, v2
    v_add_u32 v7, 0x10000, v3
    v_mov_b32 v8, 0
    v_mov_b32 v9, 0
    v_mov_b32 v10, 0
    v_mov_b32 v11, 0
    v_mov_b32 v12, 0
    v_mov_b32 v13, 0
    v_mov_b32 v14, 0
    v_mov_b32 v15, 0
    v_mov_b32 v16, 0
    v_mov_b32 v17, 0
    v_mov_b32 v18, 0
    v_mov_b32 v19, 0
    v_mov_b32 v20, 0
    v_mov_b32 v21, 0
    v_mov_b32 v22, 0
    v_mov_b32 v23, 0
    v_mov_b32 v24, 0
    v_mov_b32 v25, 0
    v_mov_b32 v26, 0
    v_mov_b32 v27, 0
    v_mov_b32 v28, 0
    v_mov_b32 v29, 0
    v_mov_b32 v30, 0
    v_mov_b32 v31, 0
    v_mov_b32 v32, 0
    v_mov_b32 v33, 0
    v_mov_b32 v34, 0
    v_mov_b32 v35, 0
    v_mov_b32 v36, 0
    v_mov_b32 v37, 0
    v_mov_b32 v38, 0
    v_mov_b32 v39, 0
    v_mov_b32 v40, 0
    v_mov_b32 v41, 0
    v_mov_b32 v42, 0
    v_mov_b32 v43, 0
    v_mov_b32 v44, 0
    v_mov_b32 v45, 0
    v_mov_b32 v46, 0
    v_mov_b32 v47, 0
    v_mov_b32 v48, 0
    v_mov_b32 v49, 0
    v_mov_b32 v50, 0
    v_mov_b32 v51, 0
    v_mov_b32 v52, 0
    v_mov_b32 v53, 0
    v_mov_b32 v54, 0
    v_mov_b32 v55, 0
    v_mov_b32 v56, 0
    v_mov_b32 v57, 0
    v_mov_b32 v58, 0
    v_mov_b32 v59, 0
    v_mov_b32 v60, 0
    v_mov_b32 v61, 0
    v_mov_b32 v62, 0
    v_mov_b32 v63, 0
    v_mov_b32 v64, 0
    v_mov_b32 v65, 0
    v_mov_b32 v66, 0
    v_mov_b32 v67, 0
    v_mov_b32 v68, 0
    v_mov_b32 v69, 0
    v_mov_b32 v70, 0
    v_mov_b32 v71, 0
    s_add_u32 m0, s59, 0
    s_nop 0
    buffer_load_dwordx4 v1, s[4:7], s53 offen lds
    s_add_u32 s53, s53, 4096
    s_add_u32 m0, s60, 0
    s_nop 0
    buffer_load_dwordx4 v1, s[4:7], s54 offen lds
    s_add_u32 s54, s54, 4096
    s_add_u32 m0, s61, 0
    s_nop 0
    buffer_load_dwordx4 v1, s[4:7], s55 offen lds
    s_add_u32 s55, s55, 4096
    s_add_u32 m0, s62, 0
    s_nop 0
    buffer_load_dwordx4 v1, s[4:7], s56 offen lds
    s_add_u32 s56, s56, 4096
    s_add_u32 m0, s59, 16384
    s_nop 0
    buffer_load_dwordx4 v1, s[4:7], s53 offen lds
    s_add_u32 s53, s53, 4096
    s_add_u32 m0, s60, 16384
    s_nop 0
    buffer_load_dwordx4 v1, s[4:7], s54 offen lds
    s_add_u32 s54, s54, 4096
    s_add_u32 m0, s61, 16384
    s_nop 0
    buffer_load_dwordx4 v1, s[4:7], s55 offen lds
    s_add_u32 s55, s55, 4096
    s_add_u32 m0, s62, 16384
    s_nop 0
    buffer_load_dwordx4 v1, s[4:7], s56 offen lds
    s_add_u32 s56, s56, 4096
    s_add_u32 m0, s59, 32768
    s_nop 0
    buffer_load_dwordx4 v1, s[4:7], s53 offen lds
    s_add_u32 s53, s53, 4096
    s_add_u32 m0, s60, 32768
    s_nop 0
    buffer_load_dwordx4 v1, s[4:7], s54 offen lds
    s_add_u32 s54, s54, 4096
    s_add_u32 m0, s61, 32768
    s_nop 0
    buffer_load_dwordx4 v1, s[4:7], s55 offen lds
    s_add_u32 s55, s55, 4096
    s_add_u32 m0, s62, 32768
    s_nop 0
    buffer_load_dwordx4 v1, s[4:7], s56 offen lds
    s_add_u32 s56, s56, 4096
    s_add_u32 m0, s59, 49152
    s_nop 0
    buffer_load_dwordx4 v1, s[4:7], s53 offen lds
    s_add_u32 s53, s53, 4096
    s_add_u32 m0, s60, 49152
    s_nop 0
    buffer_load_dwordx4 v1, s[4:7], s54 offen lds
    s_add_u32 s54, s54, 4096
    s_add_u32 m0, s61, 49152
    s_nop 0
    buffer_load_dwordx4 v1, s[4:7], s55 offen lds
    s_add_u32 s55, s55, 4096
    s_add_u32 m0, s62, 49152
    s_nop 0
    buffer_load_dwordx4 v1, s[4:7], s56 offen lds
    s_add_u32 s56, s56, 4096
    s_add_u32 m0, s59, 65536
    s_nop 0
    buffer_load_dwordx4 v1, s[4:7], s53 offen lds
    s_add_u32 s53, s53, 4096
    s_add_u32 m0, s60, 65536
    s_nop 0
    buffer_load_dwordx4 v1, s[4:7], s54 offen lds
    s_add_u32 s54, s54, 4096
    s_add_u32 m0, s61, 65536
    s_nop 0
    buffer_load_dwordx4 v1, s[4:7], s55 offen lds
    s_add_u32 s55, s55, 4096
    s_add_u32 m0, s62, 65536
    s_nop 0
    buffer_load_dwordx4 v1, s[4:7], s56 offen lds
    s_add_u32 s56, s56, 4096
    s_add_u32 m0, s59, 81920
    s_nop 0
    buffer_load_dwordx4 v1, s[4:7], s53 offen lds
    s_add_u32 s53, s53, 4096
    s_add_u32 m0, s60, 81920
    s_nop 0
    buffer_load_dwordx4 v1, s[4:7], s54 offen lds
    s_add_u32 s54, s54, 4096
    s_add_u32 m0, s61, 81920
    s_nop 0
    buffer_load_dwordx4 v1, s[4:7], s55 offen lds
    s_add_u32 s55, s55, 4096
    s_add_u32 m0, s62, 81920
    s_nop 0
    buffer_load_dwordx4 v1, s[4:7], s56 offen lds
    s_add_u32 s56, s56, 4096
    s_add_u32 m0, s59, 98304
    s_nop 0
    buffer_load_dwordx4 v1, s[4:7], s53 offen lds
    s_add_u32 s53, s53, 4096
    s_add_u32 m0, s60, 98304
    s_nop 0
    buffer_load_dwordx4 v1, s[4:7], s54 offen lds
    s_add_u32 s54, s54, 4096
    s_add_u32 m0, s61, 98304
    s_nop 0
    buffer_load_dwordx4 v1, s[4:7], s55 offen lds
    s_add_u32 s55, s55, 4096
    s_add_u32 m0, s62, 98304
    s_nop 0
    buffer_load_dwordx4 v1, s[4:7], s56 offen lds
    s_add_u32 s56, s56, 4096
    s_waitcnt vmcnt(24)
    s_barrier
    ds_read_b128 v[72:75], v2 offset:0
    ds_read_b128 v[76:79], v2 offset:1024
    ds_read_b128 v[80:83], v2 offset:4096
    ds_read_b128 v[84:87], v2 offset:5120
    ds_read_b128 v[88:91], v3 offset:0
    ds_read_b128 v[92:95], v3 offset:1024
    ds_read_b128 v[96:99], v3 offset:2048
    ds_read_b128 v[100:103], v3 offset:3072
    s_mov_b32 s50, 1
gloop_109:
    s_waitcnt vmcnt(20)
    s_barrier
    s_add_u32 m0, s59, 114688
    s_nop 0
    buffer_load_dwordx4 v1, s[4:7], s53 offen lds
    s_add_u32 s53, s53, 4096
    s_add_u32 m0, s60, 114688
    s_nop 0
    buffer_load_dwordx4 v1, s[4:7], s54 offen lds
    s_add_u32 s54, s54, 4096
    s_add_u32 m0, s61, 114688
    s_nop 0
    buffer_load_dwordx4 v1, s[4:7], s55 offen lds
    s_add_u32 s55, s55, 4096
    s_add_u32 m0, s62, 114688
    s_nop 0
    buffer_load_dwordx4 v1, s[4:7], s56 offen lds
    s_add_u32 s56, s56, 4096
    s_waitcnt lgkmcnt(0)
    ds_read_b128 v[104:107], v2 offset:16384
    ds_read_b128 v[108:111], v2 offset:17408
    ds_read_b128 v[112:115], v2 offset:20480
    ds_read_b128 v[116:119], v2 offset:21504
    ds_read_b128 v[120:123], v3 offset:16384
    ds_read_b128 v[124:127], v3 offset:17408
    ds_read_b128 v[128:131], v3 offset:18432
    ds_read_b128 v[132:135], v3 offset:19456
    v_mfma_f32_16x16x32_bf16 v[8:11], v[72:75], v[88:91], v[8:11]
    v_mfma_f32_16x16x32_bf16 v[12:15], v[72:75], v[92:95], v[12:15]
    v_mfma_f32_16x16x32_bf16 v[16:19], v[72:75], v[96:99], v[16:19]
    v_mfma_f32_16x16x32_bf16 v[20:23], v[72:75], v[100:103], v[20:23]
    v_mfma_f32_16x16x32_bf16 v[24:27], v[76:79], v[88:91], v[24:27]
    v_mfma_f32_16x16x32_bf16 v[28:31], v[76:79], v[92:95], v[28:31]
    v_mfma_f32_16x16x32_bf16 v[32:35], v[76:79], v[96:99], v[32:35]
    v_mfma_f32_16x16x32_bf16 v[36:39], v[76:79], v[100:103], v[36:39]
    v_mfma_f32_16x16x32_bf16 v[40:43], v[80:83], v[88:91], v[40:43]
    v_mfma_f32_16x16x32_bf16 v[44:47], v[80:83], v[92:95], v[44:47]
    v_mfma_f32_16x16x32_bf16 v[48:51], v[80:83], v[96:99], v[48:51]
    v_mfma_f32_16x16x32_bf16 v[52:55], v[80:83], v[100:103], v[52:55]
    v_mfma_f32_16x16x32_bf16 v[56:59], v[84:87], v[88:91], v[56:59]
    v_mfma_f32_16x16x32_bf16 v[60:63], v[84:87], v[92:95], v[60:63]
    v_mfma_f32_16x16x32_bf16 v[64:67], v[84:87], v[96:99], v[64:67]
    v_mfma_f32_16x16x32_bf16 v[68:71], v[84:87], v[100:103], v[68:71]
    s_waitcnt vmcnt(20)
    s_barrier
    s_add_u32 m0, s59, 0
    s_nop 0
    buffer_load_dwordx4 v1, s[4:7], s53 offen lds
    s_add_u32 s53, s53, 4096
    s_add_u32 m0, s60, 0
    s_nop 0
    buffer_load_dwordx4 v1, s[4:7], s54 offen lds
    s_add_u32 s54, s54, 4096
    s_add_u32 m0, s61, 0
    s_nop 0
    buffer_load_dwordx4 v1, s[4:7], s55 offen lds
    s_add_u32 s55, s55, 4096
    s_add_u32 m0, s62, 0
    s_nop 0
    buffer_load_dwordx4 v1, s[4:7], s56 offen lds
    s_add_u32 s56, s56, 4096
    s_waitcnt lgkmcnt(0)
    ds_read_b128 v[72:75], v2 offset:32768
    ds_read_b128 v[76:79], v2 offset:33792
    ds_read_b128 v[80:83], v2 offset:36864
    ds_read_b128 v[84:87], v2 offset:37888
    ds_read_b128 v[88:91], v3 offset:32768
    ds_read_b128 v[92:95], v3 offset:33792
    ds_read_b128 v[96:99], v3 offset:34816
    ds_read_b128 v[100:103], v3 offset:35840
    v_mfma_f32_16x16x32_bf16 v[8:11], v[104:107], v[120:123], v[8:11]
    v_mfma_f32_16x16x32_bf16 v[12:15], v[104:107], v[124:127], v[12:15]
    v_mfma_f32_16x16x32_bf16 v[16:19], v[104:107], v[128:131], v[16:19]
    v_mfma_f32_16x16x32_bf16 v[20:23], v[104:107], v[132:135], v[20:23]
    v_mfma_f32_16x16x32_bf16 v[24:27], v[108:111], v[120:123], v[24:27]
    v_mfma_f32_16x16x32_bf16 v[28:31], v[108:111], v[124:127], v[28:31]
    v_mfma_f32_16x16x32_bf16 v[32:35], v[108:111], v[128:131], v[32:35]
    v_mfma_f32_16x16x32_bf16 v[36:39], v[108:111], v[132:135], v[36:39]
    v_mfma_f32_16x16x32_bf16 v[40:43], v[112:115], v[120:123], v[40:43]
    v_mfma_f32_16x16x32_bf16 v[44:47], v[112:115], v[124:127], v[44:47]
    v_mfma_f32_16x16x32_bf16 v[48:51], v[112:115], v[128:131], v[48:51]
    v_mfma_f32_16x16x32_bf16 v[52:55], v[112:115], v[132:135], v[52:55]
    v_mfma_f32_16x16x32_bf16 v[56:59], v[116:119], v[120:123], v[56:59]
    v_mfma_f32_16x16x32_bf16 v[60:63], v[116:119], v[124:127], v[60:63]
    v_mfma_f32_16x16x32_bf16 v[64:67], v[116:119], v[128:131], v[64:67]
    v_mfma_f32_16x16x32_bf16 v[68:71], v[116:119], v[132:135], v[68:71]
    s_waitcnt vmcnt(20)
    s_barrier
    s_add_u32 m0, s59, 16384
    s_nop 0
    buffer_load_dwordx4 v1, s[4:7], s53 offen lds
    s_add_u32 s53, s53, 4096
    s_add_u32 m0, s60, 16384
    s_nop 0
    buffer_load_dwordx4 v1, s[4:7], s54 offen lds
    s_add_u32 s54, s54, 4096
    s_add_u32 m0, s61, 16384
    s_nop 0
    buffer_load_dwordx4 v1, s[4:7], s55 offen lds
    s_add_u32 s55, s55, 4096
    s_add_u32 m0, s62, 16384
    s_nop 0
    buffer_load_dwordx4 v1, s[4:7], s56 offen lds
    s_add_u32 s56, s56, 4096
    s_waitcnt lgkmcnt(0)
    ds_read_b128 v[104:107], v2 offset:49152
    ds_read_b128 v[108:111], v2 offset:50176
    ds_read_b128 v[112:115], v2 offset:53248
    ds_read_b128 v[116:119], v2 offset:54272
    ds_read_b128 v[120:123], v3 offset:49152
    ds_read_b128 v[124:127], v3 offset:50176
    ds_read_b128 v[128:131], v3 offset:51200
    ds_read_b128 v[132:135], v3 offset:52224
    v_mfma_f32_16x16x32_bf16 v[8:11], v[72:75], v[88:91], v[8:11]
    v_mfma_f32_16x16x32_bf16 v[12:15], v[72:75], v[92:95], v[12:15]
    v_mfma_f32_16x16x32_bf16 v[16:19], v[72:75], v[96:99], v[16:19]
    v_mfma_f32_16x16x32_bf16 v[20:23], v[72:75], v[100:103], v[20:23]
    v_mfma_f32_16x16x32_bf16 v[24:27], v[76:79], v[88:91], v[24:27]
    v_mfma_f32_16x16x32_bf16 v[28:31], v[76:79], v[92:95], v[28:31]
    v_mfma_f32_16x16x32_bf16 v[32:35], v[76:79], v[96:99], v[32:35]
    v_mfma_f32_16x16x32_bf16 v[36:39], v[76:79], v[100:103], v[36:39]
    v_mfma_f32_16x16x32_bf16 v[40:43], v[80:83], v[88:91], v[40:43]
    v_mfma_f32_16x16x32_bf16 v[44:47], v[80:83], v[92:95], v[44:47]
    v_mfma_f32_16x16x32_bf16 v[48:51], v[80:83], v[96:99], v[48:51]
    v_mfma_f32_16x16x32_bf16 v[52:55], v[80:83], v[100:103], v[52:55]
    v_mfma_f32_16x16x32_bf16 v[56:59], v[84:87], v[88:91], v[56:59]
    v_mfma_f32_16x16x32_bf16 v[60:63], v[84:87], v[92:95], v[60:63]
    v_mfma_f32_16x16x32_bf16 v[64:67], v[84:87], v[96:99], v[64:67]
    v_mfma_f32_16x16x32_bf16 v[68:71], v[84:87], v[100:103], v[68:71]
    s_waitcnt vmcnt(20)
    s_barrier
    s_add_u32 m0, s59, 32768
    s_nop 0
    buffer_load_dwordx4 v1, s[4:7], s53 offen lds
    s_add_u32 s53, s53, 4096
    s_add_u32 m0, s60, 32768
    s_nop 0
    buffer_load_dwordx4 v1, s[4:7], s54 offen lds
    s_add_u32 s54, s54, 4096
    s_add_u32 m0, s61, 32768
    s_nop 0
    buffer_load_dwordx4 v1, s[4:7], s55 offen lds
    s_add_u32 s55, s55, 4096
    s_add_u32 m0, s62, 32768
    s_nop 0
    buffer_load_dwordx4 v1, s[4:7], s56 offen lds
    s_add_u32 s56, s56, 4096
    s_waitcnt lgkmcnt(0)
    ds_read_b128 v[72:75], v6 offset:0
    ds_read_b128 v[76:79], v6 offset:1024
    ds_read_b128 v[80:83], v6 offset:4096
    ds_read_b128 v[84:87], v6 offset:5120
    ds_read_b128 v[88:91], v7 offset:0
    ds_read_b128 v[92:95], v7 offset:1024
    ds_read_b128 v[96:99], v7 offset:2048
    ds_read_b128 v[100:103], v7 offset:3072
    v_mfma_f32_16x16x32_bf16 v[8:11], v[104:107], v[120:123], v[8:11]
    v_mfma_f32_16x16x32_bf16 v[12:15], v[104:107], v[124:127], v[12:15]
    v_mfma_f32_16x16x32_bf16 v[16:19], v[104:107], v[128:131], v[16:19]
    v_mfma_f32_16x16x32_bf16 v[20:23], v[104:107], v[132:135], v[20:23]
    v_mfma_f32_16x16x32_bf16 v[24:27], v[108:111], v[120:123], v[24:27]
    v_mfma_f32_16x16x32_bf16 v[28:31], v[108:111], v[124:127], v[28:31]
    v_mfma_f32_16x16x32_bf16 v[32:35], v[108:111], v[128:131], v[32:35]
    v_mfma_f32_16x16x32_bf16 v[36:39], v[108:111], v[132:135], v[36:39]
    v_mfma_f32_16x16x32_bf16 v[40:43], v[112:115], v[120:123], v[40:43]
    v_mfma_f32_16x16x32_bf16 v[44:47], v[112:115], v[124:127], v[44:47]
    v_mfma_f32_16x16x32_bf16 v[48:51], v[112:115], v[128:131], v[48:51]
    v_mfma_f32_16x16x32_bf16 v[52:55], v[112:115], v[132:135], v[52:55]
    v_mfma_f32_16x16x32_bf16 v[56:59], v[116:119], v[120:123], v[56:59]
    v_mfma_f32_16x16x32_bf16 v[60:63], v[116:119], v[124:127], v[60:63]
    v_mfma_f32_16x16x32_bf16 v[64:67], v[116:119], v[128:131], v[64:67]
    v_mfma_f32_16x16x32_bf16 v[68:71], v[116:119], v[132:135], v[68:71]
    s_waitcnt vmcnt(20)
    s_barrier
    s_add_u32 m0, s59, 49152
    s_nop 0
    buffer_load_dwordx4 v1, s[4:7], s53 offen lds
    s_add_u32 s53, s53, 4096
    s_add_u32 m0, s60, 49152
    s_nop 0
    buffer_load_dwordx4 v1, s[4:7], s54 offen lds
    s_add_u32 s54, s54, 4096
    s_add_u32 m0, s61, 49152
    s_nop 0
    buffer_load_dwordx4 v1, s[4:7], s55 offen lds
    s_add_u32 s55, s55, 4096
    s_add_u32 m0, s62, 49152
    s_nop 0
    buffer_load_dwordx4 v1, s[4:7], s56 offen lds
    s_add_u32 s56, s56, 4096
    s_waitcnt lgkmcnt(0)
    ds_read_b128 v[104:107], v6 offset:16384
    ds_read_b128 v[108:111], v6 offset:17408
    ds_read_b128 v[112:115], v6 offset:20480
    ds_read_b128 v[116:119], v6 offset:21504
    ds_read_b128 v[120:123], v7 offset:16384
    ds_read_b128 v[124:127], v7 offset:17408
    ds_read_b128 v[128:131], v7 offset:18432
    ds_read_b128 v[132:135], v7 offset:19456
    v_mfma_f32_16x16x32_bf16 v[8:11], v[72:75], v[88:91], v[8:11]
    v_mfma_f32_16x16x32_bf16 v[12:15], v[72:75], v[92:95], v[12:15]
    v_mfma_f32_16x16x32_bf16 v[16:19], v[72:75], v[96:99], v[16:19]
    v_mfma_f32_16x16x32_bf16 v[20:23], v[72:75], v[100:103], v[20:23]
    v_mfma_f32_16x16x32_bf16 v[24:27], v[76:79], v[88:91], v[24:27]
    v_mfma_f32_16x16x32_bf16 v[28:31], v[76:79], v[92:95], v[28:31]
    v_mfma_f32_16x16x32_bf16 v[32:35], v[76:79], v[96:99], v[32:35]
    v_mfma_f32_16x16x32_bf16 v[36:39], v[76:79], v[100:103], v[36:39]
    v_mfma_f32_16x16x32_bf16 v[40:43], v[80:83], v[88:91], v[40:43]
    v_mfma_f32_16x16x32_bf16 v[44:47], v[80:83], v[92:95], v[44:47]
    v_mfma_f32_16x16x32_bf16 v[48:51], v[80:83], v[96:99], v[48:51]
    v_mfma_f32_16x16x32_bf16 v[52:55], v[80:83], v[100:103], v[52:55]
    v_mfma_f32_16x16x32_bf16 v[56:59], v[84:87], v[88:91], v[56:59]
    v_mfma_f32_16x16x32_bf16 v[60:63], v[84:87], v[92:95], v[60:63]
    v_mfma_f32_16x16x32_bf16 v[64:67], v[84:87], v[96:99], v[64:67]
    v_mfma_f32_16x16x32_bf16 v[68:71], v[84:87], v[100:103], v[68:71]
    s_waitcnt vmcnt(20)
    s_barrier
    s_add_u32 m0, s59, 65536
    s_nop 0
    buffer_load_dwordx4 v1, s[4:7], s53 offen lds
    s_add_u32 s53, s53, 4096
    s_add_u32 m0, s60, 65536
    s_nop 0
    buffer_load_dwordx4 v1, s[4:7], s54 offen lds
    s_add_u32 s54, s54, 4096
    s_add_u32 m0, s61, 65536
    s_nop 0
    buffer_load_dwordx4 v1, s[4:7], s55 offen lds
    s_add_u32 s55, s55, 4096
    s_add_u32 m0, s62, 65536
    s_nop 0
    buffer_load_dwordx4 v1, s[4:7], s56 offen lds
    s_add_u32 s56, s56, 4096
    s_waitcnt lgkmcnt(0)
    ds_read_b128 v[72:75], v6 offset:32768
    ds_read_b128 v[76:79], v6 offset:33792
    ds_read_b128 v[80:83], v6 offset:36864
    ds_read_b128 v[84:87], v6 offset:37888
    ds_read_b128 v[88:91], v7 offset:32768
    ds_read_b128 v[92:95], v7 offset:33792
    ds_read_b128 v[96:99], v7 offset:34816
    ds_read_b128 v[100:103], v7 offset:35840
    v_mfma_f32_16x16x32_bf16 v[8:11], v[104:107], v[120:123], v[8:11]
    v_mfma_f32_16x16x32_bf16 v[12:15], v[104:107], v[124:127], v[12:15]
    v_mfma_f32_16x16x32_bf16 v[16:19], v[104:107], v[128:131], v[16:19]
    v_mfma_f32_16x16x32_bf16 v[20:23], v[104:107], v[132:135], v[20:23]
    v_mfma_f32_16x16x32_bf16 v[24:27], v[108:111], v[120:123], v[24:27]
    v_mfma_f32_16x16x32_bf16 v[28:31], v[108:111], v[124:127], v[28:31]
    v_mfma_f32_16x16x32_bf16 v[32:35], v[108:111], v[128:131], v[32:35]
    v_mfma_f32_16x16x32_bf16 v[36:39], v[108:111], v[132:135], v[36:39]
    v_mfma_f32_16x16x32_bf16 v[40:43], v[112:115], v[120:123], v[40:43]
    v_mfma_f32_16x16x32_bf16 v[44:47], v[112:115], v[124:127], v[44:47]
    v_mfma_f32_16x16x32_bf16 v[48:51], v[112:115], v[128:131], v[48:51]
    v_mfma_f32_16x16x32_bf16 v[52:55], v[112:115], v[132:135], v[52:55]
    v_mfma_f32_16x16x32_bf16 v[56:59], v[116:119], v[120:123], v[56:59]
    v_mfma_f32_16x16x32_bf16 v[60:63], v[116:119], v[124:127], v[60:63]
    v_mfma_f32_16x16x32_bf16 v[64:67], v[116:119], v[128:131], v[64:67]
    v_mfma_f32_16x16x32_bf16 v[68:71], v[116:119], v[132:135], v[68:71]
    s_waitcnt vmcnt(20)
    s_barrier
    s_add_u32 m0, s59, 81920
    s_nop 0
    buffer_load_dwordx4 v1, s[4:7], s53 offen lds
    s_add_u32 s53, s53, 4096
    s_add_u32 m0, s60, 81920
    s_nop 0
    buffer_load_dwordx4 v1, s[4:7], s54 offen lds
    s_add_u32 s54, s54, 4096
    s_add_u32 m0, s61, 81920
    s_nop 0
    buffer_load_dwordx4 v1, s[4:7], s55 offen lds
    s_add_u32 s55, s55, 4096
    s_add_u32 m0, s62, 81920
    s_nop 0
    buffer_load_dwordx4 v1, s[4:7], s56 offen lds
    s_add_u32 s56, s56, 4096
    s_waitcnt lgkmcnt(0)
    ds_read_b128 v[104:107], v6 offset:49152
    ds_read_b128 v[108:111], v6 offset:50176
    ds_read_b128 v[112:115], v6 offset:53248
    ds_read_b128 v[116:119], v6 offset:54272
    ds_read_b128 v[120:123], v7 offset:49152
    ds_read_b128 v[124:127], v7 offset:50176
    ds_read_b128 v[128:131], v7 offset:51200
    ds_read_b128 v[132:135], v7 offset:52224
    v_mfma_f32_16x16x32_bf16 v[8:11], v[72:75], v[88:91], v[8:11]
    v_mfma_f32_16x16x32_bf16 v[12:15], v[72:75], v[92:95], v[12:15]
    v_mfma_f32_16x16x32_bf16 v[16:19], v[72:75], v[96:99], v[16:19]
    v_mfma_f32_16x16x32_bf16 v[20:23], v[72:75], v[100:103], v[20:23]
    v_mfma_f32_16x16x32_bf16 v[24:27], v[76:79], v[88:91], v[24:27]
    v_mfma_f32_16x16x32_bf16 v[28:31], v[76:79], v[92:95], v[28:31]
    v_mfma_f32_16x16x32_bf16 v[32:35], v[76:79], v[96:99], v[32:35]
    v_mfma_f32_16x16x32_bf16 v[36:39], v[76:79], v[100:103], v[36:39]
    v_mfma_f32_16x16x32_bf16 v[40:43], v[80:83], v[88:91], v[40:43]
    v_mfma_f32_16x16x32_bf16 v[44:47], v[80:83], v[92:95], v[44:47]
    v_mfma_f32_16x16x32_bf16 v[48:51], v[80:83], v[96:99], v[48:51]
    v_mfma_f32_16x16x32_bf16 v[52:55], v[80:83], v[100:103], v[52:55]
    v_mfma_f32_16x16x32_bf16 v[56:59], v[84:87], v[88:91], v[56:59]
    v_mfma_f32_16x16x32_bf16 v[60:63], v[84:87], v[92:95], v[60:63]
    v_mfma_f32_16x16x32_bf16 v[64:67], v[84:87], v[96:99], v[64:67]
    v_mfma_f32_16x16x32_bf16 v[68:71], v[84:87], v[100:103], v[68:71]
    s_waitcnt vmcnt(20)
    s_barrier
    s_add_u32 m0, s59, 98304
    s_nop 0
    buffer_load_dwordx4 v1, s[4:7], s53 offen lds
    s_add_u32 s53, s53, 4096
    s_add_u32 m0, s60, 98304
    s_nop 0
    buffer_load_dwordx4 v1, s[4:7], s54 offen lds
    s_add_u32 s54, s54, 4096
    s_add_u32 m0, s61, 98304
    s_nop 0
    buffer_load_dwordx4 v1, s[4:7], s55 offen lds
    s_add_u32 s55, s55, 4096
    s_add_u32 m0, s62, 98304
    s_nop 0
    buffer_load_dwordx4 v1, s[4:7], s56 offen lds
    s_add_u32 s56, s56, 4096
    s_waitcnt lgkmcnt(0)
    ds_read_b128 v[72:75], v2 offset:0
    ds_read_b128 v[76:79], v2 offset:1024
    ds_read_b128 v[80:83], v2 offset:4096
    ds_read_b128 v[84:87], v2 offset:5120
    ds_read_b128 v[88:91], v3 offset:0
    ds_read_b128 v[92:95], v3 offset:1024
    ds_read_b128 v[96:99], v3 offset:2048
    ds_read_b128 v[100:103], v3 offset:3072
    v_mfma_f32_16x16x32_bf16 v[8:11], v[104:107], v[120:123], v[8:11]
    v_mfma_f32_16x16x32_bf16 v[12:15], v[104:107], v[124:127], v[12:15]
    v_mfma_f32_16x16x32_bf16 v[16:19], v[104:107], v[128:131], v[16:19]
    v_mfma_f32_16x16x32_bf16 v[20:23], v[104:107], v[132:135], v[20:23]
    v_mfma_f32_16x16x32_bf16 v[24:27], v[108:111], v[120:123], v[24:27]
    v_mfma_f32_16x16x32_bf16 v[28:31], v[108:111], v[124:127], v[28:31]
    v_mfma_f32_16x16x32_bf16 v[32:35], v[108:111], v[128:131], v[32:35]
    v_mfma_f32_16x16x32_bf16 v[36:39], v[108:111], v[132:135], v[36:39]
    v_mfma_f32_16x16x32_bf16 v[40:43], v[112:115], v[120:123], v[40:43]
    v_mfma_f32_16x16x32_bf16 v[44:47], v[112:115], v[124:127], v[44:47]
    v_mfma_f32_16x16x32_bf16 v[48:51], v[112:115], v[128:131], v[48:51]
    v_mfma_f32_16x16x32_bf16 v[52:55], v[112:115], v[132:135], v[52:55]
    v_mfma_f32_16x16x32_bf16 v[56:59], v[116:119], v[120:123], v[56:59]
    v_mfma_f32_16x16x32_bf16 v[60:63], v[116:119], v[124:127], v[60:63]
    v_mfma_f32_16x16x32_bf16 v[64:67], v[116:119], v[128:131], v[64:67]
    v_mfma_f32_16x16x32_bf16 v[68:71], v[116:119], v[132:135], v[68:71]
    s_sub_u32 s50, s50, 1
    s_cmp_lg_u32 s50, 0
    s_cbranch_scc1 gloop_109
    s_waitcnt vmcnt(20)
    s_barrier
    s_add_u32 m0, s59, 114688
    s_nop 0
    buffer_load_dwordx4 v1, s[4:7], s53 offen lds
    s_add_u32 s53, s53, 4096
    s_add_u32 m0, s60, 114688
    s_nop 0
    buffer_load_dwordx4 v1, s[4:7], s54 offen lds
    s_add_u32 s54, s54, 4096
    s_add_u32 m0, s61, 114688
    s_nop 0
    buffer_load_dwordx4 v1, s[4:7], s55 offen lds
    s_add_u32 s55, s55, 4096
    s_add_u32 m0, s62, 114688
    s_nop 0
    buffer_load_dwordx4 v1, s[4:7], s56 offen lds
    s_add_u32 s56, s56, 4096
    s_waitcnt lgkmcnt(0)
    ds_read_b128 v[104:107], v2 offset:16384
    ds_read_b128 v[108:111], v2 offset:17408
    ds_read_b128 v[112:115], v2 offset:20480
    ds_read_b128 v[116:119], v2 offset:21504
    ds_read_b128 v[120:123], v3 offset:16384
    ds_read_b128 v[124:127], v3 offset:17408
    ds_read_b128 v[128:131], v3 offset:18432
    ds_read_b128 v[132:135], v3 offset:19456
    v_mfma_f32_16x16x32_bf16 v[8:11], v[72:75], v[88:91], v[8:11]
    v_mfma_f32_16x16x32_bf16 v[12:15], v[72:75], v[92:95], v[12:15]
    v_mfma_f32_16x16x32_bf16 v[16:19], v[72:75], v[96:99], v[16:19]
    v_mfma_f32_16x16x32_bf16 v[20:23], v[72:75], v[100:103], v[20:23]
    v_mfma_f32_16x16x32_bf16 v[24:27], v[76:79], v[88:91], v[24:27]
    v_mfma_f32_16x16x32_bf16 v[28:31], v[76:79], v[92:95], v[28:31]
    v_mfma_f32_16x16x32_bf16 v[32:35], v[76:79], v[96:99], v[32:35]
    v_mfma_f32_16x16x32_bf16 v[36:39], v[76:79], v[100:103], v[36:39]
    v_mfma_f32_16x16x32_bf16 v[40:43], v[80:83], v[88:91], v[40:43]
    v_mfma_f32_16x16x32_bf16 v[44:47], v[80:83], v[92:95], v[44:47]
    v_mfma_f32_16x16x32_bf16 v[48:51], v[80:83], v[96:99], v[48:51]
    v_mfma_f32_16x16x32_bf16 v[52:55], v[80:83], v[100:103], v[52:55]
    v_mfma_f32_16x16x32_bf16 v[56:59], v[84:87], v[88:91], v[56:59]
    v_mfma_f32_16x16x32_bf16 v[60:63], v[84:87], v[92:95], v[60:63]
    v_mfma_f32_16x16x32_bf16 v[64:67], v[84:87], v[96:99], v[64:67]
    v_mfma_f32_16x16x32_bf16 v[68:71], v[84:87], v[100:103], v[68:71]
    s_waitcnt vmcnt(20)
    s_barrier
    s_add_u32 m0, s59, 0
    s_nop 0
    buffer_load_dwordx4 v1, s[4:7], s53 offen lds
    s_add_u32 s53, s53, 4096
    s_add_u32 m0, s60, 0
    s_nop 0
    buffer_load_dwordx4 v1, s[4:7], s54 offen lds
    s_add_u32 s54, s54, 4096
    s_add_u32 m0, s61, 0
    s_nop 0
    buffer_load_dwordx4 v1, s[4:7], s55 offen lds
    s_add_u32 s55, s55, 4096
    s_add_u32 m0, s62, 0
    s_nop 0
    buffer_load_dwordx4 v1, s[4:7], s56 offen lds
    s_add_u32 s56, s56, 4096
    s_waitcnt lgkmcnt(0)
    ds_read_b128 v[72:75], v2 offset:32768
    ds_read_b128 v[76:79], v2 offset:33792
    ds_read_b128 v[80:83], v2 offset:36864
    ds_read_b128 v[84:87], v2 offset:37888
    ds_read_b128 v[88:91], v3 offset:32768
    ds_read_b128 v[92:95], v3 offset:33792
    ds_read_b128 v[96:99], v3 offset:34816
    ds_read_b128 v[100:103], v3 offset:35840
    v_mfma_f32_16x16x32_bf16 v[8:11], v[104:107], v[120:123], v[8:11]
    v_mfma_f32_16x16x32_bf16 v[12:15], v[104:107], v[124:127], v[12:15]
    v_mfma_f32_16x16x32_bf16 v[16:19], v[104:107], v[128:131], v[16:19]
    v_mfma_f32_16x16x32_bf16 v[20:23], v[104:107], v[132:135], v[20:23]
    v_mfma_f32_16x16x32_bf16 v[24:27], v[108:111], v[120:123], v[24:27]
    v_mfma_f32_16x16x32_bf16 v[28:31], v[108:111], v[124:127], v[28:31]
    v_mfma_f32_16x16x32_bf16 v[32:35], v[108:111], v[128:131], v[32:35]
    v_mfma_f32_16x16x32_bf16 v[36:39], v[108:111], v[132:135], v[36:39]
    v_mfma_f32_16x16x32_bf16 v[40:43], v[112:115], v[120:123], v[40:43]
    v_mfma_f32_16x16x32_bf16 v[44:47], v[112:115], v[124:127], v[44:47]
    v_mfma_f32_16x16x32_bf16 v[48:51], v[112:115], v[128:131], v[48:51]
    v_mfma_f32_16x16x32_bf16 v[52:55], v[112:115], v[132:135], v[52:55]
    v_mfma_f32_16x16x32_bf16 v[56:59], v[116:119], v[120:123], v[56:59]
    v_mfma_f32_16x16x32_bf16 v[60:63], v[116:119], v[124:127], v[60:63]
    v_mfma_f32_16x16x32_bf16 v[64:67], v[116:119], v[128:131], v[64:67]
    v_mfma_f32_16x16x32_bf16 v[68:71], v[116:119], v[132:135], v[68:71]
    s_waitcnt vmcnt(20)
    s_barrier
    s_add_u32 m0, s59, 16384
    s_nop 0
    buffer_load_dwordx4 v1, s[4:7], s53 offen lds
    s_add_u32 s53, s53, 4096
    s_add_u32 m0, s60, 16384
    s_nop 0
    buffer_load_dwordx4 v1, s[4:7], s54 offen lds
    s_add_u32 s54, s54, 4096
    s_add_u32 m0, s61, 16384
    s_nop 0
    buffer_load_dwordx4 v1, s[4:7], s55 offen lds
    s_add_u32 s55, s55, 4096
    s_add_u32 m0, s62, 16384
    s_nop 0
    buffer_load_dwordx4 v1, s[4:7], s56 offen lds
    s_add_u32 s56, s56, 4096
    s_waitcnt lgkmcnt(0)
    ds_read_b128 v[104:107], v2 offset:49152
    ds_read_b128 v[108:111], v2 offset:50176
    ds_read_b128 v[112:115], v2 offset:53248
    ds_read_b128 v[116:119], v2 offset:54272
    ds_read_b128 v[120:123], v3 offset:49152
    ds_read_b128 v[124:127], v3 offset:50176
    ds_read_b128 v[128:131], v3 offset:51200
    ds_read_b128 v[132:135], v3 offset:52224
    v_mfma_f32_16x16x32_bf16 v[8:11], v[72:75], v[88:91], v[8:11]
    v_mfma_f32_16x16x32_bf16 v[12:15], v[72:75], v[92:95], v[12:15]
    v_mfma_f32_16x16x32_bf16 v[16:19], v[72:75], v[96:99], v[16:19]
    v_mfma_f32_16x16x32_bf16 v[20:23], v[72:75], v[100:103], v[20:23]
    v_mfma_f32_16x16x32_bf16 v[24:27], v[76:79], v[88:91], v[24:27]
    v_mfma_f32_16x16x32_bf16 v[28:31], v[76:79], v[92:95], v[28:31]
    v_mfma_f32_16x16x32_bf16 v[32:35], v[76:79], v[96:99], v[32:35]
    v_mfma_f32_16x16x32_bf16 v[36:39], v[76:79], v[100:103], v[36:39]
    v_mfma_f32_16x16x32_bf16 v[40:43], v[80:83], v[88:91], v[40:43]
    v_mfma_f32_16x16x32_bf16 v[44:47], v[80:83], v[92:95], v[44:47]
    v_mfma_f32_16x16x32_bf16 v[48:51], v[80:83], v[96:99], v[48:51]
    v_mfma_f32_16x16x32_bf16 v[52:55], v[80:83], v[100:103], v[52:55]
    v_mfma_f32_16x16x32_bf16 v[56:59], v[84:87], v[88:91], v[56:59]
    v_mfma_f32_16x16x32_bf16 v[60:63], v[84:87], v[92:95], v[60:63]
    v_mfma_f32_16x16x32_bf16 v[64:67], v[84:87], v[96:99], v[64:67]
    v_mfma_f32_16x16x32_bf16 v[68:71], v[84:87], v[100:103], v[68:71]
    s_waitcnt vmcnt(20)
    s_barrier
    s_add_u32 m0, s59, 32768
    s_nop 0
    buffer_load_dwordx4 v1, s[4:7], s53 offen lds
    s_add_u32 s53, s53, 4096
    s_add_u32 m0, s60, 32768
    s_nop 0
    buffer_load_dwordx4 v1, s[4:7], s54 offen lds
    s_add_u32 s54, s54, 4096
    s_add_u32 m0, s61, 32768
    s_nop 0
    buffer_load_dwordx4 v1, s[4:7], s55 offen lds
    s_add_u32 s55, s55, 4096
    s_add_u32 m0, s62, 32768
    s_nop 0
    buffer_load_dwordx4 v1, s[4:7], s56 offen lds
    s_add_u32 s56, s56, 4096
    s_waitcnt lgkmcnt(0)
    ds_read_b128 v[72:75], v6 offset:0
    ds_read_b128 v[76:79], v6 offset:1024
    ds_read_b128 v[80:83], v6 offset:4096
    ds_read_b128 v[84:87], v6 offset:5120
    ds_read_b128 v[88:91], v7 offset:0
    ds_read_b128 v[92:95], v7 offset:1024
    ds_read_b128 v[96:99], v7 offset:2048
    ds_read_b128 v[100:103], v7 offset:3072
    v_mfma_f32_16x16x32_bf16 v[8:11], v[104:107], v[120:123], v[8:11]
    v_mfma_f32_16x16x32_bf16 v[12:15], v[104:107], v[124:127], v[12:15]
    v_mfma_f32_16x16x32_bf16 v[16:19], v[104:107], v[128:131], v[16:19]
    v_mfma_f32_16x16x32_bf16 v[20:23], v[104:107], v[132:135], v[20:23]
    v_mfma_f32_16x16x32_bf16 v[24:27], v[108:111], v[120:123], v[24:27]
    v_mfma_f32_16x16x32_bf16 v[28:31], v[108:111], v[124:127], v[28:31]
    v_mfma_f32_16x16x32_bf16 v[32:35], v[108:111], v[128:131], v[32:35]
    v_mfma_f32_16x16x32_bf16 v[36:39], v[108:111], v[132:135], v[36:39]
    v_mfma_f32_16x16x32_bf16 v[40:43], v[112:115], v[120:123], v[40:43]
    v_mfma_f32_16x16x32_bf16 v[44:47], v[112:115], v[124:127], v[44:47]
    v_mfma_f32_16x16x32_bf16 v[48:51], v[112:115], v[128:131], v[48:51]
    v_mfma_f32_16x16x32_bf16 v[52:55], v[112:115], v[132:135], v[52:55]
    v_mfma_f32_16x16x32_bf16 v[56:59], v[116:119], v[120:123], v[56:59]
    v_mfma_f32_16x16x32_bf16 v[60:63], v[116:119], v[124:127], v[60:63]
    v_mfma_f32_16x16x32_bf16 v[64:67], v[116:119], v[128:131], v[64:67]
    v_mfma_f32_16x16x32_bf16 v[68:71], v[116:119], v[132:135], v[68:71]
    s_waitcnt vmcnt(20)
    s_barrier
    s_add_u32 m0, s59, 49152
    s_nop 0
    buffer_load_dwordx4 v1, s[4:7], s53 offen lds
    s_add_u32 s53, s53, 4096
    s_add_u32 m0, s60, 49152
    s_nop 0
    buffer_load_dwordx4 v1, s[4:7], s54 offen lds
    s_add_u32 s54, s54, 4096
    s_add_u32 m0, s61, 49152
    s_nop 0
    buffer_load_dwordx4 v1, s[4:7], s55 offen lds
    s_add_u32 s55, s55, 4096
    s_add_u32 m0, s62, 49152
    s_nop 0
    buffer_load_dwordx4 v1, s[4:7], s56 offen lds
    s_add_u32 s56, s56, 4096
    s_waitcnt lgkmcnt(0)
    ds_read_b128 v[104:107], v6 offset:16384
    ds_read_b128 v[108:111], v6 offset:17408
    ds_read_b128 v[112:115], v6 offset:20480
    ds_read_b128 v[116:119], v6 offset:21504
    ds_read_b128 v[120:123], v7 offset:16384
    ds_read_b128 v[124:127], v7 offset:17408
    ds_read_b128 v[128:131], v7 offset:18432
    ds_read_b128 v[132:135], v7 offset:19456
    v_mfma_f32_16x16x32_bf16 v[8:11], v[72:75], v[88:91], v[8:11]
    v_mfma_f32_16x16x32_bf16 v[12:15], v[72:75], v[92:95], v[12:15]
    v_mfma_f32_16x16x32_bf16 v[16:19], v[72:75], v[96:99], v[16:19]
    v_mfma_f32_16x16x32_bf16 v[20:23], v[72:75], v[100:103], v[20:23]
    v_mfma_f32_16x16x32_bf16 v[24:27], v[76:79], v[88:91], v[24:27]
    v_mfma_f32_16x16x32_bf16 v[28:31], v[76:79], v[92:95], v[28:31]
    v_mfma_f32_16x16x32_bf16 v[32:35], v[76:79], v[96:99], v[32:35]
    v_mfma_f32_16x16x32_bf16 v[36:39], v[76:79], v[100:103], v[36:39]
    v_mfma_f32_16x16x32_bf16 v[40:43], v[80:83], v[88:91], v[40:43]
    v_mfma_f32_16x16x32_bf16 v[44:47], v[80:83], v[92:95], v[44:47]
    v_mfma_f32_16x16x32_bf16 v[48:51], v[80:83], v[96:99], v[48:51]
    v_mfma_f32_16x16x32_bf16 v[52:55], v[80:83], v[100:103], v[52:55]
    v_mfma_f32_16x16x32_bf16 v[56:59], v[84:87], v[88:91], v[56:59]
    v_mfma_f32_16x16x32_bf16 v[60:63], v[84:87], v[92:95], v[60:63]
    v_mfma_f32_16x16x32_bf16 v[64:67], v[84:87], v[96:99], v[64:67]
    v_mfma_f32_16x16x32_bf16 v[68:71], v[84:87], v[100:103], v[68:71]
    s_waitcnt vmcnt(20)
    s_barrier
    s_waitcnt lgkmcnt(0)
    ds_read_b128 v[72:75], v6 offset:32768
    ds_read_b128 v[76:79], v6 offset:33792
    ds_read_b128 v[80:83], v6 offset:36864
    ds_read_b128 v[84:87], v6 offset:37888
    ds_read_b128 v[88:91], v7 offset:32768
    ds_read_b128 v[92:95], v7 offset:33792
    ds_read_b128 v[96:99], v7 offset:34816
    ds_read_b128 v[100:103], v7 offset:35840
    v_mfma_f32_16x16x32_bf16 v[8:11], v[104:107], v[120:123], v[8:11]
    v_mfma_f32_16x16x32_bf16 v[12:15], v[104:107], v[124:127], v[12:15]
    v_mfma_f32_16x16x32_bf16 v[16:19], v[104:107], v[128:131], v[16:19]
    v_mfma_f32_16x16x32_bf16 v[20:23], v[104:107], v[132:135], v[20:23]
    v_mfma_f32_16x16x32_bf16 v[24:27], v[108:111], v[120:123], v[24:27]
    v_mfma_f32_16x16x32_bf16 v[28:31], v[108:111], v[124:127], v[28:31]
    v_mfma_f32_16x16x32_bf16 v[32:35], v[108:111], v[128:131], v[32:35]
    v_mfma_f32_16x16x32_bf16 v[36:39], v[108:111], v[132:135], v[36:39]
    v_mfma_f32_16x16x32_bf16 v[40:43], v[112:115], v[120:123], v[40:43]
    v_mfma_f32_16x16x32_bf16 v[44:47], v[112:115], v[124:127], v[44:47]
    v_mfma_f32_16x16x32_bf16 v[48:51], v[112:115], v[128:131], v[48:51]
    v_mfma_f32_16x16x32_bf16 v[52:55], v[112:115], v[132:135], v[52:55]
    v_mfma_f32_16x16x32_bf16 v[56:59], v[116:119], v[120:123], v[56:59]
    v_mfma_f32_16x16x32_bf16 v[60:63], v[116:119], v[124:127], v[60:63]
    v_mfma_f32_16x16x32_bf16 v[64:67], v[116:119], v[128:131], v[64:67]
    v_mfma_f32_16x16x32_bf16 v[68:71], v[116:119], v[132:135], v[68:71]
    s_waitcnt vmcnt(16)
    s_barrier
    s_waitcnt lgkmcnt(0)
    ds_read_b128 v[104:107], v6 offset:49152
    ds_read_b128 v[108:111], v6 offset:50176
    ds_read_b128 v[112:115], v6 offset:53248
    ds_read_b128 v[116:119], v6 offset:54272
    ds_read_b128 v[120:123], v7 offset:49152
    ds_read_b128 v[124:127], v7 offset:50176
    ds_read_b128 v[128:131], v7 offset:51200
    ds_read_b128 v[132:135], v7 offset:52224
    v_mfma_f32_16x16x32_bf16 v[8:11], v[72:75], v[88:91], v[8:11]
    v_mfma_f32_16x16x32_bf16 v[12:15], v[72:75], v[92:95], v[12:15]
    v_mfma_f32_16x16x32_bf16 v[16:19], v[72:75], v[96:99], v[16:19]
    v_mfma_f32_16x16x32_bf16 v[20:23], v[72:75], v[100:103], v[20:23]
    v_mfma_f32_16x16x32_bf16 v[24:27], v[76:79], v[88:91], v[24:27]
    v_mfma_f32_16x16x32_bf16 v[28:31], v[76:79], v[92:95], v[28:31]
    v_mfma_f32_16x16x32_bf16 v[32:35], v[76:79], v[96:99], v[32:35]
    v_mfma_f32_16x16x32_bf16 v[36:39], v[76:79], v[100:103], v[36:39]
    v_mfma_f32_16x16x32_bf16 v[40:43], v[80:83], v[88:91], v[40:43]
    v_mfma_f32_16x16x32_bf16 v[44:47], v[80:83], v[92:95], v[44:47]
    v_mfma_f32_16x16x32_bf16 v[48:51], v[80:83], v[96:99], v[48:51]
    v_mfma_f32_16x16x32_bf16 v[52:55], v[80:83], v[100:103], v[52:55]
    v_mfma_f32_16x16x32_bf16 v[56:59], v[84:87], v[88:91], v[56:59]
    v_mfma_f32_16x16x32_bf16 v[60:63], v[84:87], v[92:95], v[60:63]
    v_mfma_f32_16x16x32_bf16 v[64:67], v[84:87], v[96:99], v[64:67]
    v_mfma_f32_16x16x32_bf16 v[68:71], v[84:87], v[100:103], v[68:71]
    s_waitcnt vmcnt(12)
    s_barrier
    s_waitcnt lgkmcnt(0)
    ds_read_b128 v[72:75], v2 offset:0
    ds_read_b128 v[76:79], v2 offset:1024
    ds_read_b128 v[80:83], v2 offset:4096
    ds_read_b128 v[84:87], v2 offset:5120
    ds_read_b128 v[88:91], v3 offset:0
    ds_read_b128 v[92:95], v3 offset:1024
    ds_read_b128 v[96:99], v3 offset:2048
    ds_read_b128 v[100:103], v3 offset:3072
    v_mfma_f32_16x16x32_bf16 v[8:11], v[104:107], v[120:123], v[8:11]
    v_mfma_f32_16x16x32_bf16 v[12:15], v[104:107], v[124:127], v[12:15]
    v_mfma_f32_16x16x32_bf16 v[16:19], v[104:107], v[128:131], v[16:19]
    v_mfma_f32_16x16x32_bf16 v[20:23], v[104:107], v[132:135], v[20:23]
    v_mfma_f32_16x16x32_bf16 v[24:27], v[108:111], v[120:123], v[24:27]
    v_mfma_f32_16x16x32_bf16 v[28:31], v[108:111], v[124:127], v[28:31]
    v_mfma_f32_16x16x32_bf16 v[32:35], v[108:111], v[128:131], v[32:35]
    v_mfma_f32_16x16x32_bf16 v[36:39], v[108:111], v[132:135], v[36:39]
    v_mfma_f32_16x16x32_bf16 v[40:43], v[112:115], v[120:123], v[40:43]
    v_mfma_f32_16x16x32_bf16 v[44:47], v[112:115], v[124:127], v[44:47]
    v_mfma_f32_16x16x32_bf16 v[48:51], v[112:115], v[128:131], v[48:51]
    v_mfma_f32_16x16x32_bf16 v[52:55], v[112:115], v[132:135], v[52:55]
    v_mfma_f32_16x16x32_bf16 v[56:59], v[116:119], v[120:123], v[56:59]
    v_mfma_f32_16x16x32_bf16 v[60:63], v[116:119], v[124:127], v[60:63]
    v_mfma_f32_16x16x32_bf16 v[64:67], v[116:119], v[128:131], v[64:67]
    v_mfma_f32_16x16x32_bf16 v[68:71], v[116:119], v[132:135], v[68:71]
    s_waitcnt vmcnt(8)
    s_barrier
    s_waitcnt lgkmcnt(0)
    ds_read_b128 v[104:107], v2 offset:16384
    ds_read_b128 v[108:111], v2 offset:17408
    ds_read_b128 v[112:115], v2 offset:20480
    ds_read_b128 v[116:119], v2 offset:21504
    ds_read_b128 v[120:123], v3 offset:16384
    ds_read_b128 v[124:127], v3 offset:17408
    ds_read_b128 v[128:131], v3 offset:18432
    ds_read_b128 v[132:135], v3 offset:19456
    v_mfma_f32_16x16x32_bf16 v[8:11], v[72:75], v[88:91], v[8:11]
    v_mfma_f32_16x16x32_bf16 v[12:15], v[72:75], v[92:95], v[12:15]
    v_mfma_f32_16x16x32_bf16 v[16:19], v[72:75], v[96:99], v[16:19]
    v_mfma_f32_16x16x32_bf16 v[20:23], v[72:75], v[100:103], v[20:23]
    v_mfma_f32_16x16x32_bf16 v[24:27], v[76:79], v[88:91], v[24:27]
    v_mfma_f32_16x16x32_bf16 v[28:31], v[76:79], v[92:95], v[28:31]
    v_mfma_f32_16x16x32_bf16 v[32:35], v[76:79], v[96:99], v[32:35]
    v_mfma_f32_16x16x32_bf16 v[36:39], v[76:79], v[100:103], v[36:39]
    v_mfma_f32_16x16x32_bf16 v[40:43], v[80:83], v[88:91], v[40:43]
    v_mfma_f32_16x16x32_bf16 v[44:47], v[80:83], v[92:95], v[44:47]
    v_mfma_f32_16x16x32_bf16 v[48:51], v[80:83], v[96:99], v[48:51]
    v_mfma_f32_16x16x32_bf16 v[52:55], v[80:83], v[100:103], v[52:55]
    v_mfma_f32_16x16x32_bf16 v[56:59], v[84:87], v[88:91], v[56:59]
    v_mfma_f32_16x16x32_bf16 v[60:63], v[84:87], v[92:95], v[60:63]
    v_mfma_f32_16x16x32_bf16 v[64:67], v[84:87], v[96:99], v[64:67]
    v_mfma_f32_16x16x32_bf16 v[68:71], v[84:87], v[100:103], v[68:71]
    s_waitcnt vmcnt(4)
    s_barrier
    s_waitcnt lgkmcnt(0)
    ds_read_b128 v[72:75], v2 offset:32768
    ds_read_b128 v[76:79], v2 offset:33792
    ds_read_b128 v[80:83], v2 offset:36864
    ds_read_b128 v[84:87], v2 offset:37888
    ds_read_b128 v[88:91], v3 offset:32768
    ds_read_b128 v[92:95], v3 offset:33792
    ds_read_b128 v[96:99], v3 offset:34816
    ds_read_b128 v[100:103], v3 offset:35840
    v_mfma_f32_16x16x32_bf16 v[8:11], v[104:107], v[120:123], v[8:11]
    v_mfma_f32_16x16x32_bf16 v[12:15], v[104:107], v[124:127], v[12:15]
    v_mfma_f32_16x16x32_bf16 v[16:19], v[104:107], v[128:131], v[16:19]
    v_mfma_f32_16x16x32_bf16 v[20:23], v[104:107], v[132:135], v[20:23]
    v_mfma_f32_16x16x32_bf16 v[24:27], v[108:111], v[120:123], v[24:27]
    v_mfma_f32_16x16x32_bf16 v[28:31], v[108:111], v[124:127], v[28:31]
    v_mfma_f32_16x16x32_bf16 v[32:35], v[108:111], v[128:131], v[32:35]
    v_mfma_f32_16x16x32_bf16 v[36:39], v[108:111], v[132:135], v[36:39]
    v_mfma_f32_16x16x32_bf16 v[40:43], v[112:115], v[120:123], v[40:43]
    v_mfma_f32_16x16x32_bf16 v[44:47], v[112:115], v[124:127], v[44:47]
    v_mfma_f32_16x16x32_bf16 v[48:51], v[112:115], v[128:131], v[48:51]
    v_mfma_f32_16x16x32_bf16 v[52:55], v[112:115], v[132:135], v[52:55]
    v_mfma_f32_16x16x32_bf16 v[56:59], v[116:119], v[120:123], v[56:59]
    v_mfma_f32_16x16x32_bf16 v[60:63], v[116:119], v[124:127], v[60:63]
    v_mfma_f32_16x16x32_bf16 v[64:67], v[116:119], v[128:131], v[64:67]
    v_mfma_f32_16x16x32_bf16 v[68:71], v[116:119], v[132:135], v[68:71]
    s_waitcnt vmcnt(0)
    s_barrier
    s_waitcnt lgkmcnt(0)
    ds_read_b128 v[104:107], v2 offset:49152
    ds_read_b128 v[108:111], v2 offset:50176
    ds_read_b128 v[112:115], v2 offset:53248
    ds_read_b128 v[116:119], v2 offset:54272
    ds_read_b128 v[120:123], v3 offset:49152
    ds_read_b128 v[124:127], v3 offset:50176
    ds_read_b128 v[128:131], v3 offset:51200
    ds_read_b128 v[132:135], v3 offset:52224
    v_mfma_f32_16x16x32_bf16 v[8:11], v[72:75], v[88:91], v[8:11]
    v_mfma_f32_16x16x32_bf16 v[12:15], v[72:75], v[92:95], v[12:15]
    v_mfma_f32_16x16x32_bf16 v[16:19], v[72:75], v[96:99], v[16:19]
    v_mfma_f32_16x16x32_bf16 v[20:23], v[72:75], v[100:103], v[20:23]
    v_mfma_f32_16x16x32_bf16 v[24:27], v[76:79], v[88:91], v[24:27]
    v_mfma_f32_16x16x32_bf16 v[28:31], v[76:79], v[92:95], v[28:31]
    v_mfma_f32_16x16x32_bf16 v[32:35], v[76:79], v[96:99], v[32:35]
    v_mfma_f32_16x16x32_bf16 v[36:39], v[76:79], v[100:103], v[36:39]
    v_mfma_f32_16x16x32_bf16 v[40:43], v[80:83], v[88:91], v[40:43]
    v_mfma_f32_16x16x32_bf16 v[44:47], v[80:83], v[92:95], v[44:47]
    v_mfma_f32_16x16x32_bf16 v[48:51], v[80:83], v[96:99], v[48:51]
    v_mfma_f32_16x16x32_bf16 v[52:55], v[80:83], v[100:103], v[52:55]
    v_mfma_f32_16x16x32_bf16 v[56:59], v[84:87], v[88:91], v[56:59]
    v_mfma_f32_16x16x32_bf16 v[60:63], v[84:87], v[92:95], v[60:63]
    v_mfma_f32_16x16x32_bf16 v[64:67], v[84:87], v[96:99], v[64:67]
    v_mfma_f32_16x16x32_bf16 v[68:71], v[84:87], v[100:103], v[68:71]
    s_waitcnt lgkmcnt(0)
    v_mfma_f32_16x16x32_bf16 v[8:11], v[104:107], v[120:123], v[8:11]
    v_mfma_f32_16x16x32_bf16 v[12:15], v[104:107], v[124:127], v[12:15]
    v_mfma_f32_16x16x32_bf16 v[16:19], v[104:107], v[128:131], v[16:19]
    v_mfma_f32_16x16x32_bf16 v[20:23], v[104:107], v[132:135], v[20:23]
    v_mfma_f32_16x16x32_bf16 v[24:27], v[108:111], v[120:123], v[24:27]
    v_mfma_f32_16x16x32_bf16 v[28:31], v[108:111], v[124:127], v[28:31]
    v_mfma_f32_16x16x32_bf16 v[32:35], v[108:111], v[128:131], v[32:35]
    v_mfma_f32_16x16x32_bf16 v[36:39], v[108:111], v[132:135], v[36:39]
    v_mfma_f32_16x16x32_bf16 v[40:43], v[112:115], v[120:123], v[40:43]
    v_mfma_f32_16x16x32_bf16 v[44:47], v[112:115], v[124:127], v[44:47]
    v_mfma_f32_16x16x32_bf16 v[48:51], v[112:115], v[128:131], v[48:51]
    v_mfma_f32_16x16x32_bf16 v[52:55], v[112:115], v[132:135], v[52:55]
    v_mfma_f32_16x16x32_bf16 v[56:59], v[116:119], v[120:123], v[56:59]
    v_mfma_f32_16x16x32_bf16 v[60:63], v[116:119], v[124:127], v[60:63]
    v_mfma_f32_16x16x32_bf16 v[64:67], v[116:119], v[128:131], v[64:67]
    v_mfma_f32_16x16x32_bf16 v[68:71], v[116:119], v[132:135], v[68:71]
    s_nop 7
    s_lshl_b32 s55, s67, 1
    s_add_u32 s55, s55, s69
    s_mul_i32 s55, s55, 54
    s_lshl_b32 s56, s66, 1
    s_add_u32 s55, s55, s56
    s_add_u32 s55, s55, s68
    s_lshl_b32 s55, s55, 12
    s_add_u32 s55, s55, 115830784
    v_lshlrev_b32 v1, 4, v0
    v_cvt_pk_bf16_f32 v4, v8, v9
    v_cvt_pk_bf16_f32 v5, v40, v41
    v_lshlrev_b32 v6, 16, v4
    v_and_b32 v7, 0xffff0000, v4
    v_lshlrev_b32 v4, 16, v5
    v_and_b32 v5, 0xffff0000, v5
    v_max_f32 v6, 0, v6
    v_max_f32 v7, 0, v7
    v_mul_f32 v6, v6, v4
    v_mul_f32 v7, v7, v5
    v_cvt_pk_bf16_f32 v72, v6, v7
    v_cvt_pk_bf16_f32 v4, v10, v11
    v_cvt_pk_bf16_f32 v5, v42, v43
    v_lshlrev_b32 v6, 16, v4
    v_and_b32 v7, 0xffff0000, v4
    v_lshlrev_b32 v4, 16, v5
    v_and_b32 v5, 0xffff0000, v5
    v_max_f32 v6, 0, v6
    v_max_f32 v7, 0, v7
    v_mul_f32 v6, v6, v4
    v_mul_f32 v7, v7, v5
    v_cvt_pk_bf16_f32 v73, v6, v7
    v_cvt_pk_bf16_f32 v4, v24, v25
    v_cvt_pk_bf16_f32 v5, v56, v57
    v_lshlrev_b32 v6, 16, v4
    v_and_b32 v7, 0xffff0000, v4
    v_lshlrev_b32 v4, 16, v5
    v_and_b32 v5, 0xffff0000, v5
    v_max_f32 v6, 0, v6
    v_max_f32 v7, 0, v7
    v_mul_f32 v6, v6, v4
    v_mul_f32 v7, v7, v5
    v_cvt_pk_bf16_f32 v74, v6, v7
    v_cvt_pk_bf16_f32 v4, v26, v27
    v_cvt_pk_bf16_f32 v5, v58, v59
    v_lshlrev_b32 v6, 16, v4
    v_and_b32 v7, 0xffff0000, v4
    v_lshlrev_b32 v4, 16, v5
    v_and_b32 v5, 0xffff0000, v5
    v_max_f32 v6, 0, v6
    v_max_f32 v7, 0, v7
    v_mul_f32 v6, v6, v4
    v_mul_f32 v7, v7, v5
    v_cvt_pk_bf16_f32 v75, v6, v7
    buffer_store_dwordx4 v[72:75], v1, s[4:7], s55 offen offset:0 sc1
    v_cvt_pk_bf16_f32 v4, v12, v13
    v_cvt_pk_bf16_f32 v5, v44, v45
    v_lshlrev_b32 v6, 16, v4
    v_and_b32 v7, 0xffff0000, v4
    v_lshlrev_b32 v4, 16, v5
    v_and_b32 v5, 0xffff0000, v5
    v_max_f32 v6, 0, v6
    v_max_f32 v7, 0, v7
    v_mul_f32 v6, v6, v4
    v_mul_f32 v7, v7, v5
    v_cvt_pk_bf16_f32 v76, v6, v7
    v_cvt_pk_bf16_f32 v4, v14, v15
    v_cvt_pk_bf16_f32 v5, v46, v47
    v_lshlrev_b32 v6, 16, v4
    v_and_b32 v7, 0xffff0000, v4
    v_lshlrev_b32 v4, 16, v5
    v_and_b32 v5, 0xffff0000, v5
    v_max_f32 v6, 0, v6
    v_max_f32 v7, 0, v7
    v_mul_f32 v6, v6, v4
    v_mul_f32 v7, v7, v5
    v_cvt_pk_bf16_f32 v77, v6, v7
    v_cvt_pk_bf16_f32 v4, v28, v29
    v_cvt_pk_bf16_f32 v5, v60, v61
    v_lshlrev_b32 v6, 16, v4
    v_and_b32 v7, 0xffff0000, v4
    v_lshlrev_b32 v4, 16, v5
    v_and_b32 v5, 0xffff0000, v5
    v_max_f32 v6, 0, v6
    v_max_f32 v7, 0, v7
    v_mul_f32 v6, v6, v4
    v_mul_f32 v7, v7, v5
    v_cvt_pk_bf16_f32 v78, v6, v7
    v_cvt_pk_bf16_f32 v4, v30, v31
    v_cvt_pk_bf16_f32 v5, v62, v63
    v_lshlrev_b32 v6, 16, v4
    v_and_b32 v7, 0xffff0000, v4
    v_lshlrev_b32 v4, 16, v5
    v_and_b32 v5, 0xffff0000, v5
    v_max_f32 v6, 0, v6
    v_max_f32 v7, 0, v7
    v_mul_f32 v6, v6, v4
    v_mul_f32 v7, v7, v5
    v_cvt_pk_bf16_f32 v79, v6, v7
    buffer_store_dwordx4 v[76:79], v1, s[4:7], s55 offen offset:1024 sc1
    v_cvt_pk_bf16_f32 v4, v16, v17
    v_cvt_pk_bf16_f32 v5, v48, v49
    v_lshlrev_b32 v6, 16, v4
    v_and_b32 v7, 0xffff0000, v4
    v_lshlrev_b32 v4, 16, v5
    v_and_b32 v5, 0xffff0000, v5
    v_max_f32 v6, 0, v6
    v_max_f32 v7, 0, v7
    v_mul_f32 v6, v6, v4
    v_mul_f32 v7, v7, v5
    v_cvt_pk_bf16_f32 v80, v6, v7
    v_cvt_pk_bf16_f32 v4, v18, v19
    v_cvt_pk_bf16_f32 v5, v50, v51
    v_lshlrev_b32 v6, 16, v4
    v_and_b32 v7, 0xffff0000, v4
    v_lshlrev_b32 v4, 16, v5
    v_and_b32 v5, 0xffff0000, v5
    v_max_f32 v6, 0, v6
    v_max_f32 v7, 0, v7
    v_mul_f32 v6, v6, v4
    v_mul_f32 v7, v7, v5
    v_cvt_pk_bf16_f32 v81, v6, v7
    v_cvt_pk_bf16_f32 v4, v32, v33
    v_cvt_pk_bf16_f32 v5, v64, v65
    v_lshlrev_b32 v6, 16, v4
    v_and_b32 v7, 0xffff0000, v4
    v_lshlrev_b32 v4, 16, v5
    v_and_b32 v5, 0xffff0000, v5
    v_max_f32 v6, 0, v6
    v_max_f32 v7, 0, v7
    v_mul_f32 v6, v6, v4
    v_mul_f32 v7, v7, v5
    v_cvt_pk_bf16_f32 v82, v6, v7
    v_cvt_pk_bf16_f32 v4, v34, v35
    v_cvt_pk_bf16_f32 v5, v66, v67
    v_lshlrev_b32 v6, 16, v4
    v_and_b32 v7, 0xffff0000, v4
    v_lshlrev_b32 v4, 16, v5
    v_and_b32 v5, 0xffff0000, v5
    v_max_f32 v6, 0, v6
    v_max_f32 v7, 0, v7
    v_mul_f32 v6, v6, v4
    v_mul_f32 v7, v7, v5
    v_cvt_pk_bf16_f32 v83, v6, v7
    buffer_store_dwordx4 v[80:83], v1, s[4:7], s55 offen offset:2048 sc1
    v_cvt_pk_bf16_f32 v4, v20, v21
    v_cvt_pk_bf16_f32 v5, v52, v53
    v_lshlrev_b32 v6, 16, v4
    v_and_b32 v7, 0xffff0000, v4
    v_lshlrev_b32 v4, 16, v5
    v_and_b32 v5, 0xffff0000, v5
    v_max_f32 v6, 0, v6
    v_max_f32 v7, 0, v7
    v_mul_f32 v6, v6, v4
    v_mul_f32 v7, v7, v5
    v_cvt_pk_bf16_f32 v84, v6, v7
    v_cvt_pk_bf16_f32 v4, v22, v23
    v_cvt_pk_bf16_f32 v5, v54, v55
    v_lshlrev_b32 v6, 16, v4
    v_and_b32 v7, 0xffff0000, v4
    v_lshlrev_b32 v4, 16, v5
    v_and_b32 v5, 0xffff0000, v5
    v_max_f32 v6, 0, v6
    v_max_f32 v7, 0, v7
    v_mul_f32 v6, v6, v4
    v_mul_f32 v7, v7, v5
    v_cvt_pk_bf16_f32 v85, v6, v7
    v_cvt_pk_bf16_f32 v4, v36, v37
    v_cvt_pk_bf16_f32 v5, v68, v69
    v_lshlrev_b32 v6, 16, v4
    v_and_b32 v7, 0xffff0000, v4
    v_lshlrev_b32 v4, 16, v5
    v_and_b32 v5, 0xffff0000, v5
    v_max_f32 v6, 0, v6
    v_max_f32 v7, 0, v7
    v_mul_f32 v6, v6, v4
    v_mul_f32 v7, v7, v5
    v_cvt_pk_bf16_f32 v86, v6, v7
    v_cvt_pk_bf16_f32 v4, v38, v39
    v_cvt_pk_bf16_f32 v5, v70, v71
    v_lshlrev_b32 v6, 16, v4
    v_and_b32 v7, 0xffff0000, v4
    v_lshlrev_b32 v4, 16, v5
    v_and_b32 v5, 0xffff0000, v5
    v_max_f32 v6, 0, v6
    v_max_f32 v7, 0, v7
    v_mul_f32 v6, v6, v4
    v_mul_f32 v7, v7, v5
    v_cvt_pk_bf16_f32 v87, v6, v7
    buffer_store_dwordx4 v[84:87], v1, s[4:7], s55 offen offset:3072 sc1
    s_lshl_b32 s72, s74, 7
    s_add_u32 s72, s72, 122931200
    s_waitcnt vmcnt(0)
    s_barrier
    s_cmp_lg_u32 s3, 0
    s_cbranch_scc1 sig_110
    s_mov_b64 exec, 1
    v_mov_b32 v4, 1
    v_mov_b32 v5, 0
    buffer_atomic_add v4, v5, s[4:7], s72 offen sc1
    s_mov_b64 exec, -1
sig_110:
    s_add_u32 s74, s74, 1
    s_cmp_lt_u32 s74, 14
    s_cbranch_scc1 chain_guloop
    s_branch chain_end
chain_rdp:
    s_mov_b32 s72, 122912768
    v_mov_b32 v9, 0
    s_mov_b32 s66, 0
wt_111:
    s_add_u32 s66, s66, 1
    s_cmp_gt_u32 s66, 0x40000
    s_cbranch_scc1 chain_end
    buffer_load_dword v8, v9, s[4:7], s72 offen sc1
    s_waitcnt vmcnt(0)
    v_cmp_gt_u32 vcc, 32, v8
    s_cbranch_vccz wd_112
    s_sleep 64
    s_branch wt_111
wd_112:
    s_sub_u32 s73, s73, 115
    s_mov_b32 s74, 0
chain_dploop:
    s_lshl_b32 s72, s74, 7
    s_add_u32 s72, s72, 122931200
    v_mov_b32 v9, 0
    s_mov_b32 s66, 0
wt_113:
    s_add_u32 s66, s66, 1
    s_cmp_gt_u32 s66, 0x40000
    s_cbranch_scc1 chain_end
    buffer_load_dword v8, v9, s[4:7], s72 offen sc1
    s_waitcnt vmcnt(0)
    v_cmp_gt_u32 vcc, 27, v8
    s_cbranch_vccz wd_114
    s_sleep 64
    s_branch wt_113
wd_114:
    s_and_b32 s66, s73, 7
    s_lshr_b32 s67, s73, 3
    s_lshl_b32 s46, s74, 1
    s_add_u32 s67, s67, s46
    s_mul_i32 s44, s66, 5
    s_lshl_b32 s45, s67, 2
    s_mov_b32 s51, 0
    s_mov_b32 s52, s3
    s_add_u32 s46, s3, 0
    s_min_u32 s46, s46, 8
    s_lshl_b32 s59, s46, 10
    s_add_u32 s47, s44, s46
    s_add_u32 s48, s45, s46
    s_sub_u32 s48, s48, 5
    s_cmp_lt_u32 s46, 5
    s_cselect_b32 s47, s47, s48
    s_mov_b32 s48, 28016640
    s_cselect_b32 s48, s48, 115830784
    s_lshr_b32 s49, s47, 2
    s_mul_i32 s49, s49, 221184
    s_and_b32 s47, s47, 3
    s_lshl_b32 s47, s47, 10
    s_add_u32 s48, s48, s49
    s_add_u32 s53, s48, s47
    s_add_u32 s46, s3, 4
    s_min_u32 s46, s46, 8
    s_lshl_b32 s60, s46, 10
    s_add_u32 s47, s44, s46
    s_add_u32 s48, s45, s46
    s_sub_u32 s48, s48, 5
    s_cmp_lt_u32 s46, 5
    s_cselect_b32 s47, s47, s48
    s_mov_b32 s48, 28016640
    s_cselect_b32 s48, s48, 115830784
    s_lshr_b32 s49, s47, 2
    s_mul_i32 s49, s49, 221184
    s_and_b32 s47, s47, 3
    s_lshl_b32 s47, s47, 10
    s_add_u32 s48, s48, s49
    s_add_u32 s54, s48, s47
    s_add_u32 s46, s3, 8
    s_min_u32 s46, s46, 8
    s_lshl_b32 s61, s46, 10
    s_add_u32 s47, s44, s46
    s_add_u32 s48, s45, s46
    s_sub_u32 s48, s48, 5
    s_cmp_lt_u32 s46, 5
    s_cselect_b32 s47, s47, s48
    s_mov_b32 s48, 28016640
    s_cselect_b32 s48, s48, 115830784
    s_lshr_b32 s49, s47, 2
    s_mul_i32 s49, s49, 221184
    s_and_b32 s47, s47, 3
    s_lshl_b32 s47, s47, 10
    s_add_u32 s48, s48, s49
    s_add_u32 s55, s48, s47
    v_lshlrev_b32 v1, 4, v0
    s_lshl_b32 s46, s51, 10
    v_add_u32 v2, s46, v1
    s_lshl_b32 s46, s52, 10
    s_add_u32 s46, s46, 5120
    v_add_u32 v3, s46, v1
    v_add_u32 v6, 0x10000, v2
    v_add_u32 v7, 0x10000, v3
    v_mov_b32 v8, 0
    v_mov_b32 v9, 0
    v_mov_b32 v10, 0
    v_mov_b32 v11, 0
    v_mov_b32 v12, 0
    v_mov_b32 v13, 0
    v_mov_b32 v14, 0
    v_mov_b32 v15, 0
    v_mov_b32 v16, 0
    v_mov_b32 v17, 0
    v_mov_b32 v18, 0
    v_mov_b32 v19, 0
    v_mov_b32 v20, 0
    v_mov_b32 v21, 0
    v_mov_b32 v22, 0
    v_mov_b32 v23, 0
    v_mov_b32 v24, 0
    v_mov_b32 v25, 0
    v_mov_b32 v26, 0
    v_mov_b32 v27, 0
    s_cmp_ge_u32 s3, 1
    s_cbranch_scc1 gb2_115
    s_add_u32 m0, s59, 0
    s_nop 0
    buffer_load_dwordx4 v1, s[4:7], s53 offen lds
    s_add_u32 s53, s53, 4096
    s_add_u32 m0, s60, 0
    s_nop 0
    buffer_load_dwordx4 v1, s[4:7], s54 offen lds
    s_add_u32 s54, s54, 4096
    s_add_u32 m0, s61, 0
    s_nop 0
    buffer_load_dwordx4 v1, s[4:7], s55 offen lds
    s_add_u32 s55, s55, 4096
    s_add_u32 m0, s59, 9216
    s_nop 0
    buffer_load_dwordx4 v1, s[4:7], s53 offen lds
    s_add_u32 s53, s53, 4096
    s_add_u32 m0, s60, 9216
    s_nop 0
    buffer_load_dwordx4 v1, s[4:7], s54 offen lds
    s_add_u32 s54, s54, 4096
    s_add_u32 m0, s61, 9216
    s_nop 0
    buffer_load_dwordx4 v1, s[4:7], s55 offen lds
    s_add_u32 s55, s55, 4096
    s_add_u32 m0, s59, 18432
    s_nop 0
    buffer_load_dwordx4 v1, s[4:7], s53 offen lds
    s_add_u32 s53, s53, 4096
    s_add_u32 m0, s60, 18432
    s_nop 0
    buffer_load_dwordx4 v1, s[4:7], s54 offen lds
    s_add_u32 s54, s54, 4096
    s_add_u32 m0, s61, 18432
    s_nop 0
    buffer_load_dwordx4 v1, s[4:7], s55 offen lds
    s_add_u32 s55, s55, 4096
    s_add_u32 m0, s59, 27648
    s_nop 0
    buffer_load_dwordx4 v1, s[4:7], s53 offen lds
    s_add_u32 s53, s53, 4096
    s_add_u32 m0, s60, 27648
    s_nop 0
    buffer_load_dwordx4 v1, s[4:7], s54 offen lds
    s_add_u32 s54, s54, 4096
    s_add_u32 m0, s61, 27648
    s_nop 0
    buffer_load_dwordx4 v1, s[4:7], s55 offen lds
    s_add_u32 s55, s55, 4096
    s_add_u32 m0, s59, 36864
    s_nop 0
    buffer_load_dwordx4 v1, s[4:7], s53 offen lds
    s_add_u32 s53, s53, 4096
    s_add_u32 m0, s60, 36864
    s_nop 0
    buffer_load_dwordx4 v1, s[4:7], s54 offen lds
    s_add_u32 s54, s54, 4096
    s_add_u32 m0, s61, 36864
    s_nop 0
    buffer_load_dwordx4 v1, s[4:7], s55 offen lds
    s_add_u32 s55, s55, 4096
    s_add_u32 m0, s59, 46080
    s_nop 0
    buffer_load_dwordx4 v1, s[4:7], s53 offen lds
    s_add_u32 s53, s53, 4096
    s_add_u32 m0, s60, 46080
    s_nop 0
    buffer_load_dwordx4 v1, s[4:7], s54 offen lds
    s_add_u32 s54, s54, 4096
    s_add_u32 m0, s61, 46080
    s_nop 0
    buffer_load_dwordx4 v1, s[4:7], s55 offen lds
    s_add_u32 s55, s55, 4096
    s_add_u32 m0, s59, 55296
    s_nop 0
    buffer_load_dwordx4 v1, s[4:7], s53 offen lds
    s_add_u32 s53, s53, 4096
    s_add_u32 m0, s60, 55296
    s_nop 0
    buffer_load_dwordx4 v1, s[4:7], s54 offen lds
    s_add_u32 s54, s54, 4096
    s_add_u32 m0, s61, 55296
    s_nop 0
    buffer_load_dwordx4 v1, s[4:7], s55 offen lds
    s_add_u32 s55, s55, 4096
    s_add_u32 m0, s59, 64512
    s_nop 0
    buffer_load_dwordx4 v1, s[4:7], s53 offen lds
    s_add_u32 s53, s53, 4096
    s_add_u32 m0, s60, 64512
    s_nop 0
    buffer_load_dwordx4 v1, s[4:7], s54 offen lds
    s_add_u32 s54, s54, 4096
    s_add_u32 m0, s61, 64512
    s_nop 0
    buffer_load_dwordx4 v1, s[4:7], s55 offen lds
    s_add_u32 s55, s55, 4096
    s_add_u32 m0, s59, 73728
    s_nop 0
    buffer_load_dwordx4 v1, s[4:7], s53 offen lds
    s_add_u32 s53, s53, 4096
    s_add_u32 m0, s60, 73728
    s_nop 0
    buffer_load_dwordx4 v1, s[4:7], s54 offen lds
    s_add_u32 s54, s54, 4096
    s_add_u32 m0, s61, 73728
    s_nop 0
    buffer_load_dwordx4 v1, s[4:7], s55 offen lds
    s_add_u32 s55, s55, 4096
    s_add_u32 m0, s59, 82944
    s_nop 0
    buffer_load_dwordx4 v1, s[4:7], s53 offen lds
    s_add_u32 s53, s53, 4096
    s_add_u32 m0, s60, 82944
    s_nop 0
    buffer_load_dwordx4 v1, s[4:7], s54 offen lds
    s_add_u32 s54, s54, 4096
    s_add_u32 m0, s61, 82944
    s_nop 0
    buffer_load_dwordx4 v1, s[4:7], s55 offen lds
    s_add_u32 s55, s55, 4096
    s_add_u32 m0, s59, 92160
    s_nop 0
    buffer_load_dwordx4 v1, s[4:7], s53 offen lds
    s_add_u32 s53, s53, 4096
    s_add_u32 m0, s60, 92160
    s_nop 0
    buffer_load_dwordx4 v1, s[4:7], s54 offen lds
    s_add_u32 s54, s54, 4096
    s_add_u32 m0, s61, 92160
    s_nop 0
    buffer_load_dwordx4 v1, s[4:7], s55 offen lds
    s_add_u32 s55, s55, 4096
    s_waitcnt vmcnt(30)
    s_barrier
    ds_read_b128 v[28:31], v2 offset:0
    ds_read_b128 v[32:35], v2 offset:1024
    ds_read_b128 v[36:39], v2 offset:2048
    ds_read_b128 v[40:43], v2 offset:3072
    ds_read_b128 v[44:47], v2 offset:4096
    ds_read_b128 v[48:51], v3 offset:0
    s_mov_b32 s50, 3
gloop_117:
    s_waitcnt vmcnt(27)
    s_barrier
    s_add_u32 m0, s59, 101376
    s_nop 0
    buffer_load_dwordx4 v1, s[4:7], s53 offen lds
    s_add_u32 s53, s53, 4096
    s_add_u32 m0, s60, 101376
    s_nop 0
    buffer_load_dwordx4 v1, s[4:7], s54 offen lds
    s_add_u32 s54, s54, 4096
    s_add_u32 m0, s61, 101376
    s_nop 0
    buffer_load_dwordx4 v1, s[4:7], s55 offen lds
    s_add_u32 s55, s55, 4096
    s_waitcnt lgkmcnt(0)
    ds_read_b128 v[52:55], v2 offset:9216
    ds_read_b128 v[56:59], v2 offset:10240
    ds_read_b128 v[60:63], v2 offset:11264
    ds_read_b128 v[64:67], v2 offset:12288
    ds_read_b128 v[68:71], v2 offset:13312
    ds_read_b128 v[72:75], v3 offset:9216
    v_mfma_f32_16x16x32_bf16 v[8:11], v[28:31], v[48:51], v[8:11]
    v_mfma_f32_16x16x32_bf16 v[12:15], v[32:35], v[48:51], v[12:15]
    v_mfma_f32_16x16x32_bf16 v[16:19], v[36:39], v[48:51], v[16:19]
    v_mfma_f32_16x16x32_bf16 v[20:23], v[40:43], v[48:51], v[20:23]
    v_mfma_f32_16x16x32_bf16 v[24:27], v[44:47], v[48:51], v[24:27]
    s_waitcnt vmcnt(27)
    s_barrier
    s_add_u32 m0, s59, 0
    s_nop 0
    buffer_load_dwordx4 v1, s[4:7], s53 offen lds
    s_add_u32 s53, s53, 4096
    s_add_u32 m0, s60, 0
    s_nop 0
    buffer_load_dwordx4 v1, s[4:7], s54 offen lds
    s_add_u32 s54, s54, 4096
    s_add_u32 m0, s61, 0
    s_nop 0
    buffer_load_dwordx4 v1, s[4:7], s55 offen lds
    s_add_u32 s55, s55, 4096
    s_waitcnt lgkmcnt(0)
    ds_read_b128 v[28:31], v2 offset:18432
    ds_read_b128 v[32:35], v2 offset:19456
    ds_read_b128 v[36:39], v2 offset:20480
    ds_read_b128 v[40:43], v2 offset:21504
    ds_read_b128 v[44:47], v2 offset:22528
    ds_read_b128 v[48:51], v3 offset:18432
    v_mfma_f32_16x16x32_bf16 v[8:11], v[52:55], v[72:75], v[8:11]
    v_mfma_f32_16x16x32_bf16 v[12:15], v[56:59], v[72:75], v[12:15]
    v_mfma_f32_16x16x32_bf16 v[16:19], v[60:63], v[72:75], v[16:19]
    v_mfma_f32_16x16x32_bf16 v[20:23], v[64:67], v[72:75], v[20:23]
    v_mfma_f32_16x16x32_bf16 v[24:27], v[68:71], v[72:75], v[24:27]
    s_waitcnt vmcnt(27)
    s_barrier
    s_add_u32 m0, s59, 9216
    s_nop 0
    buffer_load_dwordx4 v1, s[4:7], s53 offen lds
    s_add_u32 s53, s53, 4096
    s_add_u32 m0, s60, 9216
    s_nop 0
    buffer_load_dwordx4 v1, s[4:7], s54 offen lds
    s_add_u32 s54, s54, 4096
    s_add_u32 m0, s61, 9216
    s_nop 0
    buffer_load_dwordx4 v1, s[4:7], s55 offen lds
    s_add_u32 s55, s55, 4096
    s_waitcnt lgkmcnt(0)
    ds_read_b128 v[52:55], v2 offset:27648
    ds_read_b128 v[56:59], v2 offset:28672
    ds_read_b128 v[60:63], v2 offset:29696
    ds_read_b128 v[64:67], v2 offset:30720
    ds_read_b128 v[68:71], v2 offset:31744
    ds_read_b128 v[72:75], v3 offset:27648
    v_mfma_f32_16x16x32_bf16 v[8:11], v[28:31], v[48:51], v[8:11]
    v_mfma_f32_16x16x32_bf16 v[12:15], v[32:35], v[48:51], v[12:15]
    v_mfma_f32_16x16x32_bf16 v[16:19], v[36:39], v[48:51], v[16:19]
    v_mfma_f32_16x16x32_bf16 v[20:23], v[40:43], v[48:51], v[20:23]
    v_mfma_f32_16x16x32_bf16 v[24:27], v[44:47], v[48:51], v[24:27]
    s_waitcnt vmcnt(27)
    s_barrier
    s_add_u32 m0, s59, 18432
    s_nop 0
    buffer_load_dwordx4 v1, s[4:7], s53 offen lds
    s_add_u32 s53, s53, 4096
    s_add_u32 m0, s60, 18432
    s_nop 0
    buffer_load_dwordx4 v1, s[4:7], s54 offen lds
    s_add_u32 s54, s54, 4096
    s_add_u32 m0, s61, 18432
    s_nop 0
    buffer_load_dwordx4 v1, s[4:7], s55 offen lds
    s_add_u32 s55, s55, 4096
    s_waitcnt lgkmcnt(0)
    ds_read_b128 v[28:31], v2 offset:36864
    ds_read_b128 v[32:35], v2 offset:37888
    ds_read_b128 v[36:39], v2 offset:38912
    ds_read_b128 v[40:43], v2 offset:39936
    ds_read_b128 v[44:47], v2 offset:40960
    ds_read_b128 v[48:51], v3 offset:36864
    v_mfma_f32_16x16x32_bf16 v[8:11], v[52:55], v[72:75], v[8:11]
    v_mfma_f32_16x16x32_bf16 v[12:15], v[56:59], v[72:75], v[12:15]
    v_mfma_f32_16x16x32_bf16 v[16:19], v[60:63], v[72:75], v[16:19]
    v_mfma_f32_16x16x32_bf16 v[20:23], v[64:67], v[72:75], v[20:23]
    v_mfma_f32_16x16x32_bf16 v[24:27], v[68:71], v[72:75], v[24:27]
    s_waitcnt vmcnt(27)
    s_barrier
    s_add_u32 m0, s59, 27648
    s_nop 0
    buffer_load_dwordx4 v1, s[4:7], s53 offen lds
    s_add_u32 s53, s53, 4096
    s_add_u32 m0, s60, 27648
    s_nop 0
    buffer_load_dwordx4 v1, s[4:7], s54 offen lds
    s_add_u32 s54, s54, 4096
    s_add_u32 m0, s61, 27648
    s_nop 0
    buffer_load_dwordx4 v1, s[4:7], s55 offen lds
    s_add_u32 s55, s55, 4096
    s_waitcnt lgkmcnt(0)
    ds_read_b128 v[52:55], v2 offset:46080
    ds_read_b128 v[56:59], v2 offset:47104
    ds_read_b128 v[60:63], v2 offset:48128
    ds_read_b128 v[64:67], v2 offset:49152
    ds_read_b128 v[68:71], v2 offset:50176
    ds_read_b128 v[72:75], v3 offset:46080
    v_mfma_f32_16x16x32_bf16 v[8:11], v[28:31], v[48:51], v[8:11]
    v_mfma_f32_16x16x32_bf16 v[12:15], v[32:35], v[48:51], v[12:15]
    v_mfma_f32_16x16x32_bf16 v[16:19], v[36:39], v[48:51], v[16:19]
    v_mfma_f32_16x16x32_bf16 v[20:23], v[40:43], v[48:51], v[20:23]
    v_mfma_f32_16x16x32_bf16 v[24:27], v[44:47], v[48:51], v[24:27]
    s_waitcnt vmcnt(27)
    s_barrier
    s_add_u32 m0, s59, 36864
    s_nop 0
    buffer_load_dwordx4 v1, s[4:7], s53 offen lds
    s_add_u32 s53, s53, 4096
    s_add_u32 m0, s60, 36864
    s_nop 0
    buffer_load_dwordx4 v1, s[4:7], s54 offen lds
    s_add_u32 s54, s54, 4096
    s_add_u32 m0, s61, 36864
    s_nop 0
    buffer_load_dwordx4 v1, s[4:7], s55 offen lds
    s_add_u32 s55, s55, 4096
    s_waitcnt lgkmcnt(0)
    ds_read_b128 v[28:31], v2 offset:55296
    ds_read_b128 v[32:35], v2 offset:56320
    ds_read_b128 v[36:39], v2 offset:57344
    ds_read_b128 v[40:43], v2 offset:58368
    ds_read_b128 v[44:47], v2 offset:59392
    ds_read_b128 v[48:51], v3 offset:55296
    v_mfma_f32_16x16x32_bf16 v[8:11], v[52:55], v[72:75], v[8:11]
    v_mfma_f32_16x16x32_bf16 v[12:15], v[56:59], v[72:75], v[12:15]
    v_mfma_f32_16x16x32_bf16 v[16:19], v[60:63], v[72:75], v[16:19]
    v_mfma_f32_16x16x32_bf16 v[20:23], v[64:67], v[72:75], v[20:23]
    v_mfma_f32_16x16x32_bf16 v[24:27], v[68:71], v[72:75], v[24:27]
    s_waitcnt vmcnt(27)
    s_barrier
    s_add_u32 m0, s59, 46080
    s_nop 0
    buffer_load_dwordx4 v1, s[4:7], s53 offen lds
    s_add_u32 s53, s53, 4096
    s_add_u32 m0, s60, 46080
    s_nop 0
    buffer_load_dwordx4 v1, s[4:7], s54 offen lds
    s_add_u32 s54, s54, 4096
    s_add_u32 m0, s61, 46080
    s_nop 0
    buffer_load_dwordx4 v1, s[4:7], s55 offen lds
    s_add_u32 s55, s55, 4096
    s_waitcnt lgkmcnt(0)
    ds_read_b128 v[52:55], v2 offset:64512
    ds_read_b128 v[56:59], v6 offset:0
    ds_read_b128 v[60:63], v6 offset:1024
    ds_read_b128 v[64:67], v6 offset:2048
    ds_read_b128 v[68:71], v6 offset:3072
    ds_read_b128 v[72:75], v3 offset:64512
    v_mfma_f32_16x16x32_bf16 v[8:11], v[28:31], v[48:51], v[8:11]
    v_mfma_f32_16x16x32_bf16 v[12:15], v[32:35], v[48:51], v[12:15]
    v_mfma_f32_16x16x32_bf16 v[16:19], v[36:39], v[48:51], v[16:19]
    v_mfma_f32_16x16x32_bf16 v[20:23], v[40:43], v[48:51], v[20:23]
    v_mfma_f32_16x16x32_bf16 v[24:27], v[44:47], v[48:51], v[24:27]
    s_waitcnt vmcnt(27)
    s_barrier
    s_add_u32 m0, s59, 55296
    s_nop 0
    buffer_load_dwordx4 v1, s[4:7], s53 offen lds
    s_add_u32 s53, s53, 4096
    s_add_u32 m0, s60, 55296
    s_nop 0
    buffer_load_dwordx4 v1, s[4:7], s54 offen lds
    s_add_u32 s54, s54, 4096
    s_add_u32 m0, s61, 55296
    s_nop 0
    buffer_load_dwordx4 v1, s[4:7], s55 offen lds
    s_add_u32 s55, s55, 4096
    s_waitcnt lgkmcnt(0)
    ds_read_b128 v[28:31], v6 offset:8192
    ds_read_b128 v[32:35], v6 offset:9216
    ds_read_b128 v[36:39], v6 offset:10240
    ds_read_b128 v[40:43], v6 offset:11264
    ds_read_b128 v[44:47], v6 offset:12288
    ds_read_b128 v[48:51], v7 offset:8192
    v_mfma_f32_16x16x32_bf16 v[8:11], v[52:55], v[72:75], v[8:11]
    v_mfma_f32_16x16x32_bf16 v[12:15], v[56:59], v[72:75], v[12:15]
    v_mfma_f32_16x16x32_bf16 v[16:19], v[60:63], v[72:75], v[16:19]
    v_mfma_f32_16x16x32_bf16 v[20:23], v[64:67], v[72:75], v[20:23]
    v_mfma_f32_16x16x32_bf16 v[24:27], v[68:71], v[72:75], v[24:27]
    s_waitcnt vmcnt(27)
    s_barrier
    s_add_u32 m0, s59, 64512
    s_nop 0
    buffer_load_dwordx4 v1, s[4:7], s53 offen lds
    s_add_u32 s53, s53, 4096
    s_add_u32 m0, s60, 64512
    s_nop 0
    buffer_load_dwordx4 v1, s[4:7], s54 offen lds
    s_add_u32 s54, s54, 4096
    s_add_u32 m0, s61, 64512
    s_nop 0
    buffer_load_dwordx4 v1, s[4:7], s55 offen lds
    s_add_u32 s55, s55, 4096
    s_waitcnt lgkmcnt(0)
    ds_read_b128 v[52:55], v6 offset:17408
    ds_read_b128 v[56:59], v6 offset:18432
    ds_read_b128 v[60:63], v6 offset:19456
    ds_read_b128 v[64:67], v6 offset:20480
    ds_read_b128 v[68:71], v6 offset:21504
    ds_read_b128 v[72:75], v7 offset:17408
    v_mfma_f32_16x16x32_bf16 v[8:11], v[28:31], v[48:51], v[8:11]
    v_mfma_f32_16x16x32_bf16 v[12:15], v[32:35], v[48:51], v[12:15]
    v_mfma_f32_16x16x32_bf16 v[16:19], v[36:39], v[48:51], v[16:19]
    v_mfma_f32_16x16x32_bf16 v[20:23], v[40:43], v[48:51], v[20:23]
    v_mfma_f32_16x16x32_bf16 v[24:27], v[44:47], v[48:51], v[24:27]
    s_waitcnt vmcnt(27)
    s_barrier
    s_add_u32 m0, s59, 73728
    s_nop 0
    buffer_load_dwordx4 v1, s[4:7], s53 offen lds
    s_add_u32 s53, s53, 4096
    s_add_u32 m0, s60, 73728
    s_nop 0
    buffer_load_dwordx4 v1, s[4:7], s54 offen lds
    s_add_u32 s54, s54, 4096
    s_add_u32 m0, s61, 73728
    s_nop 0
    buffer_load_dwordx4 v1, s[4:7], s55 offen lds
    s_add_u32 s55, s55, 4096
    s_waitcnt lgkmcnt(0)
    ds_read_b128 v[28:31], v6 offset:26624
    ds_read_b128 v[32:35], v6 offset:27648
    ds_read_b128 v[36:39], v6 offset:28672
    ds_read_b128 v[40:43], v6 offset:29696
    ds_read_b128 v[44:47], v6 offset:30720
    ds_read_b128 v[48:51], v7 offset:26624
    v_mfma_f32_16x16x32_bf16 v[8:11], v[52:55], v[72:75], v[8:11]
    v_mfma_f32_16x16x32_bf16 v[12:15], v[56:59], v[72:75], v[12:15]
    v_mfma_f32_16x16x32_bf16 v[16:19], v[60:63], v[72:75], v[16:19]
    v_mfma_f32_16x16x32_bf16 v[20:23], v[64:67], v[72:75], v[20:23]
    v_mfma_f32_16x16x32_bf16 v[24:27], v[68:71], v[72:75], v[24:27]
    s_waitcnt vmcnt(27)
    s_barrier
    s_add_u32 m0, s59, 82944
    s_nop 0
    buffer_load_dwordx4 v1, s[4:7], s53 offen lds
    s_add_u32 s53, s53, 4096
    s_add_u32 m0, s60, 82944
    s_nop 0
    buffer_load_dwordx4 v1, s[4:7], s54 offen lds
    s_add_u32 s54, s54, 4096
    s_add_u32 m0, s61, 82944
    s_nop 0
    buffer_load_dwordx4 v1, s[4:7], s55 offen lds
    s_add_u32 s55, s55, 4096
    s_waitcnt lgkmcnt(0)
    ds_read_b128 v[52:55], v6 offset:35840
    ds_read_b128 v[56:59], v6 offset:36864
    ds_read_b128 v[60:63], v6 offset:37888
    ds_read_b128 v[64:67], v6 offset:38912
    ds_read_b128 v[68:71], v6 offset:39936
    ds_read_b128 v[72:75], v7 offset:35840
    v_mfma_f32_16x16x32_bf16 v[8:11], v[28:31], v[48:51], v[8:11]
    v_mfma_f32_16x16x32_bf16 v[12:15], v[32:35], v[48:51], v[12:15]
    v_mfma_f32_16x16x32_bf16 v[16:19], v[36:39], v[48:51], v[16:19]
    v_mfma_f32_16x16x32_bf16 v[20:23], v[40:43], v[48:51], v[20:23]
    v_mfma_f32_16x16x32_bf16 v[24:27], v[44:47], v[48:51], v[24:27]
    s_waitcnt vmcnt(27)
    s_barrier
    s_add_u32 m0, s59, 92160
    s_nop 0
    buffer_load_dwordx4 v1, s[4:7], s53 offen lds
    s_add_u32 s53, s53, 4096
    s_add_u32 m0, s60, 92160
    s_nop 0
    buffer_load_dwordx4 v1, s[4:7], s54 offen lds
    s_add_u32 s54, s54, 4096
    s_add_u32 m0, s61, 92160
    s_nop 0
    buffer_load_dwordx4 v1, s[4:7], s55 offen lds
    s_add_u32 s55, s55, 4096
    s_waitcnt lgkmcnt(0)
    ds_read_b128 v[28:31], v2 offset:0
    ds_read_b128 v[32:35], v2 offset:1024
    ds_read_b128 v[36:39], v2 offset:2048
    ds_read_b128 v[40:43], v2 offset:3072
    ds_read_b128 v[44:47], v2 offset:4096
    ds_read_b128 v[48:51], v3 offset:0
    v_mfma_f32_16x16x32_bf16 v[8:11], v[52:55], v[72:75], v[8:11]
    v_mfma_f32_16x16x32_bf16 v[12:15], v[56:59], v[72:75], v[12:15]
    v_mfma_f32_16x16x32_bf16 v[16:19], v[60:63], v[72:75], v[16:19]
    v_mfma_f32_16x16x32_bf16 v[20:23], v[64:67], v[72:75], v[20:23]
    v_mfma_f32_16x16x32_bf16 v[24:27], v[68:71], v[72:75], v[24:27]
    s_sub_u32 s50, s50, 1
    s_cmp_lg_u32 s50, 0
    s_cbranch_scc1 gloop_117
    s_waitcnt vmcnt(27)
    s_barrier
    s_add_u32 m0, s59, 101376
    s_nop 0
    buffer_load_dwordx4 v1, s[4:7], s53 offen lds
    s_add_u32 s53, s53, 4096
    s_add_u32 m0, s60, 101376
    s_nop 0
    buffer_load_dwordx4 v1, s[4:7], s54 offen lds
    s_add_u32 s54, s54, 4096
    s_add_u32 m0, s61, 101376
    s_nop 0
    buffer_load_dwordx4 v1, s[4:7], s55 offen lds
    s_add_u32 s55, s55, 4096
    s_waitcnt lgkmcnt(0)
    ds_read_b128 v[52:55], v2 offset:9216
    ds_read_b128 v[56:59], v2 offset:10240
    ds_read_b128 v[60:63], v2 offset:11264
    ds_read_b128 v[64:67], v2 offset:12288
    ds_read_b128 v[68:71], v2 offset:13312
    ds_read_b128 v[72:75], v3 offset:9216
    v_mfma_f32_16x16x32_bf16 v[8:11], v[28:31], v[48:51], v[8:11]
    v_mfma_f32_16x16x32_bf16 v[12:15], v[32:35], v[48:51], v[12:15]
    v_mfma_f32_16x16x32_bf16 v[16:19], v[36:39], v[48:51], v[16:19]
    v_mfma_f32_16x16x32_bf16 v[20:23], v[40:43], v[48:51], v[20:23]
    v_mfma_f32_16x16x32_bf16 v[24:27], v[44:47], v[48:51], v[24:27]
    s_waitcnt vmcnt(27)
    s_barrier
    s_add_u32 m0, s59, 0
    s_nop 0
    buffer_load_dwordx4 v1, s[4:7], s53 offen lds
    s_add_u32 s53, s53, 4096
    s_add_u32 m0, s60, 0
    s_nop 0
    buffer_load_dwordx4 v1, s[4:7], s54 offen lds
    s_add_u32 s54, s54, 4096
    s_add_u32 m0, s61, 0
    s_nop 0
    buffer_load_dwordx4 v1, s[4:7], s55 offen lds
    s_add_u32 s55, s55, 4096
    s_waitcnt lgkmcnt(0)
    ds_read_b128 v[28:31], v2 offset:18432
    ds_read_b128 v[32:35], v2 offset:19456
    ds_read_b128 v[36:39], v2 offset:20480
    ds_read_b128 v[40:43], v2 offset:21504
    ds_read_b128 v[44:47], v2 offset:22528
    ds_read_b128 v[48:51], v3 offset:18432
    v_mfma_f32_16x16x32_bf16 v[8:11], v[52:55], v[72:75], v[8:11]
    v_mfma_f32_16x16x32_bf16 v[12:15], v[56:59], v[72:75], v[12:15]
    v_mfma_f32_16x16x32_bf16 v[16:19], v[60:63], v[72:75], v[16:19]
    v_mfma_f32_16x16x32_bf16 v[20:23], v[64:67], v[72:75], v[20:23]
    v_mfma_f32_16x16x32_bf16 v[24:27], v[68:71], v[72:75], v[24:27]
    s_waitcnt vmcnt(27)
    s_barrier
    s_add_u32 m0, s59, 9216
    s_nop 0
    buffer_load_dwordx4 v1, s[4:7], s53 offen lds
    s_add_u32 s53, s53, 4096
    s_add_u32 m0, s60, 9216
    s_nop 0
    buffer_load_dwordx4 v1, s[4:7], s54 offen lds
    s_add_u32 s54, s54, 4096
    s_add_u32 m0, s61, 9216
    s_nop 0
    buffer_load_dwordx4 v1, s[4:7], s55 offen lds
    s_add_u32 s55, s55, 4096
    s_waitcnt lgkmcnt(0)
    ds_read_b128 v[52:55], v2 offset:27648
    ds_read_b128 v[56:59], v2 offset:28672
    ds_read_b128 v[60:63], v2 offset:29696
    ds_read_b128 v[64:67], v2 offset:30720
    ds_read_b128 v[68:71], v2 offset:31744
    ds_read_b128 v[72:75], v3 offset:27648
    v_mfma_f32_16x16x32_bf16 v[8:11], v[28:31], v[48:51], v[8:11]
    v_mfma_f32_16x16x32_bf16 v[12:15], v[32:35], v[48:51], v[12:15]
    v_mfma_f32_16x16x32_bf16 v[16:19], v[36:39], v[48:51], v[16:19]
    v_mfma_f32_16x16x32_bf16 v[20:23], v[40:43], v[48:51], v[20:23]
    v_mfma_f32_16x16x32_bf16 v[24:27], v[44:47], v[48:51], v[24:27]
    s_waitcnt vmcnt(27)
    s_barrier
    s_add_u32 m0, s59, 18432
    s_nop 0
    buffer_load_dwordx4 v1, s[4:7], s53 offen lds
    s_add_u32 s53, s53, 4096
    s_add_u32 m0, s60, 18432
    s_nop 0
    buffer_load_dwordx4 v1, s[4:7], s54 offen lds
    s_add_u32 s54, s54, 4096
    s_add_u32 m0, s61, 18432
    s_nop 0
    buffer_load_dwordx4 v1, s[4:7], s55 offen lds
    s_add_u32 s55, s55, 4096
    s_waitcnt lgkmcnt(0)
    ds_read_b128 v[28:31], v2 offset:36864
    ds_read_b128 v[32:35], v2 offset:37888
    ds_read_b128 v[36:39], v2 offset:38912
    ds_read_b128 v[40:43], v2 offset:39936
    ds_read_b128 v[44:47], v2 offset:40960
    ds_read_b128 v[48:51], v3 offset:36864
    v_mfma_f32_16x16x32_bf16 v[8:11], v[52:55], v[72:75], v[8:11]
    v_mfma_f32_16x16x32_bf16 v[12:15], v[56:59], v[72:75], v[12:15]
    v_mfma_f32_16x16x32_bf16 v[16:19], v[60:63], v[72:75], v[16:19]
    v_mfma_f32_16x16x32_bf16 v[20:23], v[64:67], v[72:75], v[20:23]
    v_mfma_f32_16x16x32_bf16 v[24:27], v[68:71], v[72:75], v[24:27]
    s_waitcnt vmcnt(27)
    s_barrier
    s_add_u32 m0, s59, 27648
    s_nop 0
    buffer_load_dwordx4 v1, s[4:7], s53 offen lds
    s_add_u32 s53, s53, 4096
    s_add_u32 m0, s60, 27648
    s_nop 0
    buffer_load_dwordx4 v1, s[4:7], s54 offen lds
    s_add_u32 s54, s54, 4096
    s_add_u32 m0, s61, 27648
    s_nop 0
    buffer_load_dwordx4 v1, s[4:7], s55 offen lds
    s_add_u32 s55, s55, 4096
    s_waitcnt lgkmcnt(0)
    ds_read_b128 v[52:55], v2 offset:46080
    ds_read_b128 v[56:59], v2 offset:47104
    ds_read_b128 v[60:63], v2 offset:48128
    ds_read_b128 v[64:67], v2 offset:49152
    ds_read_b128 v[68:71], v2 offset:50176
    ds_read_b128 v[72:75], v3 offset:46080
    v_mfma_f32_16x16x32_bf16 v[8:11], v[28:31], v[48:51], v[8:11]
    v_mfma_f32_16x16x32_bf16 v[12:15], v[32:35], v[48:51], v[12:15]
    v_mfma_f32_16x16x32_bf16 v[16:19], v[36:39], v[48:51], v[16:19]
    v_mfma_f32_16x16x32_bf16 v[20:23], v[40:43], v[48:51], v[20:23]
    v_mfma_f32_16x16x32_bf16 v[24:27], v[44:47], v[48:51], v[24:27]
    s_waitcnt vmcnt(27)
    s_barrier
    s_add_u32 m0, s59, 36864
    s_nop 0
    buffer_load_dwordx4 v1, s[4:7], s53 offen lds
    s_add_u32 s53, s53, 4096
    s_add_u32 m0, s60, 36864
    s_nop 0
    buffer_load_dwordx4 v1, s[4:7], s54 offen lds
    s_add_u32 s54, s54, 4096
    s_add_u32 m0, s61, 36864
    s_nop 0
    buffer_load_dwordx4 v1, s[4:7], s55 offen lds
    s_add_u32 s55, s55, 4096
    s_waitcnt lgkmcnt(0)
    ds_read_b128 v[28:31], v2 offset:55296
    ds_read_b128 v[32:35], v2 offset:56320
    ds_read_b128 v[36:39], v2 offset:57344
    ds_read_b128 v[40:43], v2 offset:58368
    ds_read_b128 v[44:47], v2 offset:59392
    ds_read_b128 v[48:51], v3 offset:55296
    v_mfma_f32_16x16x32_bf16 v[8:11], v[52:55], v[72:75], v[8:11]
    v_mfma_f32_16x16x32_bf16 v[12:15], v[56:59], v[72:75], v[12:15]
    v_mfma_f32_16x16x32_bf16 v[16:19], v[60:63], v[72:75], v[16:19]
    v_mfma_f32_16x16x32_bf16 v[20:23], v[64:67], v[72:75], v[20:23]
    v_mfma_f32_16x16x32_bf16 v[24:27], v[68:71], v[72:75], v[24:27]
    s_waitcnt vmcnt(27)
    s_barrier
    s_add_u32 m0, s59, 46080
    s_nop 0
    buffer_load_dwordx4 v1, s[4:7], s53 offen lds
    s_add_u32 s53, s53, 4096
    s_add_u32 m0, s60, 46080
    s_nop 0
    buffer_load_dwordx4 v1, s[4:7], s54 offen lds
    s_add_u32 s54, s54, 4096
    s_add_u32 m0, s61, 46080
    s_nop 0
    buffer_load_dwordx4 v1, s[4:7], s55 offen lds
    s_add_u32 s55, s55, 4096
    s_waitcnt lgkmcnt(0)
    ds_read_b128 v[52:55], v2 offset:64512
    ds_read_b128 v[56:59], v6 offset:0
    ds_read_b128 v[60:63], v6 offset:1024
    ds_read_b128 v[64:67], v6 offset:2048
    ds_read_b128 v[68:71], v6 offset:3072
    ds_read_b128 v[72:75], v3 offset:64512
    v_mfma_f32_16x16x32_bf16 v[8:11], v[28:31], v[48:51], v[8:11]
    v_mfma_f32_16x16x32_bf16 v[12:15], v[32:35], v[48:51], v[12:15]
    v_mfma_f32_16x16x32_bf16 v[16:19], v[36:39], v[48:51], v[16:19]
    v_mfma_f32_16x16x32_bf16 v[20:23], v[40:43], v[48:51], v[20:23]
    v_mfma_f32_16x16x32_bf16 v[24:27], v[44:47], v[48:51], v[24:27]
    s_waitcnt vmcnt(27)
    s_barrier
    s_waitcnt lgkmcnt(0)
    ds_read_b128 v[28:31], v6 offset:8192
    ds_read_b128 v[32:35], v6 offset:9216
    ds_read_b128 v[36:39], v6 offset:10240
    ds_read_b128 v[40:43], v6 offset:11264
    ds_read_b128 v[44:47], v6 offset:12288
    ds_read_b128 v[48:51], v7 offset:8192
    v_mfma_f32_16x16x32_bf16 v[8:11], v[52:55], v[72:75], v[8:11]
    v_mfma_f32_16x16x32_bf16 v[12:15], v[56:59], v[72:75], v[12:15]
    v_mfma_f32_16x16x32_bf16 v[16:19], v[60:63], v[72:75], v[16:19]
    v_mfma_f32_16x16x32_bf16 v[20:23], v[64:67], v[72:75], v[20:23]
    v_mfma_f32_16x16x32_bf16 v[24:27], v[68:71], v[72:75], v[24:27]
    s_waitcnt vmcnt(24)
    s_barrier
    s_waitcnt lgkmcnt(0)
    ds_read_b128 v[52:55], v6 offset:17408
    ds_read_b128 v[56:59], v6 offset:18432
    ds_read_b128 v[60:63], v6 offset:19456
    ds_read_b128 v[64:67], v6 offset:20480
    ds_read_b128 v[68:71], v6 offset:21504
    ds_read_b128 v[72:75], v7 offset:17408
    v_mfma_f32_16x16x32_bf16 v[8:11], v[28:31], v[48:51], v[8:11]
    v_mfma_f32_16x16x32_bf16 v[12:15], v[32:35], v[48:51], v[12:15]
    v_mfma_f32_16x16x32_bf16 v[16:19], v[36:39], v[48:51], v[16:19]
    v_mfma_f32_16x16x32_bf16 v[20:23], v[40:43], v[48:51], v[20:23]
    v_mfma_f32_16x16x32_bf16 v[24:27], v[44:47], v[48:51], v[24:27]
    s_waitcnt vmcnt(21)
    s_barrier
    s_waitcnt lgkmcnt(0)
    ds_read_b128 v[28:31], v6 offset:26624
    ds_read_b128 v[32:35], v6 offset:27648
    ds_read_b128 v[36:39], v6 offset:28672
    ds_read_b128 v[40:43], v6 offset:29696
    ds_read_b128 v[44:47], v6 offset:30720
    ds_read_b128 v[48:51], v7 offset:26624
    v_mfma_f32_16x16x32_bf16 v[8:11], v[52:55], v[72:75], v[8:11]
    v_mfma_f32_16x16x32_bf16 v[12:15], v[56:59], v[72:75], v[12:15]
    v_mfma_f32_16x16x32_bf16 v[16:19], v[60:63], v[72:75], v[16:19]
    v_mfma_f32_16x16x32_bf16 v[20:23], v[64:67], v[72:75], v[20:23]
    v_mfma_f32_16x16x32_bf16 v[24:27], v[68:71], v[72:75], v[24:27]
    s_waitcnt vmcnt(18)
    s_barrier
    s_waitcnt lgkmcnt(0)
    ds_read_b128 v[52:55], v6 offset:35840
    ds_read_b128 v[56:59], v6 offset:36864
    ds_read_b128 v[60:63], v6 offset:37888
    ds_read_b128 v[64:67], v6 offset:38912
    ds_read_b128 v[68:71], v6 offset:39936
    ds_read_b128 v[72:75], v7 offset:35840
    v_mfma_f32_16x16x32_bf16 v[8:11], v[28:31], v[48:51], v[8:11]
    v_mfma_f32_16x16x32_bf16 v[12:15], v[32:35], v[48:51], v[12:15]
    v_mfma_f32_16x16x32_bf16 v[16:19], v[36:39], v[48:51], v[16:19]
    v_mfma_f32_16x16x32_bf16 v[20:23], v[40:43], v[48:51], v[20:23]
    v_mfma_f32_16x16x32_bf16 v[24:27], v[44:47], v[48:51], v[24:27]
    s_waitcnt vmcnt(15)
    s_barrier
    s_waitcnt lgkmcnt(0)
    ds_read_b128 v[28:31], v2 offset:0
    ds_read_b128 v[32:35], v2 offset:1024
    ds_read_b128 v[36:39], v2 offset:2048
    ds_read_b128 v[40:43], v2 offset:3072
    ds_read_b128 v[44:47], v2 offset:4096
    ds_read_b128 v[48:51], v3 offset:0
    v_mfma_f32_16x16x32_bf16 v[8:11], v[52:55], v[72:75], v[8:11]
    v_mfma_f32_16x16x32_bf16 v[12:15], v[56:59], v[72:75], v[12:15]
    v_mfma_f32_16x16x32_bf16 v[16:19], v[60:63], v[72:75], v[16:19]
    v_mfma_f32_16x16x32_bf16 v[20:23], v[64:67], v[72:75], v[20:23]
    v_mfma_f32_16x16x32_bf16 v[24:27], v[68:71], v[72:75], v[24:27]
    s_waitcnt vmcnt(12)
    s_barrier
    s_waitcnt lgkmcnt(0)
    ds_read_b128 v[52:55], v2 offset:9216
    ds_read_b128 v[56:59], v2 offset:10240
    ds_read_b128 v[60:63], v2 offset:11264
    ds_read_b128 v[64:67], v2 offset:12288
    ds_read_b128 v[68:71], v2 offset:13312
    ds_read_b128 v[72:75], v3 offset:9216
    v_mfma_f32_16x16x32_bf16 v[8:11], v[28:31], v[48:51], v[8:11]
    v_mfma_f32_16x16x32_bf16 v[12:15], v[32:35], v[48:51], v[12:15]
    v_mfma_f32_16x16x32_bf16 v[16:19], v[36:39], v[48:51], v[16:19]
    v_mfma_f32_16x16x32_bf16 v[20:23], v[40:43], v[48:51], v[20:23]
    v_mfma_f32_16x16x32_bf16 v[24:27], v[44:47], v[48:51], v[24:27]
    s_waitcnt vmcnt(9)
    s_barrier
    s_waitcnt lgkmcnt(0)
    ds_read_b128 v[28:31], v2 offset:18432
    ds_read_b128 v[32:35], v2 offset:19456
    ds_read_b128 v[36:39], v2 offset:20480
    ds_read_b128 v[40:43], v2 offset:21504
    ds_read_b128 v[44:47], v2 offset:22528
    ds_read_b128 v[48:51], v3 offset:18432
    v_mfma_f32_16x16x32_bf16 v[8:11], v[52:55], v[72:75], v[8:11]
    v_mfma_f32_16x16x32_bf16 v[12:15], v[56:59], v[72:75], v[12:15]
    v_mfma_f32_16x16x32_bf16 v[16:19], v[60:63], v[72:75], v[16:19]
    v_mfma_f32_16x16x32_bf16 v[20:23], v[64:67], v[72:75], v[20:23]
    v_mfma_f32_16x16x32_bf16 v[24:27], v[68:71], v[72:75], v[24:27]
    s_waitcnt vmcnt(6)
    s_barrier
    s_waitcnt lgkmcnt(0)
    ds_read_b128 v[52:55], v2 offset:27648
    ds_read_b128 v[56:59], v2 offset:28672
    ds_read_b128 v[60:63], v2 offset:29696
    ds_read_b128 v[64:67], v2 offset:30720
    ds_read_b128 v[68:71], v2 offset:31744
    ds_read_b128 v[72:75], v3 offset:27648
    v_mfma_f32_16x16x32_bf16 v[8:11], v[28:31], v[48:51], v[8:11]
    v_mfma_f32_16x16x32_bf16 v[12:15], v[32:35], v[48:51], v[12:15]
    v_mfma_f32_16x16x32_bf16 v[16:19], v[36:39], v[48:51], v[16:19]
    v_mfma_f32_16x16x32_bf16 v[20:23], v[40:43], v[48:51], v[20:23]
    v_mfma_f32_16x16x32_bf16 v[24:27], v[44:47], v[48:51], v[24:27]
    s_waitcnt vmcnt(3)
    s_barrier
    s_waitcnt lgkmcnt(0)
    ds_read_b128 v[28:31], v2 offset:36864
    ds_read_b128 v[32:35], v2 offset:37888
    ds_read_b128 v[36:39], v2 offset:38912
    ds_read_b128 v[40:43], v2 offset:39936
    ds_read_b128 v[44:47], v2 offset:40960
    ds_read_b128 v[48:51], v3 offset:36864
    v_mfma_f32_16x16x32_bf16 v[8:11], v[52:55], v[72:75], v[8:11]
    v_mfma_f32_16x16x32_bf16 v[12:15], v[56:59], v[72:75], v[12:15]
    v_mfma_f32_16x16x32_bf16 v[16:19], v[60:63], v[72:75], v[16:19]
    v_mfma_f32_16x16x32_bf16 v[20:23], v[64:67], v[72:75], v[20:23]
    v_mfma_f32_16x16x32_bf16 v[24:27], v[68:71], v[72:75], v[24:27]
    s_waitcnt vmcnt(0)
    s_barrier
    s_waitcnt lgkmcnt(0)
    ds_read_b128 v[52:55], v2 offset:46080
    ds_read_b128 v[56:59], v2 offset:47104
    ds_read_b128 v[60:63], v2 offset:48128
    ds_read_b128 v[64:67], v2 offset:49152
    ds_read_b128 v[68:71], v2 offset:50176
    ds_read_b128 v[72:75], v3 offset:46080
    v_mfma_f32_16x16x32_bf16 v[8:11], v[28:31], v[48:51], v[8:11]
    v_mfma_f32_16x16x32_bf16 v[12:15], v[32:35], v[48:51], v[12:15]
    v_mfma_f32_16x16x32_bf16 v[16:19], v[36:39], v[48:51], v[16:19]
    v_mfma_f32_16x16x32_bf16 v[20:23], v[40:43], v[48:51], v[20:23]
    v_mfma_f32_16x16x32_bf16 v[24:27], v[44:47], v[48:51], v[24:27]
    s_waitcnt lgkmcnt(0)
    v_mfma_f32_16x16x32_bf16 v[8:11], v[52:55], v[72:75], v[8:11]
    v_mfma_f32_16x16x32_bf16 v[12:15], v[56:59], v[72:75], v[12:15]
    v_mfma_f32_16x16x32_bf16 v[16:19], v[60:63], v[72:75], v[16:19]
    v_mfma_f32_16x16x32_bf16 v[20:23], v[64:67], v[72:75], v[20:23]
    v_mfma_f32_16x16x32_bf16 v[24:27], v[68:71], v[72:75], v[24:27]
    s_branch gbe_116
gb2_115:
    s_add_u32 m0, s59, 0
    s_nop 0
    buffer_load_dwordx4 v1, s[4:7], s53 offen lds
    s_add_u32 s53, s53, 4096
    s_add_u32 m0, s60, 0
    s_nop 0
    buffer_load_dwordx4 v1, s[4:7], s54 offen lds
    s_add_u32 s54, s54, 4096
    s_add_u32 m0, s59, 9216
    s_nop 0
    buffer_load_dwordx4 v1, s[4:7], s53 offen lds
    s_add_u32 s53, s53, 4096
    s_add_u32 m0, s60, 9216
    s_nop 0
    buffer_load_dwordx4 v1, s[4:7], s54 offen lds
    s_add_u32 s54, s54, 4096
    s_add_u32 m0, s59, 18432
    s_nop 0
    buffer_load_dwordx4 v1, s[4:7], s53 offen lds
    s_add_u32 s53, s53, 4096
    s_add_u32 m0, s60, 18432
    s_nop 0
    buffer_load_dwordx4 v1, s[4:7], s54 offen lds
    s_add_u32 s54, s54, 4096
    s_add_u32 m0, s59, 27648
    s_nop 0
    buffer_load_dwordx4 v1, s[4:7], s53 offen lds
    s_add_u32 s53, s53, 4096
    s_add_u32 m0, s60, 27648
    s_nop 0
    buffer_load_dwordx4 v1, s[4:7], s54 offen lds
    s_add_u32 s54, s54, 4096
    s_add_u32 m0, s59, 36864
    s_nop 0
    buffer_load_dwordx4 v1, s[4:7], s53 offen lds
    s_add_u32 s53, s53, 4096
    s_add_u32 m0, s60, 36864
    s_nop 0
    buffer_load_dwordx4 v1, s[4:7], s54 offen lds
    s_add_u32 s54, s54, 4096
    s_add_u32 m0, s59, 46080
    s_nop 0
    buffer_load_dwordx4 v1, s[4:7], s53 offen lds
    s_add_u32 s53, s53, 4096
    s_add_u32 m0, s60, 46080
    s_nop 0
    buffer_load_dwordx4 v1, s[4:7], s54 offen lds
    s_add_u32 s54, s54, 4096
    s_add_u32 m0, s59, 55296
    s_nop 0
    buffer_load_dwordx4 v1, s[4:7], s53 offen lds
    s_add_u32 s53, s53, 4096
    s_add_u32 m0, s60, 55296
    s_nop 0
    buffer_load_dwordx4 v1, s[4:7], s54 offen lds
    s_add_u32 s54, s54, 4096
    s_add_u32 m0, s59, 64512
    s_nop 0
    buffer_load_dwordx4 v1, s[4:7], s53 offen lds
    s_add_u32 s53, s53, 4096
    s_add_u32 m0, s60, 64512
    s_nop 0
    buffer_load_dwordx4 v1, s[4:7], s54 offen lds
    s_add_u32 s54, s54, 4096
    s_add_u32 m0, s59, 73728
    s_nop 0
    buffer_load_dwordx4 v1, s[4:7], s53 offen lds
    s_add_u32 s53, s53, 4096
    s_add_u32 m0, s60, 73728
    s_nop 0
    buffer_load_dwordx4 v1, s[4:7], s54 offen lds
    s_add_u32 s54, s54, 4096
    s_add_u32 m0, s59, 82944
    s_nop 0
    buffer_load_dwordx4 v1, s[4:7], s53 offen lds
    s_add_u32 s53, s53, 4096
    s_add_u32 m0, s60, 82944
    s_nop 0
    buffer_load_dwordx4 v1, s[4:7], s54 offen lds
    s_add_u32 s54, s54, 4096
    s_add_u32 m0, s59, 92160
    s_nop 0
    buffer_load_dwordx4 v1, s[4:7], s53 offen lds
    s_add_u32 s53, s53, 4096
    s_add_u32 m0, s60, 92160
    s_nop 0
    buffer_load_dwordx4 v1, s[4:7], s54 offen lds
    s_add_u32 s54, s54, 4096
    s_waitcnt vmcnt(20)
    s_barrier
    ds_read_b128 v[28:31], v2 offset:0
    ds_read_b128 v[32:35], v2 offset:1024
    ds_read_b128 v[36:39], v2 offset:2048
    ds_read_b128 v[40:43], v2 offset:3072
    ds_read_b128 v[44:47], v2 offset:4096
    ds_read_b128 v[48:51], v3 offset:0
    s_mov_b32 s50, 3
gloop_118:
    s_waitcnt vmcnt(18)
    s_barrier
    s_add_u32 m0, s59, 101376
    s_nop 0
    buffer_load_dwordx4 v1, s[4:7], s53 offen lds
    s_add_u32 s53, s53, 4096
    s_add_u32 m0, s60, 101376
    s_nop 0
    buffer_load_dwordx4 v1, s[4:7], s54 offen lds
    s_add_u32 s54, s54, 4096
    s_waitcnt lgkmcnt(0)
    ds_read_b128 v[52:55], v2 offset:9216
    ds_read_b128 v[56:59], v2 offset:10240
    ds_read_b128 v[60:63], v2 offset:11264
    ds_read_b128 v[64:67], v2 offset:12288
    ds_read_b128 v[68:71], v2 offset:13312
    ds_read_b128 v[72:75], v3 offset:9216
    v_mfma_f32_16x16x32_bf16 v[8:11], v[28:31], v[48:51], v[8:11]
    v_mfma_f32_16x16x32_bf16 v[12:15], v[32:35], v[48:51], v[12:15]
    v_mfma_f32_16x16x32_bf16 v[16:19], v[36:39], v[48:51], v[16:19]
    v_mfma_f32_16x16x32_bf16 v[20:23], v[40:43], v[48:51], v[20:23]
    v_mfma_f32_16x16x32_bf16 v[24:27], v[44:47], v[48:51], v[24:27]
    s_waitcnt vmcnt(18)
    s_barrier
    s_add_u32 m0, s59, 0
    s_nop 0
    buffer_load_dwordx4 v1, s[4:7], s53 offen lds
    s_add_u32 s53, s53, 4096
    s_add_u32 m0, s60, 0
    s_nop 0
    buffer_load_dwordx4 v1, s[4:7], s54 offen lds
    s_add_u32 s54, s54, 4096
    s_waitcnt lgkmcnt(0)
    ds_read_b128 v[28:31], v2 offset:18432
    ds_read_b128 v[32:35], v2 offset:19456
    ds_read_b128 v[36:39], v2 offset:20480
    ds_read_b128 v[40:43], v2 offset:21504
    ds_read_b128 v[44:47], v2 offset:22528
    ds_read_b128 v[48:51], v3 offset:18432
    v_mfma_f32_16x16x32_bf16 v[8:11], v[52:55], v[72:75], v[8:11]
    v_mfma_f32_16x16x32_bf16 v[12:15], v[56:59], v[72:75], v[12:15]
    v_mfma_f32_16x16x32_bf16 v[16:19], v[60:63], v[72:75], v[16:19]
    v_mfma_f32_16x16x32_bf16 v[20:23], v[64:67], v[72:75], v[20:23]
    v_mfma_f32_16x16x32_bf16 v[24:27], v[68:71], v[72:75], v[24:27]
    s_waitcnt vmcnt(18)
    s_barrier
    s_add_u32 m0, s59, 9216
    s_nop 0
    buffer_load_dwordx4 v1, s[4:7], s53 offen lds
    s_add_u32 s53, s53, 4096
    s_add_u32 m0, s60, 9216
    s_nop 0
    buffer_load_dwordx4 v1, s[4:7], s54 offen lds
    s_add_u32 s54, s54, 4096
    s_waitcnt lgkmcnt(0)
    ds_read_b128 v[52:55], v2 offset:27648
    ds_read_b128 v[56:59], v2 offset:28672
    ds_read_b128 v[60:63], v2 offset:29696
    ds_read_b128 v[64:67], v2 offset:30720
    ds_read_b128 v[68:71], v2 offset:31744
    ds_read_b128 v[72:75], v3 offset:27648
    v_mfma_f32_16x16x32_bf16 v[8:11], v[28:31], v[48:51], v[8:11]
    v_mfma_f32_16x16x32_bf16 v[12:15], v[32:35], v[48:51], v[12:15]
    v_mfma_f32_16x16x32_bf16 v[16:19], v[36:39], v[48:51], v[16:19]
    v_mfma_f32_16x16x32_bf16 v[20:23], v[40:43], v[48:51], v[20:23]
    v_mfma_f32_16x16x32_bf16 v[24:27], v[44:47], v[48:51], v[24:27]
    s_waitcnt vmcnt(18)
    s_barrier
    s_add_u32 m0, s59, 18432
    s_nop 0
    buffer_load_dwordx4 v1, s[4:7], s53 offen lds
    s_add_u32 s53, s53, 4096
    s_add_u32 m0, s60, 18432
    s_nop 0
    buffer_load_dwordx4 v1, s[4:7], s54 offen lds
    s_add_u32 s54, s54, 4096
    s_waitcnt lgkmcnt(0)
    ds_read_b128 v[28:31], v2 offset:36864
    ds_read_b128 v[32:35], v2 offset:37888
    ds_read_b128 v[36:39], v2 offset:38912
    ds_read_b128 v[40:43], v2 offset:39936
    ds_read_b128 v[44:47], v2 offset:40960
    ds_read_b128 v[48:51], v3 offset:36864
    v_mfma_f32_16x16x32_bf16 v[8:11], v[52:55], v[72:75], v[8:11]
    v_mfma_f32_16x16x32_bf16 v[12:15], v[56:59], v[72:75], v[12:15]
    v_mfma_f32_16x16x32_bf16 v[16:19], v[60:63], v[72:75], v[16:19]
    v_mfma_f32_16x16x32_bf16 v[20:23], v[64:67], v[72:75], v[20:23]
    v_mfma_f32_16x16x32_bf16 v[24:27], v[68:71], v[72:75], v[24:27]
    s_waitcnt vmcnt(18)
    s_barrier
    s_add_u32 m0, s59, 27648
    s_nop 0
    buffer_load_dwordx4 v1, s[4:7], s53 offen lds
    s_add_u32 s53, s53, 4096
    s_add_u32 m0, s60, 27648
    s_nop 0
    buffer_load_dwordx4 v1, s[4:7], s54 offen lds
    s_add_u32 s54, s54, 4096
    s_waitcnt lgkmcnt(0)
    ds_read_b128 v[52:55], v2 offset:46080
    ds_read_b128 v[56:59], v2 offset:47104
    ds_read_b128 v[60:63], v2 offset:48128
    ds_read_b128 v[64:67], v2 offset:49152
    ds_read_b128 v[68:71], v2 offset:50176
    ds_read_b128 v[72:75], v3 offset:46080
    v_mfma_f32_16x16x32_bf16 v[8:11], v[28:31], v[48:51], v[8:11]
    v_mfma_f32_16x16x32_bf16 v[12:15], v[32:35], v[48:51], v[12:15]
    v_mfma_f32_16x16x32_bf16 v[16:19], v[36:39], v[48:51], v[16:19]
    v_mfma_f32_16x16x32_bf16 v[20:23], v[40:43], v[48:51], v[20:23]
    v_mfma_f32_16x16x32_bf16 v[24:27], v[44:47], v[48:51], v[24:27]
    s_waitcnt vmcnt(18)
    s_barrier
    s_add_u32 m0, s59, 36864
    s_nop 0
    buffer_load_dwordx4 v1, s[4:7], s53 offen lds
    s_add_u32 s53, s53, 4096
    s_add_u32 m0, s60, 36864
    s_nop 0
    buffer_load_dwordx4 v1, s[4:7], s54 offen lds
    s_add_u32 s54, s54, 4096
    s_waitcnt lgkmcnt(0)
    ds_read_b128 v[28:31], v2 offset:55296
    ds_read_b128 v[32:35], v2 offset:56320
    ds_read_b128 v[36:39], v2 offset:57344
    ds_read_b128 v[40:43], v2 offset:58368
    ds_read_b128 v[44:47], v2 offset:59392
    ds_read_b128 v[48:51], v3 offset:55296
    v_mfma_f32_16x16x32_bf16 v[8:11], v[52:55], v[72:75], v[8:11]
    v_mfma_f32_16x16x32_bf16 v[12:15], v[56:59], v[72:75], v[12:15]
    v_mfma_f32_16x16x32_bf16 v[16:19], v[60:63], v[72:75], v[16:19]
    v_mfma_f32_16x16x32_bf16 v[20:23], v[64:67], v[72:75], v[20:23]
    v_mfma_f32_16x16x32_bf16 v[24:27], v[68:71], v[72:75], v[24:27]
    s_waitcnt vmcnt(18)
    s_barrier
    s_add_u32 m0, s59, 46080
    s_nop 0
    buffer_load_dwordx4 v1, s[4:7], s53 offen lds
    s_add_u32 s53, s53, 4096
    s_add_u32 m0, s60, 46080
    s_nop 0
    buffer_load_dwordx4 v1, s[4:7], s54 offen lds
    s_add_u32 s54, s54, 4096
    s_waitcnt lgkmcnt(0)
    ds_read_b128 v[52:55], v2 offset:64512
    ds_read_b128 v[56:59], v6 offset:0
    ds_read_b128 v[60:63], v6 offset:1024
    ds_read_b128 v[64:67], v6 offset:2048
    ds_read_b128 v[68:71], v6 offset:3072
    ds_read_b128 v[72:75], v3 offset:64512
    v_mfma_f32_16x16x32_bf16 v[8:11], v[28:31], v[48:51], v[8:11]
    v_mfma_f32_16x16x32_bf16 v[12:15], v[32:35], v[48:51], v[12:15]
    v_mfma_f32_16x16x32_bf16 v[16:19], v[36:39], v[48:51], v[16:19]
    v_mfma_f32_16x16x32_bf16 v[20:23], v[40:43], v[48:51], v[20:23]
    v_mfma_f32_16x16x32_bf16 v[24:27], v[44:47], v[48:51], v[24:27]
    s_waitcnt vmcnt(18)
    s_barrier
    s_add_u32 m0, s59, 55296
    s_nop 0
    buffer_load_dwordx4 v1, s[4:7], s53 offen lds
    s_add_u32 s53, s53, 4096
    s_add_u32 m0, s60, 55296
    s_nop 0
    buffer_load_dwordx4 v1, s[4:7], s54 offen lds
    s_add_u32 s54, s54, 4096
    s_waitcnt lgkmcnt(0)
    ds_read_b128 v[28:31], v6 offset:8192
    ds_read_b128 v[32:35], v6 offset:9216
    ds_read_b128 v[36:39], v6 offset:10240
    ds_read_b128 v[40:43], v6 offset:11264
    ds_read_b128 v[44:47], v6 offset:12288
    ds_read_b128 v[48:51], v7 offset:8192
    v_mfma_f32_16x16x32_bf16 v[8:11], v[52:55], v[72:75], v[8:11]
    v_mfma_f32_16x16x32_bf16 v[12:15], v[56:59], v[72:75], v[12:15]
    v_mfma_f32_16x16x32_bf16 v[16:19], v[60:63], v[72:75], v[16:19]
    v_mfma_f32_16x16x32_bf16 v[20:23], v[64:67], v[72:75], v[20:23]
    v_mfma_f32_16x16x32_bf16 v[24:27], v[68:71], v[72:75], v[24:27]
    s_waitcnt vmcnt(18)
    s_barrier
    s_add_u32 m0, s59, 64512
    s_nop 0
    buffer_load_dwordx4 v1, s[4:7], s53 offen lds
    s_add_u32 s53, s53, 4096
    s_add_u32 m0, s60, 64512
    s_nop 0
    buffer_load_dwordx4 v1, s[4:7], s54 offen lds
    s_add_u32 s54, s54, 4096
    s_waitcnt lgkmcnt(0)
    ds_read_b128 v[52:55], v6 offset:17408
    ds_read_b128 v[56:59], v6 offset:18432
    ds_read_b128 v[60:63], v6 offset:19456
    ds_read_b128 v[64:67], v6 offset:20480
    ds_read_b128 v[68:71], v6 offset:21504
    ds_read_b128 v[72:75], v7 offset:17408
    v_mfma_f32_16x16x32_bf16 v[8:11], v[28:31], v[48:51], v[8:11]
    v_mfma_f32_16x16x32_bf16 v[12:15], v[32:35], v[48:51], v[12:15]
    v_mfma_f32_16x16x32_bf16 v[16:19], v[36:39], v[48:51], v[16:19]
    v_mfma_f32_16x16x32_bf16 v[20:23], v[40:43], v[48:51], v[20:23]
    v_mfma_f32_16x16x32_bf16 v[24:27], v[44:47], v[48:51], v[24:27]
    s_waitcnt vmcnt(18)
    s_barrier
    s_add_u32 m0, s59, 73728
    s_nop 0
    buffer_load_dwordx4 v1, s[4:7], s53 offen lds
    s_add_u32 s53, s53, 4096
    s_add_u32 m0, s60, 73728
    s_nop 0
    buffer_load_dwordx4 v1, s[4:7], s54 offen lds
    s_add_u32 s54, s54, 4096
    s_waitcnt lgkmcnt(0)
    ds_read_b128 v[28:31], v6 offset:26624
    ds_read_b128 v[32:35], v6 offset:27648
    ds_read_b128 v[36:39], v6 offset:28672
    ds_read_b128 v[40:43], v6 offset:29696
    ds_read_b128 v[44:47], v6 offset:30720
    ds_read_b128 v[48:51], v7 offset:26624
    v_mfma_f32_16x16x32_bf16 v[8:11], v[52:55], v[72:75], v[8:11]
    v_mfma_f32_16x16x32_bf16 v[12:15], v[56:59], v[72:75], v[12:15]
    v_mfma_f32_16x16x32_bf16 v[16:19], v[60:63], v[72:75], v[16:19]
    v_mfma_f32_16x16x32_bf16 v[20:23], v[64:67], v[72:75], v[20:23]
    v_mfma_f32_16x16x32_bf16 v[24:27], v[68:71], v[72:75], v[24:27]
    s_waitcnt vmcnt(18)
    s_barrier
    s_add_u32 m0, s59, 82944
    s_nop 0
    buffer_load_dwordx4 v1, s[4:7], s53 offen lds
    s_add_u32 s53, s53, 4096
    s_add_u32 m0, s60, 82944
    s_nop 0
    buffer_load_dwordx4 v1, s[4:7], s54 offen lds
    s_add_u32 s54, s54, 4096
    s_waitcnt lgkmcnt(0)
    ds_read_b128 v[52:55], v6 offset:35840
    ds_read_b128 v[56:59], v6 offset:36864
    ds_read_b128 v[60:63], v6 offset:37888
    ds_read_b128 v[64:67], v6 offset:38912
    ds_read_b128 v[68:71], v6 offset:39936
    ds_read_b128 v[72:75], v7 offset:35840
    v_mfma_f32_16x16x32_bf16 v[8:11], v[28:31], v[48:51], v[8:11]
    v_mfma_f32_16x16x32_bf16 v[12:15], v[32:35], v[48:51], v[12:15]
    v_mfma_f32_16x16x32_bf16 v[16:19], v[36:39], v[48:51], v[16:19]
    v_mfma_f32_16x16x32_bf16 v[20:23], v[40:43], v[48:51], v[20:23]
    v_mfma_f32_16x16x32_bf16 v[24:27], v[44:47], v[48:51], v[24:27]
    s_waitcnt vmcnt(18)
    s_barrier
    s_add_u32 m0, s59, 92160
    s_nop 0
    buffer_load_dwordx4 v1, s[4:7], s53 offen lds
    s_add_u32 s53, s53, 4096
    s_add_u32 m0, s60, 92160
    s_nop 0
    buffer_load_dwordx4 v1, s[4:7], s54 offen lds
    s_add_u32 s54, s54, 4096
    s_waitcnt lgkmcnt(0)
    ds_read_b128 v[28:31], v2 offset:0
    ds_read_b128 v[32:35], v2 offset:1024
    ds_read_b128 v[36:39], v2 offset:2048
    ds_read_b128 v[40:43], v2 offset:3072
    ds_read_b128 v[44:47], v2 offset:4096
    ds_read_b128 v[48:51], v3 offset:0
    v_mfma_f32_16x16x32_bf16 v[8:11], v[52:55], v[72:75], v[8:11]
    v_mfma_f32_16x16x32_bf16 v[12:15], v[56:59], v[72:75], v[12:15]
    v_mfma_f32_16x16x32_bf16 v[16:19], v[60:63], v[72:75], v[16:19]
    v_mfma_f32_16x16x32_bf16 v[20:23], v[64:67], v[72:75], v[20:23]
    v_mfma_f32_16x16x32_bf16 v[24:27], v[68:71], v[72:75], v[24:27]
    s_sub_u32 s50, s50, 1
    s_cmp_lg_u32 s50, 0
    s_cbranch_scc1 gloop_118
    s_waitcnt vmcnt(18)
    s_barrier
    s_add_u32 m0, s59, 101376
    s_nop 0
    buffer_load_dwordx4 v1, s[4:7], s53 offen lds
    s_add_u32 s53, s53, 4096
    s_add_u32 m0, s60, 101376
    s_nop 0
    buffer_load_dwordx4 v1, s[4:7], s54 offen lds
    s_add_u32 s54, s54, 4096
    s_waitcnt lgkmcnt(0)
    ds_read_b128 v[52:55], v2 offset:9216
    ds_read_b128 v[56:59], v2 offset:10240
    ds_read_b128 v[60:63], v2 offset:11264
    ds_read_b128 v[64:67], v2 offset:12288
    ds_read_b128 v[68:71], v2 offset:13312
    ds_read_b128 v[72:75], v3 offset:9216
    v_mfma_f32_16x16x32_bf16 v[8:11], v[28:31], v[48:51], v[8:11]
    v_mfma_f32_16x16x32_bf16 v[12:15], v[32:35], v[48:51], v[12:15]
    v_mfma_f32_16x16x32_bf16 v[16:19], v[36:39], v[48:51], v[16:19]
    v_mfma_f32_16x16x32_bf16 v[20:23], v[40:43], v[48:51], v[20:23]
    v_mfma_f32_16x16x32_bf16 v[24:27], v[44:47], v[48:51], v[24:27]
    s_waitcnt vmcnt(18)
    s_barrier
    s_add_u32 m0, s59, 0
    s_nop 0
    buffer_load_dwordx4 v1, s[4:7], s53 offen lds
    s_add_u32 s53, s53, 4096
    s_add_u32 m0, s60, 0
    s_nop 0
    buffer_load_dwordx4 v1, s[4:7], s54 offen lds
    s_add_u32 s54, s54, 4096
    s_waitcnt lgkmcnt(0)
    ds_read_b128 v[28:31], v2 offset:18432
    ds_read_b128 v[32:35], v2 offset:19456
    ds_read_b128 v[36:39], v2 offset:20480
    ds_read_b128 v[40:43], v2 offset:21504
    ds_read_b128 v[44:47], v2 offset:22528
    ds_read_b128 v[48:51], v3 offset:18432
    v_mfma_f32_16x16x32_bf16 v[8:11], v[52:55], v[72:75], v[8:11]
    v_mfma_f32_16x16x32_bf16 v[12:15], v[56:59], v[72:75], v[12:15]
    v_mfma_f32_16x16x32_bf16 v[16:19], v[60:63], v[72:75], v[16:19]
    v_mfma_f32_16x16x32_bf16 v[20:23], v[64:67], v[72:75], v[20:23]
    v_mfma_f32_16x16x32_bf16 v[24:27], v[68:71], v[72:75], v[24:27]
    s_waitcnt vmcnt(18)
    s_barrier
    s_add_u32 m0, s59, 9216
    s_nop 0
    buffer_load_dwordx4 v1, s[4:7], s53 offen lds
    s_add_u32 s53, s53, 4096
    s_add_u32 m0, s60, 9216
    s_nop 0
    buffer_load_dwordx4 v1, s[4:7], s54 offen lds
    s_add_u32 s54, s54, 4096
    s_waitcnt lgkmcnt(0)
    ds_read_b128 v[52:55], v2 offset:27648
    ds_read_b128 v[56:59], v2 offset:28672
    ds_read_b128 v[60:63], v2 offset:29696
    ds_read_b128 v[64:67], v2 offset:30720
    ds_read_b128 v[68:71], v2 offset:31744
    ds_read_b128 v[72:75], v3 offset:27648
    v_mfma_f32_16x16x32_bf16 v[8:11], v[28:31], v[48:51], v[8:11]
    v_mfma_f32_16x16x32_bf16 v[12:15], v[32:35], v[48:51], v[12:15]
    v_mfma_f32_16x16x32_bf16 v[16:19], v[36:39], v[48:51], v[16:19]
    v_mfma_f32_16x16x32_bf16 v[20:23], v[40:43], v[48:51], v[20:23]
    v_mfma_f32_16x16x32_bf16 v[24:27], v[44:47], v[48:51], v[24:27]
    s_waitcnt vmcnt(18)
    s_barrier
    s_add_u32 m0, s59, 18432
    s_nop 0
    buffer_load_dwordx4 v1, s[4:7], s53 offen lds
    s_add_u32 s53, s53, 4096
    s_add_u32 m0, s60, 18432
    s_nop 0
    buffer_load_dwordx4 v1, s[4:7], s54 offen lds
    s_add_u32 s54, s54, 4096
    s_waitcnt lgkmcnt(0)
    ds_read_b128 v[28:31], v2 offset:36864
    ds_read_b128 v[32:35], v2 offset:37888
    ds_read_b128 v[36:39], v2 offset:38912
    ds_read_b128 v[40:43], v2 offset:39936
    ds_read_b128 v[44:47], v2 offset:40960
    ds_read_b128 v[48:51], v3 offset:36864
    v_mfma_f32_16x16x32_bf16 v[8:11], v[52:55], v[72:75], v[8:11]
    v_mfma_f32_16x16x32_bf16 v[12:15], v[56:59], v[72:75], v[12:15]
    v_mfma_f32_16x16x32_bf16 v[16:19], v[60:63], v[72:75], v[16:19]
    v_mfma_f32_16x16x32_bf16 v[20:23], v[64:67], v[72:75], v[20:23]
    v_mfma_f32_16x16x32_bf16 v[24:27], v[68:71], v[72:75], v[24:27]
    s_waitcnt vmcnt(18)
    s_barrier
    s_add_u32 m0, s59, 27648
    s_nop 0
    buffer_load_dwordx4 v1, s[4:7], s53 offen lds
    s_add_u32 s53, s53, 4096
    s_add_u32 m0, s60, 27648
    s_nop 0
    buffer_load_dwordx4 v1, s[4:7], s54 offen lds
    s_add_u32 s54, s54, 4096
    s_waitcnt lgkmcnt(0)
    ds_read_b128 v[52:55], v2 offset:46080
    ds_read_b128 v[56:59], v2 offset:47104
    ds_read_b128 v[60:63], v2 offset:48128
    ds_read_b128 v[64:67], v2 offset:49152
    ds_read_b128 v[68:71], v2 offset:50176
    ds_read_b128 v[72:75], v3 offset:46080
    v_mfma_f32_16x16x32_bf16 v[8:11], v[28:31], v[48:51], v[8:11]
    v_mfma_f32_16x16x32_bf16 v[12:15], v[32:35], v[48:51], v[12:15]
    v_mfma_f32_16x16x32_bf16 v[16:19], v[36:39], v[48:51], v[16:19]
    v_mfma_f32_16x16x32_bf16 v[20:23], v[40:43], v[48:51], v[20:23]
    v_mfma_f32_16x16x32_bf16 v[24:27], v[44:47], v[48:51], v[24:27]
    s_waitcnt vmcnt(18)
    s_barrier
    s_add_u32 m0, s59, 36864
    s_nop 0
    buffer_load_dwordx4 v1, s[4:7], s53 offen lds
    s_add_u32 s53, s53, 4096
    s_add_u32 m0, s60, 36864
    s_nop 0
    buffer_load_dwordx4 v1, s[4:7], s54 offen lds
    s_add_u32 s54, s54, 4096
    s_waitcnt lgkmcnt(0)
    ds_read_b128 v[28:31], v2 offset:55296
    ds_read_b128 v[32:35], v2 offset:56320
    ds_read_b128 v[36:39], v2 offset:57344
    ds_read_b128 v[40:43], v2 offset:58368
    ds_read_b128 v[44:47], v2 offset:59392
    ds_read_b128 v[48:51], v3 offset:55296
    v_mfma_f32_16x16x32_bf16 v[8:11], v[52:55], v[72:75], v[8:11]
    v_mfma_f32_16x16x32_bf16 v[12:15], v[56:59], v[72:75], v[12:15]
    v_mfma_f32_16x16x32_bf16 v[16:19], v[60:63], v[72:75], v[16:19]
    v_mfma_f32_16x16x32_bf16 v[20:23], v[64:67], v[72:75], v[20:23]
    v_mfma_f32_16x16x32_bf16 v[24:27], v[68:71], v[72:75], v[24:27]
    s_waitcnt vmcnt(18)
    s_barrier
    s_add_u32 m0, s59, 46080
    s_nop 0
    buffer_load_dwordx4 v1, s[4:7], s53 offen lds
    s_add_u32 s53, s53, 4096
    s_add_u32 m0, s60, 46080
    s_nop 0
    buffer_load_dwordx4 v1, s[4:7], s54 offen lds
    s_add_u32 s54, s54, 4096
    s_waitcnt lgkmcnt(0)
    ds_read_b128 v[52:55], v2 offset:64512
    ds_read_b128 v[56:59], v6 offset:0
    ds_read_b128 v[60:63], v6 offset:1024
    ds_read_b128 v[64:67], v6 offset:2048
    ds_read_b128 v[68:71], v6 offset:3072
    ds_read_b128 v[72:75], v3 offset:64512
    v_mfma_f32_16x16x32_bf16 v[8:11], v[28:31], v[48:51], v[8:11]
    v_mfma_f32_16x16x32_bf16 v[12:15], v[32:35], v[48:51], v[12:15]
    v_mfma_f32_16x16x32_bf16 v[16:19], v[36:39], v[48:51], v[16:19]
    v_mfma_f32_16x16x32_bf16 v[20:23], v[40:43], v[48:51], v[20:23]
    v_mfma_f32_16x16x32_bf16 v[24:27], v[44:47], v[48:51], v[24:27]
    s_waitcnt vmcnt(18)
    s_barrier
    s_waitcnt lgkmcnt(0)
    ds_read_b128 v[28:31], v6 offset:8192
    ds_read_b128 v[32:35], v6 offset:9216
    ds_read_b128 v[36:39], v6 offset:10240
    ds_read_b128 v[40:43], v6 offset:11264
    ds_read_b128 v[44:47], v6 offset:12288
    ds_read_b128 v[48:51], v7 offset:8192
    v_mfma_f32_16x16x32_bf16 v[8:11], v[52:55], v[72:75], v[8:11]
    v_mfma_f32_16x16x32_bf16 v[12:15], v[56:59], v[72:75], v[12:15]
    v_mfma_f32_16x16x32_bf16 v[16:19], v[60:63], v[72:75], v[16:19]
    v_mfma_f32_16x16x32_bf16 v[20:23], v[64:67], v[72:75], v[20:23]
    v_mfma_f32_16x16x32_bf16 v[24:27], v[68:71], v[72:75], v[24:27]
    s_waitcnt vmcnt(16)
    s_barrier
    s_waitcnt lgkmcnt(0)
    ds_read_b128 v[52:55], v6 offset:17408
    ds_read_b128 v[56:59], v6 offset:18432
    ds_read_b128 v[60:63], v6 offset:19456
    ds_read_b128 v[64:67], v6 offset:20480
    ds_read_b128 v[68:71], v6 offset:21504
    ds_read_b128 v[72:75], v7 offset:17408
    v_mfma_f32_16x16x32_bf16 v[8:11], v[28:31], v[48:51], v[8:11]
    v_mfma_f32_16x16x32_bf16 v[12:15], v[32:35], v[48:51], v[12:15]
    v_mfma_f32_16x16x32_bf16 v[16:19], v[36:39], v[48:51], v[16:19]
    v_mfma_f32_16x16x32_bf16 v[20:23], v[40:43], v[48:51], v[20:23]
    v_mfma_f32_16x16x32_bf16 v[24:27], v[44:47], v[48:51], v[24:27]
    s_waitcnt vmcnt(14)
    s_barrier
    s_waitcnt lgkmcnt(0)
    ds_read_b128 v[28:31], v6 offset:26624
    ds_read_b128 v[32:35], v6 offset:27648
    ds_read_b128 v[36:39], v6 offset:28672
    ds_read_b128 v[40:43], v6 offset:29696
    ds_read_b128 v[44:47], v6 offset:30720
    ds_read_b128 v[48:51], v7 offset:26624
    v_mfma_f32_16x16x32_bf16 v[8:11], v[52:55], v[72:75], v[8:11]
    v_mfma_f32_16x16x32_bf16 v[12:15], v[56:59], v[72:75], v[12:15]
    v_mfma_f32_16x16x32_bf16 v[16:19], v[60:63], v[72:75], v[16:19]
    v_mfma_f32_16x16x32_bf16 v[20:23], v[64:67], v[72:75], v[20:23]
    v_mfma_f32_16x16x32_bf16 v[24:27], v[68:71], v[72:75], v[24:27]
    s_waitcnt vmcnt(12)
    s_barrier
    s_waitcnt lgkmcnt(0)
    ds_read_b128 v[52:55], v6 offset:35840
    ds_read_b128 v[56:59], v6 offset:36864
    ds_read_b128 v[60:63], v6 offset:37888
    ds_read_b128 v[64:67], v6 offset:38912
    ds_read_b128 v[68:71], v6 offset:39936
    ds_read_b128 v[72:75], v7 offset:35840
    v_mfma_f32_16x16x32_bf16 v[8:11], v[28:31], v[48:51], v[8:11]
    v_mfma_f32_16x16x32_bf16 v[12:15], v[32:35], v[48:51], v[12:15]
    v_mfma_f32_16x16x32_bf16 v[16:19], v[36:39], v[48:51], v[16:19]
    v_mfma_f32_16x16x32_bf16 v[20:23], v[40:43], v[48:51], v[20:23]
    v_mfma_f32_16x16x32_bf16 v[24:27], v[44:47], v[48:51], v[24:27]
    s_waitcnt vmcnt(10)
    s_barrier
    s_waitcnt lgkmcnt(0)
    ds_read_b128 v[28:31], v2 offset:0
    ds_read_b128 v[32:35], v2 offset:1024
    ds_read_b128 v[36:39], v2 offset:2048
    ds_read_b128 v[40:43], v2 offset:3072
    ds_read_b128 v[44:47], v2 offset:4096
    ds_read_b128 v[48:51], v3 offset:0
    v_mfma_f32_16x16x32_bf16 v[8:11], v[52:55], v[72:75], v[8:11]
    v_mfma_f32_16x16x32_bf16 v[12:15], v[56:59], v[72:75], v[12:15]
    v_mfma_f32_16x16x32_bf16 v[16:19], v[60:63], v[72:75], v[16:19]
    v_mfma_f32_16x16x32_bf16 v[20:23], v[64:67], v[72:75], v[20:23]
    v_mfma_f32_16x16x32_bf16 v[24:27], v[68:71], v[72:75], v[24:27]
    s_waitcnt vmcnt(8)
    s_barrier
    s_waitcnt lgkmcnt(0)
    ds_read_b128 v[52:55], v2 offset:9216
    ds_read_b128 v[56:59], v2 offset:10240
    ds_read_b128 v[60:63], v2 offset:11264
    ds_read_b128 v[64:67], v2 offset:12288
    ds_read_b128 v[68:71], v2 offset:13312
    ds_read_b128 v[72:75], v3 offset:9216
    v_mfma_f32_16x16x32_bf16 v[8:11], v[28:31], v[48:51], v[8:11]
    v_mfma_f32_16x16x32_bf16 v[12:15], v[32:35], v[48:51], v[12:15]
    v_mfma_f32_16x16x32_bf16 v[16:19], v[36:39], v[48:51], v[16:19]
    v_mfma_f32_16x16x32_bf16 v[20:23], v[40:43], v[48:51], v[20:23]
    v_mfma_f32_16x16x32_bf16 v[24:27], v[44:47], v[48:51], v[24:27]
    s_waitcnt vmcnt(6)
    s_barrier
    s_waitcnt lgkmcnt(0)
    ds_read_b128 v[28:31], v2 offset:18432
    ds_read_b128 v[32:35], v2 offset:19456
    ds_read_b128 v[36:39], v2 offset:20480
    ds_read_b128 v[40:43], v2 offset:21504
    ds_read_b128 v[44:47], v2 offset:22528
    ds_read_b128 v[48:51], v3 offset:18432
    v_mfma_f32_16x16x32_bf16 v[8:11], v[52:55], v[72:75], v[8:11]
    v_mfma_f32_16x16x32_bf16 v[12:15], v[56:59], v[72:75], v[12:15]
    v_mfma_f32_16x16x32_bf16 v[16:19], v[60:63], v[72:75], v[16:19]
    v_mfma_f32_16x16x32_bf16 v[20:23], v[64:67], v[72:75], v[20:23]
    v_mfma_f32_16x16x32_bf16 v[24:27], v[68:71], v[72:75], v[24:27]
    s_waitcnt vmcnt(4)
    s_barrier
    s_waitcnt lgkmcnt(0)
    ds_read_b128 v[52:55], v2 offset:27648
    ds_read_b128 v[56:59], v2 offset:28672
    ds_read_b128 v[60:63], v2 offset:29696
    ds_read_b128 v[64:67], v2 offset:30720
    ds_read_b128 v[68:71], v2 offset:31744
    ds_read_b128 v[72:75], v3 offset:27648
    v_mfma_f32_16x16x32_bf16 v[8:11], v[28:31], v[48:51], v[8:11]
    v_mfma_f32_16x16x32_bf16 v[12:15], v[32:35], v[48:51], v[12:15]
    v_mfma_f32_16x16x32_bf16 v[16:19], v[36:39], v[48:51], v[16:19]
    v_mfma_f32_16x16x32_bf16 v[20:23], v[40:43], v[48:51], v[20:23]
    v_mfma_f32_16x16x32_bf16 v[24:27], v[44:47], v[48:51], v[24:27]
    s_waitcnt vmcnt(2)
    s_barrier
    s_waitcnt lgkmcnt(0)
    ds_read_b128 v[28:31], v2 offset:36864
    ds_read_b128 v[32:35], v2 offset:37888
    ds_read_b128 v[36:39], v2 offset:38912
    ds_read_b128 v[40:43], v2 offset:39936
    ds_read_b128 v[44:47], v2 offset:40960
    ds_read_b128 v[48:51], v3 offset:36864
    v_mfma_f32_16x16x32_bf16 v[8:11], v[52:55], v[72:75], v[8:11]
    v_mfma_f32_16x16x32_bf16 v[12:15], v[56:59], v[72:75], v[12:15]
    v_mfma_f32_16x16x32_bf16 v[16:19], v[60:63], v[72:75], v[16:19]
    v_mfma_f32_16x16x32_bf16 v[20:23], v[64:67], v[72:75], v[20:23]
    v_mfma_f32_16x16x32_bf16 v[24:27], v[68:71], v[72:75], v[24:27]
    s_waitcnt vmcnt(0)
    s_barrier
    s_waitcnt lgkmcnt(0)
    ds_read_b128 v[52:55], v2 offset:46080
    ds_read_b128 v[56:59], v2 offset:47104
    ds_read_b128 v[60:63], v2 offset:48128
    ds_read_b128 v[64:67], v2 offset:49152
    ds_read_b128 v[68:71], v2 offset:50176
    ds_read_b128 v[72:75], v3 offset:46080
    v_mfma_f32_16x16x32_bf16 v[8:11], v[28:31], v[48:51], v[8:11]
    v_mfma_f32_16x16x32_bf16 v[12:15], v[32:35], v[48:51], v[12:15]
    v_mfma_f32_16x16x32_bf16 v[16:19], v[36:39], v[48:51], v[16:19]
    v_mfma_f32_16x16x32_bf16 v[20:23], v[40:43], v[48:51], v[20:23]
    v_mfma_f32_16x16x32_bf16 v[24:27], v[44:47], v[48:51], v[24:27]
    s_waitcnt lgkmcnt(0)
    v_mfma_f32_16x16x32_bf16 v[8:11], v[52:55], v[72:75], v[8:11]
    v_mfma_f32_16x16x32_bf16 v[12:15], v[56:59], v[72:75], v[12:15]
    v_mfma_f32_16x16x32_bf16 v[16:19], v[60:63], v[72:75], v[16:19]
    v_mfma_f32_16x16x32_bf16 v[20:23], v[64:67], v[72:75], v[20:23]
    v_mfma_f32_16x16x32_bf16 v[24:27], v[68:71], v[72:75], v[24:27]
gbe_116:
    s_nop 7
    s_lshl_b32 s58, s67, 6
    s_lshl_b32 s59, s3, 4
    s_add_u32 s58, s58, s59
    s_mul_i32 s59, s66, 160
    s_mov_b32 s8, s42
    s_and_b32 s9, s43, 0xffff
    s_mov_b32 s10, 0x10000000
    s_mov_b32 s11, 0x00020000
    s_mov_b32 s55, 110587904
    s_mov_b32 s12, s38
    s_and_b32 s13, s39, 0xffff
    s_mov_b32 s14, 0x280000
    s_mov_b32 s15, 0x00020000
    s_mov_b32 s56, 0
    s_mul_i32 s57, s58, 1280
    s_add_u32 s57, s57, s59
    s_add_u32 s55, s55, s57
    s_add_u32 s56, s56, s57
    v_and_b32 v4, 15, v0
    v_lshrrev_b32 v5, 4, v0
    v_mul_u32_u24 v4, 1280, v4
    v_lshl_add_u32 v4, v5, 3, v4
    buffer_load_dwordx2 v[28:29], v4, s[8:11], s55 offen offset:0
    buffer_load_dwordx2 v[30:31], v4, s[8:11], s55 offen offset:32
    buffer_load_dwordx2 v[32:33], v4, s[8:11], s55 offen offset:64
    buffer_load_dwordx2 v[34:35], v4, s[8:11], s55 offen offset:96
    buffer_load_dwordx2 v[36:37], v4, s[8:11], s55 offen offset:128
    s_waitcnt vmcnt(0)
    v_cvt_pk_bf16_f32 v8, v8, v9
    v_and_b32 v9, 0xffff0000, v8
    v_lshlrev_b32 v8, 16, v8
    v_lshlrev_b32 v6, 16, v28
    v_and_b32 v7, 0xffff0000, v28
    v_add_f32 v6, v6, v8
    v_add_f32 v7, v7, v9
    v_cvt_pk_bf16_f32 v28, v6, v7
    v_cvt_pk_bf16_f32 v10, v10, v11
    v_and_b32 v11, 0xffff0000, v10
    v_lshlrev_b32 v10, 16, v10
    v_lshlrev_b32 v6, 16, v29
    v_and_b32 v7, 0xffff0000, v29
    v_add_f32 v6, v6, v10
    v_add_f32 v7, v7, v11
    v_cvt_pk_bf16_f32 v29, v6, v7
    buffer_store_dwordx2 v[28:29], v4, s[12:15], s56 offen offset:0
    v_cvt_pk_bf16_f32 v12, v12, v13
    v_and_b32 v13, 0xffff0000, v12
    v_lshlrev_b32 v12, 16, v12
    v_lshlrev_b32 v6, 16, v30
    v_and_b32 v7, 0xffff0000, v30
    v_add_f32 v6, v6, v12
    v_add_f32 v7, v7, v13
    v_cvt_pk_bf16_f32 v30, v6, v7
    v_cvt_pk_bf16_f32 v14, v14, v15
    v_and_b32 v15, 0xffff0000, v14
    v_lshlrev_b32 v14, 16, v14
    v_lshlrev_b32 v6, 16, v31
    v_and_b32 v7, 0xffff0000, v31
    v_add_f32 v6, v6, v14
    v_add_f32 v7, v7, v15
    v_cvt_pk_bf16_f32 v31, v6, v7
    buffer_store_dwordx2 v[30:31], v4, s[12:15], s56 offen offset:32
    v_cvt_pk_bf16_f32 v16, v16, v17
    v_and_b32 v17, 0xffff0000, v16
    v_lshlrev_b32 v16, 16, v16
    v_lshlrev_b32 v6, 16, v32
    v_and_b32 v7, 0xffff0000, v32
    v_add_f32 v6, v6, v16
    v_add_f32 v7, v7, v17
    v_cvt_pk_bf16_f32 v32, v6, v7
    v_cvt_pk_bf16_f32 v18, v18, v19
    v_and_b32 v19, 0xffff0000, v18
    v_lshlrev_b32 v18, 16, v18
    v_lshlrev_b32 v6, 16, v33
    v_and_b32 v7, 0xffff0000, v33
    v_add_f32 v6, v6, v18
    v_add_f32 v7, v7, v19
    v_cvt_pk_bf16_f32 v33, v6, v7
    buffer_store_dwordx2 v[32:33], v4, s[12:15], s56 offen offset:64
    v_cvt_pk_bf16_f32 v20, v20, v21
    v_and_b32 v21, 0xffff0000, v20
    v_lshlrev_b32 v20, 16, v20
    v_lshlrev_b32 v6, 16, v34
    v_and_b32 v7, 0xffff0000, v34
    v_add_f32 v6, v6, v20
    v_add_f32 v7, v7, v21
    v_cvt_pk_bf16_f32 v34, v6, v7
    v_cvt_pk_bf16_f32 v22, v22, v23
    v_and_b32 v23, 0xffff0000, v22
    v_lshlrev_b32 v22, 16, v22
    v_lshlrev_b32 v6, 16, v35
    v_and_b32 v7, 0xffff0000, v35
    v_add_f32 v6, v6, v22
    v_add_f32 v7, v7, v23
    v_cvt_pk_bf16_f32 v35, v6, v7
    buffer_store_dwordx2 v[34:35], v4, s[12:15], s56 offen offset:96
    v_cvt_pk_bf16_f32 v24, v24, v25
    v_and_b32 v25, 0xffff0000, v24
    v_lshlrev_b32 v24, 16, v24
    v_lshlrev_b32 v6, 16, v36
    v_and_b32 v7, 0xffff0000, v36
    v_add_f32 v6, v6, v24
    v_add_f32 v7, v7, v25
    v_cvt_pk_bf16_f32 v36, v6, v7
    v_cvt_pk_bf16_f32 v26, v26, v27
    v_and_b32 v27, 0xffff0000, v26
    v_lshlrev_b32 v26, 16, v26
    v_lshlrev_b32 v6, 16, v37
    v_and_b32 v7, 0xffff0000, v37
    v_add_f32 v6, v6, v26
    v_add_f32 v7, v7, v27
    v_cvt_pk_bf16_f32 v37, v6, v7
    buffer_store_dwordx2 v[36:37], v4, s[12:15], s56 offen offset:128
    s_barrier
    s_add_u32 s74, s74, 1
    s_cmp_lt_u32 s74, 13
    s_cbranch_scc1 chain_dploop
chain_end:
    s_endpgm
.globl osmall_kernel
.p2align 8
.type osmall_kernel,@function
osmall_kernel:
    s_cmp_ge_u32 s2, 640
    s_cbranch_scc1 osmall_kernel_end
    s_load_dwordx16 s[16:31], s[0:1], 0
    s_load_dwordx8 s[32:39], s[0:1], 64
    s_load_dwordx4 s[40:43], s[0:1], 96
    v_lshrrev_b32 v1, 6, v0
    s_nop 0
    v_readfirstlane_b32 s3, v1
    v_and_b32 v0, 63, v0
    s_mov_b32 s46, 0x6666667
    s_mul_hi_u32 s67, s2, s46
    s_mul_i32 s46, s67, 40
    s_sub_u32 s66, s2, s46
    s_add_u32 s67, s67, 112
    s_waitcnt lgkmcnt(0)
    s_mov_b32 s4, s42
    s_and_b32 s5, s43, 0xffff
    s_mov_b32 s6, 0x10000000
    s_mov_b32 s7, 0x00020000
    s_lshr_b32 s44, s66, 2
    s_mul_i32 s44, s44, 524288
    s_and_b32 s46, s66, 3
    s_lshl_b32 s46, s46, 10
    s_add_u32 s44, s44, s46
    s_add_u32 s44, s44, 18350080
    s_lshr_b32 s45, s67, 2
    s_mul_i32 s45, s45, 524288
    s_and_b32 s46, s67, 3
    s_lshl_b32 s46, s46, 10
    s_add_u32 s45, s45, s46
    s_add_u32 s45, s45, 93810688
    s_mul_i32 s46, s3, 65536
    s_add_u32 s44, s44, s46
    s_add_u32 s45, s45, s46
    v_lshlrev_b32 v1, 4, v0
    buffer_load_dwordx4 v[16:19], v1, s[4:7], s44 offen
    buffer_load_dwordx4 v[20:23], v1, s[4:7], s45 offen
    s_add_u32 s44, s44, 4096
    s_add_u32 s45, s45, 4096
    buffer_load_dwordx4 v[24:27], v1, s[4:7], s44 offen
    buffer_load_dwordx4 v[28:31], v1, s[4:7], s45 offen
    s_add_u32 s44, s44, 4096
    s_add_u32 s45, s45, 4096
    buffer_load_dwordx4 v[32:35], v1, s[4:7], s44 offen
    buffer_load_dwordx4 v[36:39], v1, s[4:7], s45 offen
    s_add_u32 s44, s44, 4096
    s_add_u32 s45, s45, 4096
    buffer_load_dwordx4 v[40:43], v1, s[4:7], s44 offen
    buffer_load_dwordx4 v[44:47], v1, s[4:7], s45 offen
    s_add_u32 s44, s44, 4096
    s_add_u32 s45, s45, 4096
    buffer_load_dwordx4 v[48:51], v1, s[4:7], s44 offen
    buffer_load_dwordx4 v[52:55], v1, s[4:7], s45 offen
    s_add_u32 s44, s44, 4096
    s_add_u32 s45, s45, 4096
    buffer_load_dwordx4 v[56:59], v1, s[4:7], s44 offen
    buffer_load_dwordx4 v[60:63], v1, s[4:7], s45 offen
    s_add_u32 s44, s44, 4096
    s_add_u32 s45, s45, 4096
    buffer_load_dwordx4 v[64:67], v1, s[4:7], s44 offen
    buffer_load_dwordx4 v[68:71], v1, s[4:7], s45 offen
    s_add_u32 s44, s44, 4096
    s_add_u32 s45, s45, 4096
    buffer_load_dwordx4 v[72:75], v1, s[4:7], s44 offen
    buffer_load_dwordx4 v[76:79], v1, s[4:7], s45 offen
    s_add_u32 s44, s44, 4096
    s_add_u32 s45, s45, 4096
    buffer_load_dwordx4 v[80:83], v1, s[4:7], s44 offen
    buffer_load_dwordx4 v[84:87], v1, s[4:7], s45 offen
    s_add_u32 s44, s44, 4096
    s_add_u32 s45, s45, 4096
    buffer_load_dwordx4 v[88:91], v1, s[4:7], s44 offen
    buffer_load_dwordx4 v[92:95], v1, s[4:7], s45 offen
    s_add_u32 s44, s44, 4096
    s_add_u32 s45, s45, 4096
    buffer_load_dwordx4 v[96:99], v1, s[4:7], s44 offen
    buffer_load_dwordx4 v[100:103], v1, s[4:7], s45 offen
    s_add_u32 s44, s44, 4096
    s_add_u32 s45, s45, 4096
    buffer_load_dwordx4 v[104:107], v1, s[4:7], s44 offen
    buffer_load_dwordx4 v[108:111], v1, s[4:7], s45 offen
    s_add_u32 s44, s44, 4096
    s_add_u32 s45, s45, 4096
    buffer_load_dwordx4 v[112:115], v1, s[4:7], s44 offen
    buffer_load_dwordx4 v[116:119], v1, s[4:7], s45 offen
    s_add_u32 s44, s44, 4096
    s_add_u32 s45, s45, 4096
    buffer_load_dwordx4 v[120:123], v1, s[4:7], s44 offen
    buffer_load_dwordx4 v[124:127], v1, s[4:7], s45 offen
    s_add_u32 s44, s44, 4096
    s_add_u32 s45, s45, 4096
    buffer_load_dwordx4 v[128:131], v1, s[4:7], s44 offen
    buffer_load_dwordx4 v[132:135], v1, s[4:7], s45 offen
    s_add_u32 s44, s44, 4096
    s_add_u32 s45, s45, 4096
    buffer_load_dwordx4 v[136:139], v1, s[4:7], s44 offen
    buffer_load_dwordx4 v[140:143], v1, s[4:7], s45 offen
    s_add_u32 s44, s44, 4096
    s_add_u32 s45, s45, 4096
    s_waitcnt vmcnt(30)
    v_mfma_f32_16x16x32_bf16 v[8:11], v[16:19], v[20:23], 0
    s_waitcnt vmcnt(28)
    v_mfma_f32_16x16x32_bf16 v[8:11], v[24:27], v[28:31], v[8:11]
    s_waitcnt vmcnt(26)
    v_mfma_f32_16x16x32_bf16 v[8:11], v[32:35], v[36:39], v[8:11]
    s_waitcnt vmcnt(24)
    v_mfma_f32_16x16x32_bf16 v[8:11], v[40:43], v[44:47], v[8:11]
    s_waitcnt vmcnt(22)
    v_mfma_f32_16x16x32_bf16 v[8:11], v[48:51], v[52:55], v[8:11]
    s_waitcnt vmcnt(20)
    v_mfma_f32_16x16x32_bf16 v[8:11], v[56:59], v[60:63], v[8:11]
    s_waitcnt vmcnt(18)
    v_mfma_f32_16x16x32_bf16 v[8:11], v[64:67], v[68:71], v[8:11]
    s_waitcnt vmcnt(16)
    v_mfma_f32_16x16x32_bf16 v[8:11], v[72:75], v[76:79], v[8:11]
    s_waitcnt vmcnt(14)
    v_mfma_f32_16x16x32_bf16 v[8:11], v[80:83], v[84:87], v[8:11]
    s_waitcnt vmcnt(12)
    v_mfma_f32_16x16x32_bf16 v[8:11], v[88:91], v[92:95], v[8:11]
    s_waitcnt vmcnt(10)
    v_mfma_f32_16x16x32_bf16 v[8:11], v[96:99], v[100:103], v[8:11]
    s_waitcnt vmcnt(8)
    v_mfma_f32_16x16x32_bf16 v[8:11], v[104:107], v[108:111], v[8:11]
    s_waitcnt vmcnt(6)
    v_mfma_f32_16x16x32_bf16 v[8:11], v[112:115], v[116:119], v[8:11]
    s_waitcnt vmcnt(4)
    v_mfma_f32_16x16x32_bf16 v[8:11], v[120:123], v[124:127], v[8:11]
    s_waitcnt vmcnt(2)
    v_mfma_f32_16x16x32_bf16 v[8:11], v[128:131], v[132:135], v[8:11]
    s_waitcnt vmcnt(0)
    v_mfma_f32_16x16x32_bf16 v[8:11], v[136:139], v[140:143], v[8:11]
    s_nop 7
    s_lshl_b32 s46, s3, 10
    v_add_u32 v2, s46, v1
    ds_write_b128 v2, v[8:11]
    s_waitcnt lgkmcnt(0)
    s_barrier
    s_cmp_lg_u32 s3, 0
    s_cbranch_scc1 osmall_kernel_end
    ds_read_b128 v[20:23], v1 offset:1024
    ds_read_b128 v[24:27], v1 offset:2048
    ds_read_b128 v[28:31], v1 offset:3072
    ds_read_b128 v[32:35], v1 offset:4096
    ds_read_b128 v[36:39], v1 offset:5120
    ds_read_b128 v[40:43], v1 offset:6144
    ds_read_b128 v[44:47], v1 offset:7168
    s_waitcnt lgkmcnt(0)
    v_add_f32 v8, v8, v20
    v_add_f32 v9, v9, v21
    v_add_f32 v10, v10, v22
    v_add_f32 v11, v11, v23
    v_add_f32 v8, v8, v24
    v_add_f32 v9, v9, v25
    v_add_f32 v10, v10, v26
    v_add_f32 v11, v11, v27
    v_add_f32 v8, v8, v28
    v_add_f32 v9, v9, v29
    v_add_f32 v10, v10, v30
    v_add_f32 v11, v11, v31
    v_add_f32 v8, v8, v32
    v_add_f32 v9, v9, v33
    v_add_f32 v10, v10, v34
    v_add_f32 v11, v11, v35
    v_add_f32 v8, v8, v36
    v_add_f32 v9, v9, v37
    v_add_f32 v10, v10, v38
    v_add_f32 v11, v11, v39
    v_add_f32 v8, v8, v40
    v_add_f32 v9, v9, v41
    v_add_f32 v10, v10, v42
    v_add_f32 v11, v11, v43
    v_add_f32 v8, v8, v44
    v_add_f32 v9, v9, v45
    v_add_f32 v10, v10, v46
    v_add_f32 v11, v11, v47
    s_lshl_b32 s58, s67, 4
    s_lshl_b32 s59, s66, 5
    s_mov_b32 s8, s16
    s_and_b32 s9, s17, 0xffff
    s_mov_b32 s10, 0x280000
    s_mov_b32 s11, 0x00020000
    s_mov_b32 s55, 0
    s_mov_b32 s12, s42
    s_and_b32 s13, s43, 0xffff
    s_mov_b32 s14, 0x10000000
    s_mov_b32 s15, 0x00020000
    s_mov_b32 s56, 110587904
    s_mul_i32 s57, s58, 1280
    s_add_u32 s57, s57, s59
    s_add_u32 s55, s55, s57
    s_add_u32 s56, s56, s57
    v_and_b32 v4, 15, v0
    v_lshrrev_b32 v5, 4, v0
    v_mul_u32_u24 v4, 1280, v4
    v_lshl_add_u32 v4, v5, 3, v4
    buffer_load_dwordx2 v[16:17], v4, s[8:11], s55 offen offset:0
    s_waitcnt vmcnt(0)
    v_cvt_pk_bf16_f32 v8, v8, v9
    v_and_b32 v9, 0xffff0000, v8
    v_lshlrev_b32 v8, 16, v8
    v_lshlrev_b32 v6, 16, v16
    v_and_b32 v7, 0xffff0000, v16
    v_add_f32 v6, v6, v8
    v_add_f32 v7, v7, v9
    v_cvt_pk_bf16_f32 v16, v6, v7
    v_cvt_pk_bf16_f32 v10, v10, v11
    v_and_b32 v11, 0xffff0000, v10
    v_lshlrev_b32 v10, 16, v10
    v_lshlrev_b32 v6, 16, v17
    v_and_b32 v7, 0xffff0000, v17
    v_add_f32 v6, v6, v10
    v_add_f32 v7, v7, v11
    v_cvt_pk_bf16_f32 v17, v6, v7
    buffer_store_dwordx2 v[16:17], v4, s[12:15], s56 offen offset:0
osmall_kernel_end:
    s_endpgm
.globl ln2_kernel
.p2align 8
.type ln2_kernel,@function
ln2_kernel:
    s_cmp_ge_u32 s2, 16
    s_cbranch_scc1 ln2_end
    s_load_dwordx16 s[16:31], s[0:1], 0
    s_load_dwordx8 s[32:39], s[0:1], 64
    s_load_dwordx4 s[40:43], s[0:1], 96
    v_lshrrev_b32 v1, 6, v0
    s_nop 0
    v_readfirstlane_b32 s3, v1
    v_and_b32 v0, 63, v0
    s_waitcnt lgkmcnt(0)
    s_mov_b32 s4, s42
    s_and_b32 s5, s43, 0xffff
    s_mov_b32 s6, 0x10000000
    s_mov_b32 s7, 0x00020000
    s_mov_b32 s8, s42
    s_and_b32 s9, s43, 0xffff
    s_mov_b32 s10, 0x10000000
    s_mov_b32 s11, 0x00020000
    s_lshl_b32 s44, s2, 2
    s_add_u32 s44, s44, s3
    s_add_u32 s44, s44, 448
    s_mul_i32 s12, s44, 5120
    s_add_u32 s12, s12, 110587904
    s_lshr_b32 s45, s44, 4
    s_mul_i32 s13, s45, 81920
    s_bfe_u32 s46, s44, 0x20002
    s_lshl_b32 s46, s46, 10
    s_add_u32 s13, s13, s46
    s_and_b32 s46, s44, 3
    s_lshl_b32 s46, s46, 6
    s_add_u32 s13, s13, s46
    s_add_u32 s13, s13, 113209344
    v_lshrrev_b32 v1, 4, v0
    v_and_b32 v2, 3, v0
    v_bfe_u32 v3, v0, 2, 2
    v_mul_u32_u24 v4, 1280, v1
    v_lshl_add_u32 v4, v2, 3, v4
    v_mul_u32_u24 v5, 320, v3
    v_add_u32 v4, v4, v5
    buffer_load_dwordx2 v[16:17], v4, s[8:11], s12 offen offset:0
    buffer_load_dwordx2 v[18:19], v4, s[8:11], s12 offen offset:32
    buffer_load_dwordx2 v[20:21], v4, s[8:11], s12 offen offset:64
    buffer_load_dwordx2 v[22:23], v4, s[8:11], s12 offen offset:96
    buffer_load_dwordx2 v[24:25], v4, s[8:11], s12 offen offset:128
    buffer_load_dwordx2 v[26:27], v4, s[8:11], s12 offen offset:160
    buffer_load_dwordx2 v[28:29], v4, s[8:11], s12 offen offset:192
    buffer_load_dwordx2 v[30:31], v4, s[8:11], s12 offen offset:224
    buffer_load_dwordx2 v[32:33], v4, s[8:11], s12 offen offset:256
    buffer_load_dwordx2 v[34:35], v4, s[8:11], s12 offen offset:288
    v_mul_u32_u24 v10, 20480, v3
    v_lshl_add_u32 v10, v2, 8, v10
    v_lshl_add_u32 v10, v1, 4, v10
    v_mov_b32 v4, 0
    v_mov_b32 v5, 0
    s_waitcnt vmcnt(0)
    v_lshlrev_b32 v40, 16, v16
    v_and_b32 v41, 0xffff0000, v16
    v_add_f32 v4, v4, v40
    v_add_f32 v5, v5, v41
    v_lshlrev_b32 v42, 16, v17
    v_and_b32 v43, 0xffff0000, v17
    v_add_f32 v4, v4, v42
    v_add_f32 v5, v5, v43
    v_lshlrev_b32 v44, 16, v18
    v_and_b32 v45, 0xffff0000, v18
    v_add_f32 v4, v4, v44
    v_add_f32 v5, v5, v45
    v_lshlrev_b32 v46, 16, v19
    v_and_b32 v47, 0xffff0000, v19
    v_add_f32 v4, v4, v46
    v_add_f32 v5, v5, v47
    v_lshlrev_b32 v48, 16, v20
    v_and_b32 v49, 0xffff0000, v20
    v_add_f32 v4, v4, v48
    v_add_f32 v5, v5, v49
    v_lshlrev_b32 v50, 16, v21
    v_and_b32 v51, 0xffff0000, v21
    v_add_f32 v4, v4, v50
    v_add_f32 v5, v5, v51
    v_lshlrev_b32 v52, 16, v22
    v_and_b32 v53, 0xffff0000, v22
    v_add_f32 v4, v4, v52
    v_add_f32 v5, v5, v53
    v_lshlrev_b32 v54, 16, v23
    v_and_b32 v55, 0xffff0000, v23
    v_add_f32 v4, v4, v54
    v_add_f32 v5, v5, v55
    v_lshlrev_b32 v56, 16, v24
    v_and_b32 v57, 0xffff0000, v24
    v_add_f32 v4, v4, v56
    v_add_f32 v5, v5, v57
    v_lshlrev_b32 v58, 16, v25
    v_and_b32 v59, 0xffff0000, v25
    v_add_f32 v4, v4, v58
    v_add_f32 v5, v5, v59
    v_lshlrev_b32 v60, 16, v26
    v_and_b32 v61, 0xffff0000, v26
    v_add_f32 v4, v4, v60
    v_add_f32 v5, v5, v61
    v_lshlrev_b32 v62, 16, v27
    v_and_b32 v63, 0xffff0000, v27
    v_add_f32 v4, v4, v62
    v_add_f32 v5, v5, v63
    v_lshlrev_b32 v64, 16, v28
    v_and_b32 v65, 0xffff0000, v28
    v_add_f32 v4, v4, v64
    v_add_f32 v5, v5, v65
    v_lshlrev_b32 v66, 16, v29
    v_and_b32 v67, 0xffff0000, v29
    v_add_f32 v4, v4, v66
    v_add_f32 v5, v5, v67
    v_lshlrev_b32 v68, 16, v30
    v_and_b32 v69, 0xffff0000, v30
    v_add_f32 v4, v4, v68
    v_add_f32 v5, v5, v69
    v_lshlrev_b32 v70, 16, v31
    v_and_b32 v71, 0xffff0000, v31
    v_add_f32 v4, v4, v70
    v_add_f32 v5, v5, v71
    v_lshlrev_b32 v72, 16, v32
    v_and_b32 v73, 0xffff0000, v32
    v_add_f32 v4, v4, v72
    v_add_f32 v5, v5, v73
    v_lshlrev_b32 v74, 16, v33
    v_and_b32 v75, 0xffff0000, v33
    v_add_f32 v4, v4, v74
    v_add_f32 v5, v5, v75
    v_lshlrev_b32 v76, 16, v34
    v_and_b32 v77, 0xffff0000, v34
    v_add_f32 v4, v4, v76
    v_add_f32 v5, v5, v77
    v_lshlrev_b32 v78, 16, v35
    v_and_b32 v79, 0xffff0000, v35
    v_add_f32 v4, v4, v78
    v_add_f32 v5, v5, v79
    v_add_f32 v4, v4, v5
    s_nop 1
    v_add_f32_dpp v4, v4, v4 row_ror:8 row_mask:0xf bank_mask:0xf
    s_nop 1
    v_add_f32_dpp v4, v4, v4 row_ror:4 row_mask:0xf bank_mask:0xf
    s_nop 1
    v_add_f32_dpp v4, v4, v4 row_ror:2 row_mask:0xf bank_mask:0xf
    s_nop 1
    v_add_f32_dpp v4, v4, v4 row_ror:1 row_mask:0xf bank_mask:0xf
    v_mul_f32 v4, 0x3acccccd, v4
    v_mov_b32 v8, 0
    v_mov_b32 v9, 0
    v_sub_f32 v6, v40, v4
    v_sub_f32 v7, v41, v4
    v_fmac_f32 v8, v6, v6
    v_fmac_f32 v9, v7, v7
    v_sub_f32 v6, v42, v4
    v_sub_f32 v7, v43, v4
    v_fmac_f32 v8, v6, v6
    v_fmac_f32 v9, v7, v7
    v_sub_f32 v6, v44, v4
    v_sub_f32 v7, v45, v4
    v_fmac_f32 v8, v6, v6
    v_fmac_f32 v9, v7, v7
    v_sub_f32 v6, v46, v4
    v_sub_f32 v7, v47, v4
    v_fmac_f32 v8, v6, v6
    v_fmac_f32 v9, v7, v7
    v_sub_f32 v6, v48, v4
    v_sub_f32 v7, v49, v4
    v_fmac_f32 v8, v6, v6
    v_fmac_f32 v9, v7, v7
    v_sub_f32 v6, v50, v4
    v_sub_f32 v7, v51, v4
    v_fmac_f32 v8, v6, v6
    v_fmac_f32 v9, v7, v7
    v_sub_f32 v6, v52, v4
    v_sub_f32 v7, v53, v4
    v_fmac_f32 v8, v6, v6
    v_fmac_f32 v9, v7, v7
    v_sub_f32 v6, v54, v4
    v_sub_f32 v7, v55, v4
    v_fmac_f32 v8, v6, v6
    v_fmac_f32 v9, v7, v7
    v_sub_f32 v6, v56, v4
    v_sub_f32 v7, v57, v4
    v_fmac_f32 v8, v6, v6
    v_fmac_f32 v9, v7, v7
    v_sub_f32 v6, v58, v4
    v_sub_f32 v7, v59, v4
    v_fmac_f32 v8, v6, v6
    v_fmac_f32 v9, v7, v7
    v_sub_f32 v6, v60, v4
    v_sub_f32 v7, v61, v4
    v_fmac_f32 v8, v6, v6
    v_fmac_f32 v9, v7, v7
    v_sub_f32 v6, v62, v4
    v_sub_f32 v7, v63, v4
    v_fmac_f32 v8, v6, v6
    v_fmac_f32 v9, v7, v7
    v_sub_f32 v6, v64, v4
    v_sub_f32 v7, v65, v4
    v_fmac_f32 v8, v6, v6
    v_fmac_f32 v9, v7, v7
    v_sub_f32 v6, v66, v4
    v_sub_f32 v7, v67, v4
    v_fmac_f32 v8, v6, v6
    v_fmac_f32 v9, v7, v7
    v_sub_f32 v6, v68, v4
    v_sub_f32 v7, v69, v4
    v_fmac_f32 v8, v6, v6
    v_fmac_f32 v9, v7, v7
    v_sub_f32 v6, v70, v4
    v_sub_f32 v7, v71, v4
    v_fmac_f32 v8, v6, v6
    v_fmac_f32 v9, v7, v7
    v_sub_f32 v6, v72, v4
    v_sub_f32 v7, v73, v4
    v_fmac_f32 v8, v6, v6
    v_fmac_f32 v9, v7, v7
    v_sub_f32 v6, v74, v4
    v_sub_f32 v7, v75, v4
    v_fmac_f32 v8, v6, v6
    v_fmac_f32 v9, v7, v7
    v_sub_f32 v6, v76, v4
    v_sub_f32 v7, v77, v4
    v_fmac_f32 v8, v6, v6
    v_fmac_f32 v9, v7, v7
    v_sub_f32 v6, v78, v4
    v_sub_f32 v7, v79, v4
    v_fmac_f32 v8, v6, v6
    v_fmac_f32 v9, v7, v7
    v_add_f32 v8, v8, v9
    s_nop 1
    v_add_f32_dpp v8, v8, v8 row_ror:8 row_mask:0xf bank_mask:0xf
    s_nop 1
    v_add_f32_dpp v8, v8, v8 row_ror:4 row_mask:0xf bank_mask:0xf
    s_nop 1
    v_add_f32_dpp v8, v8, v8 row_ror:2 row_mask:0xf bank_mask:0xf
    s_nop 1
    v_add_f32_dpp v8, v8, v8 row_ror:1 row_mask:0xf bank_mask:0xf
    v_mul_f32 v8, 0x3acccccd, v8
    v_cvt_pk_bf16_f32 v4, v4, v8
    v_and_b32 v8, 0xffff0000, v4
    v_lshlrev_b32 v4, 16, v4
    v_add_f32 v8, 0x3727c5ac, v8
    v_cvt_pk_bf16_f32 v8, v8, v8
    v_lshlrev_b32 v8, 16, v8
    v_sqrt_f32 v8, v8
    s_nop 0
    v_cvt_pk_bf16_f32 v8, v8, v8
    v_lshlrev_b32 v8, 16, v8
    v_rcp_f32 v8, v8
    s_nop 0
    v_sub_f32 v6, v40, v4
    v_sub_f32 v7, v41, v4
    v_cvt_pk_bf16_f32 v6, v6, v7
    v_and_b32 v7, 0xffff0000, v6
    v_lshlrev_b32 v6, 16, v6
    v_mul_f32 v6, v6, v8
    v_mul_f32 v7, v7, v8
    v_cvt_pk_bf16_f32 v16, v6, v7
    v_sub_f32 v6, v42, v4
    v_sub_f32 v7, v43, v4
    v_cvt_pk_bf16_f32 v6, v6, v7
    v_and_b32 v7, 0xffff0000, v6
    v_lshlrev_b32 v6, 16, v6
    v_mul_f32 v6, v6, v8
    v_mul_f32 v7, v7, v8
    v_cvt_pk_bf16_f32 v17, v6, v7
    v_sub_f32 v6, v44, v4
    v_sub_f32 v7, v45, v4
    v_cvt_pk_bf16_f32 v6, v6, v7
    v_and_b32 v7, 0xffff0000, v6
    v_lshlrev_b32 v6, 16, v6
    v_mul_f32 v6, v6, v8
    v_mul_f32 v7, v7, v8
    v_cvt_pk_bf16_f32 v18, v6, v7
    v_sub_f32 v6, v46, v4
    v_sub_f32 v7, v47, v4
    v_cvt_pk_bf16_f32 v6, v6, v7
    v_and_b32 v7, 0xffff0000, v6
    v_lshlrev_b32 v6, 16, v6
    v_mul_f32 v6, v6, v8
    v_mul_f32 v7, v7, v8
    v_cvt_pk_bf16_f32 v19, v6, v7
    v_sub_f32 v6, v48, v4
    v_sub_f32 v7, v49, v4
    v_cvt_pk_bf16_f32 v6, v6, v7
    v_and_b32 v7, 0xffff0000, v6
    v_lshlrev_b32 v6, 16, v6
    v_mul_f32 v6, v6, v8
    v_mul_f32 v7, v7, v8
    v_cvt_pk_bf16_f32 v20, v6, v7
    v_sub_f32 v6, v50, v4
    v_sub_f32 v7, v51, v4
    v_cvt_pk_bf16_f32 v6, v6, v7
    v_and_b32 v7, 0xffff0000, v6
    v_lshlrev_b32 v6, 16, v6
    v_mul_f32 v6, v6, v8
    v_mul_f32 v7, v7, v8
    v_cvt_pk_bf16_f32 v21, v6, v7
    v_sub_f32 v6, v52, v4
    v_sub_f32 v7, v53, v4
    v_cvt_pk_bf16_f32 v6, v6, v7
    v_and_b32 v7, 0xffff0000, v6
    v_lshlrev_b32 v6, 16, v6
    v_mul_f32 v6, v6, v8
    v_mul_f32 v7, v7, v8
    v_cvt_pk_bf16_f32 v22, v6, v7
    v_sub_f32 v6, v54, v4
    v_sub_f32 v7, v55, v4
    v_cvt_pk_bf16_f32 v6, v6, v7
    v_and_b32 v7, 0xffff0000, v6
    v_lshlrev_b32 v6, 16, v6
    v_mul_f32 v6, v6, v8
    v_mul_f32 v7, v7, v8
    v_cvt_pk_bf16_f32 v23, v6, v7
    v_sub_f32 v6, v56, v4
    v_sub_f32 v7, v57, v4
    v_cvt_pk_bf16_f32 v6, v6, v7
    v_and_b32 v7, 0xffff0000, v6
    v_lshlrev_b32 v6, 16, v6
    v_mul_f32 v6, v6, v8
    v_mul_f32 v7, v7, v8
    v_cvt_pk_bf16_f32 v24, v6, v7
    v_sub_f32 v6, v58, v4
    v_sub_f32 v7, v59, v4
    v_cvt_pk_bf16_f32 v6, v6, v7
    v_and_b32 v7, 0xffff0000, v6
    v_lshlrev_b32 v6, 16, v6
    v_mul_f32 v6, v6, v8
    v_mul_f32 v7, v7, v8
    v_cvt_pk_bf16_f32 v25, v6, v7
    v_sub_f32 v6, v60, v4
    v_sub_f32 v7, v61, v4
    v_cvt_pk_bf16_f32 v6, v6, v7
    v_and_b32 v7, 0xffff0000, v6
    v_lshlrev_b32 v6, 16, v6
    v_mul_f32 v6, v6, v8
    v_mul_f32 v7, v7, v8
    v_cvt_pk_bf16_f32 v26, v6, v7
    v_sub_f32 v6, v62, v4
    v_sub_f32 v7, v63, v4
    v_cvt_pk_bf16_f32 v6, v6, v7
    v_and_b32 v7, 0xffff0000, v6
    v_lshlrev_b32 v6, 16, v6
    v_mul_f32 v6, v6, v8
    v_mul_f32 v7, v7, v8
    v_cvt_pk_bf16_f32 v27, v6, v7
    v_sub_f32 v6, v64, v4
    v_sub_f32 v7, v65, v4
    v_cvt_pk_bf16_f32 v6, v6, v7
    v_and_b32 v7, 0xffff0000, v6
    v_lshlrev_b32 v6, 16, v6
    v_mul_f32 v6, v6, v8
    v_mul_f32 v7, v7, v8
    v_cvt_pk_bf16_f32 v28, v6, v7
    v_sub_f32 v6, v66, v4
    v_sub_f32 v7, v67, v4
    v_cvt_pk_bf16_f32 v6, v6, v7
    v_and_b32 v7, 0xffff0000, v6
    v_lshlrev_b32 v6, 16, v6
    v_mul_f32 v6, v6, v8
    v_mul_f32 v7, v7, v8
    v_cvt_pk_bf16_f32 v29, v6, v7
    v_sub_f32 v6, v68, v4
    v_sub_f32 v7, v69, v4
    v_cvt_pk_bf16_f32 v6, v6, v7
    v_and_b32 v7, 0xffff0000, v6
    v_lshlrev_b32 v6, 16, v6
    v_mul_f32 v6, v6, v8
    v_mul_f32 v7, v7, v8
    v_cvt_pk_bf16_f32 v30, v6, v7
    v_sub_f32 v6, v70, v4
    v_sub_f32 v7, v71, v4
    v_cvt_pk_bf16_f32 v6, v6, v7
    v_and_b32 v7, 0xffff0000, v6
    v_lshlrev_b32 v6, 16, v6
    v_mul_f32 v6, v6, v8
    v_mul_f32 v7, v7, v8
    v_cvt_pk_bf16_f32 v31, v6, v7
    v_sub_f32 v6, v72, v4
    v_sub_f32 v7, v73, v4
    v_cvt_pk_bf16_f32 v6, v6, v7
    v_and_b32 v7, 0xffff0000, v6
    v_lshlrev_b32 v6, 16, v6
    v_mul_f32 v6, v6, v8
    v_mul_f32 v7, v7, v8
    v_cvt_pk_bf16_f32 v32, v6, v7
    v_sub_f32 v6, v74, v4
    v_sub_f32 v7, v75, v4
    v_cvt_pk_bf16_f32 v6, v6, v7
    v_and_b32 v7, 0xffff0000, v6
    v_lshlrev_b32 v6, 16, v6
    v_mul_f32 v6, v6, v8
    v_mul_f32 v7, v7, v8
    v_cvt_pk_bf16_f32 v33, v6, v7
    v_sub_f32 v6, v76, v4
    v_sub_f32 v7, v77, v4
    v_cvt_pk_bf16_f32 v6, v6, v7
    v_and_b32 v7, 0xffff0000, v6
    v_lshlrev_b32 v6, 16, v6
    v_mul_f32 v6, v6, v8
    v_mul_f32 v7, v7, v8
    v_cvt_pk_bf16_f32 v34, v6, v7
    v_sub_f32 v6, v78, v4
    v_sub_f32 v7, v79, v4
    v_cvt_pk_bf16_f32 v6, v6, v7
    v_and_b32 v7, 0xffff0000, v6
    v_lshlrev_b32 v6, 16, v6
    v_mul_f32 v6, v6, v8
    v_mul_f32 v7, v7, v8
    v_cvt_pk_bf16_f32 v35, v6, v7
    buffer_store_dwordx4 v[16:19], v10, s[4:7], s13 offen
    s_add_u32 s13, s13, 4096
    buffer_store_dwordx4 v[20:23], v10, s[4:7], s13 offen
    s_add_u32 s13, s13, 4096
    buffer_store_dwordx4 v[24:27], v10, s[4:7], s13 offen
    s_add_u32 s13, s13, 4096
    buffer_store_dwordx4 v[28:31], v10, s[4:7], s13 offen
    s_add_u32 s13, s13, 4096
    buffer_store_dwordx4 v[32:35], v10, s[4:7], s13 offen
ln2_end:
    s_endpgm
.globl gusmall_kernel
.p2align 8
.type gusmall_kernel,@function
gusmall_kernel:
    s_cmp_ge_u32 s2, 432
    s_cbranch_scc1 gusmall_end
    s_load_dwordx16 s[16:31], s[0:1], 0
    s_load_dwordx8 s[32:39], s[0:1], 64
    s_load_dwordx4 s[40:43], s[0:1], 96
    v_lshrrev_b32 v1, 6, v0
    s_nop 0
    v_readfirstlane_b32 s3, v1
    v_and_b32 v0, 63, v0
    s_mov_b32 s46, 0x4bda130
    s_mul_hi_u32 s67, s2, s46
    s_mul_i32 s46, s67, 54
    s_sub_u32 s66, s2, s46
    s_waitcnt lgkmcnt(0)
    s_mov_b32 s4, s42
    s_and_b32 s5, s43, 0xffff
    s_mov_b32 s6, 0x10000000
    s_mov_b32 s7, 0x00020000
    s_lshl_b32 s47, s66, 1
    s_lshr_b32 s48, s47, 2
    s_mul_i32 s48, s48, 81920
    s_and_b32 s46, s47, 3
    s_lshl_b32 s46, s46, 10
    s_add_u32 s48, s48, s46
    s_add_u32 s48, s48, 23592960
    s_add_u32 s47, s47, 108
    s_lshr_b32 s49, s47, 2
    s_mul_i32 s49, s49, 81920
    s_and_b32 s46, s47, 3
    s_lshl_b32 s46, s46, 10
    s_add_u32 s49, s49, s46
    s_add_u32 s49, s49, 23592960
    s_lshl_b32 s47, s67, 1
    s_add_u32 s47, s47, 112
    s_lshr_b32 s50, s47, 2
    s_mul_i32 s50, s50, 81920
    s_and_b32 s46, s47, 3
    s_lshl_b32 s46, s46, 10
    s_add_u32 s50, s50, s46
    s_add_u32 s50, s50, 113209344
    s_mul_i32 s46, s3, 20480
    s_add_u32 s48, s48, s46
    s_add_u32 s49, s49, s46
    s_add_u32 s50, s50, s46
    v_lshlrev_b32 v1, 4, v0
    buffer_load_dwordx4 v[40:43], v1, s[4:7], s48 offen offset:0
    buffer_load_dwordx4 v[44:47], v1, s[4:7], s48 offen offset:1024
    s_add_u32 s48, s48, 4096
    buffer_load_dwordx4 v[48:51], v1, s[4:7], s49 offen offset:0
    buffer_load_dwordx4 v[52:55], v1, s[4:7], s49 offen offset:1024
    s_add_u32 s49, s49, 4096
    buffer_load_dwordx4 v[56:59], v1, s[4:7], s50 offen offset:0
    buffer_load_dwordx4 v[60:63], v1, s[4:7], s50 offen offset:1024
    s_add_u32 s50, s50, 4096
    buffer_load_dwordx4 v[64:67], v1, s[4:7], s48 offen offset:0
    buffer_load_dwordx4 v[68:71], v1, s[4:7], s48 offen offset:1024
    s_add_u32 s48, s48, 4096
    buffer_load_dwordx4 v[72:75], v1, s[4:7], s49 offen offset:0
    buffer_load_dwordx4 v[76:79], v1, s[4:7], s49 offen offset:1024
    s_add_u32 s49, s49, 4096
    buffer_load_dwordx4 v[80:83], v1, s[4:7], s50 offen offset:0
    buffer_load_dwordx4 v[84:87], v1, s[4:7], s50 offen offset:1024
    s_add_u32 s50, s50, 4096
    buffer_load_dwordx4 v[88:91], v1, s[4:7], s48 offen offset:0
    buffer_load_dwordx4 v[92:95], v1, s[4:7], s48 offen offset:1024
    s_add_u32 s48, s48, 4096
    buffer_load_dwordx4 v[96:99], v1, s[4:7], s49 offen offset:0
    buffer_load_dwordx4 v[100:103], v1, s[4:7], s49 offen offset:1024
    s_add_u32 s49, s49, 4096
    buffer_load_dwordx4 v[104:107], v1, s[4:7], s50 offen offset:0
    buffer_load_dwordx4 v[108:111], v1, s[4:7], s50 offen offset:1024
    s_add_u32 s50, s50, 4096
    buffer_load_dwordx4 v[112:115], v1, s[4:7], s48 offen offset:0
    buffer_load_dwordx4 v[116:119], v1, s[4:7], s48 offen offset:1024
    s_add_u32 s48, s48, 4096
    buffer_load_dwordx4 v[120:123], v1, s[4:7], s49 offen offset:0
    buffer_load_dwordx4 v[124:127], v1, s[4:7], s49 offen offset:1024
    s_add_u32 s49, s49, 4096
    buffer_load_dwordx4 v[128:131], v1, s[4:7], s50 offen offset:0
    buffer_load_dwordx4 v[132:135], v1, s[4:7], s50 offen offset:1024
    s_add_u32 s50, s50, 4096
    buffer_load_dwordx4 v[136:139], v1, s[4:7], s48 offen offset:0
    buffer_load_dwordx4 v[140:143], v1, s[4:7], s48 offen offset:1024
    s_add_u32 s48, s48, 4096
    buffer_load_dwordx4 v[144:147], v1, s[4:7], s49 offen offset:0
    buffer_load_dwordx4 v[148:151], v1, s[4:7], s49 offen offset:1024
    s_add_u32 s49, s49, 4096
    buffer_load_dwordx4 v[152:155], v1, s[4:7], s50 offen offset:0
    buffer_load_dwordx4 v[156:159], v1, s[4:7], s50 offen offset:1024
    s_add_u32 s50, s50, 4096
    s_waitcnt vmcnt(24)
    v_mfma_f32_16x16x32_bf16 v[8:11], v[40:43], v[56:59], 0
    v_mfma_f32_16x16x32_bf16 v[12:15], v[40:43], v[60:63], 0
    v_mfma_f32_16x16x32_bf16 v[16:19], v[44:47], v[56:59], 0
    v_mfma_f32_16x16x32_bf16 v[20:23], v[44:47], v[60:63], 0
    v_mfma_f32_16x16x32_bf16 v[24:27], v[48:51], v[56:59], 0
    v_mfma_f32_16x16x32_bf16 v[28:31], v[48:51], v[60:63], 0
    v_mfma_f32_16x16x32_bf16 v[32:35], v[52:55], v[56:59], 0
    v_mfma_f32_16x16x32_bf16 v[36:39], v[52:55], v[60:63], 0
    s_waitcnt vmcnt(18)
    v_mfma_f32_16x16x32_bf16 v[8:11], v[64:67], v[80:83], v[8:11]
    v_mfma_f32_16x16x32_bf16 v[12:15], v[64:67], v[84:87], v[12:15]
    v_mfma_f32_16x16x32_bf16 v[16:19], v[68:71], v[80:83], v[16:19]
    v_mfma_f32_16x16x32_bf16 v[20:23], v[68:71], v[84:87], v[20:23]
    v_mfma_f32_16x16x32_bf16 v[24:27], v[72:75], v[80:83], v[24:27]
    v_mfma_f32_16x16x32_bf16 v[28:31], v[72:75], v[84:87], v[28:31]
    v_mfma_f32_16x16x32_bf16 v[32:35], v[76:79], v[80:83], v[32:35]
    v_mfma_f32_16x16x32_bf16 v[36:39], v[76:79], v[84:87], v[36:39]
    s_waitcnt vmcnt(12)
    v_mfma_f32_16x16x32_bf16 v[8:11], v[88:91], v[104:107], v[8:11]
    v_mfma_f32_16x16x32_bf16 v[12:15], v[88:91], v[108:111], v[12:15]
    v_mfma_f32_16x16x32_bf16 v[16:19], v[92:95], v[104:107], v[16:19]
    v_mfma_f32_16x16x32_bf16 v[20:23], v[92:95], v[108:111], v[20:23]
    v_mfma_f32_16x16x32_bf16 v[24:27], v[96:99], v[104:107], v[24:27]
    v_mfma_f32_16x16x32_bf16 v[28:31], v[96:99], v[108:111], v[28:31]
    v_mfma_f32_16x16x32_bf16 v[32:35], v[100:103], v[104:107], v[32:35]
    v_mfma_f32_16x16x32_bf16 v[36:39], v[100:103], v[108:111], v[36:39]
    s_waitcnt vmcnt(6)
    v_mfma_f32_16x16x32_bf16 v[8:11], v[112:115], v[128:131], v[8:11]
    v_mfma_f32_16x16x32_bf16 v[12:15], v[112:115], v[132:135], v[12:15]
    v_mfma_f32_16x16x32_bf16 v[16:19], v[116:119], v[128:131], v[16:19]
    v_mfma_f32_16x16x32_bf16 v[20:23], v[116:119], v[132:135], v[20:23]
    v_mfma_f32_16x16x32_bf16 v[24:27], v[120:123], v[128:131], v[24:27]
    v_mfma_f32_16x16x32_bf16 v[28:31], v[120:123], v[132:135], v[28:31]
    v_mfma_f32_16x16x32_bf16 v[32:35], v[124:127], v[128:131], v[32:35]
    v_mfma_f32_16x16x32_bf16 v[36:39], v[124:127], v[132:135], v[36:39]
    s_waitcnt vmcnt(0)
    v_mfma_f32_16x16x32_bf16 v[8:11], v[136:139], v[152:155], v[8:11]
    v_mfma_f32_16x16x32_bf16 v[12:15], v[136:139], v[156:159], v[12:15]
    v_mfma_f32_16x16x32_bf16 v[16:19], v[140:143], v[152:155], v[16:19]
    v_mfma_f32_16x16x32_bf16 v[20:23], v[140:143], v[156:159], v[20:23]
    v_mfma_f32_16x16x32_bf16 v[24:27], v[144:147], v[152:155], v[24:27]
    v_mfma_f32_16x16x32_bf16 v[28:31], v[144:147], v[156:159], v[28:31]
    v_mfma_f32_16x16x32_bf16 v[32:35], v[148:151], v[152:155], v[32:35]
    v_mfma_f32_16x16x32_bf16 v[36:39], v[148:151], v[156:159], v[36:39]
    s_nop 7
    s_lshl_b32 s46, s3, 13
    v_add_u32 v2, s46, v1
    ds_write_b128 v2, v[8:11] offset:0
    ds_write_b128 v2, v[12:15] offset:1024
    ds_write_b128 v2, v[16:19] offset:2048
    ds_write_b128 v2, v[20:23] offset:3072
    ds_write_b128 v2, v[24:27] offset:4096
    ds_write_b128 v2, v[28:31] offset:5120
    ds_write_b128 v2, v[32:35] offset:6144
    ds_write_b128 v2, v[36:39] offset:7168
    s_waitcnt lgkmcnt(0)
    s_barrier
    s_cmp_ge_u32 s3, 2
    s_cbranch_scc1 gusmall_end
    s_lshl_b32 s46, s3, 10
    v_add_u32 v2, s46, v1
    ds_read_b128 v[40:43], v2 offset:0
    ds_read_b128 v[44:47], v2 offset:2048
    ds_read_b128 v[48:51], v2 offset:4096
    ds_read_b128 v[52:55], v2 offset:6144
    ds_read_b128 v[56:59], v2 offset:8192
    ds_read_b128 v[60:63], v2 offset:10240
    ds_read_b128 v[64:67], v2 offset:12288
    ds_read_b128 v[68:71], v2 offset:14336
    ds_read_b128 v[72:75], v2 offset:16384
    ds_read_b128 v[76:79], v2 offset:18432
    ds_read_b128 v[80:83], v2 offset:20480
    ds_read_b128 v[84:87], v2 offset:22528
    ds_read_b128 v[88:91], v2 offset:24576
    ds_read_b128 v[92:95], v2 offset:26624
    ds_read_b128 v[96:99], v2 offset:28672
    ds_read_b128 v[100:103], v2 offset:30720
    s_waitcnt lgkmcnt(0)
    v_add_f32 v40, v40, v56
    v_add_f32 v41, v41, v57
    v_add_f32 v42, v42, v58
    v_add_f32 v43, v43, v59
    v_add_f32 v44, v44, v60
    v_add_f32 v45, v45, v61
    v_add_f32 v46, v46, v62
    v_add_f32 v47, v47, v63
    v_add_f32 v48, v48, v64
    v_add_f32 v49, v49, v65
    v_add_f32 v50, v50, v66
    v_add_f32 v51, v51, v67
    v_add_f32 v52, v52, v68
    v_add_f32 v53, v53, v69
    v_add_f32 v54, v54, v70
    v_add_f32 v55, v55, v71
    v_add_f32 v40, v40, v72
    v_add_f32 v41, v41, v73
    v_add_f32 v42, v42, v74
    v_add_f32 v43, v43, v75
    v_add_f32 v44, v44, v76
    v_add_f32 v45, v45, v77
    v_add_f32 v46, v46, v78
    v_add_f32 v47, v47, v79
    v_add_f32 v48, v48, v80
    v_add_f32 v49, v49, v81
    v_add_f32 v50, v50, v82
    v_add_f32 v51, v51, v83
    v_add_f32 v52, v52, v84
    v_add_f32 v53, v53, v85
    v_add_f32 v54, v54, v86
    v_add_f32 v55, v55, v87
    v_add_f32 v40, v40, v88
    v_add_f32 v41, v41, v89
    v_add_f32 v42, v42, v90
    v_add_f32 v43, v43, v91
    v_add_f32 v44, v44, v92
    v_add_f32 v45, v45, v93
    v_add_f32 v46, v46, v94
    v_add_f32 v47, v47, v95
    v_add_f32 v48, v48, v96
    v_add_f32 v49, v49, v97
    v_add_f32 v50, v50, v98
    v_add_f32 v51, v51, v99
    v_add_f32 v52, v52, v100
    v_add_f32 v53, v53, v101
    v_add_f32 v54, v54, v102
    v_add_f32 v55, v55, v103
    v_cvt_pk_bf16_f32 v4, v40, v41
    v_cvt_pk_bf16_f32 v5, v48, v49
    v_lshlrev_b32 v6, 16, v4
    v_and_b32 v7, 0xffff0000, v4
    v_lshlrev_b32 v4, 16, v5
    v_and_b32 v5, 0xffff0000, v5
    v_max_f32 v6, 0, v6
    v_max_f32 v7, 0, v7
    v_mul_f32 v6, v6, v4
    v_mul_f32 v7, v7, v5
    v_cvt_pk_bf16_f32 v8, v6, v7
    v_cvt_pk_bf16_f32 v4, v42, v43
    v_cvt_pk_bf16_f32 v5, v50, v51
    v_lshlrev_b32 v6, 16, v4
    v_and_b32 v7, 0xffff0000, v4
    v_lshlrev_b32 v4, 16, v5
    v_and_b32 v5, 0xffff0000, v5
    v_max_f32 v6, 0, v6
    v_max_f32 v7, 0, v7
    v_mul_f32 v6, v6, v4
    v_mul_f32 v7, v7, v5
    v_cvt_pk_bf16_f32 v9, v6, v7
    v_cvt_pk_bf16_f32 v4, v44, v45
    v_cvt_pk_bf16_f32 v5, v52, v53
    v_lshlrev_b32 v6, 16, v4
    v_and_b32 v7, 0xffff0000, v4
    v_lshlrev_b32 v4, 16, v5
    v_and_b32 v5, 0xffff0000, v5
    v_max_f32 v6, 0, v6
    v_max_f32 v7, 0, v7
    v_mul_f32 v6, v6, v4
    v_mul_f32 v7, v7, v5
    v_cvt_pk_bf16_f32 v10, v6, v7
    v_cvt_pk_bf16_f32 v4, v46, v47
    v_cvt_pk_bf16_f32 v5, v54, v55
    v_lshlrev_b32 v6, 16, v4
    v_and_b32 v7, 0xffff0000, v4
    v_lshlrev_b32 v4, 16, v5
    v_and_b32 v5, 0xffff0000, v5
    v_max_f32 v6, 0, v6
    v_max_f32 v7, 0, v7
    v_mul_f32 v6, v6, v4
    v_mul_f32 v7, v7, v5
    v_cvt_pk_bf16_f32 v11, v6, v7
    s_lshl_b32 s47, s67, 1
    s_add_u32 s47, s47, s3
    s_add_u32 s47, s47, 112
    s_lshr_b32 s55, s47, 2
    s_mul_i32 s55, s55, 221184
    s_and_b32 s46, s47, 3
    s_lshl_b32 s46, s46, 10
    s_add_u32 s55, s55, s46
    s_add_u32 s55, s55, 115830784
    s_lshl_b32 s46, s66, 12
    s_add_u32 s55, s55, s46
    buffer_store_dwordx4 v[8:11], v1, s[4:7], s55 offen
gusmall_end:
    s_endpgm
.globl dsmall_kernel
.p2align 8
.type dsmall_kernel,@function
dsmall_kernel:
    s_cmp_ge_u32 s2, 960
    s_cbranch_scc1 dsmall_kernel_end
    s_load_dwordx16 s[16:31], s[0:1], 0
    s_load_dwordx8 s[32:39], s[0:1], 64
    s_load_dwordx4 s[40:43], s[0:1], 96
    v_lshrrev_b32 v1, 6, v0
    s_nop 0
    v_readfirstlane_b32 s3, v1
    v_and_b32 v0, 63, v0
    s_mov_b32 s46, 0x6666667
    s_mul_hi_u32 s67, s2, s46
    s_mul_i32 s46, s67, 40
    s_sub_u32 s66, s2, s46
    s_add_u32 s67, s67, 104
    s_waitcnt lgkmcnt(0)
    s_mov_b32 s4, s42
    s_and_b32 s5, s43, 0xffff
    s_mov_b32 s6, 0x10000000
    s_mov_b32 s7, 0x00020000
    s_lshr_b32 s44, s66, 2
    s_mul_i32 s44, s44, 221184
    s_and_b32 s46, s66, 3
    s_lshl_b32 s46, s46, 10
    s_add_u32 s44, s44, s46
    s_add_u32 s44, s44, 28016640
    s_lshr_b32 s45, s67, 2
    s_mul_i32 s45, s45, 221184
    s_and_b32 s46, s67, 3
    s_lshl_b32 s46, s46, 10
    s_add_u32 s45, s45, s46
    s_add_u32 s45, s45, 115830784
    s_mul_i32 s46, s3, 36864
    s_add_u32 s44, s44, s46
    s_add_u32 s45, s45, s46
    v_lshlrev_b32 v1, 4, v0
    buffer_load_dwordx4 v[16:19], v1, s[4:7], s44 offen
    buffer_load_dwordx4 v[20:23], v1, s[4:7], s45 offen
    s_add_u32 s44, s44, 4096
    s_add_u32 s45, s45, 4096
    buffer_load_dwordx4 v[24:27], v1, s[4:7], s44 offen
    buffer_load_dwordx4 v[28:31], v1, s[4:7], s45 offen
    s_add_u32 s44, s44, 4096
    s_add_u32 s45, s45, 4096
    buffer_load_dwordx4 v[32:35], v1, s[4:7], s44 offen
    buffer_load_dwordx4 v[36:39], v1, s[4:7], s45 offen
    s_add_u32 s44, s44, 4096
    s_add_u32 s45, s45, 4096
    buffer_load_dwordx4 v[40:43], v1, s[4:7], s44 offen
    buffer_load_dwordx4 v[44:47], v1, s[4:7], s45 offen
    s_add_u32 s44, s44, 4096
    s_add_u32 s45, s45, 4096
    buffer_load_dwordx4 v[48:51], v1, s[4:7], s44 offen
    buffer_load_dwordx4 v[52:55], v1, s[4:7], s45 offen
    s_add_u32 s44, s44, 4096
    s_add_u32 s45, s45, 4096
    buffer_load_dwordx4 v[56:59], v1, s[4:7], s44 offen
    buffer_load_dwordx4 v[60:63], v1, s[4:7], s45 offen
    s_add_u32 s44, s44, 4096
    s_add_u32 s45, s45, 4096
    buffer_load_dwordx4 v[64:67], v1, s[4:7], s44 offen
    buffer_load_dwordx4 v[68:71], v1, s[4:7], s45 offen
    s_add_u32 s44, s44, 4096
    s_add_u32 s45, s45, 4096
    buffer_load_dwordx4 v[72:75], v1, s[4:7], s44 offen
    buffer_load_dwordx4 v[76:79], v1, s[4:7], s45 offen
    s_add_u32 s44, s44, 4096
    s_add_u32 s45, s45, 4096
    buffer_load_dwordx4 v[80:83], v1, s[4:7], s44 offen
    buffer_load_dwordx4 v[84:87], v1, s[4:7], s45 offen
    s_add_u32 s44, s44, 4096
    s_add_u32 s45, s45, 4096
    s_waitcnt vmcnt(16)
    v_mfma_f32_16x16x32_bf16 v[8:11], v[16:19], v[20:23], 0
    s_waitcnt vmcnt(14)
    v_mfma_f32_16x16x32_bf16 v[8:11], v[24:27], v[28:31], v[8:11]
    s_waitcnt vmcnt(12)
    v_mfma_f32_16x16x32_bf16 v[8:11], v[32:35], v[36:39], v[8:11]
    s_waitcnt vmcnt(10)
    v_mfma_f32_16x16x32_bf16 v[8:11], v[40:43], v[44:47], v[8:11]
    s_waitcnt vmcnt(8)
    v_mfma_f32_16x16x32_bf16 v[8:11], v[48:51], v[52:55], v[8:11]
    s_waitcnt vmcnt(6)
    v_mfma_f32_16x16x32_bf16 v[8:11], v[56:59], v[60:63], v[8:11]
    s_waitcnt vmcnt(4)
    v_mfma_f32_16x16x32_bf16 v[8:11], v[64:67], v[68:71], v[8:11]
    s_waitcnt vmcnt(2)
    v_mfma_f32_16x16x32_bf16 v[8:11], v[72:75], v[76:79], v[8:11]
    s_waitcnt vmcnt(0)
    v_mfma_f32_16x16x32_bf16 v[8:11], v[80:83], v[84:87], v[8:11]
    s_nop 7
    s_lshl_b32 s46, s3, 10
    v_add_u32 v2, s46, v1
    ds_write_b128 v2, v[8:11]
    s_waitcnt lgkmcnt(0)
    s_barrier
    s_cmp_lg_u32 s3, 0
    s_cbranch_scc1 dsmall_kernel_end
    ds_read_b128 v[20:23], v1 offset:1024
    ds_read_b128 v[24:27], v1 offset:2048
    ds_read_b128 v[28:31], v1 offset:3072
    ds_read_b128 v[32:35], v1 offset:4096
    ds_read_b128 v[36:39], v1 offset:5120
    s_waitcnt lgkmcnt(0)
    v_add_f32 v8, v8, v20
    v_add_f32 v9, v9, v21
    v_add_f32 v10, v10, v22
    v_add_f32 v11, v11, v23
    v_add_f32 v8, v8, v24
    v_add_f32 v9, v9, v25
    v_add_f32 v10, v10, v26
    v_add_f32 v11, v11, v27
    v_add_f32 v8, v8, v28
    v_add_f32 v9, v9, v29
    v_add_f32 v10, v10, v30
    v_add_f32 v11, v11, v31
    v_add_f32 v8, v8, v32
    v_add_f32 v9, v9, v33
    v_add_f32 v10, v10, v34
    v_add_f32 v11, v11, v35
    v_add_f32 v8, v8, v36
    v_add_f32 v9, v9, v37
    v_add_f32 v10, v10, v38
    v_add_f32 v11, v11, v39
    s_lshl_b32 s58, s67, 4
    s_lshl_b32 s59, s66, 5
    s_mov_b32 s8, s42
    s_and_b32 s9, s43, 0xffff
    s_mov_b32 s10, 0x10000000
    s_mov_b32 s11, 0x00020000
    s_mov_b32 s55, 110587904
    s_mov_b32 s12, s38
    s_and_b32 s13, s39, 0xffff
    s_mov_b32 s14, 0x280000
    s_mov_b32 s15, 0x00020000
    s_mov_b32 s56, 0
    s_mul_i32 s57, s58, 1280
    s_add_u32 s57, s57, s59
    s_add_u32 s55, s55, s57
    s_add_u32 s56, s56, s57
    v_and_b32 v4, 15, v0
    v_lshrrev_b32 v5, 4, v0
    v_mul_u32_u24 v4, 1280, v4
    v_lshl_add_u32 v4, v5, 3, v4
    buffer_load_dwordx2 v[16:17], v4, s[8:11], s55 offen offset:0
    s_waitcnt vmcnt(0)
    v_cvt_pk_bf16_f32 v8, v8, v9
    v_and_b32 v9, 0xffff0000, v8
    v_lshlrev_b32 v8, 16, v8
    v_lshlrev_b32 v6, 16, v16
    v_and_b32 v7, 0xffff0000, v16
    v_add_f32 v6, v6, v8
    v_add_f32 v7, v7, v9
    v_cvt_pk_bf16_f32 v16, v6, v7
    v_cvt_pk_bf16_f32 v10, v10, v11
    v_and_b32 v11, 0xffff0000, v10
    v_lshlrev_b32 v10, 16, v10
    v_lshlrev_b32 v6, 16, v17
    v_and_b32 v7, 0xffff0000, v17
    v_add_f32 v6, v6, v10
    v_add_f32 v7, v7, v11
    v_cvt_pk_bf16_f32 v17, v6, v7
    buffer_store_dwordx2 v[16:17], v4, s[12:15], s56 offen offset:0
dsmall_kernel_end:
    s_endpgm
.section .rodata,"a"
.p2align 6
.amdhsa_kernel prep_kernel
  .amdhsa_next_free_vgpr 128
  .amdhsa_next_free_sgpr 100
  .amdhsa_accum_offset 128
  .amdhsa_group_segment_fixed_size 0
  .amdhsa_kernarg_size 112
  .amdhsa_user_sgpr_count 2
  .amdhsa_user_sgpr_kernarg_segment_ptr 1
  .amdhsa_system_sgpr_workgroup_id_x 1
.end_amdhsa_kernel
.p2align 6
.amdhsa_kernel chain_kernel
  .amdhsa_next_free_vgpr 512
  .amdhsa_next_free_sgpr 100
  .amdhsa_accum_offset 256
  .amdhsa_group_segment_fixed_size 0
  .amdhsa_kernarg_size 112
  .amdhsa_user_sgpr_count 2
  .amdhsa_user_sgpr_kernarg_segment_ptr 1
  .amdhsa_system_sgpr_workgroup_id_x 1
.end_amdhsa_kernel
.p2align 6
.amdhsa_kernel osmall_kernel
  .amdhsa_next_free_vgpr 144
  .amdhsa_next_free_sgpr 100
  .amdhsa_accum_offset 144
  .amdhsa_group_segment_fixed_size 0
  .amdhsa_kernarg_size 112
  .amdhsa_user_sgpr_count 2
  .amdhsa_user_sgpr_kernarg_segment_ptr 1
  .amdhsa_system_sgpr_workgroup_id_x 1
.end_amdhsa_kernel
.p2align 6
.amdhsa_kernel ln2_kernel
  .amdhsa_next_free_vgpr 128
  .amdhsa_next_free_sgpr 100
  .amdhsa_accum_offset 128
  .amdhsa_group_segment_fixed_size 0
  .amdhsa_kernarg_size 112
  .amdhsa_user_sgpr_count 2
  .amdhsa_user_sgpr_kernarg_segment_ptr 1
  .amdhsa_system_sgpr_workgroup_id_x 1
.end_amdhsa_kernel
.p2align 6
.amdhsa_kernel gusmall_kernel
  .amdhsa_next_free_vgpr 160
  .amdhsa_next_free_sgpr 100
  .amdhsa_accum_offset 160
  .amdhsa_group_segment_fixed_size 0
  .amdhsa_kernarg_size 112
  .amdhsa_user_sgpr_count 2
  .amdhsa_user_sgpr_kernarg_segment_ptr 1
  .amdhsa_system_sgpr_workgroup_id_x 1
.end_amdhsa_kernel
.p2align 6
.amdhsa_kernel dsmall_kernel
  .amdhsa_next_free_vgpr 88
  .amdhsa_next_free_sgpr 100
  .amdhsa_accum_offset 88
  .amdhsa_group_segment_fixed_size 0
  .amdhsa_kernarg_size 112
  .amdhsa_user_sgpr_count 2
  .amdhsa_user_sgpr_kernarg_segment_ptr 1
  .amdhsa_system_sgpr_workgroup_id_x 1
.end_amdhsa_kernel
```
